```python
import torch

def _softmax(x, axis=-1):
    return torch.softmax(x, dim=axis)

def _gelu(x):
    return torch.nn.functional.gelu(x, approximate='tanh')

def _silu(x):
    return torch.nn.functional.silu(x)

def _sigmoid(x):
    return torch.sigmoid(x)

def _layernorm(x, axis=-1, eps=1e-05):
    m = x.mean(dim=axis, keepdim=True)
    v = x.var(dim=axis, keepdim=True, unbiased=False)
    return (x - m) / torch.sqrt(v + eps)

def _scatter_add(tgt, idx, src, axis=0):
    return tgt.clone().index_add_(axis, idx, src)

def _segment_sum(src, seg, n):
    out = torch.zeros((n,) + src.shape[1:], dtype=src.dtype)
    return out.index_add_(0, seg, src)

def _pad(x, pw):
    flat = tuple((v for pair in reversed(pw) for v in pair))
    return torch.nn.functional.pad(x, flat)
kernel_name = 'adaLN_cond__memory_aug_recurrent_mem_tr__glu_gated_glu__prompt'

def setup_inputs():

    _w = lambda a: (lambda t: t.to(torch.bfloat16) if t.is_floating_point() else t)(torch.as_tensor(a))

    def _A_setup():
        B, S, Dm = (1, 2048, 576)
        H, Dh = (32, 128)
        M, seg = (8, 32)
        seg = min(seg, S)
        S = S // seg * seg
        return {'x': _w((lambda *s: torch.randn(*s, dtype=torch.bfloat16) * 0.05)(B, S, Dm)), 'mem0': _w((lambda *s: torch.randn(*s, dtype=torch.bfloat16) * 0.4)(B, M, Dm)), 'Wq': _w((lambda *s: torch.randn(*s, dtype=torch.bfloat16) * 3.2)(Dm, H, Dh) * Dm ** (-0.5)), 'Wk': _w((lambda *s: torch.randn(*s, dtype=torch.bfloat16) * 3.2)(Dm, H, Dh) * Dm ** (-0.5)), 'Wv': _w((lambda *s: torch.randn(*s, dtype=torch.bfloat16) * 0.4)(Dm, H, Dh) * Dm ** (-0.5)), 'Wo': _w((lambda *s: torch.randn(*s, dtype=torch.bfloat16) * 0.4)(H, Dh, Dm) * (H * Dh) ** (-0.5)), 'seg_len': seg}
    _A_in = _A_setup()

    def _B_setup():
        B, S, D, F = (1, 2048, 576, 4608)
        return {'x': _w((lambda *s: torch.randn(*s, dtype=torch.bfloat16) * 0.05)(B, S, D)), 'w_gate': _w((lambda *s: torch.randn(*s, dtype=torch.bfloat16) * 0.05)(D, F)), 'w_up': _w((lambda *s: torch.randn(*s, dtype=torch.bfloat16) * 0.05)(D, F)), 'w_down': _w((lambda *s: torch.randn(*s, dtype=torch.bfloat16) * 0.05)(F, D))}
    _B_in = _B_setup()
    return {'A_x': _A_in['x'], 'A_mem0': _A_in['mem0'], 'A_Wq': _A_in['Wq'], 'A_Wk': _A_in['Wk'], 'A_Wv': _A_in['Wv'], 'A_Wo': _A_in['Wo'], 'A_seg_len': _A_in['seg_len'], 'B_x': _B_in['x'], 'B_w_gate': _B_in['w_gate'], 'B_w_up': _B_in['w_up'], 'B_w_down': _B_in['w_down'], 'c': _w((lambda *s: torch.randn(*s, dtype=torch.bfloat16) * 0.1)(1, 576) * 8.0), 'w_mod': _w((lambda *s: torch.randn(*s, dtype=torch.bfloat16) * 0.1)(576, 6 * 576) * 576 ** (-0.5) * 8.0)}

def reference(A_x, A_mem0, A_Wq, A_Wk, A_Wv, A_Wo, A_seg_len, B_x, B_w_gate, B_w_up, B_w_down, c, w_mod):

    def _A_ref(x, mem0, Wq, Wk, Wv, Wo, seg_len):
        B, S, Dm = x.shape
        H, Dh = (Wq.shape[1], Wq.shape[2])
        M = mem0.shape[1]
        scale = Dh ** (-0.5)
        n_seg = S // seg_len
        L = M + seg_len
        idx = torch.arange(L)
        mask = (idx[:, None] < M) | (idx[:, None] >= idx[None, :])
        mem = mem0
        outs = []
        for s in range(n_seg):
            xs = x[:, s * seg_len:(s + 1) * seg_len, :].clone()
            h = torch.concatenate([mem, xs], axis=1)
            q = torch.einsum('btd,dhe->bhte', h, Wq)
            k = torch.einsum('btd,dhe->bhte', h, Wk)
            v = torch.einsum('btd,dhe->bhte', h, Wv)
            scores = torch.einsum('bhqe,bhke->bhqk', q, k) * scale
            scores = torch.where(mask[None, None], scores, -1000000000.0)
            p = _softmax(scores, axis=-1)
            o = torch.einsum('bhqk,bhke->bhqe', p, v)
            o = torch.einsum('bhte,hed->btd', o, Wo)
            mem = o[:, :M, :].clone()
            outs.append(o[:, M:, :])
        return torch.concatenate(outs, axis=1)

    def _B_ref(x, w_gate, w_up, w_down):
        g = torch.einsum('bsd,df->bsf', x, w_gate)
        u = torch.einsum('bsd,df->bsf', x, w_up)
        h = _sigmoid(g) * u
        return torch.einsum('bsf,fd->bsd', h, w_down)
    x = A_x
    mod = (_silu(c) @ w_mod).reshape(c.shape[0], 6, 1, -1)
    sa, ca, ga, sb, cb, gb = (mod[:, 0].clone(), mod[:, 1].clone(), mod[:, 2].clone(), mod[:, 3].clone(), mod[:, 4].clone(), mod[:, 5].clone())
    h = _layernorm(x, axis=-1) * (1 + ca) + sa
    x = x + ga * _A_ref(h, A_mem0, A_Wq, A_Wk, A_Wv, A_Wo, A_seg_len)
    h = _layernorm(x, axis=-1) * (1 + cb) + sb
    x = x + gb * _B_ref(h, B_w_gate, B_w_up, B_w_down)
    return x
```

```asm
; @launch grid=(256,1,1) block=(256,1,1) lds=163840
.amdgcn_target "amdgcn-amd-amdhsa--gfx950"
.text
.globl adaLN_cond__memory_aug_recurrent_mem_tr__glu_gated_glu__prompt_kernel
.p2align 8
.type adaLN_cond__memory_aug_recurrent_mem_tr__glu_gated_glu__prompt_kernel,@function
adaLN_cond__memory_aug_recurrent_mem_tr__glu_gated_glu__prompt_kernel:
L_first:
s_load_dwordx2 s[6:7], s[0:1], 112
s_load_dwordx2 s[4:5], s[0:1], 120
s_getreg_b32 s18, hwreg(HW_REG_XCC_ID, 0, 4)
s_waitcnt lgkmcnt(0)
s_add_u32 s8, s4, 0
s_addc_u32 s9, s5, 0
s_and_b32 s9, s9, 0xffff
s_mov_b32 s10, 268435456
s_mov_b32 s11, 0x20000
s_mov_b32 s21, 0
s_cmp_ge_u32 s2, 256
s_cbranch_scc1 L_end
s_and_b32 s18, s18, 7
v_cmp_eq_u32 vcc, 0, v0
s_nop 0
s_and_saveexec_b64 s[22:23], vcc
s_cbranch_execz L_not0
s_lshl_b32 s19, s18, 2
s_cmp_ge_u32 s18, 4
s_cselect_b32 s20, 128, 0
s_add_u32 s19, s19, s20
v_mov_b32 v1, s19
v_mov_b32 v2, 1
global_atomic_add v3, v1, v2, s[6:7] sc0
v_mov_b32 v1, 0
s_waitcnt vmcnt(0)
ds_write_b32 v1, v3
s_waitcnt lgkmcnt(0)
L_not0:
s_mov_b64 exec, s[22:23]
s_barrier
v_mov_b32 v1, 0
ds_read_b32 v3, v1
s_waitcnt lgkmcnt(0)
v_readfirstlane_b32 s17, v3
s_barrier
s_cmp_ge_u32 s17, 32
s_cbranch_scc1 L_over
L_role:
s_getpc_b64 s[22:23]
L_pc:
s_sub_u32 s22, s22, L_pc-L_first
s_subb_u32 s23, s23, 0
s_lshl_b32 s19, s17, 13
v_lshlrev_b32 v1, 7, v0
v_add_u32 v1, s19, v1
s_mov_b32 s19, L_last-L_first
v_cmp_gt_u32 vcc, s19, v1
s_mov_b64 s[24:25], exec
s_and_b64 exec, vcc, 0xffffffffffffffff
v_cmp_gt_u32 vcc, 64, v0
s_nop 0
s_and_b64 exec, exec, vcc
s_cbranch_execz L_nopf
global_load_dword v255, v1, s[22:23]
L_nopf:
s_mov_b64 exec, s[24:25]
s_cmp_eq_u32 s18, 0
s_cbranch_scc1 L_chain
s_lshl_b32 s18, s18, 5
s_add_u32 s17, s17, s18
s_sub_u32 s57, s17, 32
v_lshrrev_b32 v1, 6, v0
v_and_b32 v2, 63, v0
s_mov_b32 s18, 0xffff0000
v_readfirstlane_b32 s16, v1
s_mov_b32 s21, 0
v_lshlrev_b32 v0, 4, v2
s_sub_u32 s17, s57, 0
s_cmp_lt_u32 s57, 12
s_cbranch_scc1 L_r_op
s_sub_u32 s17, s57, 12
s_cmp_lt_u32 s57, 32
s_cbranch_scc1 L_r_qkv
s_sub_u32 s17, s57, 20
s_cmp_lt_u32 s57, 44
s_cbranch_scc1 L_r_op
s_sub_u32 s17, s57, 24
s_cmp_lt_u32 s57, 64
s_cbranch_scc1 L_r_qkv
s_sub_u32 s17, s57, 64
s_cmp_lt_u32 s57, 76
s_cbranch_scc1 L_r_dn
s_sub_u32 s17, s57, 36
s_cmp_lt_u32 s57, 96
s_cbranch_scc1 L_r_qkv
s_sub_u32 s17, s57, 96
s_cmp_lt_u32 s57, 116
s_cbranch_scc1 L_r_att
s_sub_u32 s17, s57, 56
s_cmp_lt_u32 s57, 120
s_cbranch_scc1 L_r_qkv
s_sub_u32 s17, s57, 120
s_cmp_lt_u32 s57, 128
s_cbranch_scc1 L_r_ln
s_sub_u32 s17, s57, 116
s_cmp_lt_u32 s57, 140
s_cbranch_scc1 L_r_dn
s_sub_u32 s17, s57, 140
s_cmp_lt_u32 s57, 160
s_cbranch_scc1 L_r_f1
s_sub_u32 s17, s57, 136
s_cmp_lt_u32 s57, 172
s_cbranch_scc1 L_r_dn
s_sub_u32 s17, s57, 152
s_cmp_lt_u32 s57, 192
s_cbranch_scc1 L_r_f1
s_sub_u32 s17, s57, 152
s_cmp_lt_u32 s57, 224
s_cbranch_scc1 L_r_f1
s_branch L_end
L_r_att:
s_branch L_aux
L_r_ln:
s_add_u32 s17, s17, 20
s_branch L_aux
L_r_dn:
s_add_u32 s17, s17, 28
L_aux:
s_cmp_lt_u32 s17, 16
s_cbranch_scc0 L_aux1
v_mov_b64 v[8:9], 0
v_mov_b64 v[10:11], 0
s_mul_i32 s19, s17, 20480
s_mul_i32 s20, s16, 5120
s_add_u32 s19, s19, s20
buffer_store_dwordx4 v[8:11], v0, s[8:11], s19 offen sc1
s_add_u32 s19, s19, 1024
buffer_store_dwordx4 v[8:11], v0, s[8:11], s19 offen sc1
s_add_u32 s19, s19, 1024
buffer_store_dwordx4 v[8:11], v0, s[8:11], s19 offen sc1
s_add_u32 s19, s19, 1024
buffer_store_dwordx4 v[8:11], v0, s[8:11], s19 offen sc1
s_add_u32 s19, s19, 1024
buffer_store_dwordx4 v[8:11], v0, s[8:11], s19 offen sc1
s_add_u32 s19, s19, 1024
v_mov_b64 v[12:13], -1
v_mov_b64 v[14:15], -1
s_lshl_b32 s19, s17, 2
s_add_u32 s19, s19, s16
s_mul_i32 s19, s19, 9216
s_add_u32 s19, s19, 12648448
buffer_store_dwordx4 v[12:15], v0, s[8:11], s19 offen sc1
s_add_u32 s19, s19, 1024
buffer_store_dwordx4 v[12:15], v0, s[8:11], s19 offen sc1
s_add_u32 s19, s19, 1024
buffer_store_dwordx4 v[12:15], v0, s[8:11], s19 offen sc1
s_add_u32 s19, s19, 1024
buffer_store_dwordx4 v[12:15], v0, s[8:11], s19 offen sc1
s_add_u32 s19, s19, 1024
buffer_store_dwordx4 v[12:15], v0, s[8:11], s19 offen sc1
s_add_u32 s19, s19, 1024
buffer_store_dwordx4 v[12:15], v0, s[8:11], s19 offen sc1
s_add_u32 s19, s19, 1024
buffer_store_dwordx4 v[12:15], v0, s[8:11], s19 offen sc1
s_add_u32 s19, s19, 1024
buffer_store_dwordx4 v[12:15], v0, s[8:11], s19 offen sc1
s_add_u32 s19, s19, 1024
buffer_store_dwordx4 v[12:15], v0, s[8:11], s19 offen sc1
s_add_u32 s19, s19, 1024
s_waitcnt vmcnt(0)
s_barrier
s_cmp_eq_u32 s16, 0
s_cbranch_scc0 L_if0
s_mov_b64 exec, 1
v_mov_b32 v8, 192
v_mov_b32 v9, 1
global_atomic_add v8, v9, s[6:7]
s_mov_b64 exec, -1
L_if0:
L_aux1:
s_cmp_ge_u32 s17, 28
s_cbranch_scc0 L_aux2
s_sub_u32 s36, s17, 28
s_and_b32 s37, s36, 3
s_lshr_b32 s36, s36, 2
s_load_dwordx2 s[4:5], s[0:1], 88
s_waitcnt lgkmcnt(0)
s_mov_b32 s12, s4
s_and_b32 s13, s5, 0xffff
s_mov_b32 s14, 1152
s_mov_b32 s15, 0x20000
s_mul_i32 s28, s16, 36
s_mul_i32 s19, s37, 144
s_add_u32 s28, s28, s19
s_lshl_b32 s19, s28, 1
v_lshlrev_b32 v3, 1, v2
buffer_load_ushort v8, v3, s[12:15], s19 offen
s_load_dwordx2 s[4:5], s[0:1], 96
s_waitcnt lgkmcnt(0)
s_mov_b32 s24, s4
s_and_b32 s25, s5, 0xffff
s_mov_b32 s26, 3981312
s_mov_b32 s27, 0x20000
v_lshrrev_b32 v4, 4, v2
v_mul_u32_u24 v5, 6912, v4
v_and_b32 v6, 15, v2
v_lshl_add_u32 v5, v6, 4, v5
s_mul_i32 s22, s28, 6912
s_lshl_b32 s19, s36, 8
s_add_u32 s22, s22, s19
buffer_load_dwordx4 v[20:23], v5, s[24:27], s22 offen
s_add_u32 s22, s22, 27648
buffer_load_dwordx4 v[24:27], v5, s[24:27], s22 offen
s_add_u32 s22, s22, 27648
buffer_load_dwordx4 v[28:31], v5, s[24:27], s22 offen
s_add_u32 s22, s22, 27648
buffer_load_dwordx4 v[32:35], v5, s[24:27], s22 offen
s_add_u32 s22, s22, 27648
buffer_load_dwordx4 v[36:39], v5, s[24:27], s22 offen
s_add_u32 s22, s22, 27648
buffer_load_dwordx4 v[40:43], v5, s[24:27], s22 offen
s_add_u32 s22, s22, 27648
buffer_load_dwordx4 v[44:47], v5, s[24:27], s22 offen
s_add_u32 s22, s22, 27648
buffer_load_dwordx4 v[48:51], v5, s[24:27], s22 offen
s_add_u32 s22, s22, 27648
buffer_load_dwordx4 v[52:55], v5, s[24:27], s22 offen
s_add_u32 s22, s22, 27648
s_waitcnt vmcnt(9)
s_mov_b32 s23, 3216550459
s_lshl_b32 s19, s16, 10
v_lshlrev_b32 v3, 2, v2
v_add_u32 v7, s19, v3
v_lshlrev_b32 v8, 16, v8
v_mul_f32 v11, s23, v8
v_exp_f32 v11, v11
s_nop 0
v_add_f32 v11, 1.0, v11
v_rcp_f32 v11, v11
s_nop 0
v_mul_f32 v8, v8, v11
v_cvt_pk_bf16_f32 v8, v8, v8
v_lshlrev_b32 v8, 16, v8
ds_write_b32 v7, v8
v_lshlrev_b32 v7, 2, v4
v_add_u32 v7, s19, v7
s_waitcnt lgkmcnt(0)
ds_read_b32 v164, v7
ds_read_b32 v165, v7 offset:16
ds_read_b32 v166, v7 offset:32
ds_read_b32 v167, v7 offset:48
ds_read_b32 v168, v7 offset:64
ds_read_b32 v169, v7 offset:80
ds_read_b32 v170, v7 offset:96
ds_read_b32 v171, v7 offset:112
ds_read_b32 v172, v7 offset:128
v_mov_b64 v[200:201], 0
v_mov_b64 v[202:203], 0
v_mov_b64 v[204:205], 0
v_mov_b64 v[206:207], 0
s_waitcnt lgkmcnt(0)
s_waitcnt vmcnt(8)
v_lshlrev_b32 v12, 16, v20
v_and_b32 v13, s18, v20
v_lshlrev_b32 v14, 16, v21
v_and_b32 v15, s18, v21
v_lshlrev_b32 v16, 16, v22
v_and_b32 v17, s18, v22
v_lshlrev_b32 v18, 16, v23
v_and_b32 v19, s18, v23
v_fmac_f32 v200, v164, v12
v_fmac_f32 v201, v164, v13
v_fmac_f32 v202, v164, v14
v_fmac_f32 v203, v164, v15
v_fmac_f32 v204, v164, v16
v_fmac_f32 v205, v164, v17
v_fmac_f32 v206, v164, v18
v_fmac_f32 v207, v164, v19
s_waitcnt vmcnt(7)
v_lshlrev_b32 v12, 16, v24
v_and_b32 v13, s18, v24
v_lshlrev_b32 v14, 16, v25
v_and_b32 v15, s18, v25
v_lshlrev_b32 v16, 16, v26
v_and_b32 v17, s18, v26
v_lshlrev_b32 v18, 16, v27
v_and_b32 v19, s18, v27
v_fmac_f32 v200, v165, v12
v_fmac_f32 v201, v165, v13
v_fmac_f32 v202, v165, v14
v_fmac_f32 v203, v165, v15
v_fmac_f32 v204, v165, v16
v_fmac_f32 v205, v165, v17
v_fmac_f32 v206, v165, v18
v_fmac_f32 v207, v165, v19
s_waitcnt vmcnt(6)
v_lshlrev_b32 v12, 16, v28
v_and_b32 v13, s18, v28
v_lshlrev_b32 v14, 16, v29
v_and_b32 v15, s18, v29
v_lshlrev_b32 v16, 16, v30
v_and_b32 v17, s18, v30
v_lshlrev_b32 v18, 16, v31
v_and_b32 v19, s18, v31
v_fmac_f32 v200, v166, v12
v_fmac_f32 v201, v166, v13
v_fmac_f32 v202, v166, v14
v_fmac_f32 v203, v166, v15
v_fmac_f32 v204, v166, v16
v_fmac_f32 v205, v166, v17
v_fmac_f32 v206, v166, v18
v_fmac_f32 v207, v166, v19
s_waitcnt vmcnt(5)
v_lshlrev_b32 v12, 16, v32
v_and_b32 v13, s18, v32
v_lshlrev_b32 v14, 16, v33
v_and_b32 v15, s18, v33
v_lshlrev_b32 v16, 16, v34
v_and_b32 v17, s18, v34
v_lshlrev_b32 v18, 16, v35
v_and_b32 v19, s18, v35
v_fmac_f32 v200, v167, v12
v_fmac_f32 v201, v167, v13
v_fmac_f32 v202, v167, v14
v_fmac_f32 v203, v167, v15
v_fmac_f32 v204, v167, v16
v_fmac_f32 v205, v167, v17
v_fmac_f32 v206, v167, v18
v_fmac_f32 v207, v167, v19
s_waitcnt vmcnt(4)
v_lshlrev_b32 v12, 16, v36
v_and_b32 v13, s18, v36
v_lshlrev_b32 v14, 16, v37
v_and_b32 v15, s18, v37
v_lshlrev_b32 v16, 16, v38
v_and_b32 v17, s18, v38
v_lshlrev_b32 v18, 16, v39
v_and_b32 v19, s18, v39
v_fmac_f32 v200, v168, v12
v_fmac_f32 v201, v168, v13
v_fmac_f32 v202, v168, v14
v_fmac_f32 v203, v168, v15
v_fmac_f32 v204, v168, v16
v_fmac_f32 v205, v168, v17
v_fmac_f32 v206, v168, v18
v_fmac_f32 v207, v168, v19
s_waitcnt vmcnt(3)
v_lshlrev_b32 v12, 16, v40
v_and_b32 v13, s18, v40
v_lshlrev_b32 v14, 16, v41
v_and_b32 v15, s18, v41
v_lshlrev_b32 v16, 16, v42
v_and_b32 v17, s18, v42
v_lshlrev_b32 v18, 16, v43
v_and_b32 v19, s18, v43
v_fmac_f32 v200, v169, v12
v_fmac_f32 v201, v169, v13
v_fmac_f32 v202, v169, v14
v_fmac_f32 v203, v169, v15
v_fmac_f32 v204, v169, v16
v_fmac_f32 v205, v169, v17
v_fmac_f32 v206, v169, v18
v_fmac_f32 v207, v169, v19
s_waitcnt vmcnt(2)
v_lshlrev_b32 v12, 16, v44
v_and_b32 v13, s18, v44
v_lshlrev_b32 v14, 16, v45
v_and_b32 v15, s18, v45
v_lshlrev_b32 v16, 16, v46
v_and_b32 v17, s18, v46
v_lshlrev_b32 v18, 16, v47
v_and_b32 v19, s18, v47
v_fmac_f32 v200, v170, v12
v_fmac_f32 v201, v170, v13
v_fmac_f32 v202, v170, v14
v_fmac_f32 v203, v170, v15
v_fmac_f32 v204, v170, v16
v_fmac_f32 v205, v170, v17
v_fmac_f32 v206, v170, v18
v_fmac_f32 v207, v170, v19
s_waitcnt vmcnt(1)
v_lshlrev_b32 v12, 16, v48
v_and_b32 v13, s18, v48
v_lshlrev_b32 v14, 16, v49
v_and_b32 v15, s18, v49
v_lshlrev_b32 v16, 16, v50
v_and_b32 v17, s18, v50
v_lshlrev_b32 v18, 16, v51
v_and_b32 v19, s18, v51
v_fmac_f32 v200, v171, v12
v_fmac_f32 v201, v171, v13
v_fmac_f32 v202, v171, v14
v_fmac_f32 v203, v171, v15
v_fmac_f32 v204, v171, v16
v_fmac_f32 v205, v171, v17
v_fmac_f32 v206, v171, v18
v_fmac_f32 v207, v171, v19
s_waitcnt vmcnt(0)
v_lshlrev_b32 v12, 16, v52
v_and_b32 v13, s18, v52
v_lshlrev_b32 v14, 16, v53
v_and_b32 v15, s18, v53
v_lshlrev_b32 v16, 16, v54
v_and_b32 v17, s18, v54
v_lshlrev_b32 v18, 16, v55
v_and_b32 v19, s18, v55
v_fmac_f32 v200, v172, v12
v_fmac_f32 v201, v172, v13
v_fmac_f32 v202, v172, v14
v_fmac_f32 v203, v172, v15
v_fmac_f32 v204, v172, v16
v_fmac_f32 v205, v172, v17
v_fmac_f32 v206, v172, v18
v_fmac_f32 v207, v172, v19
s_lshl_b32 s19, s16, 11
v_lshlrev_b32 v7, 9, v4
v_lshl_add_u32 v7, v6, 5, v7
v_add_u32 v7, s19, v7
ds_write_b128 v7, v[200:203] offset:4096
ds_write_b128 v7, v[204:207] offset:4112
s_waitcnt lgkmcnt(0)
s_barrier
s_cmp_eq_u32 s16, 0
s_cbranch_scc0 L_mod1p
v_lshlrev_b32 v4, 3, v2
ds_read_b64 v[20:21], v4 offset:4096
ds_read_b64 v[22:23], v4 offset:4608
ds_read_b64 v[24:25], v4 offset:5120
ds_read_b64 v[26:27], v4 offset:5632
ds_read_b64 v[28:29], v4 offset:6144
ds_read_b64 v[30:31], v4 offset:6656
ds_read_b64 v[32:33], v4 offset:7168
ds_read_b64 v[34:35], v4 offset:7680
ds_read_b64 v[36:37], v4 offset:8192
ds_read_b64 v[38:39], v4 offset:8704
ds_read_b64 v[40:41], v4 offset:9216
ds_read_b64 v[42:43], v4 offset:9728
ds_read_b64 v[44:45], v4 offset:10240
ds_read_b64 v[46:47], v4 offset:10752
ds_read_b64 v[48:49], v4 offset:11264
ds_read_b64 v[50:51], v4 offset:11776
s_waitcnt lgkmcnt(0)
v_pk_add_f32 v[20:21], v[20:21], v[36:37]
v_pk_add_f32 v[22:23], v[22:23], v[38:39]
v_pk_add_f32 v[24:25], v[24:25], v[40:41]
v_pk_add_f32 v[26:27], v[26:27], v[42:43]
v_pk_add_f32 v[28:29], v[28:29], v[44:45]
v_pk_add_f32 v[30:31], v[30:31], v[46:47]
v_pk_add_f32 v[32:33], v[32:33], v[48:49]
v_pk_add_f32 v[34:35], v[34:35], v[50:51]
v_pk_add_f32 v[20:21], v[20:21], v[28:29]
v_pk_add_f32 v[22:23], v[22:23], v[30:31]
v_pk_add_f32 v[24:25], v[24:25], v[32:33]
v_pk_add_f32 v[26:27], v[26:27], v[34:35]
v_pk_add_f32 v[20:21], v[20:21], v[24:25]
v_pk_add_f32 v[22:23], v[22:23], v[26:27]
v_pk_add_f32 v[20:21], v[20:21], v[22:23]
s_lshl_b32 s19, s36, 9
s_mul_i32 s20, s37, 4608
s_add_u32 s19, s19, s20
s_add_u32 s19, s19, 1114112
buffer_store_dwordx2 v[20:21], v4, s[8:11], s19 offen sc1
s_waitcnt vmcnt(0)
s_mov_b64 exec, 1
v_mov_b32 v8, 196
v_mov_b32 v9, 1
global_atomic_add v8, v9, s[6:7]
s_mov_b64 exec, -1
L_mod1p:
s_barrier
L_aux2:
v_and_b32 v3, 15, v2
v_lshrrev_b32 v4, 4, v2
s_lshl_b32 s19, s16, 2
v_add_u32 v4, s19, v4
v_mul_u32_u24 v5, 1152, v4
v_lshl_add_u32 v6, v3, 3, v5
v_add_u32 v6, 1024, v6
v_lshl_add_u32 v5, v3, 6, v5
v_lshrrev_b32 v7, 2, v3
v_lshl_add_u32 v7, v7, 4, v4
v_lshlrev_b32 v7, 4, v7
v_bfe_u32 v8, v3, 1, 1
v_lshl_add_u32 v7, v8, 10, v7
v_and_b32 v8, 1, v3
v_lshl_add_u32 v7, v8, 3, v7
s_load_dwordx2 s[4:5], s[0:1], 0
s_waitcnt lgkmcnt(0)
s_mov_b32 s12, s4
s_and_b32 s13, s5, 0xffff
s_mov_b32 s14, 2359296
s_mov_b32 s15, 0x20000
s_mul_i32 s37, s17, 18432
buffer_load_dwordx4 v[160:163], v5, s[12:15], s37 offen
buffer_load_dwordx4 v[164:167], v5, s[12:15], s37 offen offset:16
buffer_load_dwordx4 v[168:171], v5, s[12:15], s37 offen offset:32
buffer_load_dwordx4 v[172:175], v5, s[12:15], s37 offen offset:48
buffer_load_dwordx2 v[176:177], v6, s[12:15], s37 offen
s_add_u32 s37, s37, 1179648
buffer_load_dwordx4 v[180:183], v5, s[12:15], s37 offen
buffer_load_dwordx4 v[184:187], v5, s[12:15], s37 offen offset:16
buffer_load_dwordx4 v[188:191], v5, s[12:15], s37 offen offset:32
buffer_load_dwordx4 v[192:195], v5, s[12:15], s37 offen offset:48
buffer_load_dwordx2 v[196:197], v6, s[12:15], s37 offen
s_add_u32 s37, s37, 1179648
s_cmp_eq_u32 s16, 0
s_cbranch_scc0 L_wdoa1
v_mov_b32 v8, 0
L_wd0a1:
global_load_dword v9, v8, s[6:7] offset:196 sc1
s_waitcnt vmcnt(0)
v_cmp_gt_u32 vcc, 36, v9
s_cbranch_vccz L_wdn0a1
s_sleep 6
s_add_u32 s21, s21, 1
s_cmp_ge_u32 s21, 4194304
s_cbranch_scc1 L_abort
s_branch L_wd0a1
L_wdn0a1:
L_wd1a1:
global_load_dword v9, v8, s[6:7] offset:192 sc1
s_waitcnt vmcnt(0)
v_cmp_gt_u32 vcc, 16, v9
s_cbranch_vccz L_wdn1a1
s_sleep 6
s_add_u32 s21, s21, 1
s_cmp_ge_u32 s21, 4194304
s_cbranch_scc1 L_abort
s_branch L_wd1a1
L_wdn1a1:
L_wdoa1:
s_barrier
s_lshl_b32 s19, s16, 10
v_add_u32 v8, s19, v0
v_add_u32 v9, 4096, v8
v_min_u32 v9, 4592, v9
s_mov_b32 s19, 1114112
buffer_load_dwordx4 v[20:23], v8, s[8:11], s19 offen sc1
buffer_load_dwordx4 v[24:27], v9, s[8:11], s19 offen sc1
s_mov_b32 s19, 1118720
buffer_load_dwordx4 v[28:31], v8, s[8:11], s19 offen sc1
buffer_load_dwordx4 v[32:35], v9, s[8:11], s19 offen sc1
s_mov_b32 s19, 1123328
buffer_load_dwordx4 v[36:39], v8, s[8:11], s19 offen sc1
buffer_load_dwordx4 v[40:43], v9, s[8:11], s19 offen sc1
s_mov_b32 s19, 1127936
buffer_load_dwordx4 v[44:47], v8, s[8:11], s19 offen sc1
buffer_load_dwordx4 v[48:51], v9, s[8:11], s19 offen sc1
s_waitcnt vmcnt(0)
v_pk_add_f32 v[20:21], v[20:21], v[28:29]
v_pk_add_f32 v[36:37], v[36:37], v[44:45]
v_pk_add_f32 v[22:23], v[22:23], v[30:31]
v_pk_add_f32 v[38:39], v[38:39], v[46:47]
v_pk_add_f32 v[24:25], v[24:25], v[32:33]
v_pk_add_f32 v[40:41], v[40:41], v[48:49]
v_pk_add_f32 v[26:27], v[26:27], v[34:35]
v_pk_add_f32 v[42:43], v[42:43], v[50:51]
v_pk_add_f32 v[20:21], v[20:21], v[36:37]
v_cvt_pk_bf16_f32 v10, v20, v21
v_lshlrev_b32 v20, 16, v10
v_and_b32 v21, s18, v10
v_pk_add_f32 v[22:23], v[22:23], v[38:39]
v_cvt_pk_bf16_f32 v10, v22, v23
v_lshlrev_b32 v22, 16, v10
v_and_b32 v23, s18, v10
v_pk_add_f32 v[24:25], v[24:25], v[40:41]
v_cvt_pk_bf16_f32 v10, v24, v25
v_lshlrev_b32 v24, 16, v10
v_and_b32 v25, s18, v10
v_pk_add_f32 v[26:27], v[26:27], v[42:43]
v_cvt_pk_bf16_f32 v10, v26, v27
v_lshlrev_b32 v26, 16, v10
v_and_b32 v27, s18, v10
ds_write_b128 v8, v[20:23] offset:16384
ds_write_b128 v9, v[24:27] offset:16384
v_lshlrev_b32 v8, 7, v3
v_lshlrev_b32 v9, 4, v3
s_waitcnt lgkmcnt(0)
s_barrier
ds_read_b128 v[60:63], v8 offset:18688
ds_read_b128 v[64:67], v8 offset:18704
ds_read_b128 v[68:71], v8 offset:18720
ds_read_b128 v[72:75], v8 offset:18736
ds_read_b128 v[76:79], v8 offset:18752
ds_read_b128 v[80:83], v8 offset:18768
ds_read_b128 v[84:87], v8 offset:18784
ds_read_b128 v[88:91], v8 offset:18800
ds_read_b128 v[92:95], v9 offset:20736
s_waitcnt lgkmcnt(0)
ds_read_b128 v[96:99], v8 offset:16384
ds_read_b128 v[100:103], v8 offset:16400
ds_read_b128 v[104:107], v8 offset:16416
ds_read_b128 v[108:111], v8 offset:16432
ds_read_b128 v[112:115], v8 offset:16448
ds_read_b128 v[116:119], v8 offset:16464
ds_read_b128 v[120:123], v8 offset:16480
ds_read_b128 v[124:127], v8 offset:16496
ds_read_b128 v[128:131], v9 offset:18432
v_pk_add_f32 v[60:61], v[60:61], 1.0 op_sel_hi:[1,0]
s_nop 0
v_cvt_pk_bf16_f32 v10, v60, v61
v_lshlrev_b32 v60, 16, v10
v_and_b32 v61, s18, v10
v_pk_add_f32 v[62:63], v[62:63], 1.0 op_sel_hi:[1,0]
s_nop 0
v_cvt_pk_bf16_f32 v10, v62, v63
v_lshlrev_b32 v62, 16, v10
v_and_b32 v63, s18, v10
v_pk_add_f32 v[64:65], v[64:65], 1.0 op_sel_hi:[1,0]
s_nop 0
v_cvt_pk_bf16_f32 v10, v64, v65
v_lshlrev_b32 v64, 16, v10
v_and_b32 v65, s18, v10
v_pk_add_f32 v[66:67], v[66:67], 1.0 op_sel_hi:[1,0]
s_nop 0
v_cvt_pk_bf16_f32 v10, v66, v67
v_lshlrev_b32 v66, 16, v10
v_and_b32 v67, s18, v10
v_pk_add_f32 v[68:69], v[68:69], 1.0 op_sel_hi:[1,0]
s_nop 0
v_cvt_pk_bf16_f32 v10, v68, v69
v_lshlrev_b32 v68, 16, v10
v_and_b32 v69, s18, v10
v_pk_add_f32 v[70:71], v[70:71], 1.0 op_sel_hi:[1,0]
s_nop 0
v_cvt_pk_bf16_f32 v10, v70, v71
v_lshlrev_b32 v70, 16, v10
v_and_b32 v71, s18, v10
v_pk_add_f32 v[72:73], v[72:73], 1.0 op_sel_hi:[1,0]
s_nop 0
v_cvt_pk_bf16_f32 v10, v72, v73
v_lshlrev_b32 v72, 16, v10
v_and_b32 v73, s18, v10
v_pk_add_f32 v[74:75], v[74:75], 1.0 op_sel_hi:[1,0]
s_nop 0
v_cvt_pk_bf16_f32 v10, v74, v75
v_lshlrev_b32 v74, 16, v10
v_and_b32 v75, s18, v10
v_pk_add_f32 v[76:77], v[76:77], 1.0 op_sel_hi:[1,0]
s_nop 0
v_cvt_pk_bf16_f32 v10, v76, v77
v_lshlrev_b32 v76, 16, v10
v_and_b32 v77, s18, v10
v_pk_add_f32 v[78:79], v[78:79], 1.0 op_sel_hi:[1,0]
s_nop 0
v_cvt_pk_bf16_f32 v10, v78, v79
v_lshlrev_b32 v78, 16, v10
v_and_b32 v79, s18, v10
v_pk_add_f32 v[80:81], v[80:81], 1.0 op_sel_hi:[1,0]
s_nop 0
v_cvt_pk_bf16_f32 v10, v80, v81
v_lshlrev_b32 v80, 16, v10
v_and_b32 v81, s18, v10
v_pk_add_f32 v[82:83], v[82:83], 1.0 op_sel_hi:[1,0]
s_nop 0
v_cvt_pk_bf16_f32 v10, v82, v83
v_lshlrev_b32 v82, 16, v10
v_and_b32 v83, s18, v10
v_pk_add_f32 v[84:85], v[84:85], 1.0 op_sel_hi:[1,0]
s_nop 0
v_cvt_pk_bf16_f32 v10, v84, v85
v_lshlrev_b32 v84, 16, v10
v_and_b32 v85, s18, v10
v_pk_add_f32 v[86:87], v[86:87], 1.0 op_sel_hi:[1,0]
s_nop 0
v_cvt_pk_bf16_f32 v10, v86, v87
v_lshlrev_b32 v86, 16, v10
v_and_b32 v87, s18, v10
v_pk_add_f32 v[88:89], v[88:89], 1.0 op_sel_hi:[1,0]
s_nop 0
v_cvt_pk_bf16_f32 v10, v88, v89
v_lshlrev_b32 v88, 16, v10
v_and_b32 v89, s18, v10
v_pk_add_f32 v[90:91], v[90:91], 1.0 op_sel_hi:[1,0]
s_nop 0
v_cvt_pk_bf16_f32 v10, v90, v91
v_lshlrev_b32 v90, 16, v10
v_and_b32 v91, s18, v10
v_pk_add_f32 v[92:93], v[92:93], 1.0 op_sel_hi:[1,0]
s_nop 0
v_cvt_pk_bf16_f32 v10, v92, v93
v_lshlrev_b32 v92, 16, v10
v_and_b32 v93, s18, v10
v_pk_add_f32 v[94:95], v[94:95], 1.0 op_sel_hi:[1,0]
s_nop 0
v_cvt_pk_bf16_f32 v10, v94, v95
v_lshlrev_b32 v94, 16, v10
v_and_b32 v95, s18, v10
s_waitcnt lgkmcnt(0)
s_mov_b32 s36, s17
s_mul_i32 s38, s36, 18432
s_add_u32 s38, s38, 2097152
s_lshl_b32 s39, s36, 4
s_lshl_b32 s19, s16, 2
s_add_u32 s39, s39, s19
s_add_u32 s39, s39, 253952
v_mov_b64 v[38:39], v[160:161]
v_mov_b64 v[40:41], v[162:163]
v_mov_b64 v[42:43], v[164:165]
v_mov_b64 v[44:45], v[166:167]
v_mov_b64 v[46:47], v[168:169]
v_mov_b64 v[48:49], v[170:171]
v_mov_b64 v[50:51], v[172:173]
v_mov_b64 v[52:53], v[174:175]
v_mov_b64 v[54:55], v[176:177]
s_mov_b32 s22, 987991609
s_mov_b32 s23, 925353388
s_waitcnt vmcnt(0)
v_lshlrev_b32 v20, 16, v38
v_and_b32 v21, s18, v38
v_lshlrev_b32 v22, 16, v39
v_and_b32 v23, s18, v39
v_lshlrev_b32 v24, 16, v40
v_and_b32 v25, s18, v40
v_lshlrev_b32 v26, 16, v41
v_and_b32 v27, s18, v41
v_lshlrev_b32 v28, 16, v42
v_and_b32 v29, s18, v42
v_lshlrev_b32 v30, 16, v43
v_and_b32 v31, s18, v43
v_lshlrev_b32 v32, 16, v44
v_and_b32 v33, s18, v44
v_lshlrev_b32 v34, 16, v45
v_and_b32 v35, s18, v45
v_lshlrev_b32 v36, 16, v46
v_and_b32 v37, s18, v46
v_lshlrev_b32 v38, 16, v47
v_and_b32 v39, s18, v47
v_lshlrev_b32 v40, 16, v48
v_and_b32 v41, s18, v48
v_lshlrev_b32 v42, 16, v49
v_and_b32 v43, s18, v49
v_lshlrev_b32 v44, 16, v50
v_and_b32 v45, s18, v50
v_lshlrev_b32 v46, 16, v51
v_and_b32 v47, s18, v51
v_lshlrev_b32 v48, 16, v52
v_and_b32 v49, s18, v52
v_lshlrev_b32 v50, 16, v53
v_and_b32 v51, s18, v53
v_lshlrev_b32 v52, 16, v54
v_and_b32 v53, s18, v54
v_lshlrev_b32 v54, 16, v55
v_and_b32 v55, s18, v55
v_pk_add_f32 v[8:9], v[20:21], v[22:23]
v_pk_add_f32 v[10:11], v[24:25], v[26:27]
v_pk_add_f32 v[8:9], v[8:9], v[28:29]
v_pk_add_f32 v[10:11], v[10:11], v[30:31]
v_pk_add_f32 v[8:9], v[8:9], v[32:33]
v_pk_add_f32 v[10:11], v[10:11], v[34:35]
v_pk_add_f32 v[8:9], v[8:9], v[36:37]
v_pk_add_f32 v[10:11], v[10:11], v[38:39]
v_pk_add_f32 v[8:9], v[8:9], v[40:41]
v_pk_add_f32 v[10:11], v[10:11], v[42:43]
v_pk_add_f32 v[8:9], v[8:9], v[44:45]
v_pk_add_f32 v[10:11], v[10:11], v[46:47]
v_pk_add_f32 v[8:9], v[8:9], v[48:49]
v_pk_add_f32 v[10:11], v[10:11], v[50:51]
v_pk_add_f32 v[8:9], v[8:9], v[52:53]
v_pk_add_f32 v[10:11], v[10:11], v[54:55]
v_pk_add_f32 v[8:9], v[8:9], v[10:11]
v_add_f32 v8, v8, v9
s_nop 1
v_add_f32_dpp v8, v8, v8 row_ror:8 row_mask:0xf bank_mask:0xf
s_nop 1
v_add_f32_dpp v8, v8, v8 row_ror:4 row_mask:0xf bank_mask:0xf
s_nop 1
v_add_f32_dpp v8, v8, v8 row_ror:2 row_mask:0xf bank_mask:0xf
s_nop 1
v_add_f32_dpp v8, v8, v8 row_ror:1 row_mask:0xf bank_mask:0xf
v_mul_f32 v8, s22, v8
v_mov_b64 v[10:11], 0
v_mov_b64 v[12:13], 0
v_pk_add_f32 v[14:15], v[20:21], v[8:9] op_sel_hi:[1,0] neg_lo:[0,1] neg_hi:[0,1]
s_nop 0
v_pk_fma_f32 v[10:11], v[14:15], v[14:15], v[10:11]
v_pk_add_f32 v[16:17], v[22:23], v[8:9] op_sel_hi:[1,0] neg_lo:[0,1] neg_hi:[0,1]
s_nop 0
v_pk_fma_f32 v[12:13], v[16:17], v[16:17], v[12:13]
v_pk_add_f32 v[14:15], v[24:25], v[8:9] op_sel_hi:[1,0] neg_lo:[0,1] neg_hi:[0,1]
s_nop 0
v_pk_fma_f32 v[10:11], v[14:15], v[14:15], v[10:11]
v_pk_add_f32 v[16:17], v[26:27], v[8:9] op_sel_hi:[1,0] neg_lo:[0,1] neg_hi:[0,1]
s_nop 0
v_pk_fma_f32 v[12:13], v[16:17], v[16:17], v[12:13]
v_pk_add_f32 v[14:15], v[28:29], v[8:9] op_sel_hi:[1,0] neg_lo:[0,1] neg_hi:[0,1]
s_nop 0
v_pk_fma_f32 v[10:11], v[14:15], v[14:15], v[10:11]
v_pk_add_f32 v[16:17], v[30:31], v[8:9] op_sel_hi:[1,0] neg_lo:[0,1] neg_hi:[0,1]
s_nop 0
v_pk_fma_f32 v[12:13], v[16:17], v[16:17], v[12:13]
v_pk_add_f32 v[14:15], v[32:33], v[8:9] op_sel_hi:[1,0] neg_lo:[0,1] neg_hi:[0,1]
s_nop 0
v_pk_fma_f32 v[10:11], v[14:15], v[14:15], v[10:11]
v_pk_add_f32 v[16:17], v[34:35], v[8:9] op_sel_hi:[1,0] neg_lo:[0,1] neg_hi:[0,1]
s_nop 0
v_pk_fma_f32 v[12:13], v[16:17], v[16:17], v[12:13]
v_pk_add_f32 v[14:15], v[36:37], v[8:9] op_sel_hi:[1,0] neg_lo:[0,1] neg_hi:[0,1]
s_nop 0
v_pk_fma_f32 v[10:11], v[14:15], v[14:15], v[10:11]
v_pk_add_f32 v[16:17], v[38:39], v[8:9] op_sel_hi:[1,0] neg_lo:[0,1] neg_hi:[0,1]
s_nop 0
v_pk_fma_f32 v[12:13], v[16:17], v[16:17], v[12:13]
v_pk_add_f32 v[14:15], v[40:41], v[8:9] op_sel_hi:[1,0] neg_lo:[0,1] neg_hi:[0,1]
s_nop 0
v_pk_fma_f32 v[10:11], v[14:15], v[14:15], v[10:11]
v_pk_add_f32 v[16:17], v[42:43], v[8:9] op_sel_hi:[1,0] neg_lo:[0,1] neg_hi:[0,1]
s_nop 0
v_pk_fma_f32 v[12:13], v[16:17], v[16:17], v[12:13]
v_pk_add_f32 v[14:15], v[44:45], v[8:9] op_sel_hi:[1,0] neg_lo:[0,1] neg_hi:[0,1]
s_nop 0
v_pk_fma_f32 v[10:11], v[14:15], v[14:15], v[10:11]
v_pk_add_f32 v[16:17], v[46:47], v[8:9] op_sel_hi:[1,0] neg_lo:[0,1] neg_hi:[0,1]
s_nop 0
v_pk_fma_f32 v[12:13], v[16:17], v[16:17], v[12:13]
v_pk_add_f32 v[14:15], v[48:49], v[8:9] op_sel_hi:[1,0] neg_lo:[0,1] neg_hi:[0,1]
s_nop 0
v_pk_fma_f32 v[10:11], v[14:15], v[14:15], v[10:11]
v_pk_add_f32 v[16:17], v[50:51], v[8:9] op_sel_hi:[1,0] neg_lo:[0,1] neg_hi:[0,1]
s_nop 0
v_pk_fma_f32 v[12:13], v[16:17], v[16:17], v[12:13]
v_pk_add_f32 v[14:15], v[52:53], v[8:9] op_sel_hi:[1,0] neg_lo:[0,1] neg_hi:[0,1]
s_nop 0
v_pk_fma_f32 v[10:11], v[14:15], v[14:15], v[10:11]
v_pk_add_f32 v[16:17], v[54:55], v[8:9] op_sel_hi:[1,0] neg_lo:[0,1] neg_hi:[0,1]
s_nop 0
v_pk_fma_f32 v[12:13], v[16:17], v[16:17], v[12:13]
v_pk_add_f32 v[10:11], v[10:11], v[12:13]
v_add_f32 v9, v10, v11
s_nop 1
v_add_f32_dpp v9, v9, v9 row_ror:8 row_mask:0xf bank_mask:0xf
s_nop 1
v_add_f32_dpp v9, v9, v9 row_ror:4 row_mask:0xf bank_mask:0xf
s_nop 1
v_add_f32_dpp v9, v9, v9 row_ror:2 row_mask:0xf bank_mask:0xf
s_nop 1
v_add_f32_dpp v9, v9, v9 row_ror:1 row_mask:0xf bank_mask:0xf
v_mul_f32 v9, s22, v9
v_cvt_pk_bf16_f32 v10, v8, v9
v_lshlrev_b32 v8, 16, v10
v_and_b32 v9, s18, v10
v_add_f32 v9, s23, v9
v_cvt_pk_bf16_f32 v9, v9, v9
v_lshlrev_b32 v9, 16, v9
v_sqrt_f32 v9, v9
s_nop 0
v_cvt_pk_bf16_f32 v9, v9, v9
v_lshlrev_b32 v9, 16, v9
v_rcp_f32 v10, v9
s_nop 0
v_fma_f32 v11, -v9, v10, 1.0
v_fma_f32 v10, v11, v10, v10
v_pk_add_f32 v[20:21], v[20:21], v[8:9] op_sel_hi:[1,0] neg_lo:[0,1] neg_hi:[0,1]
v_pk_add_f32 v[22:23], v[22:23], v[8:9] op_sel_hi:[1,0] neg_lo:[0,1] neg_hi:[0,1]
v_pk_add_f32 v[24:25], v[24:25], v[8:9] op_sel_hi:[1,0] neg_lo:[0,1] neg_hi:[0,1]
v_cvt_pk_bf16_f32 v12, v20, v21
v_cvt_pk_bf16_f32 v13, v22, v23
v_cvt_pk_bf16_f32 v14, v24, v25
v_lshlrev_b32 v20, 16, v12
v_and_b32 v21, s18, v12
v_lshlrev_b32 v22, 16, v13
v_and_b32 v23, s18, v13
v_lshlrev_b32 v24, 16, v14
v_and_b32 v25, s18, v14
v_pk_mul_f32 v[20:21], v[20:21], v[10:11] op_sel_hi:[1,0]
v_pk_mul_f32 v[22:23], v[22:23], v[10:11] op_sel_hi:[1,0]
v_pk_mul_f32 v[24:25], v[24:25], v[10:11] op_sel_hi:[1,0]
v_cvt_pk_bf16_f32 v12, v20, v21
v_cvt_pk_bf16_f32 v13, v22, v23
v_cvt_pk_bf16_f32 v14, v24, v25
v_lshlrev_b32 v20, 16, v12
v_and_b32 v21, s18, v12
v_lshlrev_b32 v22, 16, v13
v_and_b32 v23, s18, v13
v_lshlrev_b32 v24, 16, v14
v_and_b32 v25, s18, v14
v_pk_mul_f32 v[20:21], v[20:21], v[60:61]
v_pk_mul_f32 v[22:23], v[22:23], v[62:63]
v_pk_mul_f32 v[24:25], v[24:25], v[64:65]
v_cvt_pk_bf16_f32 v12, v20, v21
v_cvt_pk_bf16_f32 v13, v22, v23
v_cvt_pk_bf16_f32 v14, v24, v25
v_lshlrev_b32 v20, 16, v12
v_and_b32 v21, s18, v12
v_lshlrev_b32 v22, 16, v13
v_and_b32 v23, s18, v13
v_lshlrev_b32 v24, 16, v14
v_and_b32 v25, s18, v14
v_pk_add_f32 v[20:21], v[20:21], v[96:97]
v_pk_add_f32 v[22:23], v[22:23], v[98:99]
v_pk_add_f32 v[24:25], v[24:25], v[100:101]
v_pk_add_f32 v[26:27], v[26:27], v[8:9] op_sel_hi:[1,0] neg_lo:[0,1] neg_hi:[0,1]
v_pk_add_f32 v[28:29], v[28:29], v[8:9] op_sel_hi:[1,0] neg_lo:[0,1] neg_hi:[0,1]
v_pk_add_f32 v[30:31], v[30:31], v[8:9] op_sel_hi:[1,0] neg_lo:[0,1] neg_hi:[0,1]
v_cvt_pk_bf16_f32 v12, v26, v27
v_cvt_pk_bf16_f32 v13, v28, v29
v_cvt_pk_bf16_f32 v14, v30, v31
v_lshlrev_b32 v26, 16, v12
v_and_b32 v27, s18, v12
v_lshlrev_b32 v28, 16, v13
v_and_b32 v29, s18, v13
v_lshlrev_b32 v30, 16, v14
v_and_b32 v31, s18, v14
v_pk_mul_f32 v[26:27], v[26:27], v[10:11] op_sel_hi:[1,0]
v_pk_mul_f32 v[28:29], v[28:29], v[10:11] op_sel_hi:[1,0]
v_pk_mul_f32 v[30:31], v[30:31], v[10:11] op_sel_hi:[1,0]
v_cvt_pk_bf16_f32 v12, v26, v27
v_cvt_pk_bf16_f32 v13, v28, v29
v_cvt_pk_bf16_f32 v14, v30, v31
v_lshlrev_b32 v26, 16, v12
v_and_b32 v27, s18, v12
v_lshlrev_b32 v28, 16, v13
v_and_b32 v29, s18, v13
v_lshlrev_b32 v30, 16, v14
v_and_b32 v31, s18, v14
v_pk_mul_f32 v[26:27], v[26:27], v[66:67]
v_pk_mul_f32 v[28:29], v[28:29], v[68:69]
v_pk_mul_f32 v[30:31], v[30:31], v[70:71]
v_cvt_pk_bf16_f32 v12, v26, v27
v_cvt_pk_bf16_f32 v13, v28, v29
v_cvt_pk_bf16_f32 v14, v30, v31
v_lshlrev_b32 v26, 16, v12
v_and_b32 v27, s18, v12
v_lshlrev_b32 v28, 16, v13
v_and_b32 v29, s18, v13
v_lshlrev_b32 v30, 16, v14
v_and_b32 v31, s18, v14
v_pk_add_f32 v[26:27], v[26:27], v[102:103]
v_pk_add_f32 v[28:29], v[28:29], v[104:105]
v_pk_add_f32 v[30:31], v[30:31], v[106:107]
v_pk_add_f32 v[32:33], v[32:33], v[8:9] op_sel_hi:[1,0] neg_lo:[0,1] neg_hi:[0,1]
v_pk_add_f32 v[34:35], v[34:35], v[8:9] op_sel_hi:[1,0] neg_lo:[0,1] neg_hi:[0,1]
v_pk_add_f32 v[36:37], v[36:37], v[8:9] op_sel_hi:[1,0] neg_lo:[0,1] neg_hi:[0,1]
v_cvt_pk_bf16_f32 v12, v32, v33
v_cvt_pk_bf16_f32 v13, v34, v35
v_cvt_pk_bf16_f32 v14, v36, v37
v_lshlrev_b32 v32, 16, v12
v_and_b32 v33, s18, v12
v_lshlrev_b32 v34, 16, v13
v_and_b32 v35, s18, v13
v_lshlrev_b32 v36, 16, v14
v_and_b32 v37, s18, v14
v_pk_mul_f32 v[32:33], v[32:33], v[10:11] op_sel_hi:[1,0]
v_pk_mul_f32 v[34:35], v[34:35], v[10:11] op_sel_hi:[1,0]
v_pk_mul_f32 v[36:37], v[36:37], v[10:11] op_sel_hi:[1,0]
v_cvt_pk_bf16_f32 v12, v32, v33
v_cvt_pk_bf16_f32 v13, v34, v35
v_cvt_pk_bf16_f32 v14, v36, v37
v_lshlrev_b32 v32, 16, v12
v_and_b32 v33, s18, v12
v_lshlrev_b32 v34, 16, v13
v_and_b32 v35, s18, v13
v_lshlrev_b32 v36, 16, v14
v_and_b32 v37, s18, v14
v_pk_mul_f32 v[32:33], v[32:33], v[72:73]
v_pk_mul_f32 v[34:35], v[34:35], v[74:75]
v_pk_mul_f32 v[36:37], v[36:37], v[76:77]
v_cvt_pk_bf16_f32 v12, v32, v33
v_cvt_pk_bf16_f32 v13, v34, v35
v_cvt_pk_bf16_f32 v14, v36, v37
v_lshlrev_b32 v32, 16, v12
v_and_b32 v33, s18, v12
v_lshlrev_b32 v34, 16, v13
v_and_b32 v35, s18, v13
v_lshlrev_b32 v36, 16, v14
v_and_b32 v37, s18, v14
v_pk_add_f32 v[32:33], v[32:33], v[108:109]
v_pk_add_f32 v[34:35], v[34:35], v[110:111]
v_pk_add_f32 v[36:37], v[36:37], v[112:113]
v_pk_add_f32 v[38:39], v[38:39], v[8:9] op_sel_hi:[1,0] neg_lo:[0,1] neg_hi:[0,1]
v_pk_add_f32 v[40:41], v[40:41], v[8:9] op_sel_hi:[1,0] neg_lo:[0,1] neg_hi:[0,1]
v_pk_add_f32 v[42:43], v[42:43], v[8:9] op_sel_hi:[1,0] neg_lo:[0,1] neg_hi:[0,1]
v_cvt_pk_bf16_f32 v12, v38, v39
v_cvt_pk_bf16_f32 v13, v40, v41
v_cvt_pk_bf16_f32 v14, v42, v43
v_lshlrev_b32 v38, 16, v12
v_and_b32 v39, s18, v12
v_lshlrev_b32 v40, 16, v13
v_and_b32 v41, s18, v13
v_lshlrev_b32 v42, 16, v14
v_and_b32 v43, s18, v14
v_pk_mul_f32 v[38:39], v[38:39], v[10:11] op_sel_hi:[1,0]
v_pk_mul_f32 v[40:41], v[40:41], v[10:11] op_sel_hi:[1,0]
v_pk_mul_f32 v[42:43], v[42:43], v[10:11] op_sel_hi:[1,0]
v_cvt_pk_bf16_f32 v12, v38, v39
v_cvt_pk_bf16_f32 v13, v40, v41
v_cvt_pk_bf16_f32 v14, v42, v43
v_lshlrev_b32 v38, 16, v12
v_and_b32 v39, s18, v12
v_lshlrev_b32 v40, 16, v13
v_and_b32 v41, s18, v13
v_lshlrev_b32 v42, 16, v14
v_and_b32 v43, s18, v14
v_pk_mul_f32 v[38:39], v[38:39], v[78:79]
v_pk_mul_f32 v[40:41], v[40:41], v[80:81]
v_pk_mul_f32 v[42:43], v[42:43], v[82:83]
v_cvt_pk_bf16_f32 v12, v38, v39
v_cvt_pk_bf16_f32 v13, v40, v41
v_cvt_pk_bf16_f32 v14, v42, v43
v_lshlrev_b32 v38, 16, v12
v_and_b32 v39, s18, v12
v_lshlrev_b32 v40, 16, v13
v_and_b32 v41, s18, v13
v_lshlrev_b32 v42, 16, v14
v_and_b32 v43, s18, v14
v_pk_add_f32 v[38:39], v[38:39], v[114:115]
v_pk_add_f32 v[40:41], v[40:41], v[116:117]
v_pk_add_f32 v[42:43], v[42:43], v[118:119]
v_pk_add_f32 v[44:45], v[44:45], v[8:9] op_sel_hi:[1,0] neg_lo:[0,1] neg_hi:[0,1]
v_pk_add_f32 v[46:47], v[46:47], v[8:9] op_sel_hi:[1,0] neg_lo:[0,1] neg_hi:[0,1]
v_pk_add_f32 v[48:49], v[48:49], v[8:9] op_sel_hi:[1,0] neg_lo:[0,1] neg_hi:[0,1]
v_cvt_pk_bf16_f32 v12, v44, v45
v_cvt_pk_bf16_f32 v13, v46, v47
v_cvt_pk_bf16_f32 v14, v48, v49
v_lshlrev_b32 v44, 16, v12
v_and_b32 v45, s18, v12
v_lshlrev_b32 v46, 16, v13
v_and_b32 v47, s18, v13
v_lshlrev_b32 v48, 16, v14
v_and_b32 v49, s18, v14
v_pk_mul_f32 v[44:45], v[44:45], v[10:11] op_sel_hi:[1,0]
v_pk_mul_f32 v[46:47], v[46:47], v[10:11] op_sel_hi:[1,0]
v_pk_mul_f32 v[48:49], v[48:49], v[10:11] op_sel_hi:[1,0]
v_cvt_pk_bf16_f32 v12, v44, v45
v_cvt_pk_bf16_f32 v13, v46, v47
v_cvt_pk_bf16_f32 v14, v48, v49
v_lshlrev_b32 v44, 16, v12
v_and_b32 v45, s18, v12
v_lshlrev_b32 v46, 16, v13
v_and_b32 v47, s18, v13
v_lshlrev_b32 v48, 16, v14
v_and_b32 v49, s18, v14
v_pk_mul_f32 v[44:45], v[44:45], v[84:85]
v_pk_mul_f32 v[46:47], v[46:47], v[86:87]
v_pk_mul_f32 v[48:49], v[48:49], v[88:89]
v_cvt_pk_bf16_f32 v12, v44, v45
v_cvt_pk_bf16_f32 v13, v46, v47
v_cvt_pk_bf16_f32 v14, v48, v49
v_lshlrev_b32 v44, 16, v12
v_and_b32 v45, s18, v12
v_lshlrev_b32 v46, 16, v13
v_and_b32 v47, s18, v13
v_lshlrev_b32 v48, 16, v14
v_and_b32 v49, s18, v14
v_pk_add_f32 v[44:45], v[44:45], v[120:121]
v_pk_add_f32 v[46:47], v[46:47], v[122:123]
v_pk_add_f32 v[48:49], v[48:49], v[124:125]
v_pk_add_f32 v[50:51], v[50:51], v[8:9] op_sel_hi:[1,0] neg_lo:[0,1] neg_hi:[0,1]
v_pk_add_f32 v[52:53], v[52:53], v[8:9] op_sel_hi:[1,0] neg_lo:[0,1] neg_hi:[0,1]
v_pk_add_f32 v[54:55], v[54:55], v[8:9] op_sel_hi:[1,0] neg_lo:[0,1] neg_hi:[0,1]
v_cvt_pk_bf16_f32 v12, v50, v51
v_cvt_pk_bf16_f32 v13, v52, v53
v_cvt_pk_bf16_f32 v14, v54, v55
v_lshlrev_b32 v50, 16, v12
v_and_b32 v51, s18, v12
v_lshlrev_b32 v52, 16, v13
v_and_b32 v53, s18, v13
v_lshlrev_b32 v54, 16, v14
v_and_b32 v55, s18, v14
v_pk_mul_f32 v[50:51], v[50:51], v[10:11] op_sel_hi:[1,0]
v_pk_mul_f32 v[52:53], v[52:53], v[10:11] op_sel_hi:[1,0]
v_pk_mul_f32 v[54:55], v[54:55], v[10:11] op_sel_hi:[1,0]
v_cvt_pk_bf16_f32 v12, v50, v51
v_cvt_pk_bf16_f32 v13, v52, v53
v_cvt_pk_bf16_f32 v14, v54, v55
v_lshlrev_b32 v50, 16, v12
v_and_b32 v51, s18, v12
v_lshlrev_b32 v52, 16, v13
v_and_b32 v53, s18, v13
v_lshlrev_b32 v54, 16, v14
v_and_b32 v55, s18, v14
v_pk_mul_f32 v[50:51], v[50:51], v[90:91]
v_pk_mul_f32 v[52:53], v[52:53], v[92:93]
v_pk_mul_f32 v[54:55], v[54:55], v[94:95]
v_cvt_pk_bf16_f32 v12, v50, v51
v_cvt_pk_bf16_f32 v13, v52, v53
v_cvt_pk_bf16_f32 v14, v54, v55
v_lshlrev_b32 v50, 16, v12
v_and_b32 v51, s18, v12
v_lshlrev_b32 v52, 16, v13
v_and_b32 v53, s18, v13
v_lshlrev_b32 v54, 16, v14
v_and_b32 v55, s18, v14
v_pk_add_f32 v[50:51], v[50:51], v[126:127]
v_pk_add_f32 v[52:53], v[52:53], v[128:129]
v_pk_add_f32 v[54:55], v[54:55], v[130:131]
s_mov_b32 s19, s38
v_cvt_pk_bf16_f32 v132, v20, v28
v_cvt_pk_bf16_f32 v133, v36, v44
buffer_store_dwordx2 v[132:133], v7, s[8:11], s19 offen sc1
v_cvt_pk_bf16_f32 v134, v21, v29
v_cvt_pk_bf16_f32 v135, v37, v45
buffer_store_dwordx2 v[134:135], v7, s[8:11], s19 offen offset:2048 sc1
s_add_u32 s19, s19, 4096
v_cvt_pk_bf16_f32 v136, v22, v30
v_cvt_pk_bf16_f32 v137, v38, v46
buffer_store_dwordx2 v[136:137], v7, s[8:11], s19 offen sc1
v_cvt_pk_bf16_f32 v138, v23, v31
v_cvt_pk_bf16_f32 v139, v39, v47
buffer_store_dwordx2 v[138:139], v7, s[8:11], s19 offen offset:2048 sc1
s_add_u32 s19, s19, 4096
v_cvt_pk_bf16_f32 v140, v24, v32
v_cvt_pk_bf16_f32 v141, v40, v48
buffer_store_dwordx2 v[140:141], v7, s[8:11], s19 offen sc1
v_cvt_pk_bf16_f32 v142, v25, v33
v_cvt_pk_bf16_f32 v143, v41, v49
buffer_store_dwordx2 v[142:143], v7, s[8:11], s19 offen offset:2048 sc1
s_add_u32 s19, s19, 4096
v_cvt_pk_bf16_f32 v144, v26, v34
v_cvt_pk_bf16_f32 v145, v42, v50
buffer_store_dwordx2 v[144:145], v7, s[8:11], s19 offen sc1
v_cvt_pk_bf16_f32 v146, v27, v35
v_cvt_pk_bf16_f32 v147, v43, v51
buffer_store_dwordx2 v[146:147], v7, s[8:11], s19 offen offset:2048 sc1
s_add_u32 s19, s19, 4096
v_cvt_pk_bf16_f32 v148, v52, v53
v_cvt_pk_bf16_f32 v149, v54, v55
buffer_store_dwordx2 v[148:149], v7, s[8:11], s19 offen sc1
v_mov_b32 v8, 1
s_waitcnt vmcnt(0)
buffer_store_dword v8, off, s[8:11], s39 sc1
s_add_u32 s36, s36, 64
s_cmp_lt_u32 s36, 128
s_cbranch_scc0 L_ln1e
s_mul_i32 s38, s36, 18432
s_add_u32 s38, s38, 2097152
s_lshl_b32 s39, s36, 4
s_lshl_b32 s19, s16, 2
s_add_u32 s39, s39, s19
s_add_u32 s39, s39, 253952
v_mov_b64 v[38:39], v[180:181]
v_mov_b64 v[40:41], v[182:183]
v_mov_b64 v[42:43], v[184:185]
v_mov_b64 v[44:45], v[186:187]
v_mov_b64 v[46:47], v[188:189]
v_mov_b64 v[48:49], v[190:191]
v_mov_b64 v[50:51], v[192:193]
v_mov_b64 v[52:53], v[194:195]
v_mov_b64 v[54:55], v[196:197]
s_mov_b32 s22, 987991609
s_mov_b32 s23, 925353388
s_waitcnt vmcnt(0)
v_lshlrev_b32 v20, 16, v38
v_and_b32 v21, s18, v38
v_lshlrev_b32 v22, 16, v39
v_and_b32 v23, s18, v39
v_lshlrev_b32 v24, 16, v40
v_and_b32 v25, s18, v40
v_lshlrev_b32 v26, 16, v41
v_and_b32 v27, s18, v41
v_lshlrev_b32 v28, 16, v42
v_and_b32 v29, s18, v42
v_lshlrev_b32 v30, 16, v43
v_and_b32 v31, s18, v43
v_lshlrev_b32 v32, 16, v44
v_and_b32 v33, s18, v44
v_lshlrev_b32 v34, 16, v45
v_and_b32 v35, s18, v45
v_lshlrev_b32 v36, 16, v46
v_and_b32 v37, s18, v46
v_lshlrev_b32 v38, 16, v47
v_and_b32 v39, s18, v47
v_lshlrev_b32 v40, 16, v48
v_and_b32 v41, s18, v48
v_lshlrev_b32 v42, 16, v49
v_and_b32 v43, s18, v49
v_lshlrev_b32 v44, 16, v50
v_and_b32 v45, s18, v50
v_lshlrev_b32 v46, 16, v51
v_and_b32 v47, s18, v51
v_lshlrev_b32 v48, 16, v52
v_and_b32 v49, s18, v52
v_lshlrev_b32 v50, 16, v53
v_and_b32 v51, s18, v53
v_lshlrev_b32 v52, 16, v54
v_and_b32 v53, s18, v54
v_lshlrev_b32 v54, 16, v55
v_and_b32 v55, s18, v55
v_pk_add_f32 v[8:9], v[20:21], v[22:23]
v_pk_add_f32 v[10:11], v[24:25], v[26:27]
v_pk_add_f32 v[8:9], v[8:9], v[28:29]
v_pk_add_f32 v[10:11], v[10:11], v[30:31]
v_pk_add_f32 v[8:9], v[8:9], v[32:33]
v_pk_add_f32 v[10:11], v[10:11], v[34:35]
v_pk_add_f32 v[8:9], v[8:9], v[36:37]
v_pk_add_f32 v[10:11], v[10:11], v[38:39]
v_pk_add_f32 v[8:9], v[8:9], v[40:41]
v_pk_add_f32 v[10:11], v[10:11], v[42:43]
v_pk_add_f32 v[8:9], v[8:9], v[44:45]
v_pk_add_f32 v[10:11], v[10:11], v[46:47]
v_pk_add_f32 v[8:9], v[8:9], v[48:49]
v_pk_add_f32 v[10:11], v[10:11], v[50:51]
v_pk_add_f32 v[8:9], v[8:9], v[52:53]
v_pk_add_f32 v[10:11], v[10:11], v[54:55]
v_pk_add_f32 v[8:9], v[8:9], v[10:11]
v_add_f32 v8, v8, v9
s_nop 1
v_add_f32_dpp v8, v8, v8 row_ror:8 row_mask:0xf bank_mask:0xf
s_nop 1
v_add_f32_dpp v8, v8, v8 row_ror:4 row_mask:0xf bank_mask:0xf
s_nop 1
v_add_f32_dpp v8, v8, v8 row_ror:2 row_mask:0xf bank_mask:0xf
s_nop 1
v_add_f32_dpp v8, v8, v8 row_ror:1 row_mask:0xf bank_mask:0xf
v_mul_f32 v8, s22, v8
v_mov_b64 v[10:11], 0
v_mov_b64 v[12:13], 0
v_pk_add_f32 v[14:15], v[20:21], v[8:9] op_sel_hi:[1,0] neg_lo:[0,1] neg_hi:[0,1]
s_nop 0
v_pk_fma_f32 v[10:11], v[14:15], v[14:15], v[10:11]
v_pk_add_f32 v[16:17], v[22:23], v[8:9] op_sel_hi:[1,0] neg_lo:[0,1] neg_hi:[0,1]
s_nop 0
v_pk_fma_f32 v[12:13], v[16:17], v[16:17], v[12:13]
v_pk_add_f32 v[14:15], v[24:25], v[8:9] op_sel_hi:[1,0] neg_lo:[0,1] neg_hi:[0,1]
s_nop 0
v_pk_fma_f32 v[10:11], v[14:15], v[14:15], v[10:11]
v_pk_add_f32 v[16:17], v[26:27], v[8:9] op_sel_hi:[1,0] neg_lo:[0,1] neg_hi:[0,1]
s_nop 0
v_pk_fma_f32 v[12:13], v[16:17], v[16:17], v[12:13]
v_pk_add_f32 v[14:15], v[28:29], v[8:9] op_sel_hi:[1,0] neg_lo:[0,1] neg_hi:[0,1]
s_nop 0
v_pk_fma_f32 v[10:11], v[14:15], v[14:15], v[10:11]
v_pk_add_f32 v[16:17], v[30:31], v[8:9] op_sel_hi:[1,0] neg_lo:[0,1] neg_hi:[0,1]
s_nop 0
v_pk_fma_f32 v[12:13], v[16:17], v[16:17], v[12:13]
v_pk_add_f32 v[14:15], v[32:33], v[8:9] op_sel_hi:[1,0] neg_lo:[0,1] neg_hi:[0,1]
s_nop 0
v_pk_fma_f32 v[10:11], v[14:15], v[14:15], v[10:11]
v_pk_add_f32 v[16:17], v[34:35], v[8:9] op_sel_hi:[1,0] neg_lo:[0,1] neg_hi:[0,1]
s_nop 0
v_pk_fma_f32 v[12:13], v[16:17], v[16:17], v[12:13]
v_pk_add_f32 v[14:15], v[36:37], v[8:9] op_sel_hi:[1,0] neg_lo:[0,1] neg_hi:[0,1]
s_nop 0
v_pk_fma_f32 v[10:11], v[14:15], v[14:15], v[10:11]
v_pk_add_f32 v[16:17], v[38:39], v[8:9] op_sel_hi:[1,0] neg_lo:[0,1] neg_hi:[0,1]
s_nop 0
v_pk_fma_f32 v[12:13], v[16:17], v[16:17], v[12:13]
v_pk_add_f32 v[14:15], v[40:41], v[8:9] op_sel_hi:[1,0] neg_lo:[0,1] neg_hi:[0,1]
s_nop 0
v_pk_fma_f32 v[10:11], v[14:15], v[14:15], v[10:11]
v_pk_add_f32 v[16:17], v[42:43], v[8:9] op_sel_hi:[1,0] neg_lo:[0,1] neg_hi:[0,1]
s_nop 0
v_pk_fma_f32 v[12:13], v[16:17], v[16:17], v[12:13]
v_pk_add_f32 v[14:15], v[44:45], v[8:9] op_sel_hi:[1,0] neg_lo:[0,1] neg_hi:[0,1]
s_nop 0
v_pk_fma_f32 v[10:11], v[14:15], v[14:15], v[10:11]
v_pk_add_f32 v[16:17], v[46:47], v[8:9] op_sel_hi:[1,0] neg_lo:[0,1] neg_hi:[0,1]
s_nop 0
v_pk_fma_f32 v[12:13], v[16:17], v[16:17], v[12:13]
v_pk_add_f32 v[14:15], v[48:49], v[8:9] op_sel_hi:[1,0] neg_lo:[0,1] neg_hi:[0,1]
s_nop 0
v_pk_fma_f32 v[10:11], v[14:15], v[14:15], v[10:11]
v_pk_add_f32 v[16:17], v[50:51], v[8:9] op_sel_hi:[1,0] neg_lo:[0,1] neg_hi:[0,1]
s_nop 0
v_pk_fma_f32 v[12:13], v[16:17], v[16:17], v[12:13]
v_pk_add_f32 v[14:15], v[52:53], v[8:9] op_sel_hi:[1,0] neg_lo:[0,1] neg_hi:[0,1]
s_nop 0
v_pk_fma_f32 v[10:11], v[14:15], v[14:15], v[10:11]
v_pk_add_f32 v[16:17], v[54:55], v[8:9] op_sel_hi:[1,0] neg_lo:[0,1] neg_hi:[0,1]
s_nop 0
v_pk_fma_f32 v[12:13], v[16:17], v[16:17], v[12:13]
v_pk_add_f32 v[10:11], v[10:11], v[12:13]
v_add_f32 v9, v10, v11
s_nop 1
v_add_f32_dpp v9, v9, v9 row_ror:8 row_mask:0xf bank_mask:0xf
s_nop 1
v_add_f32_dpp v9, v9, v9 row_ror:4 row_mask:0xf bank_mask:0xf
s_nop 1
v_add_f32_dpp v9, v9, v9 row_ror:2 row_mask:0xf bank_mask:0xf
s_nop 1
v_add_f32_dpp v9, v9, v9 row_ror:1 row_mask:0xf bank_mask:0xf
v_mul_f32 v9, s22, v9
v_cvt_pk_bf16_f32 v10, v8, v9
v_lshlrev_b32 v8, 16, v10
v_and_b32 v9, s18, v10
v_add_f32 v9, s23, v9
v_cvt_pk_bf16_f32 v9, v9, v9
v_lshlrev_b32 v9, 16, v9
v_sqrt_f32 v9, v9
s_nop 0
v_cvt_pk_bf16_f32 v9, v9, v9
v_lshlrev_b32 v9, 16, v9
v_rcp_f32 v10, v9
s_nop 0
v_fma_f32 v11, -v9, v10, 1.0
v_fma_f32 v10, v11, v10, v10
v_pk_add_f32 v[20:21], v[20:21], v[8:9] op_sel_hi:[1,0] neg_lo:[0,1] neg_hi:[0,1]
v_pk_add_f32 v[22:23], v[22:23], v[8:9] op_sel_hi:[1,0] neg_lo:[0,1] neg_hi:[0,1]
v_pk_add_f32 v[24:25], v[24:25], v[8:9] op_sel_hi:[1,0] neg_lo:[0,1] neg_hi:[0,1]
v_cvt_pk_bf16_f32 v12, v20, v21
v_cvt_pk_bf16_f32 v13, v22, v23
v_cvt_pk_bf16_f32 v14, v24, v25
v_lshlrev_b32 v20, 16, v12
v_and_b32 v21, s18, v12
v_lshlrev_b32 v22, 16, v13
v_and_b32 v23, s18, v13
v_lshlrev_b32 v24, 16, v14
v_and_b32 v25, s18, v14
v_pk_mul_f32 v[20:21], v[20:21], v[10:11] op_sel_hi:[1,0]
v_pk_mul_f32 v[22:23], v[22:23], v[10:11] op_sel_hi:[1,0]
v_pk_mul_f32 v[24:25], v[24:25], v[10:11] op_sel_hi:[1,0]
v_cvt_pk_bf16_f32 v12, v20, v21
v_cvt_pk_bf16_f32 v13, v22, v23
v_cvt_pk_bf16_f32 v14, v24, v25
v_lshlrev_b32 v20, 16, v12
v_and_b32 v21, s18, v12
v_lshlrev_b32 v22, 16, v13
v_and_b32 v23, s18, v13
v_lshlrev_b32 v24, 16, v14
v_and_b32 v25, s18, v14
v_pk_mul_f32 v[20:21], v[20:21], v[60:61]
v_pk_mul_f32 v[22:23], v[22:23], v[62:63]
v_pk_mul_f32 v[24:25], v[24:25], v[64:65]
v_cvt_pk_bf16_f32 v12, v20, v21
v_cvt_pk_bf16_f32 v13, v22, v23
v_cvt_pk_bf16_f32 v14, v24, v25
v_lshlrev_b32 v20, 16, v12
v_and_b32 v21, s18, v12
v_lshlrev_b32 v22, 16, v13
v_and_b32 v23, s18, v13
v_lshlrev_b32 v24, 16, v14
v_and_b32 v25, s18, v14
v_pk_add_f32 v[20:21], v[20:21], v[96:97]
v_pk_add_f32 v[22:23], v[22:23], v[98:99]
v_pk_add_f32 v[24:25], v[24:25], v[100:101]
v_pk_add_f32 v[26:27], v[26:27], v[8:9] op_sel_hi:[1,0] neg_lo:[0,1] neg_hi:[0,1]
v_pk_add_f32 v[28:29], v[28:29], v[8:9] op_sel_hi:[1,0] neg_lo:[0,1] neg_hi:[0,1]
v_pk_add_f32 v[30:31], v[30:31], v[8:9] op_sel_hi:[1,0] neg_lo:[0,1] neg_hi:[0,1]
v_cvt_pk_bf16_f32 v12, v26, v27
v_cvt_pk_bf16_f32 v13, v28, v29
v_cvt_pk_bf16_f32 v14, v30, v31
v_lshlrev_b32 v26, 16, v12
v_and_b32 v27, s18, v12
v_lshlrev_b32 v28, 16, v13
v_and_b32 v29, s18, v13
v_lshlrev_b32 v30, 16, v14
v_and_b32 v31, s18, v14
v_pk_mul_f32 v[26:27], v[26:27], v[10:11] op_sel_hi:[1,0]
v_pk_mul_f32 v[28:29], v[28:29], v[10:11] op_sel_hi:[1,0]
v_pk_mul_f32 v[30:31], v[30:31], v[10:11] op_sel_hi:[1,0]
v_cvt_pk_bf16_f32 v12, v26, v27
v_cvt_pk_bf16_f32 v13, v28, v29
v_cvt_pk_bf16_f32 v14, v30, v31
v_lshlrev_b32 v26, 16, v12
v_and_b32 v27, s18, v12
v_lshlrev_b32 v28, 16, v13
v_and_b32 v29, s18, v13
v_lshlrev_b32 v30, 16, v14
v_and_b32 v31, s18, v14
v_pk_mul_f32 v[26:27], v[26:27], v[66:67]
v_pk_mul_f32 v[28:29], v[28:29], v[68:69]
v_pk_mul_f32 v[30:31], v[30:31], v[70:71]
v_cvt_pk_bf16_f32 v12, v26, v27
v_cvt_pk_bf16_f32 v13, v28, v29
v_cvt_pk_bf16_f32 v14, v30, v31
v_lshlrev_b32 v26, 16, v12
v_and_b32 v27, s18, v12
v_lshlrev_b32 v28, 16, v13
v_and_b32 v29, s18, v13
v_lshlrev_b32 v30, 16, v14
v_and_b32 v31, s18, v14
v_pk_add_f32 v[26:27], v[26:27], v[102:103]
v_pk_add_f32 v[28:29], v[28:29], v[104:105]
v_pk_add_f32 v[30:31], v[30:31], v[106:107]
v_pk_add_f32 v[32:33], v[32:33], v[8:9] op_sel_hi:[1,0] neg_lo:[0,1] neg_hi:[0,1]
v_pk_add_f32 v[34:35], v[34:35], v[8:9] op_sel_hi:[1,0] neg_lo:[0,1] neg_hi:[0,1]
v_pk_add_f32 v[36:37], v[36:37], v[8:9] op_sel_hi:[1,0] neg_lo:[0,1] neg_hi:[0,1]
v_cvt_pk_bf16_f32 v12, v32, v33
v_cvt_pk_bf16_f32 v13, v34, v35
v_cvt_pk_bf16_f32 v14, v36, v37
v_lshlrev_b32 v32, 16, v12
v_and_b32 v33, s18, v12
v_lshlrev_b32 v34, 16, v13
v_and_b32 v35, s18, v13
v_lshlrev_b32 v36, 16, v14
v_and_b32 v37, s18, v14
v_pk_mul_f32 v[32:33], v[32:33], v[10:11] op_sel_hi:[1,0]
v_pk_mul_f32 v[34:35], v[34:35], v[10:11] op_sel_hi:[1,0]
v_pk_mul_f32 v[36:37], v[36:37], v[10:11] op_sel_hi:[1,0]
v_cvt_pk_bf16_f32 v12, v32, v33
v_cvt_pk_bf16_f32 v13, v34, v35
v_cvt_pk_bf16_f32 v14, v36, v37
v_lshlrev_b32 v32, 16, v12
v_and_b32 v33, s18, v12
v_lshlrev_b32 v34, 16, v13
v_and_b32 v35, s18, v13
v_lshlrev_b32 v36, 16, v14
v_and_b32 v37, s18, v14
v_pk_mul_f32 v[32:33], v[32:33], v[72:73]
v_pk_mul_f32 v[34:35], v[34:35], v[74:75]
v_pk_mul_f32 v[36:37], v[36:37], v[76:77]
v_cvt_pk_bf16_f32 v12, v32, v33
v_cvt_pk_bf16_f32 v13, v34, v35
v_cvt_pk_bf16_f32 v14, v36, v37
v_lshlrev_b32 v32, 16, v12
v_and_b32 v33, s18, v12
v_lshlrev_b32 v34, 16, v13
v_and_b32 v35, s18, v13
v_lshlrev_b32 v36, 16, v14
v_and_b32 v37, s18, v14
v_pk_add_f32 v[32:33], v[32:33], v[108:109]
v_pk_add_f32 v[34:35], v[34:35], v[110:111]
v_pk_add_f32 v[36:37], v[36:37], v[112:113]
v_pk_add_f32 v[38:39], v[38:39], v[8:9] op_sel_hi:[1,0] neg_lo:[0,1] neg_hi:[0,1]
v_pk_add_f32 v[40:41], v[40:41], v[8:9] op_sel_hi:[1,0] neg_lo:[0,1] neg_hi:[0,1]
v_pk_add_f32 v[42:43], v[42:43], v[8:9] op_sel_hi:[1,0] neg_lo:[0,1] neg_hi:[0,1]
v_cvt_pk_bf16_f32 v12, v38, v39
v_cvt_pk_bf16_f32 v13, v40, v41
v_cvt_pk_bf16_f32 v14, v42, v43
v_lshlrev_b32 v38, 16, v12
v_and_b32 v39, s18, v12
v_lshlrev_b32 v40, 16, v13
v_and_b32 v41, s18, v13
v_lshlrev_b32 v42, 16, v14
v_and_b32 v43, s18, v14
v_pk_mul_f32 v[38:39], v[38:39], v[10:11] op_sel_hi:[1,0]
v_pk_mul_f32 v[40:41], v[40:41], v[10:11] op_sel_hi:[1,0]
v_pk_mul_f32 v[42:43], v[42:43], v[10:11] op_sel_hi:[1,0]
v_cvt_pk_bf16_f32 v12, v38, v39
v_cvt_pk_bf16_f32 v13, v40, v41
v_cvt_pk_bf16_f32 v14, v42, v43
v_lshlrev_b32 v38, 16, v12
v_and_b32 v39, s18, v12
v_lshlrev_b32 v40, 16, v13
v_and_b32 v41, s18, v13
v_lshlrev_b32 v42, 16, v14
v_and_b32 v43, s18, v14
v_pk_mul_f32 v[38:39], v[38:39], v[78:79]
v_pk_mul_f32 v[40:41], v[40:41], v[80:81]
v_pk_mul_f32 v[42:43], v[42:43], v[82:83]
v_cvt_pk_bf16_f32 v12, v38, v39
v_cvt_pk_bf16_f32 v13, v40, v41
v_cvt_pk_bf16_f32 v14, v42, v43
v_lshlrev_b32 v38, 16, v12
v_and_b32 v39, s18, v12
v_lshlrev_b32 v40, 16, v13
v_and_b32 v41, s18, v13
v_lshlrev_b32 v42, 16, v14
v_and_b32 v43, s18, v14
v_pk_add_f32 v[38:39], v[38:39], v[114:115]
v_pk_add_f32 v[40:41], v[40:41], v[116:117]
v_pk_add_f32 v[42:43], v[42:43], v[118:119]
v_pk_add_f32 v[44:45], v[44:45], v[8:9] op_sel_hi:[1,0] neg_lo:[0,1] neg_hi:[0,1]
v_pk_add_f32 v[46:47], v[46:47], v[8:9] op_sel_hi:[1,0] neg_lo:[0,1] neg_hi:[0,1]
v_pk_add_f32 v[48:49], v[48:49], v[8:9] op_sel_hi:[1,0] neg_lo:[0,1] neg_hi:[0,1]
v_cvt_pk_bf16_f32 v12, v44, v45
v_cvt_pk_bf16_f32 v13, v46, v47
v_cvt_pk_bf16_f32 v14, v48, v49
v_lshlrev_b32 v44, 16, v12
v_and_b32 v45, s18, v12
v_lshlrev_b32 v46, 16, v13
v_and_b32 v47, s18, v13
v_lshlrev_b32 v48, 16, v14
v_and_b32 v49, s18, v14
v_pk_mul_f32 v[44:45], v[44:45], v[10:11] op_sel_hi:[1,0]
v_pk_mul_f32 v[46:47], v[46:47], v[10:11] op_sel_hi:[1,0]
v_pk_mul_f32 v[48:49], v[48:49], v[10:11] op_sel_hi:[1,0]
v_cvt_pk_bf16_f32 v12, v44, v45
v_cvt_pk_bf16_f32 v13, v46, v47
v_cvt_pk_bf16_f32 v14, v48, v49
v_lshlrev_b32 v44, 16, v12
v_and_b32 v45, s18, v12
v_lshlrev_b32 v46, 16, v13
v_and_b32 v47, s18, v13
v_lshlrev_b32 v48, 16, v14
v_and_b32 v49, s18, v14
v_pk_mul_f32 v[44:45], v[44:45], v[84:85]
v_pk_mul_f32 v[46:47], v[46:47], v[86:87]
v_pk_mul_f32 v[48:49], v[48:49], v[88:89]
v_cvt_pk_bf16_f32 v12, v44, v45
v_cvt_pk_bf16_f32 v13, v46, v47
v_cvt_pk_bf16_f32 v14, v48, v49
v_lshlrev_b32 v44, 16, v12
v_and_b32 v45, s18, v12
v_lshlrev_b32 v46, 16, v13
v_and_b32 v47, s18, v13
v_lshlrev_b32 v48, 16, v14
v_and_b32 v49, s18, v14
v_pk_add_f32 v[44:45], v[44:45], v[120:121]
v_pk_add_f32 v[46:47], v[46:47], v[122:123]
v_pk_add_f32 v[48:49], v[48:49], v[124:125]
v_pk_add_f32 v[50:51], v[50:51], v[8:9] op_sel_hi:[1,0] neg_lo:[0,1] neg_hi:[0,1]
v_pk_add_f32 v[52:53], v[52:53], v[8:9] op_sel_hi:[1,0] neg_lo:[0,1] neg_hi:[0,1]
v_pk_add_f32 v[54:55], v[54:55], v[8:9] op_sel_hi:[1,0] neg_lo:[0,1] neg_hi:[0,1]
v_cvt_pk_bf16_f32 v12, v50, v51
v_cvt_pk_bf16_f32 v13, v52, v53
v_cvt_pk_bf16_f32 v14, v54, v55
v_lshlrev_b32 v50, 16, v12
v_and_b32 v51, s18, v12
v_lshlrev_b32 v52, 16, v13
v_and_b32 v53, s18, v13
v_lshlrev_b32 v54, 16, v14
v_and_b32 v55, s18, v14
v_pk_mul_f32 v[50:51], v[50:51], v[10:11] op_sel_hi:[1,0]
v_pk_mul_f32 v[52:53], v[52:53], v[10:11] op_sel_hi:[1,0]
v_pk_mul_f32 v[54:55], v[54:55], v[10:11] op_sel_hi:[1,0]
v_cvt_pk_bf16_f32 v12, v50, v51
v_cvt_pk_bf16_f32 v13, v52, v53
v_cvt_pk_bf16_f32 v14, v54, v55
v_lshlrev_b32 v50, 16, v12
v_and_b32 v51, s18, v12
v_lshlrev_b32 v52, 16, v13
v_and_b32 v53, s18, v13
v_lshlrev_b32 v54, 16, v14
v_and_b32 v55, s18, v14
v_pk_mul_f32 v[50:51], v[50:51], v[90:91]
v_pk_mul_f32 v[52:53], v[52:53], v[92:93]
v_pk_mul_f32 v[54:55], v[54:55], v[94:95]
v_cvt_pk_bf16_f32 v12, v50, v51
v_cvt_pk_bf16_f32 v13, v52, v53
v_cvt_pk_bf16_f32 v14, v54, v55
v_lshlrev_b32 v50, 16, v12
v_and_b32 v51, s18, v12
v_lshlrev_b32 v52, 16, v13
v_and_b32 v53, s18, v13
v_lshlrev_b32 v54, 16, v14
v_and_b32 v55, s18, v14
v_pk_add_f32 v[50:51], v[50:51], v[126:127]
v_pk_add_f32 v[52:53], v[52:53], v[128:129]
v_pk_add_f32 v[54:55], v[54:55], v[130:131]
s_mov_b32 s19, s38
v_cvt_pk_bf16_f32 v132, v20, v28
v_cvt_pk_bf16_f32 v133, v36, v44
buffer_store_dwordx2 v[132:133], v7, s[8:11], s19 offen sc1
v_cvt_pk_bf16_f32 v134, v21, v29
v_cvt_pk_bf16_f32 v135, v37, v45
buffer_store_dwordx2 v[134:135], v7, s[8:11], s19 offen offset:2048 sc1
s_add_u32 s19, s19, 4096
v_cvt_pk_bf16_f32 v136, v22, v30
v_cvt_pk_bf16_f32 v137, v38, v46
buffer_store_dwordx2 v[136:137], v7, s[8:11], s19 offen sc1
v_cvt_pk_bf16_f32 v138, v23, v31
v_cvt_pk_bf16_f32 v139, v39, v47
buffer_store_dwordx2 v[138:139], v7, s[8:11], s19 offen offset:2048 sc1
s_add_u32 s19, s19, 4096
v_cvt_pk_bf16_f32 v140, v24, v32
v_cvt_pk_bf16_f32 v141, v40, v48
buffer_store_dwordx2 v[140:141], v7, s[8:11], s19 offen sc1
v_cvt_pk_bf16_f32 v142, v25, v33
v_cvt_pk_bf16_f32 v143, v41, v49
buffer_store_dwordx2 v[142:143], v7, s[8:11], s19 offen offset:2048 sc1
s_add_u32 s19, s19, 4096
v_cvt_pk_bf16_f32 v144, v26, v34
v_cvt_pk_bf16_f32 v145, v42, v50
buffer_store_dwordx2 v[144:145], v7, s[8:11], s19 offen sc1
v_cvt_pk_bf16_f32 v146, v27, v35
v_cvt_pk_bf16_f32 v147, v43, v51
buffer_store_dwordx2 v[146:147], v7, s[8:11], s19 offen offset:2048 sc1
s_add_u32 s19, s19, 4096
v_cvt_pk_bf16_f32 v148, v52, v53
v_cvt_pk_bf16_f32 v149, v54, v55
buffer_store_dwordx2 v[148:149], v7, s[8:11], s19 offen sc1
v_mov_b32 v8, 1
s_waitcnt vmcnt(0)
buffer_store_dword v8, off, s[8:11], s39 sc1
L_ln1e:
s_cmp_ge_u32 s17, 46
s_cbranch_scc0 L_aux3
s_sub_u32 s36, s17, 37
s_load_dwordx2 s[4:5], s[0:1], 88
s_waitcnt lgkmcnt(0)
s_mov_b32 s12, s4
s_and_b32 s13, s5, 0xffff
s_mov_b32 s14, 1152
s_mov_b32 s15, 0x20000
s_mul_i32 s28, s16, 144
s_lshl_b32 s19, s28, 1
v_lshlrev_b32 v3, 1, v2
buffer_load_ushort v8, v3, s[12:15], s19 offen
buffer_load_ushort v9, v3, s[12:15], s19 offen offset:128
buffer_load_ushort v10, v3, s[12:15], s19 offen offset:256
s_load_dwordx2 s[4:5], s[0:1], 96
s_waitcnt lgkmcnt(0)
s_mov_b32 s24, s4
s_and_b32 s25, s5, 0xffff
s_mov_b32 s26, 3981312
s_mov_b32 s27, 0x20000
v_lshrrev_b32 v4, 4, v2
v_mul_u32_u24 v5, 6912, v4
v_and_b32 v6, 15, v2
v_lshl_add_u32 v5, v6, 4, v5
s_mul_i32 s22, s28, 6912
s_lshl_b32 s19, s36, 8
s_add_u32 s22, s22, s19
buffer_load_dwordx4 v[20:23], v5, s[24:27], s22 offen
s_add_u32 s22, s22, 27648
buffer_load_dwordx4 v[24:27], v5, s[24:27], s22 offen
s_add_u32 s22, s22, 27648
buffer_load_dwordx4 v[28:31], v5, s[24:27], s22 offen
s_add_u32 s22, s22, 27648
buffer_load_dwordx4 v[32:35], v5, s[24:27], s22 offen
s_add_u32 s22, s22, 27648
buffer_load_dwordx4 v[36:39], v5, s[24:27], s22 offen
s_add_u32 s22, s22, 27648
buffer_load_dwordx4 v[40:43], v5, s[24:27], s22 offen
s_add_u32 s22, s22, 27648
buffer_load_dwordx4 v[44:47], v5, s[24:27], s22 offen
s_add_u32 s22, s22, 27648
buffer_load_dwordx4 v[48:51], v5, s[24:27], s22 offen
s_add_u32 s22, s22, 27648
buffer_load_dwordx4 v[52:55], v5, s[24:27], s22 offen
s_add_u32 s22, s22, 27648
buffer_load_dwordx4 v[56:59], v5, s[24:27], s22 offen
s_add_u32 s22, s22, 27648
buffer_load_dwordx4 v[60:63], v5, s[24:27], s22 offen
s_add_u32 s22, s22, 27648
buffer_load_dwordx4 v[64:67], v5, s[24:27], s22 offen
s_add_u32 s22, s22, 27648
buffer_load_dwordx4 v[68:71], v5, s[24:27], s22 offen
s_add_u32 s22, s22, 27648
buffer_load_dwordx4 v[72:75], v5, s[24:27], s22 offen
s_add_u32 s22, s22, 27648
buffer_load_dwordx4 v[76:79], v5, s[24:27], s22 offen
s_add_u32 s22, s22, 27648
buffer_load_dwordx4 v[80:83], v5, s[24:27], s22 offen
s_add_u32 s22, s22, 27648
buffer_load_dwordx4 v[84:87], v5, s[24:27], s22 offen
s_add_u32 s22, s22, 27648
buffer_load_dwordx4 v[88:91], v5, s[24:27], s22 offen
s_add_u32 s22, s22, 27648
buffer_load_dwordx4 v[92:95], v5, s[24:27], s22 offen
s_add_u32 s22, s22, 27648
buffer_load_dwordx4 v[96:99], v5, s[24:27], s22 offen
s_add_u32 s22, s22, 27648
buffer_load_dwordx4 v[100:103], v5, s[24:27], s22 offen
s_add_u32 s22, s22, 27648
buffer_load_dwordx4 v[104:107], v5, s[24:27], s22 offen
s_add_u32 s22, s22, 27648
buffer_load_dwordx4 v[108:111], v5, s[24:27], s22 offen
s_add_u32 s22, s22, 27648
buffer_load_dwordx4 v[112:115], v5, s[24:27], s22 offen
s_add_u32 s22, s22, 27648
buffer_load_dwordx4 v[116:119], v5, s[24:27], s22 offen
s_add_u32 s22, s22, 27648
buffer_load_dwordx4 v[120:123], v5, s[24:27], s22 offen
s_add_u32 s22, s22, 27648
buffer_load_dwordx4 v[124:127], v5, s[24:27], s22 offen
s_add_u32 s22, s22, 27648
buffer_load_dwordx4 v[128:131], v5, s[24:27], s22 offen
s_add_u32 s22, s22, 27648
buffer_load_dwordx4 v[132:135], v5, s[24:27], s22 offen
s_add_u32 s22, s22, 27648
buffer_load_dwordx4 v[136:139], v5, s[24:27], s22 offen
s_add_u32 s22, s22, 27648
buffer_load_dwordx4 v[140:143], v5, s[24:27], s22 offen
s_add_u32 s22, s22, 27648
buffer_load_dwordx4 v[144:147], v5, s[24:27], s22 offen
s_add_u32 s22, s22, 27648
buffer_load_dwordx4 v[148:151], v5, s[24:27], s22 offen
s_add_u32 s22, s22, 27648
buffer_load_dwordx4 v[152:155], v5, s[24:27], s22 offen
s_add_u32 s22, s22, 27648
buffer_load_dwordx4 v[156:159], v5, s[24:27], s22 offen
s_add_u32 s22, s22, 27648
buffer_load_dwordx4 v[160:163], v5, s[24:27], s22 offen
s_add_u32 s22, s22, 27648
s_waitcnt vmcnt(36)
s_mov_b32 s23, 3216550459
s_lshl_b32 s19, s16, 10
v_lshlrev_b32 v3, 2, v2
v_add_u32 v7, s19, v3
v_lshlrev_b32 v8, 16, v8
v_mul_f32 v11, s23, v8
v_exp_f32 v11, v11
s_nop 0
v_add_f32 v11, 1.0, v11
v_rcp_f32 v11, v11
s_nop 0
v_mul_f32 v8, v8, v11
v_cvt_pk_bf16_f32 v8, v8, v8
v_lshlrev_b32 v8, 16, v8
ds_write_b32 v7, v8
v_lshlrev_b32 v9, 16, v9
v_mul_f32 v11, s23, v9
v_exp_f32 v11, v11
s_nop 0
v_add_f32 v11, 1.0, v11
v_rcp_f32 v11, v11
s_nop 0
v_mul_f32 v9, v9, v11
v_cvt_pk_bf16_f32 v9, v9, v9
v_lshlrev_b32 v9, 16, v9
ds_write_b32 v7, v9 offset:256
v_lshlrev_b32 v10, 16, v10
v_mul_f32 v11, s23, v10
v_exp_f32 v11, v11
s_nop 0
v_add_f32 v11, 1.0, v11
v_rcp_f32 v11, v11
s_nop 0
v_mul_f32 v10, v10, v11
v_cvt_pk_bf16_f32 v10, v10, v10
v_lshlrev_b32 v10, 16, v10
ds_write_b32 v7, v10 offset:512
v_lshlrev_b32 v7, 2, v4
v_add_u32 v7, s19, v7
s_waitcnt lgkmcnt(0)
ds_read_b32 v164, v7
ds_read_b32 v165, v7 offset:16
ds_read_b32 v166, v7 offset:32
ds_read_b32 v167, v7 offset:48
ds_read_b32 v168, v7 offset:64
ds_read_b32 v169, v7 offset:80
ds_read_b32 v170, v7 offset:96
ds_read_b32 v171, v7 offset:112
ds_read_b32 v172, v7 offset:128
ds_read_b32 v173, v7 offset:144
ds_read_b32 v174, v7 offset:160
ds_read_b32 v175, v7 offset:176
ds_read_b32 v176, v7 offset:192
ds_read_b32 v177, v7 offset:208
ds_read_b32 v178, v7 offset:224
ds_read_b32 v179, v7 offset:240
ds_read_b32 v180, v7 offset:256
ds_read_b32 v181, v7 offset:272
ds_read_b32 v182, v7 offset:288
ds_read_b32 v183, v7 offset:304
ds_read_b32 v184, v7 offset:320
ds_read_b32 v185, v7 offset:336
ds_read_b32 v186, v7 offset:352
ds_read_b32 v187, v7 offset:368
ds_read_b32 v188, v7 offset:384
ds_read_b32 v189, v7 offset:400
ds_read_b32 v190, v7 offset:416
ds_read_b32 v191, v7 offset:432
ds_read_b32 v192, v7 offset:448
ds_read_b32 v193, v7 offset:464
ds_read_b32 v194, v7 offset:480
ds_read_b32 v195, v7 offset:496
ds_read_b32 v196, v7 offset:512
ds_read_b32 v197, v7 offset:528
ds_read_b32 v198, v7 offset:544
ds_read_b32 v199, v7 offset:560
v_mov_b64 v[200:201], 0
v_mov_b64 v[202:203], 0
v_mov_b64 v[204:205], 0
v_mov_b64 v[206:207], 0
s_waitcnt lgkmcnt(0)
s_waitcnt vmcnt(35)
v_lshlrev_b32 v12, 16, v20
v_and_b32 v13, s18, v20
v_lshlrev_b32 v14, 16, v21
v_and_b32 v15, s18, v21
v_lshlrev_b32 v16, 16, v22
v_and_b32 v17, s18, v22
v_lshlrev_b32 v18, 16, v23
v_and_b32 v19, s18, v23
v_fmac_f32 v200, v164, v12
v_fmac_f32 v201, v164, v13
v_fmac_f32 v202, v164, v14
v_fmac_f32 v203, v164, v15
v_fmac_f32 v204, v164, v16
v_fmac_f32 v205, v164, v17
v_fmac_f32 v206, v164, v18
v_fmac_f32 v207, v164, v19
s_waitcnt vmcnt(34)
v_lshlrev_b32 v12, 16, v24
v_and_b32 v13, s18, v24
v_lshlrev_b32 v14, 16, v25
v_and_b32 v15, s18, v25
v_lshlrev_b32 v16, 16, v26
v_and_b32 v17, s18, v26
v_lshlrev_b32 v18, 16, v27
v_and_b32 v19, s18, v27
v_fmac_f32 v200, v165, v12
v_fmac_f32 v201, v165, v13
v_fmac_f32 v202, v165, v14
v_fmac_f32 v203, v165, v15
v_fmac_f32 v204, v165, v16
v_fmac_f32 v205, v165, v17
v_fmac_f32 v206, v165, v18
v_fmac_f32 v207, v165, v19
s_waitcnt vmcnt(33)
v_lshlrev_b32 v12, 16, v28
v_and_b32 v13, s18, v28
v_lshlrev_b32 v14, 16, v29
v_and_b32 v15, s18, v29
v_lshlrev_b32 v16, 16, v30
v_and_b32 v17, s18, v30
v_lshlrev_b32 v18, 16, v31
v_and_b32 v19, s18, v31
v_fmac_f32 v200, v166, v12
v_fmac_f32 v201, v166, v13
v_fmac_f32 v202, v166, v14
v_fmac_f32 v203, v166, v15
v_fmac_f32 v204, v166, v16
v_fmac_f32 v205, v166, v17
v_fmac_f32 v206, v166, v18
v_fmac_f32 v207, v166, v19
s_waitcnt vmcnt(32)
v_lshlrev_b32 v12, 16, v32
v_and_b32 v13, s18, v32
v_lshlrev_b32 v14, 16, v33
v_and_b32 v15, s18, v33
v_lshlrev_b32 v16, 16, v34
v_and_b32 v17, s18, v34
v_lshlrev_b32 v18, 16, v35
v_and_b32 v19, s18, v35
v_fmac_f32 v200, v167, v12
v_fmac_f32 v201, v167, v13
v_fmac_f32 v202, v167, v14
v_fmac_f32 v203, v167, v15
v_fmac_f32 v204, v167, v16
v_fmac_f32 v205, v167, v17
v_fmac_f32 v206, v167, v18
v_fmac_f32 v207, v167, v19
s_waitcnt vmcnt(31)
v_lshlrev_b32 v12, 16, v36
v_and_b32 v13, s18, v36
v_lshlrev_b32 v14, 16, v37
v_and_b32 v15, s18, v37
v_lshlrev_b32 v16, 16, v38
v_and_b32 v17, s18, v38
v_lshlrev_b32 v18, 16, v39
v_and_b32 v19, s18, v39
v_fmac_f32 v200, v168, v12
v_fmac_f32 v201, v168, v13
v_fmac_f32 v202, v168, v14
v_fmac_f32 v203, v168, v15
v_fmac_f32 v204, v168, v16
v_fmac_f32 v205, v168, v17
v_fmac_f32 v206, v168, v18
v_fmac_f32 v207, v168, v19
s_waitcnt vmcnt(30)
v_lshlrev_b32 v12, 16, v40
v_and_b32 v13, s18, v40
v_lshlrev_b32 v14, 16, v41
v_and_b32 v15, s18, v41
v_lshlrev_b32 v16, 16, v42
v_and_b32 v17, s18, v42
v_lshlrev_b32 v18, 16, v43
v_and_b32 v19, s18, v43
v_fmac_f32 v200, v169, v12
v_fmac_f32 v201, v169, v13
v_fmac_f32 v202, v169, v14
v_fmac_f32 v203, v169, v15
v_fmac_f32 v204, v169, v16
v_fmac_f32 v205, v169, v17
v_fmac_f32 v206, v169, v18
v_fmac_f32 v207, v169, v19
s_waitcnt vmcnt(29)
v_lshlrev_b32 v12, 16, v44
v_and_b32 v13, s18, v44
v_lshlrev_b32 v14, 16, v45
v_and_b32 v15, s18, v45
v_lshlrev_b32 v16, 16, v46
v_and_b32 v17, s18, v46
v_lshlrev_b32 v18, 16, v47
v_and_b32 v19, s18, v47
v_fmac_f32 v200, v170, v12
v_fmac_f32 v201, v170, v13
v_fmac_f32 v202, v170, v14
v_fmac_f32 v203, v170, v15
v_fmac_f32 v204, v170, v16
v_fmac_f32 v205, v170, v17
v_fmac_f32 v206, v170, v18
v_fmac_f32 v207, v170, v19
s_waitcnt vmcnt(28)
v_lshlrev_b32 v12, 16, v48
v_and_b32 v13, s18, v48
v_lshlrev_b32 v14, 16, v49
v_and_b32 v15, s18, v49
v_lshlrev_b32 v16, 16, v50
v_and_b32 v17, s18, v50
v_lshlrev_b32 v18, 16, v51
v_and_b32 v19, s18, v51
v_fmac_f32 v200, v171, v12
v_fmac_f32 v201, v171, v13
v_fmac_f32 v202, v171, v14
v_fmac_f32 v203, v171, v15
v_fmac_f32 v204, v171, v16
v_fmac_f32 v205, v171, v17
v_fmac_f32 v206, v171, v18
v_fmac_f32 v207, v171, v19
s_waitcnt vmcnt(27)
v_lshlrev_b32 v12, 16, v52
v_and_b32 v13, s18, v52
v_lshlrev_b32 v14, 16, v53
v_and_b32 v15, s18, v53
v_lshlrev_b32 v16, 16, v54
v_and_b32 v17, s18, v54
v_lshlrev_b32 v18, 16, v55
v_and_b32 v19, s18, v55
v_fmac_f32 v200, v172, v12
v_fmac_f32 v201, v172, v13
v_fmac_f32 v202, v172, v14
v_fmac_f32 v203, v172, v15
v_fmac_f32 v204, v172, v16
v_fmac_f32 v205, v172, v17
v_fmac_f32 v206, v172, v18
v_fmac_f32 v207, v172, v19
s_waitcnt vmcnt(26)
v_lshlrev_b32 v12, 16, v56
v_and_b32 v13, s18, v56
v_lshlrev_b32 v14, 16, v57
v_and_b32 v15, s18, v57
v_lshlrev_b32 v16, 16, v58
v_and_b32 v17, s18, v58
v_lshlrev_b32 v18, 16, v59
v_and_b32 v19, s18, v59
v_fmac_f32 v200, v173, v12
v_fmac_f32 v201, v173, v13
v_fmac_f32 v202, v173, v14
v_fmac_f32 v203, v173, v15
v_fmac_f32 v204, v173, v16
v_fmac_f32 v205, v173, v17
v_fmac_f32 v206, v173, v18
v_fmac_f32 v207, v173, v19
s_waitcnt vmcnt(25)
v_lshlrev_b32 v12, 16, v60
v_and_b32 v13, s18, v60
v_lshlrev_b32 v14, 16, v61
v_and_b32 v15, s18, v61
v_lshlrev_b32 v16, 16, v62
v_and_b32 v17, s18, v62
v_lshlrev_b32 v18, 16, v63
v_and_b32 v19, s18, v63
v_fmac_f32 v200, v174, v12
v_fmac_f32 v201, v174, v13
v_fmac_f32 v202, v174, v14
v_fmac_f32 v203, v174, v15
v_fmac_f32 v204, v174, v16
v_fmac_f32 v205, v174, v17
v_fmac_f32 v206, v174, v18
v_fmac_f32 v207, v174, v19
s_waitcnt vmcnt(24)
v_lshlrev_b32 v12, 16, v64
v_and_b32 v13, s18, v64
v_lshlrev_b32 v14, 16, v65
v_and_b32 v15, s18, v65
v_lshlrev_b32 v16, 16, v66
v_and_b32 v17, s18, v66
v_lshlrev_b32 v18, 16, v67
v_and_b32 v19, s18, v67
v_fmac_f32 v200, v175, v12
v_fmac_f32 v201, v175, v13
v_fmac_f32 v202, v175, v14
v_fmac_f32 v203, v175, v15
v_fmac_f32 v204, v175, v16
v_fmac_f32 v205, v175, v17
v_fmac_f32 v206, v175, v18
v_fmac_f32 v207, v175, v19
s_waitcnt vmcnt(23)
v_lshlrev_b32 v12, 16, v68
v_and_b32 v13, s18, v68
v_lshlrev_b32 v14, 16, v69
v_and_b32 v15, s18, v69
v_lshlrev_b32 v16, 16, v70
v_and_b32 v17, s18, v70
v_lshlrev_b32 v18, 16, v71
v_and_b32 v19, s18, v71
v_fmac_f32 v200, v176, v12
v_fmac_f32 v201, v176, v13
v_fmac_f32 v202, v176, v14
v_fmac_f32 v203, v176, v15
v_fmac_f32 v204, v176, v16
v_fmac_f32 v205, v176, v17
v_fmac_f32 v206, v176, v18
v_fmac_f32 v207, v176, v19
s_waitcnt vmcnt(22)
v_lshlrev_b32 v12, 16, v72
v_and_b32 v13, s18, v72
v_lshlrev_b32 v14, 16, v73
v_and_b32 v15, s18, v73
v_lshlrev_b32 v16, 16, v74
v_and_b32 v17, s18, v74
v_lshlrev_b32 v18, 16, v75
v_and_b32 v19, s18, v75
v_fmac_f32 v200, v177, v12
v_fmac_f32 v201, v177, v13
v_fmac_f32 v202, v177, v14
v_fmac_f32 v203, v177, v15
v_fmac_f32 v204, v177, v16
v_fmac_f32 v205, v177, v17
v_fmac_f32 v206, v177, v18
v_fmac_f32 v207, v177, v19
s_waitcnt vmcnt(21)
v_lshlrev_b32 v12, 16, v76
v_and_b32 v13, s18, v76
v_lshlrev_b32 v14, 16, v77
v_and_b32 v15, s18, v77
v_lshlrev_b32 v16, 16, v78
v_and_b32 v17, s18, v78
v_lshlrev_b32 v18, 16, v79
v_and_b32 v19, s18, v79
v_fmac_f32 v200, v178, v12
v_fmac_f32 v201, v178, v13
v_fmac_f32 v202, v178, v14
v_fmac_f32 v203, v178, v15
v_fmac_f32 v204, v178, v16
v_fmac_f32 v205, v178, v17
v_fmac_f32 v206, v178, v18
v_fmac_f32 v207, v178, v19
s_waitcnt vmcnt(20)
v_lshlrev_b32 v12, 16, v80
v_and_b32 v13, s18, v80
v_lshlrev_b32 v14, 16, v81
v_and_b32 v15, s18, v81
v_lshlrev_b32 v16, 16, v82
v_and_b32 v17, s18, v82
v_lshlrev_b32 v18, 16, v83
v_and_b32 v19, s18, v83
v_fmac_f32 v200, v179, v12
v_fmac_f32 v201, v179, v13
v_fmac_f32 v202, v179, v14
v_fmac_f32 v203, v179, v15
v_fmac_f32 v204, v179, v16
v_fmac_f32 v205, v179, v17
v_fmac_f32 v206, v179, v18
v_fmac_f32 v207, v179, v19
s_waitcnt vmcnt(19)
v_lshlrev_b32 v12, 16, v84
v_and_b32 v13, s18, v84
v_lshlrev_b32 v14, 16, v85
v_and_b32 v15, s18, v85
v_lshlrev_b32 v16, 16, v86
v_and_b32 v17, s18, v86
v_lshlrev_b32 v18, 16, v87
v_and_b32 v19, s18, v87
v_fmac_f32 v200, v180, v12
v_fmac_f32 v201, v180, v13
v_fmac_f32 v202, v180, v14
v_fmac_f32 v203, v180, v15
v_fmac_f32 v204, v180, v16
v_fmac_f32 v205, v180, v17
v_fmac_f32 v206, v180, v18
v_fmac_f32 v207, v180, v19
s_waitcnt vmcnt(18)
v_lshlrev_b32 v12, 16, v88
v_and_b32 v13, s18, v88
v_lshlrev_b32 v14, 16, v89
v_and_b32 v15, s18, v89
v_lshlrev_b32 v16, 16, v90
v_and_b32 v17, s18, v90
v_lshlrev_b32 v18, 16, v91
v_and_b32 v19, s18, v91
v_fmac_f32 v200, v181, v12
v_fmac_f32 v201, v181, v13
v_fmac_f32 v202, v181, v14
v_fmac_f32 v203, v181, v15
v_fmac_f32 v204, v181, v16
v_fmac_f32 v205, v181, v17
v_fmac_f32 v206, v181, v18
v_fmac_f32 v207, v181, v19
s_waitcnt vmcnt(17)
v_lshlrev_b32 v12, 16, v92
v_and_b32 v13, s18, v92
v_lshlrev_b32 v14, 16, v93
v_and_b32 v15, s18, v93
v_lshlrev_b32 v16, 16, v94
v_and_b32 v17, s18, v94
v_lshlrev_b32 v18, 16, v95
v_and_b32 v19, s18, v95
v_fmac_f32 v200, v182, v12
v_fmac_f32 v201, v182, v13
v_fmac_f32 v202, v182, v14
v_fmac_f32 v203, v182, v15
v_fmac_f32 v204, v182, v16
v_fmac_f32 v205, v182, v17
v_fmac_f32 v206, v182, v18
v_fmac_f32 v207, v182, v19
s_waitcnt vmcnt(16)
v_lshlrev_b32 v12, 16, v96
v_and_b32 v13, s18, v96
v_lshlrev_b32 v14, 16, v97
v_and_b32 v15, s18, v97
v_lshlrev_b32 v16, 16, v98
v_and_b32 v17, s18, v98
v_lshlrev_b32 v18, 16, v99
v_and_b32 v19, s18, v99
v_fmac_f32 v200, v183, v12
v_fmac_f32 v201, v183, v13
v_fmac_f32 v202, v183, v14
v_fmac_f32 v203, v183, v15
v_fmac_f32 v204, v183, v16
v_fmac_f32 v205, v183, v17
v_fmac_f32 v206, v183, v18
v_fmac_f32 v207, v183, v19
s_waitcnt vmcnt(15)
v_lshlrev_b32 v12, 16, v100
v_and_b32 v13, s18, v100
v_lshlrev_b32 v14, 16, v101
v_and_b32 v15, s18, v101
v_lshlrev_b32 v16, 16, v102
v_and_b32 v17, s18, v102
v_lshlrev_b32 v18, 16, v103
v_and_b32 v19, s18, v103
v_fmac_f32 v200, v184, v12
v_fmac_f32 v201, v184, v13
v_fmac_f32 v202, v184, v14
v_fmac_f32 v203, v184, v15
v_fmac_f32 v204, v184, v16
v_fmac_f32 v205, v184, v17
v_fmac_f32 v206, v184, v18
v_fmac_f32 v207, v184, v19
s_waitcnt vmcnt(14)
v_lshlrev_b32 v12, 16, v104
v_and_b32 v13, s18, v104
v_lshlrev_b32 v14, 16, v105
v_and_b32 v15, s18, v105
v_lshlrev_b32 v16, 16, v106
v_and_b32 v17, s18, v106
v_lshlrev_b32 v18, 16, v107
v_and_b32 v19, s18, v107
v_fmac_f32 v200, v185, v12
v_fmac_f32 v201, v185, v13
v_fmac_f32 v202, v185, v14
v_fmac_f32 v203, v185, v15
v_fmac_f32 v204, v185, v16
v_fmac_f32 v205, v185, v17
v_fmac_f32 v206, v185, v18
v_fmac_f32 v207, v185, v19
s_waitcnt vmcnt(13)
v_lshlrev_b32 v12, 16, v108
v_and_b32 v13, s18, v108
v_lshlrev_b32 v14, 16, v109
v_and_b32 v15, s18, v109
v_lshlrev_b32 v16, 16, v110
v_and_b32 v17, s18, v110
v_lshlrev_b32 v18, 16, v111
v_and_b32 v19, s18, v111
v_fmac_f32 v200, v186, v12
v_fmac_f32 v201, v186, v13
v_fmac_f32 v202, v186, v14
v_fmac_f32 v203, v186, v15
v_fmac_f32 v204, v186, v16
v_fmac_f32 v205, v186, v17
v_fmac_f32 v206, v186, v18
v_fmac_f32 v207, v186, v19
s_waitcnt vmcnt(12)
v_lshlrev_b32 v12, 16, v112
v_and_b32 v13, s18, v112
v_lshlrev_b32 v14, 16, v113
v_and_b32 v15, s18, v113
v_lshlrev_b32 v16, 16, v114
v_and_b32 v17, s18, v114
v_lshlrev_b32 v18, 16, v115
v_and_b32 v19, s18, v115
v_fmac_f32 v200, v187, v12
v_fmac_f32 v201, v187, v13
v_fmac_f32 v202, v187, v14
v_fmac_f32 v203, v187, v15
v_fmac_f32 v204, v187, v16
v_fmac_f32 v205, v187, v17
v_fmac_f32 v206, v187, v18
v_fmac_f32 v207, v187, v19
s_waitcnt vmcnt(11)
v_lshlrev_b32 v12, 16, v116
v_and_b32 v13, s18, v116
v_lshlrev_b32 v14, 16, v117
v_and_b32 v15, s18, v117
v_lshlrev_b32 v16, 16, v118
v_and_b32 v17, s18, v118
v_lshlrev_b32 v18, 16, v119
v_and_b32 v19, s18, v119
v_fmac_f32 v200, v188, v12
v_fmac_f32 v201, v188, v13
v_fmac_f32 v202, v188, v14
v_fmac_f32 v203, v188, v15
v_fmac_f32 v204, v188, v16
v_fmac_f32 v205, v188, v17
v_fmac_f32 v206, v188, v18
v_fmac_f32 v207, v188, v19
s_waitcnt vmcnt(10)
v_lshlrev_b32 v12, 16, v120
v_and_b32 v13, s18, v120
v_lshlrev_b32 v14, 16, v121
v_and_b32 v15, s18, v121
v_lshlrev_b32 v16, 16, v122
v_and_b32 v17, s18, v122
v_lshlrev_b32 v18, 16, v123
v_and_b32 v19, s18, v123
v_fmac_f32 v200, v189, v12
v_fmac_f32 v201, v189, v13
v_fmac_f32 v202, v189, v14
v_fmac_f32 v203, v189, v15
v_fmac_f32 v204, v189, v16
v_fmac_f32 v205, v189, v17
v_fmac_f32 v206, v189, v18
v_fmac_f32 v207, v189, v19
s_waitcnt vmcnt(9)
v_lshlrev_b32 v12, 16, v124
v_and_b32 v13, s18, v124
v_lshlrev_b32 v14, 16, v125
v_and_b32 v15, s18, v125
v_lshlrev_b32 v16, 16, v126
v_and_b32 v17, s18, v126
v_lshlrev_b32 v18, 16, v127
v_and_b32 v19, s18, v127
v_fmac_f32 v200, v190, v12
v_fmac_f32 v201, v190, v13
v_fmac_f32 v202, v190, v14
v_fmac_f32 v203, v190, v15
v_fmac_f32 v204, v190, v16
v_fmac_f32 v205, v190, v17
v_fmac_f32 v206, v190, v18
v_fmac_f32 v207, v190, v19
s_waitcnt vmcnt(8)
v_lshlrev_b32 v12, 16, v128
v_and_b32 v13, s18, v128
v_lshlrev_b32 v14, 16, v129
v_and_b32 v15, s18, v129
v_lshlrev_b32 v16, 16, v130
v_and_b32 v17, s18, v130
v_lshlrev_b32 v18, 16, v131
v_and_b32 v19, s18, v131
v_fmac_f32 v200, v191, v12
v_fmac_f32 v201, v191, v13
v_fmac_f32 v202, v191, v14
v_fmac_f32 v203, v191, v15
v_fmac_f32 v204, v191, v16
v_fmac_f32 v205, v191, v17
v_fmac_f32 v206, v191, v18
v_fmac_f32 v207, v191, v19
s_waitcnt vmcnt(7)
v_lshlrev_b32 v12, 16, v132
v_and_b32 v13, s18, v132
v_lshlrev_b32 v14, 16, v133
v_and_b32 v15, s18, v133
v_lshlrev_b32 v16, 16, v134
v_and_b32 v17, s18, v134
v_lshlrev_b32 v18, 16, v135
v_and_b32 v19, s18, v135
v_fmac_f32 v200, v192, v12
v_fmac_f32 v201, v192, v13
v_fmac_f32 v202, v192, v14
v_fmac_f32 v203, v192, v15
v_fmac_f32 v204, v192, v16
v_fmac_f32 v205, v192, v17
v_fmac_f32 v206, v192, v18
v_fmac_f32 v207, v192, v19
s_waitcnt vmcnt(6)
v_lshlrev_b32 v12, 16, v136
v_and_b32 v13, s18, v136
v_lshlrev_b32 v14, 16, v137
v_and_b32 v15, s18, v137
v_lshlrev_b32 v16, 16, v138
v_and_b32 v17, s18, v138
v_lshlrev_b32 v18, 16, v139
v_and_b32 v19, s18, v139
v_fmac_f32 v200, v193, v12
v_fmac_f32 v201, v193, v13
v_fmac_f32 v202, v193, v14
v_fmac_f32 v203, v193, v15
v_fmac_f32 v204, v193, v16
v_fmac_f32 v205, v193, v17
v_fmac_f32 v206, v193, v18
v_fmac_f32 v207, v193, v19
s_waitcnt vmcnt(5)
v_lshlrev_b32 v12, 16, v140
v_and_b32 v13, s18, v140
v_lshlrev_b32 v14, 16, v141
v_and_b32 v15, s18, v141
v_lshlrev_b32 v16, 16, v142
v_and_b32 v17, s18, v142
v_lshlrev_b32 v18, 16, v143
v_and_b32 v19, s18, v143
v_fmac_f32 v200, v194, v12
v_fmac_f32 v201, v194, v13
v_fmac_f32 v202, v194, v14
v_fmac_f32 v203, v194, v15
v_fmac_f32 v204, v194, v16
v_fmac_f32 v205, v194, v17
v_fmac_f32 v206, v194, v18
v_fmac_f32 v207, v194, v19
s_waitcnt vmcnt(4)
v_lshlrev_b32 v12, 16, v144
v_and_b32 v13, s18, v144
v_lshlrev_b32 v14, 16, v145
v_and_b32 v15, s18, v145
v_lshlrev_b32 v16, 16, v146
v_and_b32 v17, s18, v146
v_lshlrev_b32 v18, 16, v147
v_and_b32 v19, s18, v147
v_fmac_f32 v200, v195, v12
v_fmac_f32 v201, v195, v13
v_fmac_f32 v202, v195, v14
v_fmac_f32 v203, v195, v15
v_fmac_f32 v204, v195, v16
v_fmac_f32 v205, v195, v17
v_fmac_f32 v206, v195, v18
v_fmac_f32 v207, v195, v19
s_waitcnt vmcnt(3)
v_lshlrev_b32 v12, 16, v148
v_and_b32 v13, s18, v148
v_lshlrev_b32 v14, 16, v149
v_and_b32 v15, s18, v149
v_lshlrev_b32 v16, 16, v150
v_and_b32 v17, s18, v150
v_lshlrev_b32 v18, 16, v151
v_and_b32 v19, s18, v151
v_fmac_f32 v200, v196, v12
v_fmac_f32 v201, v196, v13
v_fmac_f32 v202, v196, v14
v_fmac_f32 v203, v196, v15
v_fmac_f32 v204, v196, v16
v_fmac_f32 v205, v196, v17
v_fmac_f32 v206, v196, v18
v_fmac_f32 v207, v196, v19
s_waitcnt vmcnt(2)
v_lshlrev_b32 v12, 16, v152
v_and_b32 v13, s18, v152
v_lshlrev_b32 v14, 16, v153
v_and_b32 v15, s18, v153
v_lshlrev_b32 v16, 16, v154
v_and_b32 v17, s18, v154
v_lshlrev_b32 v18, 16, v155
v_and_b32 v19, s18, v155
v_fmac_f32 v200, v197, v12
v_fmac_f32 v201, v197, v13
v_fmac_f32 v202, v197, v14
v_fmac_f32 v203, v197, v15
v_fmac_f32 v204, v197, v16
v_fmac_f32 v205, v197, v17
v_fmac_f32 v206, v197, v18
v_fmac_f32 v207, v197, v19
s_waitcnt vmcnt(1)
v_lshlrev_b32 v12, 16, v156
v_and_b32 v13, s18, v156
v_lshlrev_b32 v14, 16, v157
v_and_b32 v15, s18, v157
v_lshlrev_b32 v16, 16, v158
v_and_b32 v17, s18, v158
v_lshlrev_b32 v18, 16, v159
v_and_b32 v19, s18, v159
v_fmac_f32 v200, v198, v12
v_fmac_f32 v201, v198, v13
v_fmac_f32 v202, v198, v14
v_fmac_f32 v203, v198, v15
v_fmac_f32 v204, v198, v16
v_fmac_f32 v205, v198, v17
v_fmac_f32 v206, v198, v18
v_fmac_f32 v207, v198, v19
s_waitcnt vmcnt(0)
v_lshlrev_b32 v12, 16, v160
v_and_b32 v13, s18, v160
v_lshlrev_b32 v14, 16, v161
v_and_b32 v15, s18, v161
v_lshlrev_b32 v16, 16, v162
v_and_b32 v17, s18, v162
v_lshlrev_b32 v18, 16, v163
v_and_b32 v19, s18, v163
v_fmac_f32 v200, v199, v12
v_fmac_f32 v201, v199, v13
v_fmac_f32 v202, v199, v14
v_fmac_f32 v203, v199, v15
v_fmac_f32 v204, v199, v16
v_fmac_f32 v205, v199, v17
v_fmac_f32 v206, v199, v18
v_fmac_f32 v207, v199, v19
s_lshl_b32 s19, s16, 11
v_lshlrev_b32 v7, 9, v4
v_lshl_add_u32 v7, v6, 5, v7
v_add_u32 v7, s19, v7
ds_write_b128 v7, v[200:203] offset:4096
ds_write_b128 v7, v[204:207] offset:4112
s_waitcnt lgkmcnt(0)
s_barrier
s_cmp_eq_u32 s16, 0
s_cbranch_scc0 L_mod1f
v_lshlrev_b32 v4, 3, v2
ds_read_b64 v[20:21], v4 offset:4096
ds_read_b64 v[22:23], v4 offset:4608
ds_read_b64 v[24:25], v4 offset:5120
ds_read_b64 v[26:27], v4 offset:5632
ds_read_b64 v[28:29], v4 offset:6144
ds_read_b64 v[30:31], v4 offset:6656
ds_read_b64 v[32:33], v4 offset:7168
ds_read_b64 v[34:35], v4 offset:7680
ds_read_b64 v[36:37], v4 offset:8192
ds_read_b64 v[38:39], v4 offset:8704
ds_read_b64 v[40:41], v4 offset:9216
ds_read_b64 v[42:43], v4 offset:9728
ds_read_b64 v[44:45], v4 offset:10240
ds_read_b64 v[46:47], v4 offset:10752
ds_read_b64 v[48:49], v4 offset:11264
ds_read_b64 v[50:51], v4 offset:11776
s_waitcnt lgkmcnt(0)
v_pk_add_f32 v[20:21], v[20:21], v[36:37]
v_pk_add_f32 v[22:23], v[22:23], v[38:39]
v_pk_add_f32 v[24:25], v[24:25], v[40:41]
v_pk_add_f32 v[26:27], v[26:27], v[42:43]
v_pk_add_f32 v[28:29], v[28:29], v[44:45]
v_pk_add_f32 v[30:31], v[30:31], v[46:47]
v_pk_add_f32 v[32:33], v[32:33], v[48:49]
v_pk_add_f32 v[34:35], v[34:35], v[50:51]
v_pk_add_f32 v[20:21], v[20:21], v[28:29]
v_pk_add_f32 v[22:23], v[22:23], v[30:31]
v_pk_add_f32 v[24:25], v[24:25], v[32:33]
v_pk_add_f32 v[26:27], v[26:27], v[34:35]
v_pk_add_f32 v[20:21], v[20:21], v[24:25]
v_pk_add_f32 v[22:23], v[22:23], v[26:27]
v_pk_add_f32 v[20:21], v[20:21], v[22:23]
v_cvt_pk_bf16_f32 v12, v20, v21
s_lshl_b32 s19, s36, 8
s_add_u32 s19, s19, 1048576
buffer_store_dword v12, v3, s[8:11], s19 offen sc1
s_waitcnt vmcnt(0)
s_mov_b64 exec, 1
v_mov_b32 v8, 100
v_mov_b32 v9, 1
global_atomic_add v8, v9, s[6:7]
s_mov_b64 exec, -1
L_mod1f:
s_barrier
L_aux3:
s_cmp_lt_u32 s17, 28
s_cbranch_scc0 L_aux4
s_cmp_eq_u32 s16, 0
s_cbranch_scc0 L_wdoa5
v_mov_b32 v8, 0
L_wd0a5:
global_load_dword v9, v8, s[6:7] offset:68 sc1
s_waitcnt vmcnt(0)
v_cmp_gt_u32 vcc, 32, v9
s_cbranch_vccz L_wdn0a5
s_sleep 60
s_add_u32 s21, s21, 1
s_cmp_ge_u32 s21, 4194304
s_cbranch_scc1 L_abort
s_branch L_wd0a5
L_wdn0a5:
L_wdoa5:
s_barrier
v_mov_b64 v[8:9], -1
v_mov_b64 v[10:11], -1
s_lshl_b32 s22, s17, 2
s_add_u32 s22, s22, s16
s_lshl_b32 s22, s22, 10
s_add_u32 s19, s22, 24117248
L_pf0:
s_cmp_lt_u32 s19, 25165824
s_cbranch_scc0 L_pfo0
buffer_store_dwordx4 v[8:11], v0, s[8:11], s19 offen sc1
s_add_u32 s19, s19, 114688
s_branch L_pf0
L_pfo0:
s_add_u32 s19, s22, 98566144
L_pf1:
s_cmp_lt_u32 s19, 100663296
s_cbranch_scc0 L_pfo1
buffer_store_dwordx4 v[8:11], v0, s[8:11], s19 offen sc1
s_add_u32 s19, s19, 114688
s_branch L_pf1
L_pfo1:
s_add_u32 s19, s22, 125763584
L_pf2:
s_cmp_lt_u32 s19, 126353408
s_cbranch_scc0 L_pfo2
buffer_store_dwordx4 v[8:11], v0, s[8:11], s19 offen sc1
s_add_u32 s19, s19, 114688
s_branch L_pf2
L_pfo2:
s_add_u32 s19, s22, 130482176
L_pf3:
s_cmp_lt_u32 s19, 131072000
s_cbranch_scc0 L_pfo3
buffer_store_dwordx4 v[8:11], v0, s[8:11], s19 offen sc1
s_add_u32 s19, s19, 114688
s_branch L_pf3
L_pfo3:
s_add_u32 s19, s22, 10452992
L_pf4:
s_cmp_lt_u32 s19, 10747904
s_cbranch_scc0 L_pfo4
buffer_store_dwordx4 v[8:11], v0, s[8:11], s19 offen sc1
s_add_u32 s19, s19, 114688
s_branch L_pf4
L_pfo4:
s_add_u32 s19, s22, 117178368
L_pf5:
s_cmp_lt_u32 s19, 119537664
s_cbranch_scc0 L_pfo5
buffer_store_dwordx4 v[8:11], v0, s[8:11], s19 offen sc1
s_add_u32 s19, s19, 114688
s_branch L_pf5
L_pfo5:
s_waitcnt vmcnt(0)
s_barrier
s_cmp_eq_u32 s16, 0
s_cbranch_scc0 L_pfe
s_mov_b64 exec, 1
v_mov_b32 v8, 104
v_mov_b32 v9, 1
global_atomic_add v8, v9, s[6:7]
s_mov_b64 exec, -1
L_pfe:
L_aux4:
s_cmp_lt_u32 s17, 20
s_cbranch_scc1 L_att
s_cmp_lt_u32 s17, 28
s_cbranch_scc0 L_dn
s_sub_u32 s17, s17, 20
s_cmp_eq_u32 s16, 0
s_cbranch_scc0 L_wdol1
v_mov_b32 v8, 0
L_wd0l1:
global_load_dword v9, v8, s[6:7] offset:100 sc1
s_waitcnt vmcnt(0)
v_cmp_gt_u32 vcc, 18, v9
s_cbranch_vccz L_wdn0l1
s_sleep 24
s_add_u32 s21, s21, 1
s_cmp_ge_u32 s21, 4194304
s_cbranch_scc1 L_abort
s_branch L_wd0l1
L_wdn0l1:
L_wd1l1:
global_load_dword v9, v8, s[6:7] offset:104 sc1
s_waitcnt vmcnt(0)
v_cmp_gt_u32 vcc, 28, v9
s_cbranch_vccz L_wdn1l1
s_sleep 24
s_add_u32 s21, s21, 1
s_cmp_ge_u32 s21, 4194304
s_cbranch_scc1 L_abort
s_branch L_wd1l1
L_wdn1l1:
L_wdol1:
s_barrier
s_load_dwordx2 s[4:5], s[0:1], 0
s_waitcnt lgkmcnt(0)
s_mov_b32 s12, s4
s_and_b32 s13, s5, 0xffff
s_mov_b32 s14, 2359296
s_mov_b32 s15, 0x20000
v_and_b32 v3, 31, v2
v_lshrrev_b32 v4, 5, v2
s_lshl_b32 s19, s16, 1
v_add_u32 v4, s19, v4
v_lshlrev_b32 v8, 5, v3
v_lshlrev_b32 v9, 2, v3
v_mul_u32_u24 v10, 1152, v4
v_add_u32 v5, v10, v8
v_add_u32 v6, v10, v9
v_lshlrev_b32 v1, 1, v5
v_lshlrev_b32 v19, 1, v6
v_lshrrev_b32 v7, 3, v3
v_lshl_add_u32 v7, v7, 3, v4
v_lshlrev_b32 v7, 4, v7
v_bfe_u32 v11, v3, 2, 1
v_lshl_add_u32 v7, v11, 9, v7
v_and_b32 v11, 3, v3
v_lshl_add_u32 v7, v11, 2, v7
v_lshl_add_u32 v162, v3, 4, v10
v_lshrrev_b32 v11, 5, v2
v_lshlrev_b32 v163, 10, v11
v_bfe_u32 v11, v2, 3, 2
v_lshl_add_u32 v163, v11, 8, v163
v_and_b32 v11, 7, v2
v_lshl_add_u32 v163, v11, 4, v163
s_lshl_b32 s19, s16, 10
v_add_u32 v164, s19, v0
v_lshrrev_b32 v11, 4, v2
v_add_u32 v11, 0, v11
v_add_u32 v12, 3, v11
v_cmp_gt_u32 vcc, 9, v11
s_nop 1
v_cndmask_b32 v11, v12, v11, vcc
v_and_b32 v11, 3, v11
v_xor_b32 v11, v11, v2
v_lshlrev_b32 v180, 4, v11
v_lshrrev_b32 v11, 4, v2
v_add_u32 v11, 4, v11
v_add_u32 v12, 3, v11
v_cmp_gt_u32 vcc, 9, v11
s_nop 1
v_cndmask_b32 v11, v12, v11, vcc
v_and_b32 v11, 3, v11
v_xor_b32 v11, v11, v2
v_lshlrev_b32 v181, 4, v11
v_lshrrev_b32 v11, 4, v2
v_add_u32 v11, 8, v11
v_add_u32 v12, 3, v11
v_cmp_gt_u32 vcc, 9, v11
s_nop 1
v_cndmask_b32 v11, v12, v11, vcc
v_and_b32 v11, 3, v11
v_xor_b32 v11, v11, v2
v_lshlrev_b32 v182, 4, v11
v_lshrrev_b32 v11, 4, v2
v_add_u32 v11, 12, v11
v_add_u32 v12, 3, v11
v_cmp_gt_u32 vcc, 9, v11
s_nop 1
v_cndmask_b32 v11, v12, v11, vcc
v_and_b32 v11, 3, v11
v_xor_b32 v11, v11, v2
v_lshlrev_b32 v183, 4, v11
v_lshrrev_b32 v11, 4, v2
v_add_u32 v11, 16, v11
v_add_u32 v12, 3, v11
v_cmp_gt_u32 vcc, 9, v11
s_nop 1
v_cndmask_b32 v11, v12, v11, vcc
v_and_b32 v11, 3, v11
v_xor_b32 v11, v11, v2
v_lshlrev_b32 v184, 4, v11
s_mul_i32 s40, s16, 10240
s_add_u32 s40, s40, 32768
v_lshrrev_b32 v11, 5, v2
v_mul_u32_u24 v11, 2304, v11
v_add_u32 v11, s40, v11
v_lshl_add_u32 v189, v3, 3, v11
v_lshl_add_u32 v11, v3, 6, v11
v_bfe_u32 v12, v3, 2, 2
v_lshl_add_u32 v185, v12, 4, v11
v_xor_b32 v186, 16, v185
v_xor_b32 v187, 32, v185
v_xor_b32 v188, 48, v185
s_mov_b32 s19, 1050880
buffer_load_dwordx4 v[50:53], v8, s[8:11], s19 offen sc1
buffer_load_dwordx4 v[54:57], v8, s[8:11], s19 offen offset:16 sc1
buffer_load_dword v58, v9, s[8:11], s19 offen offset:1024 sc1
s_mov_b32 s19, 1053184
buffer_load_dwordx4 v[70:73], v8, s[8:11], s19 offen sc1
buffer_load_dwordx4 v[74:77], v8, s[8:11], s19 offen offset:16 sc1
buffer_load_dword v78, v9, s[8:11], s19 offen offset:1024 sc1
s_mov_b32 s19, 1052032
buffer_load_dwordx4 v[90:93], v8, s[8:11], s19 offen sc1
buffer_load_dwordx4 v[94:97], v8, s[8:11], s19 offen offset:16 sc1
buffer_load_dword v98, v9, s[8:11], s19 offen offset:1024 sc1
s_waitcnt vmcnt(0)
v_lshlrev_b32 v40, 16, v50
v_and_b32 v41, s18, v50
v_lshlrev_b32 v42, 16, v51
v_and_b32 v43, s18, v51
v_lshlrev_b32 v44, 16, v52
v_and_b32 v45, s18, v52
v_lshlrev_b32 v46, 16, v53
v_and_b32 v47, s18, v53
v_lshlrev_b32 v48, 16, v54
v_and_b32 v49, s18, v54
v_lshlrev_b32 v50, 16, v55
v_and_b32 v51, s18, v55
v_lshlrev_b32 v52, 16, v56
v_and_b32 v53, s18, v56
v_lshlrev_b32 v54, 16, v57
v_and_b32 v55, s18, v57
v_lshlrev_b32 v56, 16, v58
v_and_b32 v57, s18, v58
v_lshlrev_b32 v60, 16, v70
v_and_b32 v61, s18, v70
v_lshlrev_b32 v62, 16, v71
v_and_b32 v63, s18, v71
v_lshlrev_b32 v64, 16, v72
v_and_b32 v65, s18, v72
v_lshlrev_b32 v66, 16, v73
v_and_b32 v67, s18, v73
v_lshlrev_b32 v68, 16, v74
v_and_b32 v69, s18, v74
v_lshlrev_b32 v70, 16, v75
v_and_b32 v71, s18, v75
v_lshlrev_b32 v72, 16, v76
v_and_b32 v73, s18, v76
v_lshlrev_b32 v74, 16, v77
v_and_b32 v75, s18, v77
v_lshlrev_b32 v76, 16, v78
v_and_b32 v77, s18, v78
v_lshlrev_b32 v80, 16, v90
v_and_b32 v81, s18, v90
v_lshlrev_b32 v82, 16, v91
v_and_b32 v83, s18, v91
v_lshlrev_b32 v84, 16, v92
v_and_b32 v85, s18, v92
v_lshlrev_b32 v86, 16, v93
v_and_b32 v87, s18, v93
v_lshlrev_b32 v88, 16, v94
v_and_b32 v89, s18, v94
v_lshlrev_b32 v90, 16, v95
v_and_b32 v91, s18, v95
v_lshlrev_b32 v92, 16, v96
v_and_b32 v93, s18, v96
v_lshlrev_b32 v94, 16, v97
v_and_b32 v95, s18, v97
v_lshlrev_b32 v96, 16, v98
v_and_b32 v97, s18, v98
v_pk_add_f32 v[60:61], v[60:61], 1.0 op_sel_hi:[1,0]
s_nop 0
v_cvt_pk_bf16_f32 v10, v60, v61
v_lshlrev_b32 v60, 16, v10
v_and_b32 v61, s18, v10
v_pk_add_f32 v[62:63], v[62:63], 1.0 op_sel_hi:[1,0]
s_nop 0
v_cvt_pk_bf16_f32 v10, v62, v63
v_lshlrev_b32 v62, 16, v10
v_and_b32 v63, s18, v10
v_pk_add_f32 v[64:65], v[64:65], 1.0 op_sel_hi:[1,0]
s_nop 0
v_cvt_pk_bf16_f32 v10, v64, v65
v_lshlrev_b32 v64, 16, v10
v_and_b32 v65, s18, v10
v_pk_add_f32 v[66:67], v[66:67], 1.0 op_sel_hi:[1,0]
s_nop 0
v_cvt_pk_bf16_f32 v10, v66, v67
v_lshlrev_b32 v66, 16, v10
v_and_b32 v67, s18, v10
v_pk_add_f32 v[68:69], v[68:69], 1.0 op_sel_hi:[1,0]
s_nop 0
v_cvt_pk_bf16_f32 v10, v68, v69
v_lshlrev_b32 v68, 16, v10
v_and_b32 v69, s18, v10
v_pk_add_f32 v[70:71], v[70:71], 1.0 op_sel_hi:[1,0]
s_nop 0
v_cvt_pk_bf16_f32 v10, v70, v71
v_lshlrev_b32 v70, 16, v10
v_and_b32 v71, s18, v10
v_pk_add_f32 v[72:73], v[72:73], 1.0 op_sel_hi:[1,0]
s_nop 0
v_cvt_pk_bf16_f32 v10, v72, v73
v_lshlrev_b32 v72, 16, v10
v_and_b32 v73, s18, v10
v_pk_add_f32 v[74:75], v[74:75], 1.0 op_sel_hi:[1,0]
s_nop 0
v_cvt_pk_bf16_f32 v10, v74, v75
v_lshlrev_b32 v74, 16, v10
v_and_b32 v75, s18, v10
v_pk_add_f32 v[76:77], v[76:77], 1.0 op_sel_hi:[1,0]
s_nop 0
v_cvt_pk_bf16_f32 v10, v76, v77
v_lshlrev_b32 v76, 16, v10
v_and_b32 v77, s18, v10
v_min_u32 v160, 47, v2
v_lshlrev_b32 v160, 2, v160
v_and_b32 v190, 31, v2
v_mul_u32_u24 v190, 9, v190
v_lshrrev_b32 v190, 3, v190
v_lshlrev_b32 v190, 7, v190
v_lshrrev_b32 v11, 5, v2
s_mov_b32 s19, 4718592
v_mul_lo_u32 v11, v11, s19
v_add3_u32 v190, v190, v11, 60
v_add_u32 v190, 64, v190
s_mov_b32 s44, 0
s_mov_b32 s22, 987991609
s_mov_b32 s23, 925353388
s_mov_b32 s36, s17
s_mov_b32 s33, 1073741824
v_mov_b32 v161, 1
s_mul_i32 s37, s36, 9216
buffer_load_dwordx4 v[170:173], v5, s[12:15], s37 offen
buffer_load_dwordx4 v[174:177], v5, s[12:15], s37 offen offset:16
buffer_load_dword v178, v6, s[12:15], s37 offen offset:1024
L_ln2:
s_mul_i32 s37, s36, 9216
s_lshl_b32 s34, s37, 1
s_add_u32 s34, s34, 121634816
s_lshr_b32 s19, s36, 1
s_lshl_b32 s35, s19, 8
s_add_u32 s35, s35, 221184
s_mul_i32 s38, s19, 18432
s_and_b32 s19, s36, 1
s_lshl_b32 s19, s19, 7
s_add_u32 s38, s38, s19
s_add_u32 s38, s38, 8388608
s_mul_i32 s19, s16, 4608
s_add_u32 s34, s34, s19
s_cmp_ge_u32 s36, 224
s_cbranch_scc0 L_wvl2
L_l2r:
L_wpl:
buffer_load_dword v8, v190, s[8:11], s34 offen sc1
s_waitcnt vmcnt(0)
v_cmp_eq_u32 vcc, -1, v8
s_cbranch_vccz L_wpol
s_add_u32 s21, s21, 1
s_cmp_ge_u32 s21, 4194304
s_cbranch_scc1 L_abort
s_branch L_wpl
L_wpol:
s_branch L_wvol2
L_wvl2:
buffer_load_dword v8, v160, s[8:11], s35 offen sc1
s_waitcnt vmcnt(0)
v_cmp_eq_u32 vcc, 0, v8
s_cbranch_vccz L_wvol2
s_sleep 1
s_add_u32 s21, s21, 1
s_cmp_ge_u32 s21, 4194304
s_cbranch_scc1 L_abort
s_branch L_wvl2
L_wvol2:
s_add_u32 s41, s34, 4718592
s_add_u32 s19, s40, 0
s_mov_b32 m0, s19
s_nop 0
buffer_load_dwordx4 v180, s[8:11], s34 offen sc1 lds
buffer_load_dwordx4 v181, s[8:11], s34 offen offset:1024 sc1 lds
buffer_load_dwordx4 v182, s[8:11], s34 offen offset:2048 sc1 lds
buffer_load_dwordx4 v183, s[8:11], s34 offen offset:3072 sc1 lds
s_add_u32 s19, s40, 5120
s_mov_b32 m0, s19
s_nop 0
buffer_load_dwordx4 v180, s[8:11], s41 offen sc1 lds
buffer_load_dwordx4 v181, s[8:11], s41 offen offset:1024 sc1 lds
buffer_load_dwordx4 v182, s[8:11], s41 offen offset:2048 sc1 lds
buffer_load_dwordx4 v183, s[8:11], s41 offen offset:3072 sc1 lds
s_add_u32 s43, s34, 4096
s_add_u32 s41, s41, 4096
s_mov_b64 exec, 0xffffffff
s_add_u32 s19, s40, 4096
s_mov_b32 m0, s19
s_nop 0
buffer_load_dwordx4 v184, s[8:11], s43 offen sc1 lds
s_add_u32 s19, s40, 9216
s_mov_b32 m0, s19
s_nop 0
buffer_load_dwordx4 v184, s[8:11], s41 offen sc1 lds
s_mov_b64 exec, -1
s_waitcnt vmcnt(0)
ds_read_b128 v[100:103], v185
ds_read_b128 v[104:107], v186
ds_read_b128 v[108:111], v187
ds_read_b128 v[112:115], v188
ds_read_b64 v[116:117], v189 offset:2048
ds_read_b128 v[120:123], v185 offset:5120
ds_read_b128 v[124:127], v186 offset:5120
ds_read_b128 v[128:131], v187 offset:5120
ds_read_b128 v[132:135], v188 offset:5120
ds_read_b64 v[136:137], v189 offset:7168
v_lshlrev_b32 v20, 16, v170
v_and_b32 v21, s18, v170
v_lshlrev_b32 v22, 16, v171
v_and_b32 v23, s18, v171
v_lshlrev_b32 v24, 16, v172
v_and_b32 v25, s18, v172
v_lshlrev_b32 v26, 16, v173
v_and_b32 v27, s18, v173
v_lshlrev_b32 v28, 16, v174
v_and_b32 v29, s18, v174
v_lshlrev_b32 v30, 16, v175
v_and_b32 v31, s18, v175
v_lshlrev_b32 v32, 16, v176
v_and_b32 v33, s18, v176
v_lshlrev_b32 v34, 16, v177
v_and_b32 v35, s18, v177
v_lshlrev_b32 v36, 16, v178
v_and_b32 v37, s18, v178
s_waitcnt lgkmcnt(0)
v_pk_add_f32 v[100:101], v[100:101], v[120:121]
v_pk_add_f32 v[102:103], v[102:103], v[122:123]
v_pk_add_f32 v[104:105], v[104:105], v[124:125]
v_pk_add_f32 v[106:107], v[106:107], v[126:127]
v_pk_add_f32 v[108:109], v[108:109], v[128:129]
v_pk_add_f32 v[110:111], v[110:111], v[130:131]
v_pk_add_f32 v[112:113], v[112:113], v[132:133]
v_pk_add_f32 v[114:115], v[114:115], v[134:135]
v_pk_add_f32 v[116:117], v[116:117], v[136:137]
v_pk_add_f32 v[8:9], v[102:103], v[100:101]
v_pk_add_f32 v[8:9], v[104:105], v[8:9]
v_pk_add_f32 v[8:9], v[106:107], v[8:9]
v_pk_add_f32 v[8:9], v[108:109], v[8:9]
v_pk_add_f32 v[8:9], v[110:111], v[8:9]
v_pk_add_f32 v[8:9], v[112:113], v[8:9]
v_pk_add_f32 v[8:9], v[114:115], v[8:9]
v_pk_add_f32 v[8:9], v[116:117], v[8:9]
v_cmp_u_f32 vcc, v8, v9
s_cbranch_vccnz L_l2x
L_l2y:
s_mov_b32 s44, 0
s_add_u32 s37, s37, 5242880
s_lshl_b32 s39, s36, 4
s_lshl_b32 s19, s16, 2
s_add_u32 s39, s39, s19
s_add_u32 s39, s39, 258048
v_cvt_pk_bf16_f32 v120, v100, v101
v_cvt_pk_bf16_f32 v121, v102, v103
v_cvt_pk_bf16_f32 v122, v104, v105
v_cvt_pk_bf16_f32 v123, v106, v107
v_cvt_pk_bf16_f32 v124, v108, v109
v_cvt_pk_bf16_f32 v125, v110, v111
v_cvt_pk_bf16_f32 v126, v112, v113
v_cvt_pk_bf16_f32 v127, v114, v115
v_cvt_pk_bf16_f32 v128, v116, v117
v_lshlrev_b32 v100, 16, v120
v_and_b32 v101, s18, v120
v_lshlrev_b32 v102, 16, v121
v_and_b32 v103, s18, v121
v_lshlrev_b32 v104, 16, v122
v_and_b32 v105, s18, v122
v_lshlrev_b32 v106, 16, v123
v_and_b32 v107, s18, v123
v_lshlrev_b32 v108, 16, v124
v_and_b32 v109, s18, v124
v_lshlrev_b32 v110, 16, v125
v_and_b32 v111, s18, v125
v_lshlrev_b32 v112, 16, v126
v_and_b32 v113, s18, v126
v_lshlrev_b32 v114, 16, v127
v_and_b32 v115, s18, v127
v_lshlrev_b32 v116, 16, v128
v_and_b32 v117, s18, v128
v_pk_mul_f32 v[100:101], v[100:101], v[40:41]
v_pk_mul_f32 v[102:103], v[102:103], v[42:43]
v_pk_mul_f32 v[104:105], v[104:105], v[44:45]
v_pk_mul_f32 v[106:107], v[106:107], v[46:47]
v_pk_mul_f32 v[108:109], v[108:109], v[48:49]
v_pk_mul_f32 v[110:111], v[110:111], v[50:51]
v_pk_mul_f32 v[112:113], v[112:113], v[52:53]
v_pk_mul_f32 v[114:115], v[114:115], v[54:55]
v_pk_mul_f32 v[116:117], v[116:117], v[56:57]
v_cvt_pk_bf16_f32 v120, v100, v101
v_cvt_pk_bf16_f32 v121, v102, v103
v_cvt_pk_bf16_f32 v122, v104, v105
v_cvt_pk_bf16_f32 v123, v106, v107
v_cvt_pk_bf16_f32 v124, v108, v109
v_cvt_pk_bf16_f32 v125, v110, v111
v_cvt_pk_bf16_f32 v126, v112, v113
v_cvt_pk_bf16_f32 v127, v114, v115
v_cvt_pk_bf16_f32 v128, v116, v117
v_lshlrev_b32 v100, 16, v120
v_and_b32 v101, s18, v120
v_lshlrev_b32 v102, 16, v121
v_and_b32 v103, s18, v121
v_lshlrev_b32 v104, 16, v122
v_and_b32 v105, s18, v122
v_lshlrev_b32 v106, 16, v123
v_and_b32 v107, s18, v123
v_lshlrev_b32 v108, 16, v124
v_and_b32 v109, s18, v124
v_lshlrev_b32 v110, 16, v125
v_and_b32 v111, s18, v125
v_lshlrev_b32 v112, 16, v126
v_and_b32 v113, s18, v126
v_lshlrev_b32 v114, 16, v127
v_and_b32 v115, s18, v127
v_lshlrev_b32 v116, 16, v128
v_and_b32 v117, s18, v128
v_pk_add_f32 v[20:21], v[20:21], v[100:101]
v_pk_add_f32 v[22:23], v[22:23], v[102:103]
v_pk_add_f32 v[24:25], v[24:25], v[104:105]
v_pk_add_f32 v[26:27], v[26:27], v[106:107]
v_pk_add_f32 v[28:29], v[28:29], v[108:109]
v_pk_add_f32 v[30:31], v[30:31], v[110:111]
v_pk_add_f32 v[32:33], v[32:33], v[112:113]
v_pk_add_f32 v[34:35], v[34:35], v[114:115]
v_pk_add_f32 v[36:37], v[36:37], v[116:117]
v_cvt_pk_bf16_f32 v140, v20, v21
v_cvt_pk_bf16_f32 v141, v22, v23
v_cvt_pk_bf16_f32 v142, v24, v25
v_cvt_pk_bf16_f32 v143, v26, v27
v_cvt_pk_bf16_f32 v144, v28, v29
v_cvt_pk_bf16_f32 v145, v30, v31
v_cvt_pk_bf16_f32 v146, v32, v33
v_cvt_pk_bf16_f32 v147, v34, v35
v_cvt_pk_bf16_f32 v148, v36, v37
v_lshlrev_b32 v20, 16, v140
v_and_b32 v21, s18, v140
v_lshlrev_b32 v22, 16, v141
v_and_b32 v23, s18, v141
v_lshlrev_b32 v24, 16, v142
v_and_b32 v25, s18, v142
v_lshlrev_b32 v26, 16, v143
v_and_b32 v27, s18, v143
v_lshlrev_b32 v28, 16, v144
v_and_b32 v29, s18, v144
v_lshlrev_b32 v30, 16, v145
v_and_b32 v31, s18, v145
v_lshlrev_b32 v32, 16, v146
v_and_b32 v33, s18, v146
v_lshlrev_b32 v34, 16, v147
v_and_b32 v35, s18, v147
v_lshlrev_b32 v36, 16, v148
v_and_b32 v37, s18, v148
v_pk_add_f32 v[8:9], v[20:21], v[22:23]
v_pk_add_f32 v[10:11], v[24:25], v[26:27]
v_pk_add_f32 v[8:9], v[8:9], v[28:29]
v_pk_add_f32 v[10:11], v[10:11], v[30:31]
v_pk_add_f32 v[8:9], v[8:9], v[32:33]
v_pk_add_f32 v[10:11], v[10:11], v[34:35]
v_pk_add_f32 v[8:9], v[8:9], v[36:37]
v_pk_add_f32 v[8:9], v[8:9], v[10:11]
v_add_f32 v8, v8, v9
buffer_store_dwordx4 v[140:143], v162, s[8:11], s37 offen sc1
buffer_store_dwordx4 v[144:147], v162, s[8:11], s37 offen offset:512 sc1
buffer_store_dword v148, v6, s[8:11], s37 offen offset:1024 sc1
v_add_f32_dpp v8, v8, v8 row_ror:8 row_mask:0xf bank_mask:0xf
s_nop 1
v_add_f32_dpp v8, v8, v8 row_ror:4 row_mask:0xf bank_mask:0xf
s_nop 1
v_add_f32_dpp v8, v8, v8 row_ror:2 row_mask:0xf bank_mask:0xf
s_nop 1
v_add_f32_dpp v8, v8, v8 row_ror:1 row_mask:0xf bank_mask:0xf
v_mov_b32 v18, v8
s_nop 1
v_permlane16_swap_b32 v8, v18
v_add_f32 v8, v8, v18
v_mul_f32 v8, s22, v8
v_mov_b64 v[10:11], 0
v_mov_b64 v[12:13], 0
v_pk_add_f32 v[14:15], v[20:21], v[8:9] op_sel_hi:[1,0] neg_lo:[0,1] neg_hi:[0,1]
s_nop 0
v_pk_fma_f32 v[10:11], v[14:15], v[14:15], v[10:11]
v_pk_add_f32 v[16:17], v[22:23], v[8:9] op_sel_hi:[1,0] neg_lo:[0,1] neg_hi:[0,1]
s_nop 0
v_pk_fma_f32 v[12:13], v[16:17], v[16:17], v[12:13]
v_pk_add_f32 v[14:15], v[24:25], v[8:9] op_sel_hi:[1,0] neg_lo:[0,1] neg_hi:[0,1]
s_nop 0
v_pk_fma_f32 v[10:11], v[14:15], v[14:15], v[10:11]
v_pk_add_f32 v[16:17], v[26:27], v[8:9] op_sel_hi:[1,0] neg_lo:[0,1] neg_hi:[0,1]
s_nop 0
v_pk_fma_f32 v[12:13], v[16:17], v[16:17], v[12:13]
v_pk_add_f32 v[14:15], v[28:29], v[8:9] op_sel_hi:[1,0] neg_lo:[0,1] neg_hi:[0,1]
s_nop 0
v_pk_fma_f32 v[10:11], v[14:15], v[14:15], v[10:11]
v_pk_add_f32 v[16:17], v[30:31], v[8:9] op_sel_hi:[1,0] neg_lo:[0,1] neg_hi:[0,1]
s_nop 0
v_pk_fma_f32 v[12:13], v[16:17], v[16:17], v[12:13]
v_pk_add_f32 v[14:15], v[32:33], v[8:9] op_sel_hi:[1,0] neg_lo:[0,1] neg_hi:[0,1]
s_nop 0
v_pk_fma_f32 v[10:11], v[14:15], v[14:15], v[10:11]
v_pk_add_f32 v[16:17], v[34:35], v[8:9] op_sel_hi:[1,0] neg_lo:[0,1] neg_hi:[0,1]
s_nop 0
v_pk_fma_f32 v[12:13], v[16:17], v[16:17], v[12:13]
v_pk_add_f32 v[14:15], v[36:37], v[8:9] op_sel_hi:[1,0] neg_lo:[0,1] neg_hi:[0,1]
s_nop 0
v_pk_fma_f32 v[10:11], v[14:15], v[14:15], v[10:11]
v_pk_add_f32 v[10:11], v[10:11], v[12:13]
v_add_f32 v9, v10, v11
s_nop 1
v_add_f32_dpp v9, v9, v9 row_ror:8 row_mask:0xf bank_mask:0xf
s_nop 1
v_add_f32_dpp v9, v9, v9 row_ror:4 row_mask:0xf bank_mask:0xf
s_nop 1
v_add_f32_dpp v9, v9, v9 row_ror:2 row_mask:0xf bank_mask:0xf
s_nop 1
v_add_f32_dpp v9, v9, v9 row_ror:1 row_mask:0xf bank_mask:0xf
v_mov_b32 v18, v9
s_nop 1
v_permlane16_swap_b32 v9, v18
v_add_f32 v9, v9, v18
v_mul_f32 v9, s22, v9
v_cvt_pk_bf16_f32 v10, v8, v9
v_lshlrev_b32 v8, 16, v10
v_and_b32 v9, s18, v10
v_add_f32 v9, s23, v9
v_cvt_pk_bf16_f32 v9, v9, v9
v_lshlrev_b32 v9, 16, v9
v_sqrt_f32 v9, v9
s_nop 0
v_cvt_pk_bf16_f32 v9, v9, v9
v_lshlrev_b32 v9, 16, v9
v_rcp_f32 v10, v9
s_nop 0
v_fma_f32 v11, -v9, v10, 1.0
v_fma_f32 v10, v11, v10, v10
v_pk_add_f32 v[20:21], v[20:21], v[8:9] op_sel_hi:[1,0] neg_lo:[0,1] neg_hi:[0,1]
v_pk_add_f32 v[22:23], v[22:23], v[8:9] op_sel_hi:[1,0] neg_lo:[0,1] neg_hi:[0,1]
v_pk_add_f32 v[24:25], v[24:25], v[8:9] op_sel_hi:[1,0] neg_lo:[0,1] neg_hi:[0,1]
v_pk_add_f32 v[26:27], v[26:27], v[8:9] op_sel_hi:[1,0] neg_lo:[0,1] neg_hi:[0,1]
v_pk_add_f32 v[28:29], v[28:29], v[8:9] op_sel_hi:[1,0] neg_lo:[0,1] neg_hi:[0,1]
v_pk_add_f32 v[30:31], v[30:31], v[8:9] op_sel_hi:[1,0] neg_lo:[0,1] neg_hi:[0,1]
v_pk_add_f32 v[32:33], v[32:33], v[8:9] op_sel_hi:[1,0] neg_lo:[0,1] neg_hi:[0,1]
v_pk_add_f32 v[34:35], v[34:35], v[8:9] op_sel_hi:[1,0] neg_lo:[0,1] neg_hi:[0,1]
v_pk_add_f32 v[36:37], v[36:37], v[8:9] op_sel_hi:[1,0] neg_lo:[0,1] neg_hi:[0,1]
v_cvt_pk_bf16_f32 v120, v20, v21
v_cvt_pk_bf16_f32 v121, v22, v23
v_cvt_pk_bf16_f32 v122, v24, v25
v_cvt_pk_bf16_f32 v123, v26, v27
v_cvt_pk_bf16_f32 v124, v28, v29
v_cvt_pk_bf16_f32 v125, v30, v31
v_cvt_pk_bf16_f32 v126, v32, v33
v_cvt_pk_bf16_f32 v127, v34, v35
v_cvt_pk_bf16_f32 v128, v36, v37
v_lshlrev_b32 v20, 16, v120
v_and_b32 v21, s18, v120
v_lshlrev_b32 v22, 16, v121
v_and_b32 v23, s18, v121
v_lshlrev_b32 v24, 16, v122
v_and_b32 v25, s18, v122
v_lshlrev_b32 v26, 16, v123
v_and_b32 v27, s18, v123
v_lshlrev_b32 v28, 16, v124
v_and_b32 v29, s18, v124
v_lshlrev_b32 v30, 16, v125
v_and_b32 v31, s18, v125
v_lshlrev_b32 v32, 16, v126
v_and_b32 v33, s18, v126
v_lshlrev_b32 v34, 16, v127
v_and_b32 v35, s18, v127
v_lshlrev_b32 v36, 16, v128
v_and_b32 v37, s18, v128
v_pk_mul_f32 v[20:21], v[20:21], v[10:11] op_sel_hi:[1,0]
v_pk_mul_f32 v[22:23], v[22:23], v[10:11] op_sel_hi:[1,0]
v_pk_mul_f32 v[24:25], v[24:25], v[10:11] op_sel_hi:[1,0]
v_pk_mul_f32 v[26:27], v[26:27], v[10:11] op_sel_hi:[1,0]
v_pk_mul_f32 v[28:29], v[28:29], v[10:11] op_sel_hi:[1,0]
v_pk_mul_f32 v[30:31], v[30:31], v[10:11] op_sel_hi:[1,0]
v_pk_mul_f32 v[32:33], v[32:33], v[10:11] op_sel_hi:[1,0]
v_pk_mul_f32 v[34:35], v[34:35], v[10:11] op_sel_hi:[1,0]
v_pk_mul_f32 v[36:37], v[36:37], v[10:11] op_sel_hi:[1,0]
v_cvt_pk_bf16_f32 v120, v20, v21
v_cvt_pk_bf16_f32 v121, v22, v23
v_cvt_pk_bf16_f32 v122, v24, v25
v_cvt_pk_bf16_f32 v123, v26, v27
v_cvt_pk_bf16_f32 v124, v28, v29
v_cvt_pk_bf16_f32 v125, v30, v31
v_cvt_pk_bf16_f32 v126, v32, v33
v_cvt_pk_bf16_f32 v127, v34, v35
v_cvt_pk_bf16_f32 v128, v36, v37
v_lshlrev_b32 v20, 16, v120
v_and_b32 v21, s18, v120
v_lshlrev_b32 v22, 16, v121
v_and_b32 v23, s18, v121
v_lshlrev_b32 v24, 16, v122
v_and_b32 v25, s18, v122
v_lshlrev_b32 v26, 16, v123
v_and_b32 v27, s18, v123
v_lshlrev_b32 v28, 16, v124
v_and_b32 v29, s18, v124
v_lshlrev_b32 v30, 16, v125
v_and_b32 v31, s18, v125
v_lshlrev_b32 v32, 16, v126
v_and_b32 v33, s18, v126
v_lshlrev_b32 v34, 16, v127
v_and_b32 v35, s18, v127
v_lshlrev_b32 v36, 16, v128
v_and_b32 v37, s18, v128
v_pk_mul_f32 v[20:21], v[20:21], v[60:61]
v_pk_mul_f32 v[22:23], v[22:23], v[62:63]
v_pk_mul_f32 v[24:25], v[24:25], v[64:65]
v_pk_mul_f32 v[26:27], v[26:27], v[66:67]
v_pk_mul_f32 v[28:29], v[28:29], v[68:69]
v_pk_mul_f32 v[30:31], v[30:31], v[70:71]
v_pk_mul_f32 v[32:33], v[32:33], v[72:73]
v_pk_mul_f32 v[34:35], v[34:35], v[74:75]
v_pk_mul_f32 v[36:37], v[36:37], v[76:77]
v_cvt_pk_bf16_f32 v120, v20, v21
v_cvt_pk_bf16_f32 v121, v22, v23
v_cvt_pk_bf16_f32 v122, v24, v25
v_cvt_pk_bf16_f32 v123, v26, v27
v_cvt_pk_bf16_f32 v124, v28, v29
v_cvt_pk_bf16_f32 v125, v30, v31
v_cvt_pk_bf16_f32 v126, v32, v33
v_cvt_pk_bf16_f32 v127, v34, v35
v_cvt_pk_bf16_f32 v128, v36, v37
v_lshlrev_b32 v20, 16, v120
v_and_b32 v21, s18, v120
v_lshlrev_b32 v22, 16, v121
v_and_b32 v23, s18, v121
v_lshlrev_b32 v24, 16, v122
v_and_b32 v25, s18, v122
v_lshlrev_b32 v26, 16, v123
v_and_b32 v27, s18, v123
v_lshlrev_b32 v28, 16, v124
v_and_b32 v29, s18, v124
v_lshlrev_b32 v30, 16, v125
v_and_b32 v31, s18, v125
v_lshlrev_b32 v32, 16, v126
v_and_b32 v33, s18, v126
v_lshlrev_b32 v34, 16, v127
v_and_b32 v35, s18, v127
v_lshlrev_b32 v36, 16, v128
v_and_b32 v37, s18, v128
v_pk_add_f32 v[20:21], v[20:21], v[80:81]
v_pk_add_f32 v[22:23], v[22:23], v[82:83]
v_pk_add_f32 v[24:25], v[24:25], v[84:85]
v_pk_add_f32 v[26:27], v[26:27], v[86:87]
v_pk_add_f32 v[28:29], v[28:29], v[88:89]
v_pk_add_f32 v[30:31], v[30:31], v[90:91]
v_pk_add_f32 v[32:33], v[32:33], v[92:93]
v_pk_add_f32 v[34:35], v[34:35], v[94:95]
v_pk_add_f32 v[36:37], v[36:37], v[96:97]
v_cvt_pk_bf16_f32 v100, v20, v28
ds_write_b32 v7, v100
v_cvt_pk_bf16_f32 v101, v21, v29
ds_write_b32 v7, v101 offset:1024
v_cvt_pk_bf16_f32 v102, v22, v30
ds_write_b32 v7, v102 offset:2048
v_cvt_pk_bf16_f32 v103, v23, v31
ds_write_b32 v7, v103 offset:3072
v_cvt_pk_bf16_f32 v104, v24, v32
ds_write_b32 v7, v104 offset:4096
v_cvt_pk_bf16_f32 v105, v25, v33
ds_write_b32 v7, v105 offset:5120
v_cvt_pk_bf16_f32 v106, v26, v34
ds_write_b32 v7, v106 offset:6144
v_cvt_pk_bf16_f32 v107, v27, v35
ds_write_b32 v7, v107 offset:7168
v_cvt_pk_bf16_f32 v108, v36, v37
ds_write_b32 v7, v108 offset:8192
s_lshl_b32 s19, s16, 11
s_add_u32 s38, s38, s19
s_add_u32 s19, s38, 8192
s_add_u32 s20, s38, 16384
s_cmp_eq_u32 s16, 0
s_cselect_b32 s20, s20, 1073741824
s_waitcnt vmcnt(0) lgkmcnt(0)
s_barrier
ds_read_b128 v[120:123], v164
ds_read_b128 v[124:127], v164 offset:4096
ds_read_b128 v[128:131], v164 offset:8192
v_xor_b32 v7, 0x4000, v7
v_xor_b32 v164, 0x4000, v164
s_waitcnt lgkmcnt(2)
buffer_store_dwordx4 v[120:123], v163, s[8:11], s38 offen sc1
s_waitcnt lgkmcnt(1)
buffer_store_dwordx4 v[124:127], v163, s[8:11], s19 offen sc1
s_waitcnt lgkmcnt(0)
buffer_store_dwordx4 v[128:131], v163, s[8:11], s20 offen sc1
s_sub_u32 s37, s37, 5169152
buffer_load_dwordx4 v[170:173], v5, s[12:15], s37 offen
buffer_load_dwordx4 v[174:177], v5, s[12:15], s37 offen offset:16
buffer_load_dword v178, v6, s[12:15], s37 offen offset:1024
s_waitcnt vmcnt(3)
buffer_store_dword v161, off, s[8:11], s39 sc1
s_add_u32 s36, s36, 8
s_cmp_lt_u32 s36, 256
s_cbranch_scc1 L_ln2
s_waitcnt vmcnt(0)
s_endpgm
L_l2x:
s_add_u32 s44, s44, 1
s_cmp_ge_u32 s44, 3
s_cbranch_scc1 L_l2y
s_cmp_lt_u32 s36, 224
s_cbranch_scc1 L_l2y
s_branch L_l2r
L_att:
s_cmp_eq_u32 s16, 0
s_cbranch_scc0 L_wdoat0
v_mov_b32 v8, 0
L_wd0at0:
global_load_dword v9, v8, s[6:7] offset:104 sc1
s_waitcnt vmcnt(0)
v_cmp_gt_u32 vcc, 28, v9
s_cbranch_vccz L_wdn0at0
s_sleep 24
s_add_u32 s21, s21, 1
s_cmp_ge_u32 s21, 4194304
s_cbranch_scc1 L_abort
s_branch L_wd0at0
L_wdn0at0:
L_wdoat0:
s_barrier
s_mul_i32 s38, s16, 20
s_add_u32 s38, s38, s17
v_lshrrev_b32 v4, 4, v2
v_and_b32 v5, 15, v2
v_lshrrev_b32 v6, 2, v5
v_lshlrev_b32 v6, 5, v6
v_and_b32 v7, 1, v5
v_lshl_add_u32 v6, v7, 4, v6
v_lshl_add_u32 v3, v4, 7, v6
v_lshlrev_b32 v1, 3, v2
v_lshlrev_b32 v4, 2, v4
v_sub_u32 v5, v5, v4
v_cmp_le_i32 s[60:61], 0, v5
v_cmp_le_i32 s[62:63], 1, v5
v_cmp_le_i32 s[64:65], 2, v5
v_cmp_le_i32 s[66:67], 3, v5
v_mov_b32 v6, 0xff800000
v_mov_b32 v7, 1
s_mov_b32 s34, 1035273459
s_mov_b32 s35, s34
s_mov_b32 s36, 1069066811
s_mov_b32 s37, s36
s_mov_b32 s39, 0
s_mov_b32 s56, 1073741824
v_min_u32 v230, 7, v2
v_lshlrev_b32 v230, 2, v230
s_lshl_b32 s28, s38, 13
s_add_u32 s28, s28, 67108864
s_lshl_b32 s29, s38, 14
s_add_u32 s29, s29, 33554432
s_lshl_b32 s59, s38, 5
s_add_u32 s59, s59, 0
L_at:
s_cmp_eq_u32 s39, 0
s_cbranch_scc0 L_atq
L_wvat1:
buffer_load_dword v231, v230, s[8:11], s59 offen sc1
s_waitcnt vmcnt(0)
v_cmp_eq_u32 vcc, 0, v231
s_cbranch_vccz L_wvoat1
s_sleep 16
s_add_u32 s21, s21, 1
s_cmp_ge_u32 s21, 4194304
s_cbranch_scc1 L_abort
s_branch L_wvat1
L_wvoat1:
s_add_u32 s19, s29, 0
s_add_u32 s20, s29, 4096
buffer_load_dwordx4 v[72:75], v0, s[8:11], s19 offen
buffer_load_dwordx4 v[76:79], v0, s[8:11], s19 offen offset:1024
buffer_load_dwordx4 v[80:83], v0, s[8:11], s19 offen offset:2048
buffer_load_dwordx4 v[84:87], v0, s[8:11], s19 offen offset:3072
buffer_load_dwordx4 v[88:91], v0, s[8:11], s20 offen
buffer_load_dwordx4 v[92:95], v0, s[8:11], s20 offen offset:1024
buffer_load_dwordx4 v[96:99], v0, s[8:11], s20 offen offset:2048
buffer_load_dwordx4 v[100:103], v0, s[8:11], s20 offen offset:3072
s_add_u32 s19, s28, 0
s_add_u32 s20, s28, 4096
buffer_load_dwordx4 v[40:43], v0, s[8:11], s19 offen
buffer_load_dwordx4 v[44:47], v0, s[8:11], s19 offen offset:1024
buffer_load_dwordx4 v[48:51], v0, s[8:11], s19 offen offset:2048
buffer_load_dwordx4 v[52:55], v0, s[8:11], s19 offen offset:3072
buffer_load_dwordx4 v[56:59], v0, s[8:11], s20 offen
buffer_load_dwordx4 v[60:63], v0, s[8:11], s20 offen offset:1024
buffer_load_dwordx4 v[64:67], v0, s[8:11], s20 offen offset:2048
buffer_load_dwordx4 v[68:71], v0, s[8:11], s20 offen offset:3072
s_add_u32 s19, s29, 8192
s_add_u32 s20, s29, 12288
buffer_load_dwordx4 v[104:107], v0, s[8:11], s19 offen
buffer_load_dwordx4 v[108:111], v0, s[8:11], s19 offen offset:1024
buffer_load_dwordx4 v[112:115], v0, s[8:11], s19 offen offset:2048
buffer_load_dwordx4 v[116:119], v0, s[8:11], s19 offen offset:3072
buffer_load_dwordx4 v[120:123], v0, s[8:11], s20 offen
buffer_load_dwordx4 v[124:127], v0, s[8:11], s20 offen offset:1024
buffer_load_dwordx4 v[128:131], v0, s[8:11], s20 offen offset:2048
buffer_load_dwordx4 v[132:135], v0, s[8:11], s20 offen offset:3072
s_waitcnt vmcnt(8)
L_atq:
s_and_b32 s23, s38, 31
s_lshr_b32 s22, s38, 5
s_lshl_b32 s30, s38, 12
s_add_u32 s30, s30, 16777216
s_lshl_b32 s33, s38, 2
s_add_u32 s33, s33, 212992
s_add_u32 s31, s59, 65536
s_lshl_b32 s32, s22, 18
s_lshl_b32 s19, s23, 12
s_add_u32 s32, s32, s19
s_add_u32 s32, s32, 83886080
s_add_u32 s38, s38, 80
s_lshl_b32 s28, s38, 13
s_add_u32 s28, s28, 67108864
s_lshl_b32 s29, s38, 14
s_add_u32 s29, s29, 33554432
s_lshl_b32 s59, s38, 5
s_add_u32 s59, s59, 0
buffer_load_dword v232, v230, s[8:11], s59 offen sc1
buffer_load_dword v231, v230, s[8:11], s31 offen sc1
v_mfma_f32_16x16x32_bf16 v[8:11], v[72:75], v[40:43], 0
v_mfma_f32_16x16x32_bf16 v[16:19], v[72:75], v[56:59], 0
v_mfma_f32_16x16x32_bf16 v[20:23], v[88:91], v[56:59], 0
v_mfma_f32_16x16x32_bf16 v[8:11], v[76:79], v[44:47], v[8:11]
v_mfma_f32_16x16x32_bf16 v[16:19], v[76:79], v[60:63], v[16:19]
v_mfma_f32_16x16x32_bf16 v[20:23], v[92:95], v[60:63], v[20:23]
v_mfma_f32_16x16x32_bf16 v[8:11], v[80:83], v[48:51], v[8:11]
v_mfma_f32_16x16x32_bf16 v[16:19], v[80:83], v[64:67], v[16:19]
v_mfma_f32_16x16x32_bf16 v[20:23], v[96:99], v[64:67], v[20:23]
v_mfma_f32_16x16x32_bf16 v[8:11], v[84:87], v[52:55], v[8:11]
v_mfma_f32_16x16x32_bf16 v[16:19], v[84:87], v[68:71], v[16:19]
v_mfma_f32_16x16x32_bf16 v[20:23], v[100:103], v[68:71], v[20:23]
v_cvt_pk_bf16_f32 v28, v8, v9
v_cvt_pk_bf16_f32 v29, v10, v11
s_nop 1
v_cvt_pk_bf16_f32 v30, v16, v17
v_cvt_pk_bf16_f32 v31, v18, v19
s_nop 1
v_cvt_pk_bf16_f32 v32, v20, v21
v_cvt_pk_bf16_f32 v33, v22, v23
v_lshlrev_b32 v8, 16, v28
v_and_b32 v9, s18, v28
v_lshlrev_b32 v10, 16, v29
v_and_b32 v11, s18, v29
v_lshlrev_b32 v16, 16, v30
v_and_b32 v17, s18, v30
v_lshlrev_b32 v18, 16, v31
v_and_b32 v19, s18, v31
v_lshlrev_b32 v20, 16, v32
v_and_b32 v21, s18, v32
v_lshlrev_b32 v22, 16, v33
v_and_b32 v23, s18, v33
v_pk_mul_f32 v[8:9], v[8:9], s[34:35]
v_pk_mul_f32 v[10:11], v[10:11], s[34:35]
v_pk_mul_f32 v[16:17], v[16:17], s[34:35]
v_pk_mul_f32 v[18:19], v[18:19], s[34:35]
v_pk_mul_f32 v[20:21], v[20:21], s[34:35]
v_pk_mul_f32 v[22:23], v[22:23], s[34:35]
v_cvt_pk_bf16_f32 v28, v8, v9
v_cvt_pk_bf16_f32 v29, v10, v11
v_cvt_pk_bf16_f32 v30, v16, v17
v_cvt_pk_bf16_f32 v31, v18, v19
v_cvt_pk_bf16_f32 v32, v20, v21
v_cvt_pk_bf16_f32 v33, v22, v23
v_lshlrev_b32 v8, 16, v28
v_and_b32 v9, s18, v28
v_lshlrev_b32 v10, 16, v29
v_and_b32 v11, s18, v29
v_lshlrev_b32 v16, 16, v30
v_and_b32 v17, s18, v30
v_lshlrev_b32 v18, 16, v31
v_and_b32 v19, s18, v31
v_lshlrev_b32 v20, 16, v32
v_and_b32 v21, s18, v32
v_lshlrev_b32 v22, 16, v33
v_and_b32 v23, s18, v33
v_cndmask_b32 v8, v6, v8, s[60:61]
v_cndmask_b32 v9, v6, v9, s[62:63]
v_cndmask_b32 v10, v6, v10, s[64:65]
v_cndmask_b32 v11, v6, v11, s[66:67]
v_cndmask_b32 v20, v6, v20, s[60:61]
v_cndmask_b32 v21, v6, v21, s[62:63]
v_cndmask_b32 v22, v6, v22, s[64:65]
v_cndmask_b32 v23, v6, v23, s[66:67]
v_max3_f32 v14, v8, v9, v10
v_max_f32 v36, v14, v11
v_max3_f32 v26, v16, v17, v18
v_max3_f32 v26, v26, v19, v20
v_max3_f32 v26, v26, v21, v22
v_max_f32 v37, v26, v23
s_waitcnt vmcnt(0)
v_cmp_eq_u32 vcc, 0, v232
s_mov_b32 s39, 0
s_cbranch_vccnz L_atk
s_cmp_lt_u32 s38, 2048
s_cbranch_scc0 L_atk
s_mov_b32 s39, 1
L_atk:
s_cmp_ge_u32 s22, 56
s_cbranch_scc1 L_atf
v_cmp_eq_u32 vcc, 0, v231
s_cbranch_vccz L_atm
L_wvat2:
buffer_load_dword v231, v230, s[8:11], s31 offen sc1
s_waitcnt vmcnt(0)
v_cmp_eq_u32 vcc, 0, v231
s_cbranch_vccz L_wvoat2
s_sleep 2
s_add_u32 s21, s21, 1
s_cmp_ge_u32 s21, 4194304
s_cbranch_scc1 L_abort
s_branch L_wvat2
L_wvoat2:
L_atm:
buffer_load_dwordx4 v[136:139], v3, s[8:11], s30 offen
buffer_load_dwordx4 v[140:143], v3, s[8:11], s30 offen offset:512
buffer_load_dwordx4 v[144:147], v3, s[8:11], s30 offen offset:1024
buffer_load_dwordx4 v[148:151], v3, s[8:11], s30 offen offset:1536
buffer_load_dwordx2 v[152:153], v1, s[8:11], s30 offen offset:2048
buffer_load_dwordx2 v[154:155], v1, s[8:11], s30 offen offset:2560
buffer_load_dwordx2 v[156:157], v1, s[8:11], s30 offen offset:3072
buffer_load_dwordx2 v[158:159], v1, s[8:11], s30 offen offset:3584
L_atg:
s_waitcnt vmcnt(7)
v_mfma_f32_16x16x32_bf16 v[12:15], v[136:139], v[40:43], 0
v_mfma_f32_16x16x32_bf16 v[24:27], v[136:139], v[56:59], 0
s_waitcnt vmcnt(6)
v_mfma_f32_16x16x32_bf16 v[12:15], v[140:143], v[44:47], v[12:15]
v_mfma_f32_16x16x32_bf16 v[24:27], v[140:143], v[60:63], v[24:27]
s_waitcnt vmcnt(5)
v_mfma_f32_16x16x32_bf16 v[12:15], v[144:147], v[48:51], v[12:15]
v_mfma_f32_16x16x32_bf16 v[24:27], v[144:147], v[64:67], v[24:27]
s_waitcnt vmcnt(4)
v_mfma_f32_16x16x32_bf16 v[12:15], v[148:151], v[52:55], v[12:15]
v_mfma_f32_16x16x32_bf16 v[24:27], v[148:151], v[68:71], v[24:27]
s_waitcnt vmcnt(0)
s_cmp_eq_u32 s39, 0
s_nop 3
s_cbranch_scc1 L_atn1
s_add_u32 s19, s29, 0
s_add_u32 s20, s29, 4096
buffer_load_dwordx4 v[72:75], v0, s[8:11], s19 offen
buffer_load_dwordx4 v[76:79], v0, s[8:11], s19 offen offset:1024
buffer_load_dwordx4 v[80:83], v0, s[8:11], s19 offen offset:2048
buffer_load_dwordx4 v[84:87], v0, s[8:11], s19 offen offset:3072
buffer_load_dwordx4 v[88:91], v0, s[8:11], s20 offen
buffer_load_dwordx4 v[92:95], v0, s[8:11], s20 offen offset:1024
buffer_load_dwordx4 v[96:99], v0, s[8:11], s20 offen offset:2048
buffer_load_dwordx4 v[100:103], v0, s[8:11], s20 offen offset:3072
s_add_u32 s19, s28, 0
s_add_u32 s20, s28, 4096
buffer_load_dwordx4 v[40:43], v0, s[8:11], s19 offen
buffer_load_dwordx4 v[44:47], v0, s[8:11], s19 offen offset:1024
buffer_load_dwordx4 v[48:51], v0, s[8:11], s19 offen offset:2048
buffer_load_dwordx4 v[52:55], v0, s[8:11], s19 offen offset:3072
buffer_load_dwordx4 v[56:59], v0, s[8:11], s20 offen
buffer_load_dwordx4 v[60:63], v0, s[8:11], s20 offen offset:1024
buffer_load_dwordx4 v[64:67], v0, s[8:11], s20 offen offset:2048
buffer_load_dwordx4 v[68:71], v0, s[8:11], s20 offen offset:3072
L_atn1:
v_cvt_pk_bf16_f32 v28, v12, v13
v_cvt_pk_bf16_f32 v29, v24, v25
v_lshlrev_b32 v12, 16, v28
v_and_b32 v13, s18, v28
v_lshlrev_b32 v24, 16, v29
v_and_b32 v25, s18, v29
v_pk_mul_f32 v[12:13], v[12:13], s[34:35]
v_pk_mul_f32 v[24:25], v[24:25], s[34:35]
v_cvt_pk_bf16_f32 v28, v12, v13
v_cvt_pk_bf16_f32 v29, v24, v25
v_lshlrev_b32 v12, 16, v28
v_and_b32 v13, s18, v28
v_lshlrev_b32 v24, 16, v29
v_and_b32 v25, s18, v29
v_max3_f32 v36, v36, v12, v13
v_max3_f32 v37, v37, v24, v25
v_mov_b32 v38, v36
v_mov_b32 v39, v37
s_nop 0
v_permlane32_swap_b32 v36, v38
v_permlane32_swap_b32 v37, v39
v_max_f32 v36, v36, v38
v_max_f32 v37, v37, v39
v_mov_b32 v38, v36
v_mov_b32 v39, v37
s_nop 0
v_permlane16_swap_b32 v36, v38
v_permlane16_swap_b32 v37, v39
v_max_f32 v36, v36, v38
v_max_f32 v37, v37, v39
v_pk_add_f32 v[8:9], v[8:9], v[36:37] op_sel_hi:[1,0] neg_lo:[0,1] neg_hi:[0,1]
v_pk_add_f32 v[10:11], v[10:11], v[36:37] op_sel_hi:[1,0] neg_lo:[0,1] neg_hi:[0,1]
v_pk_add_f32 v[12:13], v[12:13], v[36:37] op_sel_hi:[1,0] neg_lo:[0,1] neg_hi:[0,1]
v_pk_add_f32 v[16:17], v[16:17], v[36:37] op_sel:[0,1] neg_lo:[0,1] neg_hi:[0,1]
v_pk_add_f32 v[18:19], v[18:19], v[36:37] op_sel:[0,1] neg_lo:[0,1] neg_hi:[0,1]
v_pk_add_f32 v[20:21], v[20:21], v[36:37] op_sel:[0,1] neg_lo:[0,1] neg_hi:[0,1]
v_pk_add_f32 v[22:23], v[22:23], v[36:37] op_sel:[0,1] neg_lo:[0,1] neg_hi:[0,1]
v_pk_add_f32 v[24:25], v[24:25], v[36:37] op_sel:[0,1] neg_lo:[0,1] neg_hi:[0,1]
v_pk_mul_f32 v[8:9], v[8:9], s[36:37]
v_pk_mul_f32 v[10:11], v[10:11], s[36:37]
v_pk_mul_f32 v[12:13], v[12:13], s[36:37]
v_pk_mul_f32 v[16:17], v[16:17], s[36:37]
v_pk_mul_f32 v[18:19], v[18:19], s[36:37]
v_pk_mul_f32 v[20:21], v[20:21], s[36:37]
v_pk_mul_f32 v[22:23], v[22:23], s[36:37]
v_pk_mul_f32 v[24:25], v[24:25], s[36:37]
v_exp_f32 v8, v8
v_exp_f32 v9, v9
v_exp_f32 v10, v10
v_exp_f32 v11, v11
v_exp_f32 v12, v12
v_exp_f32 v13, v13
v_exp_f32 v16, v16
v_exp_f32 v17, v17
v_exp_f32 v18, v18
v_exp_f32 v19, v19
v_exp_f32 v20, v20
v_exp_f32 v21, v21
v_exp_f32 v22, v22
v_exp_f32 v23, v23
v_exp_f32 v24, v24
v_exp_f32 v25, v25
v_pk_add_f32 v[28:29], v[8:9], v[10:11]
v_pk_add_f32 v[30:31], v[16:17], v[18:19]
v_pk_add_f32 v[32:33], v[20:21], v[22:23]
v_pk_add_f32 v[28:29], v[28:29], v[12:13]
v_pk_add_f32 v[30:31], v[30:31], v[24:25]
v_pk_add_f32 v[30:31], v[30:31], v[32:33]
v_add_f32 v36, v28, v29
v_add_f32 v37, v30, v31
v_mov_b32 v38, v36
v_mov_b32 v39, v37
s_nop 0
v_permlane32_swap_b32 v36, v38
v_permlane32_swap_b32 v37, v39
v_add_f32 v36, v36, v38
v_add_f32 v37, v37, v39
v_mov_b32 v38, v36
v_mov_b32 v39, v37
s_nop 0
v_permlane16_swap_b32 v36, v38
v_permlane16_swap_b32 v37, v39
v_add_f32 v36, v36, v38
v_add_f32 v37, v37, v39
v_rcp_f32 v36, v36
v_rcp_f32 v37, v37
s_nop 0
v_pk_mul_f32 v[8:9], v[8:9], v[36:37] op_sel_hi:[1,0]
v_pk_mul_f32 v[10:11], v[10:11], v[36:37] op_sel_hi:[1,0]
v_pk_mul_f32 v[12:13], v[12:13], v[36:37] op_sel_hi:[1,0]
v_pk_mul_f32 v[16:17], v[16:17], v[36:37] op_sel:[0,1]
v_pk_mul_f32 v[18:19], v[18:19], v[36:37] op_sel:[0,1]
v_pk_mul_f32 v[20:21], v[20:21], v[36:37] op_sel:[0,1]
v_pk_mul_f32 v[22:23], v[22:23], v[36:37] op_sel:[0,1]
v_pk_mul_f32 v[24:25], v[24:25], v[36:37] op_sel:[0,1]
v_cvt_pk_bf16_f32 v28, v8, v9
v_cvt_pk_bf16_f32 v29, v10, v11
v_cvt_pk_bf16_f32 v32, v16, v17
v_cvt_pk_bf16_f32 v33, v18, v19
v_cvt_pk_bf16_f32 v34, v20, v21
v_cvt_pk_bf16_f32 v35, v22, v23
v_cvt_pk_bf16_f32 v8, v12, v13
v_cvt_pk_bf16_f32 v12, v24, v25
v_mov_b32 v9, 0
v_mov_b32 v10, 0
v_mov_b32 v11, v8
v_mov_b32 v13, 0
v_mov_b32 v14, 0
v_mov_b32 v15, v12
v_mfma_f32_16x16x16_bf16 v[160:163], v[104:105], v[28:29], 0
v_mfma_f32_16x16x16_bf16 v[164:167], v[108:109], v[28:29], 0
v_mfma_f32_16x16x16_bf16 v[168:171], v[112:113], v[28:29], 0
v_mfma_f32_16x16x16_bf16 v[172:175], v[116:117], v[28:29], 0
v_mfma_f32_16x16x16_bf16 v[176:179], v[120:121], v[28:29], 0
v_mfma_f32_16x16x16_bf16 v[180:183], v[124:125], v[28:29], 0
v_mfma_f32_16x16x16_bf16 v[184:187], v[128:129], v[28:29], 0
v_mfma_f32_16x16x16_bf16 v[188:191], v[132:133], v[28:29], 0
v_mfma_f32_16x16x16_bf16 v[160:163], v[152:153], v[8:9], v[160:163]
v_mfma_f32_16x16x16_bf16 v[164:167], v[152:153], v[10:11], v[164:167]
v_mfma_f32_16x16x16_bf16 v[168:171], v[154:155], v[8:9], v[168:171]
v_mfma_f32_16x16x16_bf16 v[172:175], v[154:155], v[10:11], v[172:175]
v_mfma_f32_16x16x16_bf16 v[176:179], v[156:157], v[8:9], v[176:179]
v_mfma_f32_16x16x16_bf16 v[180:183], v[156:157], v[10:11], v[180:183]
v_mfma_f32_16x16x16_bf16 v[184:187], v[158:159], v[8:9], v[184:187]
v_mfma_f32_16x16x16_bf16 v[188:191], v[158:159], v[10:11], v[188:191]
v_mfma_f32_16x16x32_bf16 v[192:195], v[104:107], v[32:35], 0
v_mfma_f32_16x16x32_bf16 v[196:199], v[108:111], v[32:35], 0
v_mfma_f32_16x16x32_bf16 v[200:203], v[112:115], v[32:35], 0
v_mfma_f32_16x16x32_bf16 v[204:207], v[116:119], v[32:35], 0
v_mfma_f32_16x16x32_bf16 v[208:211], v[120:123], v[32:35], 0
v_mfma_f32_16x16x32_bf16 v[212:215], v[124:127], v[32:35], 0
v_mfma_f32_16x16x32_bf16 v[216:219], v[128:131], v[32:35], 0
v_mfma_f32_16x16x32_bf16 v[220:223], v[132:135], v[32:35], 0
v_mfma_f32_16x16x16_bf16 v[192:195], v[152:153], v[12:13], v[192:195]
v_mfma_f32_16x16x16_bf16 v[196:199], v[152:153], v[14:15], v[196:199]
v_mfma_f32_16x16x16_bf16 v[200:203], v[154:155], v[12:13], v[200:203]
v_mfma_f32_16x16x16_bf16 v[204:207], v[154:155], v[14:15], v[204:207]
v_mfma_f32_16x16x16_bf16 v[208:211], v[156:157], v[12:13], v[208:211]
v_mfma_f32_16x16x16_bf16 v[212:215], v[156:157], v[14:15], v[212:215]
v_mfma_f32_16x16x16_bf16 v[216:219], v[158:159], v[12:13], v[216:219]
v_mfma_f32_16x16x16_bf16 v[220:223], v[158:159], v[14:15], v[220:223]
v_cvt_pk_bf16_f32 v160, v160, v161
v_cvt_pk_bf16_f32 v161, v162, v163
v_cvt_pk_bf16_f32 v162, v164, v165
v_cvt_pk_bf16_f32 v163, v166, v167
buffer_store_dwordx4 v[160:163], v0, s[8:11], s32 offen sc1
v_cvt_pk_bf16_f32 v168, v168, v169
v_cvt_pk_bf16_f32 v169, v170, v171
v_cvt_pk_bf16_f32 v170, v172, v173
v_cvt_pk_bf16_f32 v171, v174, v175
buffer_store_dwordx4 v[168:171], v0, s[8:11], s32 offen offset:1024 sc1
v_cvt_pk_bf16_f32 v176, v176, v177
v_cvt_pk_bf16_f32 v177, v178, v179
v_cvt_pk_bf16_f32 v178, v180, v181
v_cvt_pk_bf16_f32 v179, v182, v183
buffer_store_dwordx4 v[176:179], v0, s[8:11], s32 offen offset:2048 sc1
v_cvt_pk_bf16_f32 v184, v184, v185
v_cvt_pk_bf16_f32 v185, v186, v187
v_cvt_pk_bf16_f32 v186, v188, v189
v_cvt_pk_bf16_f32 v187, v190, v191
buffer_store_dwordx4 v[184:187], v0, s[8:11], s32 offen offset:3072 sc1
s_add_u32 s32, s32, 131072
v_cvt_pk_bf16_f32 v192, v192, v193
v_cvt_pk_bf16_f32 v193, v194, v195
v_cvt_pk_bf16_f32 v194, v196, v197
v_cvt_pk_bf16_f32 v195, v198, v199
buffer_store_dwordx4 v[192:195], v0, s[8:11], s32 offen sc1
v_cvt_pk_bf16_f32 v200, v200, v201
v_cvt_pk_bf16_f32 v201, v202, v203
v_cvt_pk_bf16_f32 v202, v204, v205
v_cvt_pk_bf16_f32 v203, v206, v207
buffer_store_dwordx4 v[200:203], v0, s[8:11], s32 offen offset:1024 sc1
v_cvt_pk_bf16_f32 v208, v208, v209
v_cvt_pk_bf16_f32 v209, v210, v211
v_cvt_pk_bf16_f32 v210, v212, v213
v_cvt_pk_bf16_f32 v211, v214, v215
buffer_store_dwordx4 v[208:211], v0, s[8:11], s32 offen offset:2048 sc1
v_cvt_pk_bf16_f32 v216, v216, v217
v_cvt_pk_bf16_f32 v217, v218, v219
v_cvt_pk_bf16_f32 v218, v220, v221
v_cvt_pk_bf16_f32 v219, v222, v223
buffer_store_dwordx4 v[216:219], v0, s[8:11], s32 offen offset:3072 sc1
s_cmp_eq_u32 s39, 0
s_cbranch_scc1 L_atn2
s_add_u32 s19, s29, 8192
s_add_u32 s20, s29, 12288
buffer_load_dwordx4 v[104:107], v0, s[8:11], s19 offen
buffer_load_dwordx4 v[108:111], v0, s[8:11], s19 offen offset:1024
buffer_load_dwordx4 v[112:115], v0, s[8:11], s19 offen offset:2048
buffer_load_dwordx4 v[116:119], v0, s[8:11], s19 offen offset:3072
buffer_load_dwordx4 v[120:123], v0, s[8:11], s20 offen
buffer_load_dwordx4 v[124:127], v0, s[8:11], s20 offen offset:1024
buffer_load_dwordx4 v[128:131], v0, s[8:11], s20 offen offset:2048
buffer_load_dwordx4 v[132:135], v0, s[8:11], s20 offen offset:3072
s_waitcnt vmcnt(8)
s_branch L_atn3
L_atn2:
s_waitcnt vmcnt(0)
L_atn3:
buffer_store_dword v7, off, s[8:11], s33 sc1
s_cmp_lt_u32 s38, 2048
s_cbranch_scc1 L_at
s_waitcnt vmcnt(0)
s_endpgm
L_atf:
buffer_load_dwordx4 v[136:139], v3, s[8:11], s30 offen sc1
buffer_load_dwordx4 v[140:143], v3, s[8:11], s30 offen offset:512 sc1
buffer_load_dwordx4 v[144:147], v3, s[8:11], s30 offen offset:1024 sc1
buffer_load_dwordx4 v[148:151], v3, s[8:11], s30 offen offset:1536 sc1
buffer_load_dwordx2 v[152:153], v1, s[8:11], s30 offen offset:2048 sc1
buffer_load_dwordx2 v[154:155], v1, s[8:11], s30 offen offset:2560 sc1
buffer_load_dwordx2 v[156:157], v1, s[8:11], s30 offen offset:3072 sc1
buffer_load_dwordx2 v[158:159], v1, s[8:11], s30 offen offset:3584 sc1
s_add_u32 s21, s21, 1
s_cmp_ge_u32 s21, 4194304
s_cbranch_scc1 L_abort
s_waitcnt vmcnt(0)
v_max_u32 v231, v136, v137
v_max3_u32 v231, v231, v138, v139
v_max3_u32 v231, v231, v140, v141
v_max3_u32 v231, v231, v142, v143
v_max3_u32 v231, v231, v144, v145
v_max3_u32 v231, v231, v146, v147
v_max3_u32 v231, v231, v148, v149
v_max3_u32 v231, v231, v150, v151
v_max3_u32 v231, v231, v152, v153
v_max3_u32 v231, v231, v154, v155
v_max3_u32 v231, v231, v156, v157
v_max3_u32 v231, v231, v158, v159
v_cmp_eq_u32 vcc, -1, v231
s_cbranch_vccnz L_atf
s_branch L_atg
L_r_qkv:
v_lshrrev_b32 v3, 3, v2
v_mul_u32_u24 v3, 8192, v3
v_and_b32 v4, 7, v2
v_lshl_add_u32 v3, v4, 4, v3
v_lshrrev_b32 v4, 4, v2
v_bfe_u32 v5, v2, 2, 2
v_and_b32 v6, 3, v2
v_lshlrev_b32 v6, 3, v6
s_lshl_b32 s19, s16, 5
v_add_u32 v6, s19, v6
v_lshlrev_b32 v7, 4, v4
v_add_u32 v8, v7, v5
v_lshl_add_u32 v9, v8, 7, v6
v_add_u32 v9, 65536, v9
v_lshl_add_u32 v8, v8, 10, v6
v_add_u32 v10, 73728, v8
v_add_u32 v11, 73728, v9
s_load_dwordx2 s[4:5], s[0:1], 16
s_waitcnt lgkmcnt(0)
s_mov_b32 s12, s4
s_and_b32 s13, s5, 0xffff
s_mov_b32 s14, 4718592
s_mov_b32 s15, 0x20000
s_mul_i32 s22, s16, 1179648
s_lshl_b32 s19, s17, 7
s_add_u32 s22, s22, s19
s_mul_i32 s23, s16, 18432
s_add_u32 s23, s23, 0
s_mov_b32 m0, s23
s_add_u32 s23, s23, 1024
buffer_load_dwordx4 v3, s[12:15], s22 offen lds
s_add_u32 s22, s22, 65536
s_mov_b32 m0, s23
s_add_u32 s23, s23, 1024
buffer_load_dwordx4 v3, s[12:15], s22 offen lds
s_add_u32 s22, s22, 65536
s_mov_b32 m0, s23
s_add_u32 s23, s23, 1024
buffer_load_dwordx4 v3, s[12:15], s22 offen lds
s_add_u32 s22, s22, 65536
s_mov_b32 m0, s23
s_add_u32 s23, s23, 1024
buffer_load_dwordx4 v3, s[12:15], s22 offen lds
s_add_u32 s22, s22, 65536
s_mov_b32 m0, s23
s_add_u32 s23, s23, 1024
buffer_load_dwordx4 v3, s[12:15], s22 offen lds
s_add_u32 s22, s22, 65536
s_mov_b32 m0, s23
s_add_u32 s23, s23, 1024
buffer_load_dwordx4 v3, s[12:15], s22 offen lds
s_add_u32 s22, s22, 65536
s_mov_b32 m0, s23
s_add_u32 s23, s23, 1024
buffer_load_dwordx4 v3, s[12:15], s22 offen lds
s_add_u32 s22, s22, 65536
s_mov_b32 m0, s23
s_add_u32 s23, s23, 1024
buffer_load_dwordx4 v3, s[12:15], s22 offen lds
s_add_u32 s22, s22, 65536
s_mov_b32 m0, s23
s_add_u32 s23, s23, 1024
buffer_load_dwordx4 v3, s[12:15], s22 offen lds
s_add_u32 s22, s22, 65536
s_mov_b32 m0, s23
s_add_u32 s23, s23, 1024
buffer_load_dwordx4 v3, s[12:15], s22 offen lds
s_add_u32 s22, s22, 65536
s_mov_b32 m0, s23
s_add_u32 s23, s23, 1024
buffer_load_dwordx4 v3, s[12:15], s22 offen lds
s_add_u32 s22, s22, 65536
s_mov_b32 m0, s23
s_add_u32 s23, s23, 1024
buffer_load_dwordx4 v3, s[12:15], s22 offen lds
s_add_u32 s22, s22, 65536
s_mov_b32 m0, s23
s_add_u32 s23, s23, 1024
buffer_load_dwordx4 v3, s[12:15], s22 offen lds
s_add_u32 s22, s22, 65536
s_mov_b32 m0, s23
s_add_u32 s23, s23, 1024
buffer_load_dwordx4 v3, s[12:15], s22 offen lds
s_add_u32 s22, s22, 65536
s_mov_b32 m0, s23
s_add_u32 s23, s23, 1024
buffer_load_dwordx4 v3, s[12:15], s22 offen lds
s_add_u32 s22, s22, 65536
s_mov_b32 m0, s23
s_add_u32 s23, s23, 1024
buffer_load_dwordx4 v3, s[12:15], s22 offen lds
s_add_u32 s22, s22, 65536
s_mov_b32 m0, s23
s_add_u32 s23, s23, 1024
buffer_load_dwordx4 v3, s[12:15], s22 offen lds
s_add_u32 s22, s22, 65536
s_mov_b32 m0, s23
s_add_u32 s23, s23, 1024
buffer_load_dwordx4 v3, s[12:15], s22 offen lds
s_add_u32 s22, s22, 65536
s_load_dwordx2 s[4:5], s[0:1], 24
s_waitcnt lgkmcnt(0)
s_mov_b32 s12, s4
s_and_b32 s13, s5, 0xffff
s_mov_b32 s14, 4718592
s_mov_b32 s15, 0x20000
s_mul_i32 s22, s16, 1179648
s_lshl_b32 s19, s17, 7
s_add_u32 s22, s22, s19
s_mul_i32 s23, s16, 18432
s_add_u32 s23, s23, 73728
s_mov_b32 m0, s23
s_add_u32 s23, s23, 1024
buffer_load_dwordx4 v3, s[12:15], s22 offen lds
s_add_u32 s22, s22, 65536
s_mov_b32 m0, s23
s_add_u32 s23, s23, 1024
buffer_load_dwordx4 v3, s[12:15], s22 offen lds
s_add_u32 s22, s22, 65536
s_mov_b32 m0, s23
s_add_u32 s23, s23, 1024
buffer_load_dwordx4 v3, s[12:15], s22 offen lds
s_add_u32 s22, s22, 65536
s_mov_b32 m0, s23
s_add_u32 s23, s23, 1024
buffer_load_dwordx4 v3, s[12:15], s22 offen lds
s_add_u32 s22, s22, 65536
s_mov_b32 m0, s23
s_add_u32 s23, s23, 1024
buffer_load_dwordx4 v3, s[12:15], s22 offen lds
s_add_u32 s22, s22, 65536
s_mov_b32 m0, s23
s_add_u32 s23, s23, 1024
buffer_load_dwordx4 v3, s[12:15], s22 offen lds
s_add_u32 s22, s22, 65536
s_mov_b32 m0, s23
s_add_u32 s23, s23, 1024
buffer_load_dwordx4 v3, s[12:15], s22 offen lds
s_add_u32 s22, s22, 65536
s_mov_b32 m0, s23
s_add_u32 s23, s23, 1024
buffer_load_dwordx4 v3, s[12:15], s22 offen lds
s_add_u32 s22, s22, 65536
s_mov_b32 m0, s23
s_add_u32 s23, s23, 1024
buffer_load_dwordx4 v3, s[12:15], s22 offen lds
s_add_u32 s22, s22, 65536
s_mov_b32 m0, s23
s_add_u32 s23, s23, 1024
buffer_load_dwordx4 v3, s[12:15], s22 offen lds
s_add_u32 s22, s22, 65536
s_mov_b32 m0, s23
s_add_u32 s23, s23, 1024
buffer_load_dwordx4 v3, s[12:15], s22 offen lds
s_add_u32 s22, s22, 65536
s_mov_b32 m0, s23
s_add_u32 s23, s23, 1024
buffer_load_dwordx4 v3, s[12:15], s22 offen lds
s_add_u32 s22, s22, 65536
s_mov_b32 m0, s23
s_add_u32 s23, s23, 1024
buffer_load_dwordx4 v3, s[12:15], s22 offen lds
s_add_u32 s22, s22, 65536
s_mov_b32 m0, s23
s_add_u32 s23, s23, 1024
buffer_load_dwordx4 v3, s[12:15], s22 offen lds
s_add_u32 s22, s22, 65536
s_mov_b32 m0, s23
s_add_u32 s23, s23, 1024
buffer_load_dwordx4 v3, s[12:15], s22 offen lds
s_add_u32 s22, s22, 65536
s_mov_b32 m0, s23
s_add_u32 s23, s23, 1024
buffer_load_dwordx4 v3, s[12:15], s22 offen lds
s_add_u32 s22, s22, 65536
s_mov_b32 m0, s23
s_add_u32 s23, s23, 1024
buffer_load_dwordx4 v3, s[12:15], s22 offen lds
s_add_u32 s22, s22, 65536
s_mov_b32 m0, s23
s_add_u32 s23, s23, 1024
buffer_load_dwordx4 v3, s[12:15], s22 offen lds
s_add_u32 s22, s22, 65536
s_waitcnt vmcnt(0)
s_barrier
ds_read_b64_tr_b16 a[0:1], v8
ds_read_b64_tr_b16 a[2:3], v8 offset:4096
ds_read_b64_tr_b16 a[4:5], v8 offset:8192
ds_read_b64_tr_b16 a[6:7], v8 offset:12288
ds_read_b64_tr_b16 a[8:9], v8 offset:128
ds_read_b64_tr_b16 a[10:11], v8 offset:4224
ds_read_b64_tr_b16 a[12:13], v8 offset:8320
ds_read_b64_tr_b16 a[14:15], v8 offset:12416
ds_read_b64_tr_b16 a[16:17], v8 offset:256
ds_read_b64_tr_b16 a[18:19], v8 offset:4352
ds_read_b64_tr_b16 a[20:21], v8 offset:8448
ds_read_b64_tr_b16 a[22:23], v8 offset:12544
ds_read_b64_tr_b16 a[24:25], v8 offset:384
ds_read_b64_tr_b16 a[26:27], v8 offset:4480
ds_read_b64_tr_b16 a[28:29], v8 offset:8576
ds_read_b64_tr_b16 a[30:31], v8 offset:12672
ds_read_b64_tr_b16 a[32:33], v8 offset:512
ds_read_b64_tr_b16 a[34:35], v8 offset:4608
ds_read_b64_tr_b16 a[36:37], v8 offset:8704
ds_read_b64_tr_b16 a[38:39], v8 offset:12800
ds_read_b64_tr_b16 a[40:41], v8 offset:640
ds_read_b64_tr_b16 a[42:43], v8 offset:4736
ds_read_b64_tr_b16 a[44:45], v8 offset:8832
ds_read_b64_tr_b16 a[46:47], v8 offset:12928
ds_read_b64_tr_b16 a[48:49], v8 offset:768
ds_read_b64_tr_b16 a[50:51], v8 offset:4864
ds_read_b64_tr_b16 a[52:53], v8 offset:8960
ds_read_b64_tr_b16 a[54:55], v8 offset:13056
ds_read_b64_tr_b16 a[56:57], v8 offset:896
ds_read_b64_tr_b16 a[58:59], v8 offset:4992
ds_read_b64_tr_b16 a[60:61], v8 offset:9088
ds_read_b64_tr_b16 a[62:63], v8 offset:13184
ds_read_b64_tr_b16 a[64:65], v9
ds_read_b64_tr_b16 a[66:67], v9 offset:512
ds_read_b64_tr_b16 a[68:69], v9 offset:1024
ds_read_b64_tr_b16 a[70:71], v9 offset:1536
ds_read_b64_tr_b16 a[72:73], v10
ds_read_b64_tr_b16 a[74:75], v10 offset:4096
ds_read_b64_tr_b16 a[76:77], v10 offset:8192
ds_read_b64_tr_b16 a[78:79], v10 offset:12288
ds_read_b64_tr_b16 a[80:81], v10 offset:128
ds_read_b64_tr_b16 a[82:83], v10 offset:4224
ds_read_b64_tr_b16 a[84:85], v10 offset:8320
ds_read_b64_tr_b16 a[86:87], v10 offset:12416
ds_read_b64_tr_b16 a[88:89], v10 offset:256
ds_read_b64_tr_b16 a[90:91], v10 offset:4352
ds_read_b64_tr_b16 a[92:93], v10 offset:8448
ds_read_b64_tr_b16 a[94:95], v10 offset:12544
ds_read_b64_tr_b16 a[96:97], v10 offset:384
ds_read_b64_tr_b16 a[98:99], v10 offset:4480
ds_read_b64_tr_b16 a[100:101], v10 offset:8576
ds_read_b64_tr_b16 a[102:103], v10 offset:12672
ds_read_b64_tr_b16 a[104:105], v10 offset:512
ds_read_b64_tr_b16 a[106:107], v10 offset:4608
ds_read_b64_tr_b16 a[108:109], v10 offset:8704
ds_read_b64_tr_b16 a[110:111], v10 offset:12800
ds_read_b64_tr_b16 a[112:113], v10 offset:640
ds_read_b64_tr_b16 a[114:115], v10 offset:4736
ds_read_b64_tr_b16 a[116:117], v10 offset:8832
ds_read_b64_tr_b16 a[118:119], v10 offset:12928
ds_read_b64_tr_b16 a[120:121], v10 offset:768
ds_read_b64_tr_b16 a[122:123], v10 offset:4864
ds_read_b64_tr_b16 a[124:125], v10 offset:8960
ds_read_b64_tr_b16 a[126:127], v10 offset:13056
ds_read_b64_tr_b16 a[128:129], v10 offset:896
ds_read_b64_tr_b16 a[130:131], v10 offset:4992
ds_read_b64_tr_b16 a[132:133], v10 offset:9088
ds_read_b64_tr_b16 a[134:135], v10 offset:13184
ds_read_b64_tr_b16 a[136:137], v11
ds_read_b64_tr_b16 a[138:139], v11 offset:512
ds_read_b64_tr_b16 a[140:141], v11 offset:1024
ds_read_b64_tr_b16 a[142:143], v11 offset:1536
s_waitcnt lgkmcnt(0)
s_barrier
s_load_dwordx2 s[4:5], s[0:1], 32
s_waitcnt lgkmcnt(0)
s_mov_b32 s12, s4
s_and_b32 s13, s5, 0xffff
s_mov_b32 s14, 4718592
s_mov_b32 s15, 0x20000
s_mul_i32 s22, s16, 1179648
s_lshl_b32 s19, s17, 7
s_add_u32 s22, s22, s19
s_mul_i32 s23, s16, 18432
s_add_u32 s23, s23, 0
s_mov_b32 m0, s23
s_add_u32 s23, s23, 1024
buffer_load_dwordx4 v3, s[12:15], s22 offen lds
s_add_u32 s22, s22, 65536
s_mov_b32 m0, s23
s_add_u32 s23, s23, 1024
buffer_load_dwordx4 v3, s[12:15], s22 offen lds
s_add_u32 s22, s22, 65536
s_mov_b32 m0, s23
s_add_u32 s23, s23, 1024
buffer_load_dwordx4 v3, s[12:15], s22 offen lds
s_add_u32 s22, s22, 65536
s_mov_b32 m0, s23
s_add_u32 s23, s23, 1024
buffer_load_dwordx4 v3, s[12:15], s22 offen lds
s_add_u32 s22, s22, 65536
s_mov_b32 m0, s23
s_add_u32 s23, s23, 1024
buffer_load_dwordx4 v3, s[12:15], s22 offen lds
s_add_u32 s22, s22, 65536
s_mov_b32 m0, s23
s_add_u32 s23, s23, 1024
buffer_load_dwordx4 v3, s[12:15], s22 offen lds
s_add_u32 s22, s22, 65536
s_mov_b32 m0, s23
s_add_u32 s23, s23, 1024
buffer_load_dwordx4 v3, s[12:15], s22 offen lds
s_add_u32 s22, s22, 65536
s_mov_b32 m0, s23
s_add_u32 s23, s23, 1024
buffer_load_dwordx4 v3, s[12:15], s22 offen lds
s_add_u32 s22, s22, 65536
s_mov_b32 m0, s23
s_add_u32 s23, s23, 1024
buffer_load_dwordx4 v3, s[12:15], s22 offen lds
s_add_u32 s22, s22, 65536
s_mov_b32 m0, s23
s_add_u32 s23, s23, 1024
buffer_load_dwordx4 v3, s[12:15], s22 offen lds
s_add_u32 s22, s22, 65536
s_mov_b32 m0, s23
s_add_u32 s23, s23, 1024
buffer_load_dwordx4 v3, s[12:15], s22 offen lds
s_add_u32 s22, s22, 65536
s_mov_b32 m0, s23
s_add_u32 s23, s23, 1024
buffer_load_dwordx4 v3, s[12:15], s22 offen lds
s_add_u32 s22, s22, 65536
s_mov_b32 m0, s23
s_add_u32 s23, s23, 1024
buffer_load_dwordx4 v3, s[12:15], s22 offen lds
s_add_u32 s22, s22, 65536
s_mov_b32 m0, s23
s_add_u32 s23, s23, 1024
buffer_load_dwordx4 v3, s[12:15], s22 offen lds
s_add_u32 s22, s22, 65536
s_mov_b32 m0, s23
s_add_u32 s23, s23, 1024
buffer_load_dwordx4 v3, s[12:15], s22 offen lds
s_add_u32 s22, s22, 65536
s_mov_b32 m0, s23
s_add_u32 s23, s23, 1024
buffer_load_dwordx4 v3, s[12:15], s22 offen lds
s_add_u32 s22, s22, 65536
s_mov_b32 m0, s23
s_add_u32 s23, s23, 1024
buffer_load_dwordx4 v3, s[12:15], s22 offen lds
s_add_u32 s22, s22, 65536
s_mov_b32 m0, s23
s_add_u32 s23, s23, 1024
buffer_load_dwordx4 v3, s[12:15], s22 offen lds
s_add_u32 s22, s22, 65536
s_waitcnt vmcnt(0)
s_barrier
ds_read_b64_tr_b16 a[144:145], v8
ds_read_b64_tr_b16 a[146:147], v8 offset:4096
ds_read_b64_tr_b16 a[148:149], v8 offset:8192
ds_read_b64_tr_b16 a[150:151], v8 offset:12288
ds_read_b64_tr_b16 a[152:153], v8 offset:128
ds_read_b64_tr_b16 a[154:155], v8 offset:4224
ds_read_b64_tr_b16 a[156:157], v8 offset:8320
ds_read_b64_tr_b16 a[158:159], v8 offset:12416
ds_read_b64_tr_b16 a[160:161], v8 offset:256
ds_read_b64_tr_b16 a[162:163], v8 offset:4352
ds_read_b64_tr_b16 a[164:165], v8 offset:8448
ds_read_b64_tr_b16 a[166:167], v8 offset:12544
ds_read_b64_tr_b16 a[168:169], v8 offset:384
ds_read_b64_tr_b16 a[170:171], v8 offset:4480
ds_read_b64_tr_b16 a[172:173], v8 offset:8576
ds_read_b64_tr_b16 a[174:175], v8 offset:12672
ds_read_b64_tr_b16 a[176:177], v8 offset:512
ds_read_b64_tr_b16 a[178:179], v8 offset:4608
ds_read_b64_tr_b16 a[180:181], v8 offset:8704
ds_read_b64_tr_b16 a[182:183], v8 offset:12800
ds_read_b64_tr_b16 a[184:185], v8 offset:640
ds_read_b64_tr_b16 a[186:187], v8 offset:4736
ds_read_b64_tr_b16 a[188:189], v8 offset:8832
ds_read_b64_tr_b16 a[190:191], v8 offset:12928
ds_read_b64_tr_b16 a[192:193], v8 offset:768
ds_read_b64_tr_b16 a[194:195], v8 offset:4864
ds_read_b64_tr_b16 a[196:197], v8 offset:8960
ds_read_b64_tr_b16 a[198:199], v8 offset:13056
ds_read_b64_tr_b16 a[200:201], v8 offset:896
ds_read_b64_tr_b16 a[202:203], v8 offset:4992
ds_read_b64_tr_b16 a[204:205], v8 offset:9088
ds_read_b64_tr_b16 a[206:207], v8 offset:13184
ds_read_b64_tr_b16 a[208:209], v9
ds_read_b64_tr_b16 a[210:211], v9 offset:512
ds_read_b64_tr_b16 a[212:213], v9 offset:1024
ds_read_b64_tr_b16 a[214:215], v9 offset:1536
s_waitcnt lgkmcnt(0)
s_barrier
v_lshrrev_b32 v4, 4, v2
v_and_b32 v5, 15, v2
v_and_b32 v6, 1, v4
v_lshlrev_b32 v6, 12, v6
v_lshrrev_b32 v7, 1, v4
v_lshl_add_u32 v6, v7, 8, v6
v_lshl_add_u32 v3, v5, 4, v6
v_and_b32 v6, 1, v4
v_lshlrev_b32 v6, 3, v6
v_lshl_add_u32 v6, v7, 7, v6
v_lshrrev_b32 v7, 2, v5
v_lshl_add_u32 v6, v7, 5, v6
v_and_b32 v7, 1, v5
v_lshl_add_u32 v6, v7, 4, v6
v_and_b32 v7, 2, v5
v_lshl_add_u32 v4, v7, 29, v6
v_and_b32 v5, 0xffffffdf, v0
v_lshlrev_b32 v6, 3, v2
v_mov_b32 v7, 1
s_and_b32 s19, s17, 1
s_lshl_b32 s19, s19, 2
s_add_u32 s38, s19, s16
s_lshr_b32 s39, s17, 1
s_lshl_b32 s28, s39, 13
s_lshl_b32 s19, s38, 9
s_add_u32 s28, s28, s19
s_add_u32 s28, s28, 67108864
s_lshl_b32 s29, s39, 14
s_add_u32 s29, s29, s19
s_add_u32 s29, s29, 33554432
s_lshl_b32 s30, s17, 4
s_lshl_b32 s19, s16, 2
s_add_u32 s30, s30, s19
s_add_u32 s31, s30, 65536
s_add_u32 s30, s30, 0
s_mov_b32 s56, 1073741824
s_mov_b32 s34, 1073741824
s_lshl_b32 s36, s39, 12
s_add_u32 s36, s36, 16777216
s_mov_b32 s35, 262208
s_mov_b32 s22, 0
s_mov_b32 s23, 0
s_mov_b32 s32, 0
s_mov_b32 s33, 253952
s_mov_b32 s37, 2097152
s_cmp_eq_u32 s16, 0
s_cbranch_scc0 L_wdoq0
v_mov_b32 v8, 0
L_wd0q0:
global_load_dword v9, v8, s[6:7] offset:192 sc1
s_waitcnt vmcnt(0)
v_cmp_gt_u32 vcc, 16, v9
s_cbranch_vccz L_wdn0q0
s_sleep 24
s_add_u32 s21, s21, 1
s_cmp_ge_u32 s21, 4194304
s_cbranch_scc1 L_abort
s_branch L_wd0q0
L_wdn0q0:
L_wdoq0:
s_barrier
v_min_u32 v160, 7, v2
v_lshlrev_b32 v160, 2, v160
L_wvq1:
buffer_load_dword v162, v160, s[8:11], s33 offen sc1
s_waitcnt vmcnt(0)
v_cmp_eq_u32 vcc, 0, v162
s_cbranch_vccz L_wvoq1
s_sleep 4
s_add_u32 s21, s21, 1
s_cmp_ge_u32 s21, 4194304
s_cbranch_scc1 L_abort
s_branch L_wvq1
L_wvoq1:
s_and_b32 s19, s16, 1
s_mul_i32 s19, s19, 18432
s_lshr_b32 s20, s16, 1
s_lshl_b32 s20, s20, 10
s_add_u32 s19, s19, s20
s_add_u32 s20, s19, s32
s_add_u32 s19, s19, s37
s_mov_b32 m0, s20
s_add_u32 s20, s20, 2048
buffer_load_dwordx4 v0, s[8:11], s19 offen lds
s_add_u32 s19, s19, 2048
s_mov_b32 m0, s20
s_add_u32 s20, s20, 2048
buffer_load_dwordx4 v0, s[8:11], s19 offen lds
s_add_u32 s19, s19, 2048
s_mov_b32 m0, s20
s_add_u32 s20, s20, 2048
buffer_load_dwordx4 v0, s[8:11], s19 offen lds
s_add_u32 s19, s19, 2048
s_mov_b32 m0, s20
s_add_u32 s20, s20, 2048
buffer_load_dwordx4 v0, s[8:11], s19 offen lds
s_add_u32 s19, s19, 2048
s_mov_b32 m0, s20
s_add_u32 s20, s20, 2048
buffer_load_dwordx4 v0, s[8:11], s19 offen lds
s_add_u32 s19, s19, 2048
s_mov_b32 m0, s20
s_add_u32 s20, s20, 2048
buffer_load_dwordx4 v0, s[8:11], s19 offen lds
s_add_u32 s19, s19, 2048
s_mov_b32 m0, s20
s_add_u32 s20, s20, 2048
buffer_load_dwordx4 v0, s[8:11], s19 offen lds
s_add_u32 s19, s19, 2048
s_mov_b32 m0, s20
s_add_u32 s20, s20, 2048
buffer_load_dwordx4 v0, s[8:11], s19 offen lds
s_add_u32 s19, s19, 2048
s_mov_b32 m0, s20
s_add_u32 s20, s20, 2048
buffer_load_dwordx4 v0, s[8:11], s19 offen lds
s_add_u32 s19, s19, 2048
buffer_load_dword v163, v160, s[8:11], s33 offen offset:32 sc1
v_mov_b32 v166, 0
v_mov_b32 v164, 92160
s_lshl_b32 s19, s16, 2
v_add_u32 v161, s19, v164
v_add_u32 v165, 73728, v5
ds_write_b32 v161, v166
s_mov_b32 s59, 1073741824
s_mov_b32 s62, 1073741824
s_mov_b32 s63, 1073741824
s_mov_b32 s61, 0
s_mov_b32 s57, 1073741824
s_waitcnt vmcnt(0) lgkmcnt(0)
v_min_u32 v184, 8, v2
v_lshlrev_b32 v184, 10, v184
v_add_u32 v184, 1020, v184
s_mov_b32 s70, 0
L_qx:
s_barrier
ds_read_b128 v[168:171], v164
v_xor_b32 v164, 16, v164
v_xor_b32 v161, 16, v161
v_add_u32 v1, s32, v0
s_sub_u32 s32, 36864, s32
s_add_u32 s33, s33, 32
s_add_u32 s37, s37, 36864
s_cmp_lt_u32 s22, 63
s_cbranch_scc0 L_qpf
v_cmp_eq_u32 vcc, 0, v163
s_cbranch_vccz L_qpf
L_wvq2:
buffer_load_dword v162, v160, s[8:11], s33 offen sc1
s_waitcnt vmcnt(0)
v_cmp_eq_u32 vcc, 0, v162
s_cbranch_vccz L_wvoq2
s_sleep 8
s_add_u32 s21, s21, 1
s_cmp_ge_u32 s21, 4194304
s_cbranch_scc1 L_abort
s_branch L_wvq2
L_wvoq2:
L_qpf:
ds_read_b128 v[40:43], v1
ds_read_b128 v[44:47], v1 offset:18432
ds_read_b128 v[48:51], v1 offset:1024
ds_read_b128 v[52:55], v1 offset:19456
ds_read_b128 v[56:59], v1 offset:2048
ds_read_b128 v[60:63], v1 offset:20480
s_waitcnt lgkmcnt(4)
v_mfma_f32_16x16x32_bf16 v[8:11], a[0:3], v[40:43], 0
ds_read_b128 v[64:67], v1 offset:3072
ds_read_b128 v[68:71], v1 offset:21504
v_mfma_f32_16x16x32_bf16 v[12:15], a[0:3], v[44:47], 0
buffer_load_dword v163, v160, s[8:11], s33 offen offset:32 sc1
v_min_u32 v168, v168, v169
v_min3_u32 v168, v168, v170, v171
s_nop 0
v_readfirstlane_b32 s19, v168
s_nop 0
s_add_u32 s61, s61, s19
s_mul_i32 s19, s61, 9216
s_add_u32 s19, s19, 12648448
s_nop 0
buffer_load_dword v185, v184, s[8:11], s19 offen sc1
v_mfma_f32_16x16x32_bf16 v[16:19], a[72:75], v[40:43], 0
v_mfma_f32_16x16x32_bf16 v[20:23], a[72:75], v[44:47], 0
s_and_b32 s64, s16, 1
s_mul_i32 s64, s64, 18432
s_lshr_b32 s65, s16, 1
s_lshl_b32 s65, s65, 10
s_add_u32 s64, s64, s65
s_add_u32 s65, s64, s32
s_add_u32 s64, s64, s37
s_mov_b32 m0, s65
s_add_u32 s65, s65, 2048
buffer_load_dwordx4 v0, s[8:11], s64 offen lds
s_add_u32 s64, s64, 2048
v_mfma_f32_16x16x32_bf16 v[24:27], v[40:43], a[144:147], 0
v_mfma_f32_16x16x32_bf16 v[28:31], v[44:47], a[144:147], 0
s_waitcnt lgkmcnt(4)
v_mfma_f32_16x16x32_bf16 v[8:11], a[4:7], v[48:51], v[8:11]
ds_read_b128 v[40:43], v1 offset:4096
ds_read_b128 v[44:47], v1 offset:22528
v_mfma_f32_16x16x32_bf16 v[12:15], a[4:7], v[52:55], v[12:15]
v_mfma_f32_16x16x32_bf16 v[16:19], a[76:79], v[48:51], v[16:19]
v_mfma_f32_16x16x32_bf16 v[20:23], a[76:79], v[52:55], v[20:23]
s_mov_b32 m0, s65
s_add_u32 s65, s65, 2048
buffer_load_dwordx4 v0, s[8:11], s64 offen lds
s_add_u32 s64, s64, 2048
v_mfma_f32_16x16x32_bf16 v[24:27], v[48:51], a[148:151], v[24:27]
v_mfma_f32_16x16x32_bf16 v[28:31], v[52:55], a[148:151], v[28:31]
s_waitcnt lgkmcnt(4)
v_mfma_f32_16x16x32_bf16 v[8:11], a[8:11], v[56:59], v[8:11]
ds_read_b128 v[48:51], v1 offset:5120
ds_read_b128 v[52:55], v1 offset:23552
v_mfma_f32_16x16x32_bf16 v[12:15], a[8:11], v[60:63], v[12:15]
v_mfma_f32_16x16x32_bf16 v[16:19], a[80:83], v[56:59], v[16:19]
v_mfma_f32_16x16x32_bf16 v[20:23], a[80:83], v[60:63], v[20:23]
s_mov_b32 m0, s65
s_add_u32 s65, s65, 2048
buffer_load_dwordx4 v0, s[8:11], s64 offen lds
s_add_u32 s64, s64, 2048
v_mfma_f32_16x16x32_bf16 v[24:27], v[56:59], a[152:155], v[24:27]
v_mfma_f32_16x16x32_bf16 v[28:31], v[60:63], a[152:155], v[28:31]
s_waitcnt lgkmcnt(4)
v_mfma_f32_16x16x32_bf16 v[8:11], a[12:15], v[64:67], v[8:11]
ds_read_b128 v[56:59], v1 offset:6144
ds_read_b128 v[60:63], v1 offset:24576
v_mfma_f32_16x16x32_bf16 v[12:15], a[12:15], v[68:71], v[12:15]
v_mfma_f32_16x16x32_bf16 v[16:19], a[84:87], v[64:67], v[16:19]
v_mfma_f32_16x16x32_bf16 v[20:23], a[84:87], v[68:71], v[20:23]
s_mov_b32 m0, s65
s_add_u32 s65, s65, 2048
buffer_load_dwordx4 v0, s[8:11], s64 offen lds
s_add_u32 s64, s64, 2048
v_mfma_f32_16x16x32_bf16 v[24:27], v[64:67], a[156:159], v[24:27]
v_mfma_f32_16x16x32_bf16 v[28:31], v[68:71], a[156:159], v[28:31]
s_waitcnt lgkmcnt(4)
v_mfma_f32_16x16x32_bf16 v[8:11], a[16:19], v[40:43], v[8:11]
ds_read_b128 v[64:67], v1 offset:7168
ds_read_b128 v[68:71], v1 offset:25600
v_mfma_f32_16x16x32_bf16 v[12:15], a[16:19], v[44:47], v[12:15]
v_mfma_f32_16x16x32_bf16 v[16:19], a[88:91], v[40:43], v[16:19]
v_mfma_f32_16x16x32_bf16 v[20:23], a[88:91], v[44:47], v[20:23]
s_mov_b32 m0, s65
s_add_u32 s65, s65, 2048
buffer_load_dwordx4 v0, s[8:11], s64 offen lds
s_add_u32 s64, s64, 2048
v_mfma_f32_16x16x32_bf16 v[24:27], v[40:43], a[160:163], v[24:27]
v_mfma_f32_16x16x32_bf16 v[28:31], v[44:47], a[160:163], v[28:31]
s_waitcnt lgkmcnt(4)
v_mfma_f32_16x16x32_bf16 v[8:11], a[20:23], v[48:51], v[8:11]
ds_read_b128 v[40:43], v1 offset:8192
ds_read_b128 v[44:47], v1 offset:26624
v_mfma_f32_16x16x32_bf16 v[12:15], a[20:23], v[52:55], v[12:15]
v_mfma_f32_16x16x32_bf16 v[16:19], a[92:95], v[48:51], v[16:19]
v_mfma_f32_16x16x32_bf16 v[20:23], a[92:95], v[52:55], v[20:23]
s_mov_b32 m0, s65
s_add_u32 s65, s65, 2048
buffer_load_dwordx4 v0, s[8:11], s64 offen lds
s_add_u32 s64, s64, 2048
v_mfma_f32_16x16x32_bf16 v[24:27], v[48:51], a[164:167], v[24:27]
v_mfma_f32_16x16x32_bf16 v[28:31], v[52:55], a[164:167], v[28:31]
s_waitcnt lgkmcnt(4)
v_mfma_f32_16x16x32_bf16 v[8:11], a[24:27], v[56:59], v[8:11]
ds_read_b128 v[48:51], v1 offset:9216
ds_read_b128 v[52:55], v1 offset:27648
v_mfma_f32_16x16x32_bf16 v[12:15], a[24:27], v[60:63], v[12:15]
s_waitcnt vmcnt(6)
v_cmp_eq_u32 vcc, -1, v185
s_cmp_lt_u32 s61, 62
s_cselect_b32 s71, 1, 0
s_cmp_eq_u32 s70, 0
s_cselect_b32 s71, s71, 0
v_mfma_f32_16x16x32_bf16 v[16:19], a[96:99], v[56:59], v[16:19]
v_mfma_f32_16x16x32_bf16 v[20:23], a[96:99], v[60:63], v[20:23]
s_mov_b32 m0, s65
s_add_u32 s65, s65, 2048
buffer_load_dwordx4 v0, s[8:11], s64 offen lds
s_add_u32 s64, s64, 2048
v_mfma_f32_16x16x32_bf16 v[24:27], v[56:59], a[168:171], v[24:27]
v_mfma_f32_16x16x32_bf16 v[28:31], v[60:63], a[168:171], v[28:31]
s_cmp_eq_u64 vcc, 0
s_cselect_b32 s71, s71, 0
s_waitcnt lgkmcnt(4)
v_mfma_f32_16x16x32_bf16 v[8:11], a[28:31], v[64:67], v[8:11]
ds_read_b128 v[56:59], v1 offset:10240
ds_read_b128 v[60:63], v1 offset:28672
v_mfma_f32_16x16x32_bf16 v[12:15], a[28:31], v[68:71], v[12:15]
s_mul_i32 s67, s61, 9216
s_add_u32 s67, s67, 12648448
s_cmp_eq_u32 s71, 0
s_cselect_b32 s67, 1073741824, s67
s_and_b32 s68, s61, 1
s_mul_i32 s68, s68, 9216
s_add_u32 s68, s68, 73728
v_mfma_f32_16x16x32_bf16 v[16:19], a[100:103], v[64:67], v[16:19]
v_mfma_f32_16x16x32_bf16 v[20:23], a[100:103], v[68:71], v[20:23]
s_mov_b32 m0, s65
s_add_u32 s65, s65, 2048
buffer_load_dwordx4 v0, s[8:11], s64 offen lds
s_add_u32 s64, s64, 2048
v_mfma_f32_16x16x32_bf16 v[24:27], v[64:67], a[172:175], v[24:27]
v_mfma_f32_16x16x32_bf16 v[28:31], v[68:71], a[172:175], v[28:31]
s_add_u32 s19, s68, 8192
s_mov_b32 m0, s19
s_add_u32 s19, s67, 8192
buffer_load_dwordx4 v0, s[8:11], s19 offen lds
s_lshl_b32 s19, s16, 10
s_add_u32 s67, s67, s19
s_waitcnt lgkmcnt(4)
v_mfma_f32_16x16x32_bf16 v[8:11], a[32:35], v[40:43], v[8:11]
ds_read_b128 v[64:67], v1 offset:11264
ds_read_b128 v[68:71], v1 offset:29696
v_mfma_f32_16x16x32_bf16 v[12:15], a[32:35], v[44:47], v[12:15]
s_add_u32 s69, s68, s19
s_mov_b32 m0, s69
s_add_u32 s69, s69, 4096
buffer_load_dwordx4 v0, s[8:11], s67 offen lds
v_mfma_f32_16x16x32_bf16 v[16:19], a[104:107], v[40:43], v[16:19]
v_mfma_f32_16x16x32_bf16 v[20:23], a[104:107], v[44:47], v[20:23]
s_mov_b32 m0, s65
s_add_u32 s65, s65, 2048
buffer_load_dwordx4 v0, s[8:11], s64 offen lds
s_add_u32 s64, s64, 2048
v_mfma_f32_16x16x32_bf16 v[24:27], v[40:43], a[176:179], v[24:27]
v_mfma_f32_16x16x32_bf16 v[28:31], v[44:47], a[176:179], v[28:31]
s_mov_b32 m0, s69
s_add_u32 s67, s67, 4096
buffer_load_dwordx4 v0, s[8:11], s67 offen lds
s_waitcnt lgkmcnt(4)
v_mfma_f32_16x16x32_bf16 v[8:11], a[36:39], v[48:51], v[8:11]
ds_read_b128 v[40:43], v1 offset:12288
ds_read_b128 v[44:47], v1 offset:30720
v_mfma_f32_16x16x32_bf16 v[12:15], a[36:39], v[52:55], v[12:15]
buffer_store_dword v7, off, s[8:11], s34 sc1
s_mov_b32 s34, 1073741824
buffer_store_dword v7, off, s[8:11], s57 sc1
s_mov_b32 s57, s56
v_mfma_f32_16x16x32_bf16 v[16:19], a[108:111], v[48:51], v[16:19]
v_mfma_f32_16x16x32_bf16 v[20:23], a[108:111], v[52:55], v[20:23]
v_mfma_f32_16x16x32_bf16 v[24:27], v[48:51], a[180:183], v[24:27]
v_mfma_f32_16x16x32_bf16 v[28:31], v[52:55], a[180:183], v[28:31]
s_waitcnt lgkmcnt(4)
v_mfma_f32_16x16x32_bf16 v[8:11], a[40:43], v[56:59], v[8:11]
ds_read_b128 v[48:51], v1 offset:13312
ds_read_b128 v[52:55], v1 offset:31744
v_mfma_f32_16x16x32_bf16 v[12:15], a[40:43], v[60:63], v[12:15]
buffer_store_dwordx4 v[76:79], v3, s[8:11], s63 offen sc1
v_mfma_f32_16x16x32_bf16 v[16:19], a[112:115], v[56:59], v[16:19]
v_mfma_f32_16x16x32_bf16 v[20:23], a[112:115], v[60:63], v[20:23]
v_mfma_f32_16x16x32_bf16 v[24:27], v[56:59], a[184:187], v[24:27]
v_mfma_f32_16x16x32_bf16 v[28:31], v[60:63], a[184:187], v[28:31]
s_waitcnt lgkmcnt(4)
v_mfma_f32_16x16x32_bf16 v[8:11], a[44:47], v[64:67], v[8:11]
ds_read_b128 v[56:59], v1 offset:14336
ds_read_b128 v[60:63], v1 offset:32768
v_mfma_f32_16x16x32_bf16 v[12:15], a[44:47], v[68:71], v[12:15]
v_mfma_f32_16x16x32_bf16 v[16:19], a[116:119], v[64:67], v[16:19]
v_mfma_f32_16x16x32_bf16 v[20:23], a[116:119], v[68:71], v[20:23]
v_mfma_f32_16x16x32_bf16 v[24:27], v[64:67], a[188:191], v[24:27]
v_mfma_f32_16x16x32_bf16 v[28:31], v[68:71], a[188:191], v[28:31]
s_waitcnt lgkmcnt(4)
v_mfma_f32_16x16x32_bf16 v[8:11], a[48:51], v[40:43], v[8:11]
ds_read_b128 v[64:67], v1 offset:15360
ds_read_b128 v[68:71], v1 offset:33792
v_mfma_f32_16x16x32_bf16 v[12:15], a[48:51], v[44:47], v[12:15]
v_mfma_f32_16x16x32_bf16 v[16:19], a[120:123], v[40:43], v[16:19]
v_mfma_f32_16x16x32_bf16 v[20:23], a[120:123], v[44:47], v[20:23]
v_mov_b32 v166, s71
ds_write_b32 v161, v166
v_mfma_f32_16x16x32_bf16 v[24:27], v[40:43], a[192:195], v[24:27]
v_mfma_f32_16x16x32_bf16 v[28:31], v[44:47], a[192:195], v[28:31]
s_waitcnt lgkmcnt(4)
v_mfma_f32_16x16x32_bf16 v[8:11], a[52:55], v[48:51], v[8:11]
ds_read_b128 v[40:43], v1 offset:16384
ds_read_b128 v[44:47], v1 offset:34816
v_mfma_f32_16x16x32_bf16 v[12:15], a[52:55], v[52:55], v[12:15]
buffer_store_dwordx4 v[80:83], v0, s[8:11], s59 offen sc1
v_mfma_f32_16x16x32_bf16 v[16:19], a[124:127], v[48:51], v[16:19]
v_mfma_f32_16x16x32_bf16 v[20:23], a[124:127], v[52:55], v[20:23]
v_mfma_f32_16x16x32_bf16 v[24:27], v[48:51], a[196:199], v[24:27]
v_mfma_f32_16x16x32_bf16 v[28:31], v[52:55], a[196:199], v[28:31]
s_waitcnt lgkmcnt(4)
v_mfma_f32_16x16x32_bf16 v[8:11], a[56:59], v[56:59], v[8:11]
ds_read_b128 v[48:51], v1 offset:17408
ds_read_b128 v[52:55], v1 offset:35840
v_mfma_f32_16x16x32_bf16 v[12:15], a[56:59], v[60:63], v[12:15]
v_mfma_f32_16x16x32_bf16 v[16:19], a[128:131], v[56:59], v[16:19]
v_mfma_f32_16x16x32_bf16 v[20:23], a[128:131], v[60:63], v[20:23]
v_mfma_f32_16x16x32_bf16 v[24:27], v[56:59], a[200:203], v[24:27]
v_mfma_f32_16x16x32_bf16 v[28:31], v[60:63], a[200:203], v[28:31]
s_waitcnt lgkmcnt(4)
v_mfma_f32_16x16x32_bf16 v[8:11], a[60:63], v[64:67], v[8:11]
v_mfma_f32_16x16x32_bf16 v[12:15], a[60:63], v[68:71], v[12:15]
v_mfma_f32_16x16x32_bf16 v[16:19], a[132:135], v[64:67], v[16:19]
v_mfma_f32_16x16x32_bf16 v[20:23], a[132:135], v[68:71], v[20:23]
v_mfma_f32_16x16x32_bf16 v[24:27], v[64:67], a[204:207], v[24:27]
v_mfma_f32_16x16x32_bf16 v[28:31], v[68:71], a[204:207], v[28:31]
s_waitcnt lgkmcnt(2)
v_mfma_f32_16x16x32_bf16 v[8:11], a[64:67], v[40:43], v[8:11]
v_mfma_f32_16x16x32_bf16 v[12:15], a[64:67], v[44:47], v[12:15]
buffer_store_dwordx4 v[72:75], v3, s[8:11], s62 offen sc1
v_mfma_f32_16x16x32_bf16 v[16:19], a[136:139], v[40:43], v[16:19]
v_mfma_f32_16x16x32_bf16 v[20:23], a[136:139], v[44:47], v[20:23]
v_mfma_f32_16x16x32_bf16 v[24:27], v[40:43], a[208:211], v[24:27]
v_mfma_f32_16x16x32_bf16 v[28:31], v[44:47], a[208:211], v[28:31]
s_waitcnt lgkmcnt(0)
v_mfma_f32_16x16x32_bf16 v[8:11], a[68:71], v[48:51], v[8:11]
v_mfma_f32_16x16x32_bf16 v[12:15], a[68:71], v[52:55], v[12:15]
v_mfma_f32_16x16x32_bf16 v[16:19], a[140:143], v[48:51], v[16:19]
v_mfma_f32_16x16x32_bf16 v[20:23], a[140:143], v[52:55], v[20:23]
v_mfma_f32_16x16x32_bf16 v[24:27], v[48:51], a[212:215], v[24:27]
v_mfma_f32_16x16x32_bf16 v[28:31], v[52:55], a[212:215], v[28:31]
s_waitcnt vmcnt(5)
s_mov_b32 s56, s30
s_add_u32 s30, s30, 1024
v_cvt_pk_bf16_f32 v72, v8, v9
v_cvt_pk_bf16_f32 v73, v10, v11
v_cvt_pk_bf16_f32 v74, v12, v13
v_cvt_pk_bf16_f32 v75, v14, v15
s_nop 0
v_permlane16_swap_b32 v72, v74
v_permlane16_swap_b32 v73, v75
v_cvt_pk_bf16_f32 v76, v16, v17
v_cvt_pk_bf16_f32 v77, v18, v19
v_cvt_pk_bf16_f32 v78, v20, v21
v_cvt_pk_bf16_f32 v79, v22, v23
s_nop 0
v_permlane16_swap_b32 v76, v78
v_permlane16_swap_b32 v77, v79
v_cvt_pk_bf16_f32 v80, v24, v25
v_cvt_pk_bf16_f32 v81, v26, v27
v_cvt_pk_bf16_f32 v82, v28, v29
v_cvt_pk_bf16_f32 v83, v30, v31
s_mov_b32 s62, s28
s_mov_b32 s63, s29
s_lshl_b32 s19, s38, 9
s_add_u32 s19, s19, s29
s_add_u32 s59, s19, 8192
s_add_u32 s28, s28, 262144
s_add_u32 s29, s29, 524288
s_add_u32 s22, s22, 1
s_cmp_le_u32 s22, 4
s_cbranch_scc1 L_qfast
L_qfb:
s_cmp_lt_u32 s23, s61
s_cbranch_scc0 L_qnom
s_cmp_eq_u32 s23, 40
s_cbranch_scc0 L_qpx
v_mov_b32 v88, 0
L_qqx:
global_load_dword v89, v88, s[6:7] offset:104 sc1
s_waitcnt vmcnt(0)
v_cmp_gt_u32 vcc, 28, v89
s_cbranch_vccz L_qpx
s_add_u32 s21, s21, 1
s_cmp_ge_u32 s21, 4194304
s_cbranch_scc1 L_abort
s_branch L_qqx
L_qpx:
s_and_b32 s19, s23, 1
s_mul_i32 s19, s19, 9216
v_add_u32 v167, s19, v165
ds_read_b128 v[88:91], v167
ds_read_b128 v[92:95], v167 offset:32
ds_read_b128 v[96:99], v167 offset:1024
ds_read_b128 v[100:103], v167 offset:1056
ds_read_b128 v[104:107], v167 offset:2048
ds_read_b128 v[108:111], v167 offset:2080
s_waitcnt lgkmcnt(5)
v_mfma_f32_16x16x32_bf16 v[32:35], a[72:75], v[88:91], 0
v_mfma_f32_16x16x32_bf16 v[36:39], v[88:91], a[144:147], 0
ds_read_b128 v[112:115], v167 offset:3072
s_waitcnt lgkmcnt(5)
v_mfma_f32_16x16x32_bf16 v[32:35], a[76:79], v[92:95], v[32:35]
v_mfma_f32_16x16x32_bf16 v[36:39], v[92:95], a[148:151], v[36:39]
ds_read_b128 v[116:119], v167 offset:3104
s_waitcnt lgkmcnt(5)
v_mfma_f32_16x16x32_bf16 v[32:35], a[80:83], v[96:99], v[32:35]
v_mfma_f32_16x16x32_bf16 v[36:39], v[96:99], a[152:155], v[36:39]
ds_read_b128 v[120:123], v167 offset:4096
s_waitcnt lgkmcnt(5)
v_mfma_f32_16x16x32_bf16 v[32:35], a[84:87], v[100:103], v[32:35]
v_mfma_f32_16x16x32_bf16 v[36:39], v[100:103], a[156:159], v[36:39]
ds_read_b128 v[124:127], v167 offset:4128
s_waitcnt lgkmcnt(5)
v_mfma_f32_16x16x32_bf16 v[32:35], a[88:91], v[104:107], v[32:35]
v_mfma_f32_16x16x32_bf16 v[36:39], v[104:107], a[160:163], v[36:39]
ds_read_b128 v[128:131], v167 offset:5120
s_waitcnt lgkmcnt(5)
v_mfma_f32_16x16x32_bf16 v[32:35], a[92:95], v[108:111], v[32:35]
v_mfma_f32_16x16x32_bf16 v[36:39], v[108:111], a[164:167], v[36:39]
ds_read_b128 v[132:135], v167 offset:5152
s_waitcnt lgkmcnt(5)
v_mfma_f32_16x16x32_bf16 v[32:35], a[96:99], v[112:115], v[32:35]
v_mfma_f32_16x16x32_bf16 v[36:39], v[112:115], a[168:171], v[36:39]
ds_read_b128 v[136:139], v167 offset:6144
s_waitcnt lgkmcnt(5)
v_mfma_f32_16x16x32_bf16 v[32:35], a[100:103], v[116:119], v[32:35]
v_mfma_f32_16x16x32_bf16 v[36:39], v[116:119], a[172:175], v[36:39]
ds_read_b128 v[140:143], v167 offset:6176
s_waitcnt lgkmcnt(5)
v_mfma_f32_16x16x32_bf16 v[32:35], a[104:107], v[120:123], v[32:35]
v_mfma_f32_16x16x32_bf16 v[36:39], v[120:123], a[176:179], v[36:39]
ds_read_b128 v[144:147], v167 offset:7168
s_waitcnt lgkmcnt(5)
v_mfma_f32_16x16x32_bf16 v[32:35], a[108:111], v[124:127], v[32:35]
v_mfma_f32_16x16x32_bf16 v[36:39], v[124:127], a[180:183], v[36:39]
ds_read_b128 v[148:151], v167 offset:7200
s_waitcnt lgkmcnt(5)
v_mfma_f32_16x16x32_bf16 v[32:35], a[112:115], v[128:131], v[32:35]
v_mfma_f32_16x16x32_bf16 v[36:39], v[128:131], a[184:187], v[36:39]
ds_read_b128 v[152:155], v167 offset:8192
s_waitcnt lgkmcnt(5)
v_mfma_f32_16x16x32_bf16 v[32:35], a[116:119], v[132:135], v[32:35]
v_mfma_f32_16x16x32_bf16 v[36:39], v[132:135], a[188:191], v[36:39]
ds_read_b128 v[156:159], v167 offset:8224
s_waitcnt lgkmcnt(5)
v_mfma_f32_16x16x32_bf16 v[32:35], a[120:123], v[136:139], v[32:35]
v_mfma_f32_16x16x32_bf16 v[36:39], v[136:139], a[192:195], v[36:39]
s_waitcnt lgkmcnt(4)
v_mfma_f32_16x16x32_bf16 v[32:35], a[124:127], v[140:143], v[32:35]
v_mfma_f32_16x16x32_bf16 v[36:39], v[140:143], a[196:199], v[36:39]
s_waitcnt lgkmcnt(3)
v_mfma_f32_16x16x32_bf16 v[32:35], a[128:131], v[144:147], v[32:35]
v_mfma_f32_16x16x32_bf16 v[36:39], v[144:147], a[200:203], v[36:39]
s_waitcnt lgkmcnt(2)
v_mfma_f32_16x16x32_bf16 v[32:35], a[132:135], v[148:151], v[32:35]
v_mfma_f32_16x16x32_bf16 v[36:39], v[148:151], a[204:207], v[36:39]
s_waitcnt lgkmcnt(1)
v_mfma_f32_16x16x32_bf16 v[32:35], a[136:139], v[152:155], v[32:35]
v_mfma_f32_16x16x32_bf16 v[36:39], v[152:155], a[208:211], v[36:39]
s_waitcnt lgkmcnt(0)
v_mfma_f32_16x16x32_bf16 v[32:35], a[140:143], v[156:159], v[32:35]
v_mfma_f32_16x16x32_bf16 v[36:39], v[156:159], a[212:215], v[36:39]
s_lshl_b32 s19, s38, 8
s_add_u32 s19, s19, s36
s_lshr_b32 s20, s38, 1
s_lshl_b32 s20, s20, 9
s_add_u32 s20, s20, s36
s_and_b32 s39, s38, 1
s_lshl_b32 s39, s39, 2
s_add_u32 s20, s20, s39
v_cmp_u_f32 vcc, v32, v32
v_cvt_pk_bf16_f32 v84, v32, v33
v_cvt_pk_bf16_f32 v85, v34, v35
v_cvt_pk_bf16_f32 v86, v36, v37
s_cbranch_vccnz L_qn_x
L_qk_x:
s_mov_b32 s70, 0
buffer_store_dwordx2 v[84:85], v4, s[8:11], s19 offen sc1
buffer_store_dword v86, v6, s[8:11], s20 offen offset:2048 sc1
s_mov_b32 s34, s31
s_add_u32 s31, s31, 1024
s_add_u32 s36, s36, 131072
s_add_u32 s23, s23, 1
L_qe_x:
L_qnom:
s_cmp_lt_u32 s22, 64
s_cbranch_scc0 L_qd
s_add_u32 s19, s23, 24
s_cmp_lt_u32 s22, s19
s_cbranch_scc1 L_qx
L_qba:
s_barrier
ds_read_b128 v[168:171], v164
v_xor_b32 v164, 16, v164
v_xor_b32 v161, 16, v161
s_add_u32 s21, s21, 1
s_cmp_ge_u32 s21, 4194304
s_cbranch_scc1 L_abort
s_waitcnt lgkmcnt(0)
v_min_u32 v168, v168, v169
v_min3_u32 v168, v168, v170, v171
s_nop 0
v_readfirstlane_b32 s19, v168
s_nop 0
s_add_u32 s61, s61, s19
s_cmp_lt_u32 s23, s61
s_cbranch_scc1 L_qb1a
L_qb2a:
s_mul_i32 s19, s61, 9216
s_add_u32 s19, s19, 12648448
buffer_load_dword v185, v184, s[8:11], s19 offen sc1
s_waitcnt vmcnt(0)
buffer_store_dword v7, off, s[8:11], s34 sc1
s_mov_b32 s34, 1073741824
buffer_store_dword v7, off, s[8:11], s57 sc1
s_mov_b32 s57, 1073741824
v_cmp_eq_u32 vcc, -1, v185
s_cbranch_vccz L_qb3a
s_sleep 1
s_add_u32 s21, s21, 1
s_cmp_ge_u32 s21, 4194304
s_cbranch_scc1 L_abort
s_branch L_qb2a
L_qb3a:
s_cmp_eq_u32 s70, 0
s_cbranch_scc1 L_qb4a
s_mul_i32 s67, s61, 9216
s_add_u32 s67, s67, 12648448
s_and_b32 s68, s61, 1
s_mul_i32 s68, s68, 9216
s_add_u32 s68, s68, 73728
s_add_u32 s19, s68, 8192
s_mov_b32 m0, s19
s_add_u32 s19, s67, 8192
buffer_load_dwordx4 v0, s[8:11], s19 offen sc1 lds
s_lshl_b32 s19, s16, 10
s_add_u32 s67, s67, s19
s_add_u32 s69, s68, s19
s_mov_b32 m0, s69
s_add_u32 s69, s69, 4096
buffer_load_dwordx4 v0, s[8:11], s67 offen sc1 lds
s_mov_b32 m0, s69
s_add_u32 s67, s67, 4096
buffer_load_dwordx4 v0, s[8:11], s67 offen sc1 lds
s_branch L_qb5a
L_qb4a:
s_mul_i32 s67, s61, 9216
s_add_u32 s67, s67, 12648448
s_and_b32 s68, s61, 1
s_mul_i32 s68, s68, 9216
s_add_u32 s68, s68, 73728
s_add_u32 s19, s68, 8192
s_mov_b32 m0, s19
s_add_u32 s19, s67, 8192
buffer_load_dwordx4 v0, s[8:11], s19 offen lds
s_lshl_b32 s19, s16, 10
s_add_u32 s67, s67, s19
s_add_u32 s69, s68, s19
s_mov_b32 m0, s69
s_add_u32 s69, s69, 4096
buffer_load_dwordx4 v0, s[8:11], s67 offen lds
s_mov_b32 m0, s69
s_add_u32 s67, s67, 4096
buffer_load_dwordx4 v0, s[8:11], s67 offen lds
L_qb5a:
s_waitcnt vmcnt(0)
v_mov_b32 v166, 1
ds_write_b32 v161, v166
s_waitcnt lgkmcnt(0)
s_branch L_qba
L_qb1a:
v_mov_b32 v166, 0
ds_write_b32 v161, v166
s_waitcnt vmcnt(0)
buffer_store_dword v7, off, s[8:11], s34 sc1
s_cmp_eq_u32 s23, 40
s_cbranch_scc0 L_qpa
v_mov_b32 v88, 0
L_qqa:
global_load_dword v89, v88, s[6:7] offset:104 sc1
s_waitcnt vmcnt(0)
v_cmp_gt_u32 vcc, 28, v89
s_cbranch_vccz L_qpa
s_add_u32 s21, s21, 1
s_cmp_ge_u32 s21, 4194304
s_cbranch_scc1 L_abort
s_branch L_qqa
L_qpa:
s_and_b32 s19, s23, 1
s_mul_i32 s19, s19, 9216
v_add_u32 v167, s19, v165
ds_read_b128 v[88:91], v167
ds_read_b128 v[92:95], v167 offset:32
ds_read_b128 v[96:99], v167 offset:1024
ds_read_b128 v[100:103], v167 offset:1056
ds_read_b128 v[104:107], v167 offset:2048
ds_read_b128 v[108:111], v167 offset:2080
s_waitcnt lgkmcnt(5)
v_mfma_f32_16x16x32_bf16 v[32:35], a[72:75], v[88:91], 0
v_mfma_f32_16x16x32_bf16 v[36:39], v[88:91], a[144:147], 0
ds_read_b128 v[112:115], v167 offset:3072
s_waitcnt lgkmcnt(5)
v_mfma_f32_16x16x32_bf16 v[32:35], a[76:79], v[92:95], v[32:35]
v_mfma_f32_16x16x32_bf16 v[36:39], v[92:95], a[148:151], v[36:39]
ds_read_b128 v[116:119], v167 offset:3104
s_waitcnt lgkmcnt(5)
v_mfma_f32_16x16x32_bf16 v[32:35], a[80:83], v[96:99], v[32:35]
v_mfma_f32_16x16x32_bf16 v[36:39], v[96:99], a[152:155], v[36:39]
ds_read_b128 v[120:123], v167 offset:4096
s_waitcnt lgkmcnt(5)
v_mfma_f32_16x16x32_bf16 v[32:35], a[84:87], v[100:103], v[32:35]
v_mfma_f32_16x16x32_bf16 v[36:39], v[100:103], a[156:159], v[36:39]
ds_read_b128 v[124:127], v167 offset:4128
s_waitcnt lgkmcnt(5)
v_mfma_f32_16x16x32_bf16 v[32:35], a[88:91], v[104:107], v[32:35]
v_mfma_f32_16x16x32_bf16 v[36:39], v[104:107], a[160:163], v[36:39]
ds_read_b128 v[128:131], v167 offset:5120
s_waitcnt lgkmcnt(5)
v_mfma_f32_16x16x32_bf16 v[32:35], a[92:95], v[108:111], v[32:35]
v_mfma_f32_16x16x32_bf16 v[36:39], v[108:111], a[164:167], v[36:39]
ds_read_b128 v[132:135], v167 offset:5152
s_waitcnt lgkmcnt(5)
v_mfma_f32_16x16x32_bf16 v[32:35], a[96:99], v[112:115], v[32:35]
v_mfma_f32_16x16x32_bf16 v[36:39], v[112:115], a[168:171], v[36:39]
ds_read_b128 v[136:139], v167 offset:6144
s_waitcnt lgkmcnt(5)
v_mfma_f32_16x16x32_bf16 v[32:35], a[100:103], v[116:119], v[32:35]
v_mfma_f32_16x16x32_bf16 v[36:39], v[116:119], a[172:175], v[36:39]
ds_read_b128 v[140:143], v167 offset:6176
s_waitcnt lgkmcnt(5)
v_mfma_f32_16x16x32_bf16 v[32:35], a[104:107], v[120:123], v[32:35]
v_mfma_f32_16x16x32_bf16 v[36:39], v[120:123], a[176:179], v[36:39]
ds_read_b128 v[144:147], v167 offset:7168
s_waitcnt lgkmcnt(5)
v_mfma_f32_16x16x32_bf16 v[32:35], a[108:111], v[124:127], v[32:35]
v_mfma_f32_16x16x32_bf16 v[36:39], v[124:127], a[180:183], v[36:39]
ds_read_b128 v[148:151], v167 offset:7200
s_waitcnt lgkmcnt(5)
v_mfma_f32_16x16x32_bf16 v[32:35], a[112:115], v[128:131], v[32:35]
v_mfma_f32_16x16x32_bf16 v[36:39], v[128:131], a[184:187], v[36:39]
ds_read_b128 v[152:155], v167 offset:8192
s_waitcnt lgkmcnt(5)
v_mfma_f32_16x16x32_bf16 v[32:35], a[116:119], v[132:135], v[32:35]
v_mfma_f32_16x16x32_bf16 v[36:39], v[132:135], a[188:191], v[36:39]
ds_read_b128 v[156:159], v167 offset:8224
s_waitcnt lgkmcnt(5)
v_mfma_f32_16x16x32_bf16 v[32:35], a[120:123], v[136:139], v[32:35]
v_mfma_f32_16x16x32_bf16 v[36:39], v[136:139], a[192:195], v[36:39]
s_waitcnt lgkmcnt(4)
v_mfma_f32_16x16x32_bf16 v[32:35], a[124:127], v[140:143], v[32:35]
v_mfma_f32_16x16x32_bf16 v[36:39], v[140:143], a[196:199], v[36:39]
s_waitcnt lgkmcnt(3)
v_mfma_f32_16x16x32_bf16 v[32:35], a[128:131], v[144:147], v[32:35]
v_mfma_f32_16x16x32_bf16 v[36:39], v[144:147], a[200:203], v[36:39]
s_waitcnt lgkmcnt(2)
v_mfma_f32_16x16x32_bf16 v[32:35], a[132:135], v[148:151], v[32:35]
v_mfma_f32_16x16x32_bf16 v[36:39], v[148:151], a[204:207], v[36:39]
s_waitcnt lgkmcnt(1)
v_mfma_f32_16x16x32_bf16 v[32:35], a[136:139], v[152:155], v[32:35]
v_mfma_f32_16x16x32_bf16 v[36:39], v[152:155], a[208:211], v[36:39]
s_waitcnt lgkmcnt(0)
v_mfma_f32_16x16x32_bf16 v[32:35], a[140:143], v[156:159], v[32:35]
v_mfma_f32_16x16x32_bf16 v[36:39], v[156:159], a[212:215], v[36:39]
s_lshl_b32 s19, s38, 8
s_add_u32 s19, s19, s36
s_lshr_b32 s20, s38, 1
s_lshl_b32 s20, s20, 9
s_add_u32 s20, s20, s36
s_and_b32 s39, s38, 1
s_lshl_b32 s39, s39, 2
s_add_u32 s20, s20, s39
v_cmp_u_f32 vcc, v32, v32
v_cvt_pk_bf16_f32 v84, v32, v33
v_cvt_pk_bf16_f32 v85, v34, v35
v_cvt_pk_bf16_f32 v86, v36, v37
s_cbranch_vccnz L_qn_a
L_qk_a:
s_mov_b32 s70, 0
buffer_store_dwordx2 v[84:85], v4, s[8:11], s19 offen sc1
buffer_store_dword v86, v6, s[8:11], s20 offen offset:2048 sc1
s_mov_b32 s34, s31
s_add_u32 s31, s31, 1024
s_add_u32 s36, s36, 131072
s_add_u32 s23, s23, 1
L_qe_a:
s_branch L_qx
L_qd:
buffer_store_dwordx4 v[72:75], v3, s[8:11], s62 offen sc1
buffer_store_dwordx4 v[76:79], v3, s[8:11], s63 offen sc1
buffer_store_dwordx4 v[80:83], v0, s[8:11], s59 offen sc1
s_waitcnt vmcnt(0)
buffer_store_dword v7, off, s[8:11], s57 sc1
buffer_store_dword v7, off, s[8:11], s56 sc1
buffer_store_dword v7, off, s[8:11], s34 sc1
s_mov_b32 s34, 1073741824
s_mov_b32 s57, 1073741824
L_qm:
s_cmp_lt_u32 s23, 62
s_cbranch_scc0 L_qend
L_qbb:
s_barrier
ds_read_b128 v[168:171], v164
v_xor_b32 v164, 16, v164
v_xor_b32 v161, 16, v161
s_add_u32 s21, s21, 1
s_cmp_ge_u32 s21, 4194304
s_cbranch_scc1 L_abort
s_waitcnt lgkmcnt(0)
v_min_u32 v168, v168, v169
v_min3_u32 v168, v168, v170, v171
s_nop 0
v_readfirstlane_b32 s19, v168
s_nop 0
s_add_u32 s61, s61, s19
s_cmp_lt_u32 s23, s61
s_cbranch_scc1 L_qb1b
L_qb2b:
s_mul_i32 s19, s61, 9216
s_add_u32 s19, s19, 12648448
buffer_load_dword v185, v184, s[8:11], s19 offen sc1
s_waitcnt vmcnt(0)
buffer_store_dword v7, off, s[8:11], s34 sc1
s_mov_b32 s34, 1073741824
buffer_store_dword v7, off, s[8:11], s57 sc1
s_mov_b32 s57, 1073741824
v_cmp_eq_u32 vcc, -1, v185
s_cbranch_vccz L_qb3b
s_sleep 1
s_add_u32 s21, s21, 1
s_cmp_ge_u32 s21, 4194304
s_cbranch_scc1 L_abort
s_branch L_qb2b
L_qb3b:
s_cmp_eq_u32 s70, 0
s_cbranch_scc1 L_qb4b
s_mul_i32 s67, s61, 9216
s_add_u32 s67, s67, 12648448
s_and_b32 s68, s61, 1
s_mul_i32 s68, s68, 9216
s_add_u32 s68, s68, 73728
s_add_u32 s19, s68, 8192
s_mov_b32 m0, s19
s_add_u32 s19, s67, 8192
buffer_load_dwordx4 v0, s[8:11], s19 offen sc1 lds
s_lshl_b32 s19, s16, 10
s_add_u32 s67, s67, s19
s_add_u32 s69, s68, s19
s_mov_b32 m0, s69
s_add_u32 s69, s69, 4096
buffer_load_dwordx4 v0, s[8:11], s67 offen sc1 lds
s_mov_b32 m0, s69
s_add_u32 s67, s67, 4096
buffer_load_dwordx4 v0, s[8:11], s67 offen sc1 lds
s_branch L_qb5b
L_qb4b:
s_mul_i32 s67, s61, 9216
s_add_u32 s67, s67, 12648448
s_and_b32 s68, s61, 1
s_mul_i32 s68, s68, 9216
s_add_u32 s68, s68, 73728
s_add_u32 s19, s68, 8192
s_mov_b32 m0, s19
s_add_u32 s19, s67, 8192
buffer_load_dwordx4 v0, s[8:11], s19 offen lds
s_lshl_b32 s19, s16, 10
s_add_u32 s67, s67, s19
s_add_u32 s69, s68, s19
s_mov_b32 m0, s69
s_add_u32 s69, s69, 4096
buffer_load_dwordx4 v0, s[8:11], s67 offen lds
s_mov_b32 m0, s69
s_add_u32 s67, s67, 4096
buffer_load_dwordx4 v0, s[8:11], s67 offen lds
L_qb5b:
s_waitcnt vmcnt(0)
v_mov_b32 v166, 1
ds_write_b32 v161, v166
s_waitcnt lgkmcnt(0)
s_branch L_qbb
L_qb1b:
v_mov_b32 v166, 0
ds_write_b32 v161, v166
s_waitcnt vmcnt(0)
buffer_store_dword v7, off, s[8:11], s34 sc1
s_cmp_eq_u32 s23, 40
s_cbranch_scc0 L_qpb
v_mov_b32 v88, 0
L_qqb:
global_load_dword v89, v88, s[6:7] offset:104 sc1
s_waitcnt vmcnt(0)
v_cmp_gt_u32 vcc, 28, v89
s_cbranch_vccz L_qpb
s_add_u32 s21, s21, 1
s_cmp_ge_u32 s21, 4194304
s_cbranch_scc1 L_abort
s_branch L_qqb
L_qpb:
s_and_b32 s19, s23, 1
s_mul_i32 s19, s19, 9216
v_add_u32 v167, s19, v165
ds_read_b128 v[88:91], v167
ds_read_b128 v[92:95], v167 offset:32
ds_read_b128 v[96:99], v167 offset:1024
ds_read_b128 v[100:103], v167 offset:1056
ds_read_b128 v[104:107], v167 offset:2048
ds_read_b128 v[108:111], v167 offset:2080
s_waitcnt lgkmcnt(5)
v_mfma_f32_16x16x32_bf16 v[32:35], a[72:75], v[88:91], 0
v_mfma_f32_16x16x32_bf16 v[36:39], v[88:91], a[144:147], 0
ds_read_b128 v[112:115], v167 offset:3072
s_waitcnt lgkmcnt(5)
v_mfma_f32_16x16x32_bf16 v[32:35], a[76:79], v[92:95], v[32:35]
v_mfma_f32_16x16x32_bf16 v[36:39], v[92:95], a[148:151], v[36:39]
ds_read_b128 v[116:119], v167 offset:3104
s_waitcnt lgkmcnt(5)
v_mfma_f32_16x16x32_bf16 v[32:35], a[80:83], v[96:99], v[32:35]
v_mfma_f32_16x16x32_bf16 v[36:39], v[96:99], a[152:155], v[36:39]
ds_read_b128 v[120:123], v167 offset:4096
s_waitcnt lgkmcnt(5)
v_mfma_f32_16x16x32_bf16 v[32:35], a[84:87], v[100:103], v[32:35]
v_mfma_f32_16x16x32_bf16 v[36:39], v[100:103], a[156:159], v[36:39]
ds_read_b128 v[124:127], v167 offset:4128
s_waitcnt lgkmcnt(5)
v_mfma_f32_16x16x32_bf16 v[32:35], a[88:91], v[104:107], v[32:35]
v_mfma_f32_16x16x32_bf16 v[36:39], v[104:107], a[160:163], v[36:39]
ds_read_b128 v[128:131], v167 offset:5120
s_waitcnt lgkmcnt(5)
v_mfma_f32_16x16x32_bf16 v[32:35], a[92:95], v[108:111], v[32:35]
v_mfma_f32_16x16x32_bf16 v[36:39], v[108:111], a[164:167], v[36:39]
ds_read_b128 v[132:135], v167 offset:5152
s_waitcnt lgkmcnt(5)
v_mfma_f32_16x16x32_bf16 v[32:35], a[96:99], v[112:115], v[32:35]
v_mfma_f32_16x16x32_bf16 v[36:39], v[112:115], a[168:171], v[36:39]
ds_read_b128 v[136:139], v167 offset:6144
s_waitcnt lgkmcnt(5)
v_mfma_f32_16x16x32_bf16 v[32:35], a[100:103], v[116:119], v[32:35]
v_mfma_f32_16x16x32_bf16 v[36:39], v[116:119], a[172:175], v[36:39]
ds_read_b128 v[140:143], v167 offset:6176
s_waitcnt lgkmcnt(5)
v_mfma_f32_16x16x32_bf16 v[32:35], a[104:107], v[120:123], v[32:35]
v_mfma_f32_16x16x32_bf16 v[36:39], v[120:123], a[176:179], v[36:39]
ds_read_b128 v[144:147], v167 offset:7168
s_waitcnt lgkmcnt(5)
v_mfma_f32_16x16x32_bf16 v[32:35], a[108:111], v[124:127], v[32:35]
v_mfma_f32_16x16x32_bf16 v[36:39], v[124:127], a[180:183], v[36:39]
ds_read_b128 v[148:151], v167 offset:7200
s_waitcnt lgkmcnt(5)
v_mfma_f32_16x16x32_bf16 v[32:35], a[112:115], v[128:131], v[32:35]
v_mfma_f32_16x16x32_bf16 v[36:39], v[128:131], a[184:187], v[36:39]
ds_read_b128 v[152:155], v167 offset:8192
s_waitcnt lgkmcnt(5)
v_mfma_f32_16x16x32_bf16 v[32:35], a[116:119], v[132:135], v[32:35]
v_mfma_f32_16x16x32_bf16 v[36:39], v[132:135], a[188:191], v[36:39]
ds_read_b128 v[156:159], v167 offset:8224
s_waitcnt lgkmcnt(5)
v_mfma_f32_16x16x32_bf16 v[32:35], a[120:123], v[136:139], v[32:35]
v_mfma_f32_16x16x32_bf16 v[36:39], v[136:139], a[192:195], v[36:39]
s_waitcnt lgkmcnt(4)
v_mfma_f32_16x16x32_bf16 v[32:35], a[124:127], v[140:143], v[32:35]
v_mfma_f32_16x16x32_bf16 v[36:39], v[140:143], a[196:199], v[36:39]
s_waitcnt lgkmcnt(3)
v_mfma_f32_16x16x32_bf16 v[32:35], a[128:131], v[144:147], v[32:35]
v_mfma_f32_16x16x32_bf16 v[36:39], v[144:147], a[200:203], v[36:39]
s_waitcnt lgkmcnt(2)
v_mfma_f32_16x16x32_bf16 v[32:35], a[132:135], v[148:151], v[32:35]
v_mfma_f32_16x16x32_bf16 v[36:39], v[148:151], a[204:207], v[36:39]
s_waitcnt lgkmcnt(1)
v_mfma_f32_16x16x32_bf16 v[32:35], a[136:139], v[152:155], v[32:35]
v_mfma_f32_16x16x32_bf16 v[36:39], v[152:155], a[208:211], v[36:39]
s_waitcnt lgkmcnt(0)
v_mfma_f32_16x16x32_bf16 v[32:35], a[140:143], v[156:159], v[32:35]
v_mfma_f32_16x16x32_bf16 v[36:39], v[156:159], a[212:215], v[36:39]
s_lshl_b32 s19, s38, 8
s_add_u32 s19, s19, s36
s_lshr_b32 s20, s38, 1
s_lshl_b32 s20, s20, 9
s_add_u32 s20, s20, s36
s_and_b32 s39, s38, 1
s_lshl_b32 s39, s39, 2
s_add_u32 s20, s20, s39
v_cmp_u_f32 vcc, v32, v32
v_cvt_pk_bf16_f32 v84, v32, v33
v_cvt_pk_bf16_f32 v85, v34, v35
v_cvt_pk_bf16_f32 v86, v36, v37
s_cbranch_vccnz L_qn_b
L_qk_b:
s_mov_b32 s70, 0
buffer_store_dwordx2 v[84:85], v4, s[8:11], s19 offen sc1
buffer_store_dword v86, v6, s[8:11], s20 offen offset:2048 sc1
s_mov_b32 s34, s31
s_add_u32 s31, s31, 1024
s_add_u32 s36, s36, 131072
s_add_u32 s23, s23, 1
L_qe_b:
s_branch L_qm
L_qend:
s_waitcnt vmcnt(0)
buffer_store_dword v7, off, s[8:11], s34 sc1
s_waitcnt vmcnt(0)
s_endpgm
L_qn_x:
s_add_u32 s70, s70, 1
s_cmp_ge_u32 s70, 3
s_cbranch_scc1 L_qk_x
s_mov_b32 s61, s23
v_mov_b32 v166, 0
ds_write_b32 v161, v166
s_waitcnt lgkmcnt(0)
s_branch L_qe_x
L_qn_a:
s_add_u32 s70, s70, 1
s_cmp_ge_u32 s70, 3
s_cbranch_scc1 L_qk_a
s_mov_b32 s61, s23
v_mov_b32 v166, 0
ds_write_b32 v161, v166
s_waitcnt lgkmcnt(0)
s_branch L_qe_a
L_qn_b:
s_add_u32 s70, s70, 1
s_cmp_ge_u32 s70, 3
s_cbranch_scc1 L_qk_b
s_mov_b32 s61, s23
v_mov_b32 v166, 0
ds_write_b32 v161, v166
s_waitcnt lgkmcnt(0)
s_branch L_qe_b
L_qfast:
buffer_store_dwordx4 v[76:79], v3, s[8:11], s63 offen sc1
buffer_store_dwordx4 v[80:83], v0, s[8:11], s59 offen sc1
buffer_store_dwordx4 v[72:75], v3, s[8:11], s62 offen sc1
s_mov_b32 s62, 1073741824
s_mov_b32 s63, 1073741824
s_mov_b32 s59, 1073741824
s_waitcnt vmcnt(0)
buffer_store_dword v7, off, s[8:11], s56 sc1
s_mov_b32 s56, 1073741824
s_branch L_qfb
L_r_f1:
s_cmp_eq_u32 s16, 0
s_cbranch_scc0 L_wdof0
v_mov_b32 v8, 0
s_sleep 100
L_wd0f0:
global_load_dword v9, v8, s[6:7] offset:68 sc1
s_waitcnt vmcnt(0)
v_cmp_gt_u32 vcc, 32, v9
s_cbranch_vccz L_wdn0f0
s_sleep 100
s_add_u32 s21, s21, 1
s_cmp_ge_u32 s21, 4194304
s_cbranch_scc1 L_abort
s_branch L_wd0f0
L_wdn0f0:
L_wdof0:
s_barrier
v_lshrrev_b32 v3, 3, v2
v_mul_u32_u24 v3, 9216, v3
v_and_b32 v4, 7, v2
v_lshl_add_u32 v3, v4, 4, v3
v_lshrrev_b32 v4, 4, v2
v_bfe_u32 v5, v2, 2, 2
v_and_b32 v6, 3, v2
v_lshlrev_b32 v6, 3, v6
s_lshl_b32 s19, s16, 5
v_add_u32 v6, s19, v6
v_lshlrev_b32 v7, 4, v4
v_add_u32 v8, v7, v5
v_lshl_add_u32 v9, v8, 7, v6
v_add_u32 v9, 65536, v9
v_lshl_add_u32 v8, v8, 10, v6
v_add_u32 v10, 73728, v8
v_add_u32 v11, 73728, v9
s_load_dwordx2 s[4:5], s[0:1], 64
s_waitcnt lgkmcnt(0)
s_mov_b32 s12, s4
s_and_b32 s13, s5, 0xffff
s_mov_b32 s14, 5308416
s_mov_b32 s15, 0x20000
s_mul_i32 s22, s16, 1327104
s_lshl_b32 s19, s17, 7
s_add_u32 s22, s22, s19
s_mul_i32 s23, s16, 18432
s_add_u32 s23, s23, 0
s_mov_b32 m0, s23
s_add_u32 s23, s23, 1024
buffer_load_dwordx4 v3, s[12:15], s22 offen lds
s_add_u32 s22, s22, 73728
s_mov_b32 m0, s23
s_add_u32 s23, s23, 1024
buffer_load_dwordx4 v3, s[12:15], s22 offen lds
s_add_u32 s22, s22, 73728
s_mov_b32 m0, s23
s_add_u32 s23, s23, 1024
buffer_load_dwordx4 v3, s[12:15], s22 offen lds
s_add_u32 s22, s22, 73728
s_mov_b32 m0, s23
s_add_u32 s23, s23, 1024
buffer_load_dwordx4 v3, s[12:15], s22 offen lds
s_add_u32 s22, s22, 73728
s_mov_b32 m0, s23
s_add_u32 s23, s23, 1024
buffer_load_dwordx4 v3, s[12:15], s22 offen lds
s_add_u32 s22, s22, 73728
s_mov_b32 m0, s23
s_add_u32 s23, s23, 1024
buffer_load_dwordx4 v3, s[12:15], s22 offen lds
s_add_u32 s22, s22, 73728
s_mov_b32 m0, s23
s_add_u32 s23, s23, 1024
buffer_load_dwordx4 v3, s[12:15], s22 offen lds
s_add_u32 s22, s22, 73728
s_mov_b32 m0, s23
s_add_u32 s23, s23, 1024
buffer_load_dwordx4 v3, s[12:15], s22 offen lds
s_add_u32 s22, s22, 73728
s_mov_b32 m0, s23
s_add_u32 s23, s23, 1024
buffer_load_dwordx4 v3, s[12:15], s22 offen lds
s_add_u32 s22, s22, 73728
s_mov_b32 m0, s23
s_add_u32 s23, s23, 1024
buffer_load_dwordx4 v3, s[12:15], s22 offen lds
s_add_u32 s22, s22, 73728
s_mov_b32 m0, s23
s_add_u32 s23, s23, 1024
buffer_load_dwordx4 v3, s[12:15], s22 offen lds
s_add_u32 s22, s22, 73728
s_mov_b32 m0, s23
s_add_u32 s23, s23, 1024
buffer_load_dwordx4 v3, s[12:15], s22 offen lds
s_add_u32 s22, s22, 73728
s_mov_b32 m0, s23
s_add_u32 s23, s23, 1024
buffer_load_dwordx4 v3, s[12:15], s22 offen lds
s_add_u32 s22, s22, 73728
s_mov_b32 m0, s23
s_add_u32 s23, s23, 1024
buffer_load_dwordx4 v3, s[12:15], s22 offen lds
s_add_u32 s22, s22, 73728
s_mov_b32 m0, s23
s_add_u32 s23, s23, 1024
buffer_load_dwordx4 v3, s[12:15], s22 offen lds
s_add_u32 s22, s22, 73728
s_mov_b32 m0, s23
s_add_u32 s23, s23, 1024
buffer_load_dwordx4 v3, s[12:15], s22 offen lds
s_add_u32 s22, s22, 73728
s_mov_b32 m0, s23
s_add_u32 s23, s23, 1024
buffer_load_dwordx4 v3, s[12:15], s22 offen lds
s_add_u32 s22, s22, 73728
s_mov_b32 m0, s23
s_add_u32 s23, s23, 1024
buffer_load_dwordx4 v3, s[12:15], s22 offen lds
s_add_u32 s22, s22, 73728
s_load_dwordx2 s[4:5], s[0:1], 72
s_waitcnt lgkmcnt(0)
s_mov_b32 s12, s4
s_and_b32 s13, s5, 0xffff
s_mov_b32 s14, 5308416
s_mov_b32 s15, 0x20000
s_mul_i32 s22, s16, 1327104
s_lshl_b32 s19, s17, 7
s_add_u32 s22, s22, s19
s_mul_i32 s23, s16, 18432
s_add_u32 s23, s23, 73728
s_mov_b32 m0, s23
s_add_u32 s23, s23, 1024
buffer_load_dwordx4 v3, s[12:15], s22 offen lds
s_add_u32 s22, s22, 73728
s_mov_b32 m0, s23
s_add_u32 s23, s23, 1024
buffer_load_dwordx4 v3, s[12:15], s22 offen lds
s_add_u32 s22, s22, 73728
s_mov_b32 m0, s23
s_add_u32 s23, s23, 1024
buffer_load_dwordx4 v3, s[12:15], s22 offen lds
s_add_u32 s22, s22, 73728
s_mov_b32 m0, s23
s_add_u32 s23, s23, 1024
buffer_load_dwordx4 v3, s[12:15], s22 offen lds
s_add_u32 s22, s22, 73728
s_mov_b32 m0, s23
s_add_u32 s23, s23, 1024
buffer_load_dwordx4 v3, s[12:15], s22 offen lds
s_add_u32 s22, s22, 73728
s_mov_b32 m0, s23
s_add_u32 s23, s23, 1024
buffer_load_dwordx4 v3, s[12:15], s22 offen lds
s_add_u32 s22, s22, 73728
s_mov_b32 m0, s23
s_add_u32 s23, s23, 1024
buffer_load_dwordx4 v3, s[12:15], s22 offen lds
s_add_u32 s22, s22, 73728
s_mov_b32 m0, s23
s_add_u32 s23, s23, 1024
buffer_load_dwordx4 v3, s[12:15], s22 offen lds
s_add_u32 s22, s22, 73728
s_mov_b32 m0, s23
s_add_u32 s23, s23, 1024
buffer_load_dwordx4 v3, s[12:15], s22 offen lds
s_add_u32 s22, s22, 73728
s_mov_b32 m0, s23
s_add_u32 s23, s23, 1024
buffer_load_dwordx4 v3, s[12:15], s22 offen lds
s_add_u32 s22, s22, 73728
s_mov_b32 m0, s23
s_add_u32 s23, s23, 1024
buffer_load_dwordx4 v3, s[12:15], s22 offen lds
s_add_u32 s22, s22, 73728
s_mov_b32 m0, s23
s_add_u32 s23, s23, 1024
buffer_load_dwordx4 v3, s[12:15], s22 offen lds
s_add_u32 s22, s22, 73728
s_mov_b32 m0, s23
s_add_u32 s23, s23, 1024
buffer_load_dwordx4 v3, s[12:15], s22 offen lds
s_add_u32 s22, s22, 73728
s_mov_b32 m0, s23
s_add_u32 s23, s23, 1024
buffer_load_dwordx4 v3, s[12:15], s22 offen lds
s_add_u32 s22, s22, 73728
s_mov_b32 m0, s23
s_add_u32 s23, s23, 1024
buffer_load_dwordx4 v3, s[12:15], s22 offen lds
s_add_u32 s22, s22, 73728
s_mov_b32 m0, s23
s_add_u32 s23, s23, 1024
buffer_load_dwordx4 v3, s[12:15], s22 offen lds
s_add_u32 s22, s22, 73728
s_mov_b32 m0, s23
s_add_u32 s23, s23, 1024
buffer_load_dwordx4 v3, s[12:15], s22 offen lds
s_add_u32 s22, s22, 73728
s_mov_b32 m0, s23
s_add_u32 s23, s23, 1024
buffer_load_dwordx4 v3, s[12:15], s22 offen lds
s_add_u32 s22, s22, 73728
s_waitcnt vmcnt(0)
s_barrier
ds_read_b64_tr_b16 a[0:1], v8
ds_read_b64_tr_b16 a[2:3], v8 offset:4096
ds_read_b64_tr_b16 a[4:5], v8 offset:8192
ds_read_b64_tr_b16 a[6:7], v8 offset:12288
ds_read_b64_tr_b16 a[8:9], v8 offset:128
ds_read_b64_tr_b16 a[10:11], v8 offset:4224
ds_read_b64_tr_b16 a[12:13], v8 offset:8320
ds_read_b64_tr_b16 a[14:15], v8 offset:12416
ds_read_b64_tr_b16 a[16:17], v8 offset:256
ds_read_b64_tr_b16 a[18:19], v8 offset:4352
ds_read_b64_tr_b16 a[20:21], v8 offset:8448
ds_read_b64_tr_b16 a[22:23], v8 offset:12544
ds_read_b64_tr_b16 a[24:25], v8 offset:384
ds_read_b64_tr_b16 a[26:27], v8 offset:4480
ds_read_b64_tr_b16 a[28:29], v8 offset:8576
ds_read_b64_tr_b16 a[30:31], v8 offset:12672
ds_read_b64_tr_b16 a[32:33], v8 offset:512
ds_read_b64_tr_b16 a[34:35], v8 offset:4608
ds_read_b64_tr_b16 a[36:37], v8 offset:8704
ds_read_b64_tr_b16 a[38:39], v8 offset:12800
ds_read_b64_tr_b16 a[40:41], v8 offset:640
ds_read_b64_tr_b16 a[42:43], v8 offset:4736
ds_read_b64_tr_b16 a[44:45], v8 offset:8832
ds_read_b64_tr_b16 a[46:47], v8 offset:12928
ds_read_b64_tr_b16 a[48:49], v8 offset:768
ds_read_b64_tr_b16 a[50:51], v8 offset:4864
ds_read_b64_tr_b16 a[52:53], v8 offset:8960
ds_read_b64_tr_b16 a[54:55], v8 offset:13056
ds_read_b64_tr_b16 a[56:57], v8 offset:896
ds_read_b64_tr_b16 a[58:59], v8 offset:4992
ds_read_b64_tr_b16 a[60:61], v8 offset:9088
ds_read_b64_tr_b16 a[62:63], v8 offset:13184
ds_read_b64_tr_b16 a[64:65], v9
ds_read_b64_tr_b16 a[66:67], v9 offset:512
ds_read_b64_tr_b16 a[68:69], v9 offset:1024
ds_read_b64_tr_b16 a[70:71], v9 offset:1536
ds_read_b64_tr_b16 a[72:73], v10
ds_read_b64_tr_b16 a[74:75], v10 offset:4096
ds_read_b64_tr_b16 a[76:77], v10 offset:8192
ds_read_b64_tr_b16 a[78:79], v10 offset:12288
ds_read_b64_tr_b16 a[80:81], v10 offset:128
ds_read_b64_tr_b16 a[82:83], v10 offset:4224
ds_read_b64_tr_b16 a[84:85], v10 offset:8320
ds_read_b64_tr_b16 a[86:87], v10 offset:12416
ds_read_b64_tr_b16 a[88:89], v10 offset:256
ds_read_b64_tr_b16 a[90:91], v10 offset:4352
ds_read_b64_tr_b16 a[92:93], v10 offset:8448
ds_read_b64_tr_b16 a[94:95], v10 offset:12544
ds_read_b64_tr_b16 a[96:97], v10 offset:384
ds_read_b64_tr_b16 a[98:99], v10 offset:4480
ds_read_b64_tr_b16 a[100:101], v10 offset:8576
ds_read_b64_tr_b16 a[102:103], v10 offset:12672
ds_read_b64_tr_b16 a[104:105], v10 offset:512
ds_read_b64_tr_b16 a[106:107], v10 offset:4608
ds_read_b64_tr_b16 a[108:109], v10 offset:8704
ds_read_b64_tr_b16 a[110:111], v10 offset:12800
ds_read_b64_tr_b16 a[112:113], v10 offset:640
ds_read_b64_tr_b16 a[114:115], v10 offset:4736
ds_read_b64_tr_b16 a[116:117], v10 offset:8832
ds_read_b64_tr_b16 a[118:119], v10 offset:12928
ds_read_b64_tr_b16 a[120:121], v10 offset:768
ds_read_b64_tr_b16 a[122:123], v10 offset:4864
ds_read_b64_tr_b16 a[124:125], v10 offset:8960
ds_read_b64_tr_b16 a[126:127], v10 offset:13056
ds_read_b64_tr_b16 a[128:129], v10 offset:896
ds_read_b64_tr_b16 a[130:131], v10 offset:4992
ds_read_b64_tr_b16 a[132:133], v10 offset:9088
ds_read_b64_tr_b16 a[134:135], v10 offset:13184
ds_read_b64_tr_b16 a[136:137], v11
ds_read_b64_tr_b16 a[138:139], v11 offset:512
ds_read_b64_tr_b16 a[140:141], v11 offset:1024
ds_read_b64_tr_b16 a[142:143], v11 offset:1536
s_waitcnt lgkmcnt(0)
s_barrier
v_lshrrev_b32 v4, 4, v2
v_and_b32 v5, 15, v2
v_and_b32 v6, 1, v4
v_mul_u32_u24 v6, 147456, v6
v_lshrrev_b32 v7, 1, v4
v_lshl_add_u32 v6, v7, 8, v6
v_lshl_add_u32 v3, v5, 4, v6
v_mov_b32 v7, 1
s_lshl_b32 s19, s17, 2
s_add_u32 s19, s19, s16
s_lshl_b32 s28, s19, 9
s_add_u32 s28, s28, 100663296
s_lshl_b32 s30, s19, 2
s_add_u32 s30, s30, 131072
s_mov_b32 s22, 0
s_mov_b32 s32, 0
s_mov_b32 s33, 258048
s_mov_b32 s37, 8388608
s_mov_b32 s34, 3216550459
s_mov_b32 s35, s34
s_cmp_eq_u32 s16, 0
s_cbranch_scc0 L_wdof1
v_mov_b32 v8, 0
L_wd0f1:
global_load_dword v9, v8, s[6:7] offset:192 sc1
s_waitcnt vmcnt(0)
v_cmp_gt_u32 vcc, 16, v9
s_cbranch_vccz L_wdn0f1
s_sleep 24
s_add_u32 s21, s21, 1
s_cmp_ge_u32 s21, 4194304
s_cbranch_scc1 L_abort
s_branch L_wd0f1
L_wdn0f1:
L_wd1f1:
global_load_dword v9, v8, s[6:7] offset:104 sc1
s_waitcnt vmcnt(0)
v_cmp_gt_u32 vcc, 28, v9
s_cbranch_vccz L_wdn1f1
s_sleep 24
s_add_u32 s21, s21, 1
s_cmp_ge_u32 s21, 4194304
s_cbranch_scc1 L_abort
s_branch L_wd1f1
L_wdn1f1:
L_wdof1:
s_barrier
v_min_u32 v160, 15, v2
v_lshlrev_b32 v160, 2, v160
v_mul_u32_u24 v161, 9, v2
v_lshrrev_b32 v161, 1, v161
v_lshlrev_b32 v161, 7, v161
v_add_u32 v161, 124, v161
s_mov_b32 s39, 0
s_mov_b32 s36, 1073741824
s_mov_b32 s38, 0
L_f1:
s_cmp_eq_u32 s38, 0
s_cbranch_scc0 L_f1c
s_cmp_ge_u32 s22, 56
s_cbranch_scc0 L_f1f
L_f1r:
L_wpf:
buffer_load_dword v162, v161, s[8:11], s37 offen sc1
s_waitcnt vmcnt(0)
buffer_store_dword v7, off, s[8:11], s36 sc1
s_mov_b32 s36, 1073741824
v_cmp_eq_u32 vcc, -1, v162
s_cbranch_vccz L_wpof
s_add_u32 s21, s21, 1
s_cmp_ge_u32 s21, 4194304
s_cbranch_scc1 L_abort
s_branch L_wpf
L_wpof:
s_branch L_f1g
L_f1f:
L_wvf2:
buffer_load_dword v162, v160, s[8:11], s33 offen sc1
s_waitcnt vmcnt(0)
buffer_store_dword v7, off, s[8:11], s36 sc1
s_mov_b32 s36, 1073741824
v_cmp_eq_u32 vcc, 0, v162
s_cbranch_vccz L_wvof2
s_sleep 2
s_add_u32 s21, s21, 1
s_cmp_ge_u32 s21, 4194304
s_cbranch_scc1 L_abort
s_branch L_wvf2
L_wvof2:
L_f1g:
s_and_b32 s19, s16, 1
s_mul_i32 s19, s19, 18432
s_lshr_b32 s20, s16, 1
s_lshl_b32 s20, s20, 10
s_add_u32 s19, s19, s20
s_add_u32 s20, s19, s32
s_add_u32 s19, s19, s37
s_mov_b32 m0, s20
s_add_u32 s20, s20, 2048
buffer_load_dwordx4 v0, s[8:11], s19 offen sc1 lds
s_add_u32 s19, s19, 2048
s_mov_b32 m0, s20
s_add_u32 s20, s20, 2048
buffer_load_dwordx4 v0, s[8:11], s19 offen sc1 lds
s_add_u32 s19, s19, 2048
s_mov_b32 m0, s20
s_add_u32 s20, s20, 2048
buffer_load_dwordx4 v0, s[8:11], s19 offen sc1 lds
s_add_u32 s19, s19, 2048
s_mov_b32 m0, s20
s_add_u32 s20, s20, 2048
buffer_load_dwordx4 v0, s[8:11], s19 offen sc1 lds
s_add_u32 s19, s19, 2048
s_mov_b32 m0, s20
s_add_u32 s20, s20, 2048
buffer_load_dwordx4 v0, s[8:11], s19 offen sc1 lds
s_add_u32 s19, s19, 2048
s_mov_b32 m0, s20
s_add_u32 s20, s20, 2048
buffer_load_dwordx4 v0, s[8:11], s19 offen sc1 lds
s_add_u32 s19, s19, 2048
s_mov_b32 m0, s20
s_add_u32 s20, s20, 2048
buffer_load_dwordx4 v0, s[8:11], s19 offen sc1 lds
s_add_u32 s19, s19, 2048
s_mov_b32 m0, s20
s_add_u32 s20, s20, 2048
buffer_load_dwordx4 v0, s[8:11], s19 offen sc1 lds
s_add_u32 s19, s19, 2048
s_mov_b32 m0, s20
s_add_u32 s20, s20, 2048
buffer_load_dwordx4 v0, s[8:11], s19 offen sc1 lds
s_add_u32 s19, s19, 2048
L_f1c:
v_add_u32 v1, s32, v0
s_sub_u32 s32, 36864, s32
s_add_u32 s33, s33, 64
s_add_u32 s37, s37, 36864
buffer_load_dword v162, v160, s[8:11], s33 offen sc1
s_waitcnt vmcnt(8)
s_barrier
ds_read_b128 v[40:43], v1
ds_read_b128 v[44:47], v1 offset:18432
ds_read_b128 v[48:51], v1 offset:1024
ds_read_b128 v[52:55], v1 offset:19456
ds_read_b128 v[56:59], v1 offset:2048
ds_read_b128 v[60:63], v1 offset:20480
s_waitcnt lgkmcnt(4)
v_mfma_f32_16x16x32_bf16 v[8:11], a[0:3], v[40:43], 0
ds_read_b128 v[64:67], v1 offset:3072
ds_read_b128 v[68:71], v1 offset:21504
v_mfma_f32_16x16x32_bf16 v[12:15], a[0:3], v[44:47], 0
v_mfma_f32_16x16x32_bf16 v[16:19], a[72:75], v[40:43], 0
v_mfma_f32_16x16x32_bf16 v[20:23], a[72:75], v[44:47], 0
s_waitcnt lgkmcnt(4)
v_mfma_f32_16x16x32_bf16 v[8:11], a[4:7], v[48:51], v[8:11]
s_waitcnt vmcnt(5)
s_barrier
ds_read_b128 v[40:43], v1 offset:4096
ds_read_b128 v[44:47], v1 offset:22528
v_mfma_f32_16x16x32_bf16 v[12:15], a[4:7], v[52:55], v[12:15]
v_mfma_f32_16x16x32_bf16 v[16:19], a[76:79], v[48:51], v[16:19]
v_mfma_f32_16x16x32_bf16 v[20:23], a[76:79], v[52:55], v[20:23]
s_waitcnt lgkmcnt(4)
v_mfma_f32_16x16x32_bf16 v[8:11], a[8:11], v[56:59], v[8:11]
ds_read_b128 v[48:51], v1 offset:5120
ds_read_b128 v[52:55], v1 offset:23552
v_mfma_f32_16x16x32_bf16 v[12:15], a[8:11], v[60:63], v[12:15]
v_mfma_f32_16x16x32_bf16 v[16:19], a[80:83], v[56:59], v[16:19]
v_mfma_f32_16x16x32_bf16 v[20:23], a[80:83], v[60:63], v[20:23]
s_waitcnt lgkmcnt(4)
v_mfma_f32_16x16x32_bf16 v[8:11], a[12:15], v[64:67], v[8:11]
ds_read_b128 v[56:59], v1 offset:6144
ds_read_b128 v[60:63], v1 offset:24576
v_mfma_f32_16x16x32_bf16 v[12:15], a[12:15], v[68:71], v[12:15]
v_mfma_f32_16x16x32_bf16 v[16:19], a[84:87], v[64:67], v[16:19]
v_mfma_f32_16x16x32_bf16 v[20:23], a[84:87], v[68:71], v[20:23]
s_waitcnt lgkmcnt(4)
v_mfma_f32_16x16x32_bf16 v[8:11], a[16:19], v[40:43], v[8:11]
ds_read_b128 v[64:67], v1 offset:7168
ds_read_b128 v[68:71], v1 offset:25600
v_mfma_f32_16x16x32_bf16 v[12:15], a[16:19], v[44:47], v[12:15]
v_mfma_f32_16x16x32_bf16 v[16:19], a[88:91], v[40:43], v[16:19]
v_mfma_f32_16x16x32_bf16 v[20:23], a[88:91], v[44:47], v[20:23]
s_waitcnt lgkmcnt(4)
v_mfma_f32_16x16x32_bf16 v[8:11], a[20:23], v[48:51], v[8:11]
ds_read_b128 v[40:43], v1 offset:8192
ds_read_b128 v[44:47], v1 offset:26624
v_mfma_f32_16x16x32_bf16 v[12:15], a[20:23], v[52:55], v[12:15]
v_mfma_f32_16x16x32_bf16 v[16:19], a[92:95], v[48:51], v[16:19]
v_mfma_f32_16x16x32_bf16 v[20:23], a[92:95], v[52:55], v[20:23]
s_waitcnt lgkmcnt(4)
v_mfma_f32_16x16x32_bf16 v[8:11], a[24:27], v[56:59], v[8:11]
ds_read_b128 v[48:51], v1 offset:9216
ds_read_b128 v[52:55], v1 offset:27648
v_mfma_f32_16x16x32_bf16 v[12:15], a[24:27], v[60:63], v[12:15]
v_mfma_f32_16x16x32_bf16 v[16:19], a[96:99], v[56:59], v[16:19]
v_mfma_f32_16x16x32_bf16 v[20:23], a[96:99], v[60:63], v[20:23]
s_waitcnt lgkmcnt(4)
v_mfma_f32_16x16x32_bf16 v[8:11], a[28:31], v[64:67], v[8:11]
s_waitcnt vmcnt(0)
buffer_store_dword v7, off, s[8:11], s36 sc1
s_barrier
ds_read_b128 v[56:59], v1 offset:10240
ds_read_b128 v[60:63], v1 offset:28672
v_mfma_f32_16x16x32_bf16 v[12:15], a[28:31], v[68:71], v[12:15]
v_mfma_f32_16x16x32_bf16 v[16:19], a[100:103], v[64:67], v[16:19]
v_mfma_f32_16x16x32_bf16 v[20:23], a[100:103], v[68:71], v[20:23]
s_waitcnt lgkmcnt(4)
v_mfma_f32_16x16x32_bf16 v[8:11], a[32:35], v[40:43], v[8:11]
ds_read_b128 v[64:67], v1 offset:11264
ds_read_b128 v[68:71], v1 offset:29696
v_mfma_f32_16x16x32_bf16 v[12:15], a[32:35], v[44:47], v[12:15]
v_mfma_f32_16x16x32_bf16 v[16:19], a[104:107], v[40:43], v[16:19]
v_mfma_f32_16x16x32_bf16 v[20:23], a[104:107], v[44:47], v[20:23]
v_cmp_eq_u32 vcc, 0, v162
s_mov_b32 s38, 0
s_cbranch_vccnz L_f1d
s_cmp_lt_u32 s22, 63
s_cbranch_scc0 L_f1d
s_mov_b32 s38, 1
s_waitcnt lgkmcnt(4)
v_mfma_f32_16x16x32_bf16 v[8:11], a[36:39], v[48:51], v[8:11]
ds_read_b128 v[40:43], v1 offset:12288
ds_read_b128 v[44:47], v1 offset:30720
v_mfma_f32_16x16x32_bf16 v[12:15], a[36:39], v[52:55], v[12:15]
v_mfma_f32_16x16x32_bf16 v[16:19], a[108:111], v[48:51], v[16:19]
s_and_b32 s19, s16, 1
s_mul_i32 s19, s19, 18432
s_lshr_b32 s20, s16, 1
s_lshl_b32 s20, s20, 10
s_add_u32 s19, s19, s20
s_add_u32 s20, s19, s32
s_add_u32 s19, s19, s37
s_mov_b32 m0, s20
s_add_u32 s20, s20, 2048
buffer_load_dwordx4 v0, s[8:11], s19 offen lds
s_add_u32 s19, s19, 2048
v_mfma_f32_16x16x32_bf16 v[20:23], a[108:111], v[52:55], v[20:23]
s_waitcnt lgkmcnt(4)
v_mfma_f32_16x16x32_bf16 v[8:11], a[40:43], v[56:59], v[8:11]
ds_read_b128 v[48:51], v1 offset:13312
ds_read_b128 v[52:55], v1 offset:31744
v_mfma_f32_16x16x32_bf16 v[12:15], a[40:43], v[60:63], v[12:15]
v_mfma_f32_16x16x32_bf16 v[16:19], a[112:115], v[56:59], v[16:19]
s_mov_b32 m0, s20
s_add_u32 s20, s20, 2048
buffer_load_dwordx4 v0, s[8:11], s19 offen lds
s_add_u32 s19, s19, 2048
v_mfma_f32_16x16x32_bf16 v[20:23], a[112:115], v[60:63], v[20:23]
s_waitcnt lgkmcnt(4)
v_mfma_f32_16x16x32_bf16 v[8:11], a[44:47], v[64:67], v[8:11]
ds_read_b128 v[56:59], v1 offset:14336
ds_read_b128 v[60:63], v1 offset:32768
v_mfma_f32_16x16x32_bf16 v[12:15], a[44:47], v[68:71], v[12:15]
v_mfma_f32_16x16x32_bf16 v[16:19], a[116:119], v[64:67], v[16:19]
s_mov_b32 m0, s20
s_add_u32 s20, s20, 2048
buffer_load_dwordx4 v0, s[8:11], s19 offen lds
s_add_u32 s19, s19, 2048
v_mfma_f32_16x16x32_bf16 v[20:23], a[116:119], v[68:71], v[20:23]
s_waitcnt lgkmcnt(4)
v_mfma_f32_16x16x32_bf16 v[8:11], a[48:51], v[40:43], v[8:11]
ds_read_b128 v[64:67], v1 offset:15360
ds_read_b128 v[68:71], v1 offset:33792
v_mfma_f32_16x16x32_bf16 v[12:15], a[48:51], v[44:47], v[12:15]
v_mfma_f32_16x16x32_bf16 v[16:19], a[120:123], v[40:43], v[16:19]
s_mov_b32 m0, s20
s_add_u32 s20, s20, 2048
buffer_load_dwordx4 v0, s[8:11], s19 offen lds
s_add_u32 s19, s19, 2048
v_mfma_f32_16x16x32_bf16 v[20:23], a[120:123], v[44:47], v[20:23]
s_waitcnt lgkmcnt(4)
v_mfma_f32_16x16x32_bf16 v[8:11], a[52:55], v[48:51], v[8:11]
ds_read_b128 v[40:43], v1 offset:16384
ds_read_b128 v[44:47], v1 offset:34816
v_mfma_f32_16x16x32_bf16 v[12:15], a[52:55], v[52:55], v[12:15]
v_mfma_f32_16x16x32_bf16 v[16:19], a[124:127], v[48:51], v[16:19]
s_mov_b32 m0, s20
s_add_u32 s20, s20, 2048
buffer_load_dwordx4 v0, s[8:11], s19 offen lds
s_add_u32 s19, s19, 2048
v_mfma_f32_16x16x32_bf16 v[20:23], a[124:127], v[52:55], v[20:23]
s_waitcnt lgkmcnt(4)
v_mfma_f32_16x16x32_bf16 v[8:11], a[56:59], v[56:59], v[8:11]
ds_read_b128 v[48:51], v1 offset:17408
ds_read_b128 v[52:55], v1 offset:35840
v_mfma_f32_16x16x32_bf16 v[12:15], a[56:59], v[60:63], v[12:15]
v_mfma_f32_16x16x32_bf16 v[16:19], a[128:131], v[56:59], v[16:19]
s_mov_b32 m0, s20
s_add_u32 s20, s20, 2048
buffer_load_dwordx4 v0, s[8:11], s19 offen lds
s_add_u32 s19, s19, 2048
v_mfma_f32_16x16x32_bf16 v[20:23], a[128:131], v[60:63], v[20:23]
s_waitcnt lgkmcnt(4)
v_mfma_f32_16x16x32_bf16 v[8:11], a[60:63], v[64:67], v[8:11]
v_mfma_f32_16x16x32_bf16 v[12:15], a[60:63], v[68:71], v[12:15]
v_mfma_f32_16x16x32_bf16 v[16:19], a[132:135], v[64:67], v[16:19]
s_mov_b32 m0, s20
s_add_u32 s20, s20, 2048
buffer_load_dwordx4 v0, s[8:11], s19 offen lds
s_add_u32 s19, s19, 2048
v_mfma_f32_16x16x32_bf16 v[20:23], a[132:135], v[68:71], v[20:23]
s_waitcnt lgkmcnt(2)
v_mfma_f32_16x16x32_bf16 v[8:11], a[64:67], v[40:43], v[8:11]
v_mfma_f32_16x16x32_bf16 v[12:15], a[64:67], v[44:47], v[12:15]
v_mfma_f32_16x16x32_bf16 v[16:19], a[136:139], v[40:43], v[16:19]
s_mov_b32 m0, s20
s_add_u32 s20, s20, 2048
buffer_load_dwordx4 v0, s[8:11], s19 offen lds
s_add_u32 s19, s19, 2048
v_mfma_f32_16x16x32_bf16 v[20:23], a[136:139], v[44:47], v[20:23]
s_waitcnt lgkmcnt(0)
v_mfma_f32_16x16x32_bf16 v[8:11], a[68:71], v[48:51], v[8:11]
v_mfma_f32_16x16x32_bf16 v[12:15], a[68:71], v[52:55], v[12:15]
v_mfma_f32_16x16x32_bf16 v[16:19], a[140:143], v[48:51], v[16:19]
s_mov_b32 m0, s20
s_add_u32 s20, s20, 2048
buffer_load_dwordx4 v0, s[8:11], s19 offen lds
s_add_u32 s19, s19, 2048
v_mfma_f32_16x16x32_bf16 v[20:23], a[140:143], v[52:55], v[20:23]
s_branch L_f1e
L_f1d:
s_waitcnt lgkmcnt(4)
v_mfma_f32_16x16x32_bf16 v[8:11], a[36:39], v[48:51], v[8:11]
ds_read_b128 v[40:43], v1 offset:12288
ds_read_b128 v[44:47], v1 offset:30720
v_mfma_f32_16x16x32_bf16 v[12:15], a[36:39], v[52:55], v[12:15]
v_mfma_f32_16x16x32_bf16 v[16:19], a[108:111], v[48:51], v[16:19]
v_mfma_f32_16x16x32_bf16 v[20:23], a[108:111], v[52:55], v[20:23]
s_waitcnt lgkmcnt(4)
v_mfma_f32_16x16x32_bf16 v[8:11], a[40:43], v[56:59], v[8:11]
ds_read_b128 v[48:51], v1 offset:13312
ds_read_b128 v[52:55], v1 offset:31744
v_mfma_f32_16x16x32_bf16 v[12:15], a[40:43], v[60:63], v[12:15]
v_mfma_f32_16x16x32_bf16 v[16:19], a[112:115], v[56:59], v[16:19]
v_mfma_f32_16x16x32_bf16 v[20:23], a[112:115], v[60:63], v[20:23]
s_waitcnt lgkmcnt(4)
v_mfma_f32_16x16x32_bf16 v[8:11], a[44:47], v[64:67], v[8:11]
ds_read_b128 v[56:59], v1 offset:14336
ds_read_b128 v[60:63], v1 offset:32768
v_mfma_f32_16x16x32_bf16 v[12:15], a[44:47], v[68:71], v[12:15]
v_mfma_f32_16x16x32_bf16 v[16:19], a[116:119], v[64:67], v[16:19]
v_mfma_f32_16x16x32_bf16 v[20:23], a[116:119], v[68:71], v[20:23]
s_waitcnt lgkmcnt(4)
v_mfma_f32_16x16x32_bf16 v[8:11], a[48:51], v[40:43], v[8:11]
ds_read_b128 v[64:67], v1 offset:15360
ds_read_b128 v[68:71], v1 offset:33792
v_mfma_f32_16x16x32_bf16 v[12:15], a[48:51], v[44:47], v[12:15]
v_mfma_f32_16x16x32_bf16 v[16:19], a[120:123], v[40:43], v[16:19]
v_mfma_f32_16x16x32_bf16 v[20:23], a[120:123], v[44:47], v[20:23]
s_waitcnt lgkmcnt(4)
v_mfma_f32_16x16x32_bf16 v[8:11], a[52:55], v[48:51], v[8:11]
ds_read_b128 v[40:43], v1 offset:16384
ds_read_b128 v[44:47], v1 offset:34816
v_mfma_f32_16x16x32_bf16 v[12:15], a[52:55], v[52:55], v[12:15]
v_mfma_f32_16x16x32_bf16 v[16:19], a[124:127], v[48:51], v[16:19]
v_mfma_f32_16x16x32_bf16 v[20:23], a[124:127], v[52:55], v[20:23]
s_waitcnt lgkmcnt(4)
v_mfma_f32_16x16x32_bf16 v[8:11], a[56:59], v[56:59], v[8:11]
ds_read_b128 v[48:51], v1 offset:17408
ds_read_b128 v[52:55], v1 offset:35840
v_mfma_f32_16x16x32_bf16 v[12:15], a[56:59], v[60:63], v[12:15]
v_mfma_f32_16x16x32_bf16 v[16:19], a[128:131], v[56:59], v[16:19]
v_mfma_f32_16x16x32_bf16 v[20:23], a[128:131], v[60:63], v[20:23]
s_waitcnt lgkmcnt(4)
v_mfma_f32_16x16x32_bf16 v[8:11], a[60:63], v[64:67], v[8:11]
v_mfma_f32_16x16x32_bf16 v[12:15], a[60:63], v[68:71], v[12:15]
v_mfma_f32_16x16x32_bf16 v[16:19], a[132:135], v[64:67], v[16:19]
v_mfma_f32_16x16x32_bf16 v[20:23], a[132:135], v[68:71], v[20:23]
s_waitcnt lgkmcnt(2)
v_mfma_f32_16x16x32_bf16 v[8:11], a[64:67], v[40:43], v[8:11]
v_mfma_f32_16x16x32_bf16 v[12:15], a[64:67], v[44:47], v[12:15]
v_mfma_f32_16x16x32_bf16 v[16:19], a[136:139], v[40:43], v[16:19]
v_mfma_f32_16x16x32_bf16 v[20:23], a[136:139], v[44:47], v[20:23]
s_waitcnt lgkmcnt(0)
v_mfma_f32_16x16x32_bf16 v[8:11], a[68:71], v[48:51], v[8:11]
v_mfma_f32_16x16x32_bf16 v[12:15], a[68:71], v[52:55], v[12:15]
v_mfma_f32_16x16x32_bf16 v[16:19], a[140:143], v[48:51], v[16:19]
v_mfma_f32_16x16x32_bf16 v[20:23], a[140:143], v[52:55], v[20:23]
L_f1e:
v_cmp_u_f32 vcc, v8, v12
s_cbranch_vccnz L_f1x
L_f1y:
s_mov_b32 s39, 0
v_cvt_pk_bf16_f32 v72, v8, v9
v_cvt_pk_bf16_f32 v73, v10, v11
v_cvt_pk_bf16_f32 v74, v12, v13
v_cvt_pk_bf16_f32 v75, v14, v15
v_cvt_pk_bf16_f32 v76, v16, v17
v_cvt_pk_bf16_f32 v77, v18, v19
v_cvt_pk_bf16_f32 v78, v20, v21
v_cvt_pk_bf16_f32 v79, v22, v23
v_lshlrev_b32 v8, 16, v72
v_and_b32 v9, s18, v72
v_lshlrev_b32 v10, 16, v73
v_and_b32 v11, s18, v73
v_lshlrev_b32 v12, 16, v74
v_and_b32 v13, s18, v74
v_lshlrev_b32 v14, 16, v75
v_and_b32 v15, s18, v75
v_lshlrev_b32 v16, 16, v76
v_and_b32 v17, s18, v76
v_lshlrev_b32 v18, 16, v77
v_and_b32 v19, s18, v77
v_lshlrev_b32 v20, 16, v78
v_and_b32 v21, s18, v78
v_lshlrev_b32 v22, 16, v79
v_and_b32 v23, s18, v79
v_pk_mul_f32 v[8:9], v[8:9], s[34:35]
v_pk_mul_f32 v[10:11], v[10:11], s[34:35]
v_pk_mul_f32 v[12:13], v[12:13], s[34:35]
v_pk_mul_f32 v[14:15], v[14:15], s[34:35]
v_exp_f32 v8, v8
v_exp_f32 v9, v9
v_exp_f32 v10, v10
v_exp_f32 v11, v11
v_exp_f32 v12, v12
v_exp_f32 v13, v13
v_exp_f32 v14, v14
v_exp_f32 v15, v15
v_pk_add_f32 v[8:9], v[8:9], 1.0 op_sel_hi:[1,0]
v_pk_add_f32 v[10:11], v[10:11], 1.0 op_sel_hi:[1,0]
v_pk_add_f32 v[12:13], v[12:13], 1.0 op_sel_hi:[1,0]
v_pk_add_f32 v[14:15], v[14:15], 1.0 op_sel_hi:[1,0]
v_rcp_f32 v8, v8
v_rcp_f32 v9, v9
v_rcp_f32 v10, v10
v_rcp_f32 v11, v11
v_rcp_f32 v12, v12
v_rcp_f32 v13, v13
v_rcp_f32 v14, v14
v_rcp_f32 v15, v15
v_cvt_pk_bf16_f32 v72, v8, v9
v_cvt_pk_bf16_f32 v73, v10, v11
v_cvt_pk_bf16_f32 v74, v12, v13
v_cvt_pk_bf16_f32 v75, v14, v15
v_lshlrev_b32 v8, 16, v72
v_and_b32 v9, s18, v72
v_lshlrev_b32 v10, 16, v73
v_and_b32 v11, s18, v73
v_lshlrev_b32 v12, 16, v74
v_and_b32 v13, s18, v74
v_lshlrev_b32 v14, 16, v75
v_and_b32 v15, s18, v75
v_pk_mul_f32 v[8:9], v[8:9], v[16:17]
v_pk_mul_f32 v[10:11], v[10:11], v[18:19]
v_pk_mul_f32 v[12:13], v[12:13], v[20:21]
v_pk_mul_f32 v[14:15], v[14:15], v[22:23]
v_cvt_pk_bf16_f32 v76, v8, v9
v_cvt_pk_bf16_f32 v77, v10, v11
v_cvt_pk_bf16_f32 v78, v12, v13
v_cvt_pk_bf16_f32 v79, v14, v15
s_nop 0
v_permlane16_swap_b32 v76, v78
v_permlane16_swap_b32 v77, v79
buffer_store_dwordx4 v[76:79], v3, s[8:11], s28 offen sc1
s_add_u32 s28, s28, 294912
s_add_u32 s22, s22, 1
s_mov_b32 s36, s30
s_add_u32 s30, s30, 1280
s_cmp_lt_u32 s22, 64
s_cbranch_scc1 L_f1
s_waitcnt vmcnt(0)
buffer_store_dword v7, off, s[8:11], s36 sc1
s_waitcnt vmcnt(0)
s_endpgm
L_f1x:
s_add_u32 s39, s39, 1
s_cmp_ge_u32 s39, 3
s_cbranch_scc1 L_f1y
s_cmp_lt_u32 s22, 56
s_cbranch_scc1 L_f1y
s_sub_u32 s33, s33, 64
s_sub_u32 s37, s37, 36864
s_waitcnt vmcnt(0)
s_branch L_f1r
L_r_op:
s_mul_i32 s22, s17, 43
s_lshr_b32 s22, s22, 9
s_mul_i32 s19, s22, 12
s_sub_u32 s23, s17, s19
s_mov_b32 s59, s23
s_and_b32 s32, s23, 1
s_lshr_b32 s23, s23, 1
s_lshl_b32 s32, s32, 2
s_add_u32 s32, s32, s16
s_cmp_eq_u32 s16, 0
s_cbranch_scc0 L_wdog0o
v_mov_b32 v8, 0
s_sleep 100
L_wd0g0o:
global_load_dword v9, v8, s[6:7] offset:68 sc1
s_waitcnt vmcnt(0)
v_cmp_gt_u32 vcc, 32, v9
s_cbranch_vccz L_wdn0g0o
s_sleep 100
s_add_u32 s21, s21, 1
s_cmp_ge_u32 s21, 4194304
s_cbranch_scc1 L_abort
s_branch L_wd0g0o
L_wdn0g0o:
L_wdog0o:
s_barrier
s_load_dwordx2 s[4:5], s[0:1], 40
s_waitcnt lgkmcnt(0)
s_mov_b32 s12, s4
s_and_b32 s13, s5, 0xffff
s_mov_b32 s14, 4718592
s_mov_b32 s15, 0x20000
v_add_u32 v8, 0, v2
v_mul_u32_u24 v9, 171, v8
v_lshrrev_b32 v9, 11, v9
v_mul_u32_u24 v10, 12, v9
v_sub_u32 v8, v8, v10
v_mul_u32_u24 v9, 1152, v9
v_lshl_add_u32 v12, v8, 4, v9
v_add_u32 v8, 64, v2
v_mul_u32_u24 v9, 171, v8
v_lshrrev_b32 v9, 11, v9
v_mul_u32_u24 v10, 12, v9
v_sub_u32 v8, v8, v10
v_mul_u32_u24 v9, 1152, v9
v_lshl_add_u32 v13, v8, 4, v9
v_add_u32 v8, 128, v2
v_mul_u32_u24 v9, 171, v8
v_lshrrev_b32 v9, 11, v9
v_mul_u32_u24 v10, 12, v9
v_sub_u32 v8, v8, v10
v_mul_u32_u24 v9, 1152, v9
v_lshl_add_u32 v14, v8, 4, v9
v_add_u32 v8, 192, v2
v_mul_u32_u24 v9, 171, v8
v_lshrrev_b32 v9, 11, v9
v_mul_u32_u24 v10, 12, v9
v_sub_u32 v8, v8, v10
v_mul_u32_u24 v9, 1152, v9
v_lshl_add_u32 v15, v8, 4, v9
v_add_u32 v8, 256, v2
v_mul_u32_u24 v9, 171, v8
v_lshrrev_b32 v9, 11, v9
v_mul_u32_u24 v10, 12, v9
v_sub_u32 v8, v8, v10
v_mul_u32_u24 v9, 1152, v9
v_lshl_add_u32 v16, v8, 4, v9
v_add_u32 v8, 320, v2
v_mul_u32_u24 v9, 171, v8
v_lshrrev_b32 v9, 11, v9
v_mul_u32_u24 v10, 12, v9
v_sub_u32 v8, v8, v10
v_mul_u32_u24 v9, 1152, v9
v_lshl_add_u32 v17, v8, 4, v9
v_lshrrev_b32 v8, 4, v2
v_lshlrev_b32 v8, 2, v8
v_bfe_u32 v9, v2, 2, 2
v_add_u32 v8, v8, v9
v_mul_u32_u24 v8, 192, v8
v_and_b32 v9, 3, v2
v_lshl_add_u32 v8, v9, 3, v8
s_mul_i32 s33, s16, 36864
v_add_u32 v6, s33, v8
s_mul_i32 s34, s32, 589824
s_mul_i32 s19, s23, 192
s_add_u32 s34, s34, s19
s_mov_b32 s35, s33
s_mov_b32 m0, s35
s_add_u32 s35, s35, 1024
buffer_load_dwordx4 v12, s[12:15], s34 offen lds
s_mov_b32 m0, s35
s_add_u32 s35, s35, 1024
buffer_load_dwordx4 v13, s[12:15], s34 offen lds
s_mov_b32 m0, s35
s_add_u32 s35, s35, 1024
buffer_load_dwordx4 v14, s[12:15], s34 offen lds
s_mov_b32 m0, s35
s_add_u32 s35, s35, 1024
buffer_load_dwordx4 v15, s[12:15], s34 offen lds
s_mov_b32 m0, s35
s_add_u32 s35, s35, 1024
buffer_load_dwordx4 v16, s[12:15], s34 offen lds
s_mov_b32 m0, s35
s_add_u32 s35, s35, 1024
buffer_load_dwordx4 v17, s[12:15], s34 offen lds
s_add_u32 s34, s34, 36864
s_mov_b32 m0, s35
s_add_u32 s35, s35, 1024
buffer_load_dwordx4 v12, s[12:15], s34 offen lds
s_mov_b32 m0, s35
s_add_u32 s35, s35, 1024
buffer_load_dwordx4 v13, s[12:15], s34 offen lds
s_mov_b32 m0, s35
s_add_u32 s35, s35, 1024
buffer_load_dwordx4 v14, s[12:15], s34 offen lds
s_mov_b32 m0, s35
s_add_u32 s35, s35, 1024
buffer_load_dwordx4 v15, s[12:15], s34 offen lds
s_mov_b32 m0, s35
s_add_u32 s35, s35, 1024
buffer_load_dwordx4 v16, s[12:15], s34 offen lds
s_mov_b32 m0, s35
s_add_u32 s35, s35, 1024
buffer_load_dwordx4 v17, s[12:15], s34 offen lds
s_add_u32 s34, s34, 36864
s_mov_b32 m0, s35
s_add_u32 s35, s35, 1024
buffer_load_dwordx4 v12, s[12:15], s34 offen lds
s_mov_b32 m0, s35
s_add_u32 s35, s35, 1024
buffer_load_dwordx4 v13, s[12:15], s34 offen lds
s_mov_b32 m0, s35
s_add_u32 s35, s35, 1024
buffer_load_dwordx4 v14, s[12:15], s34 offen lds
s_mov_b32 m0, s35
s_add_u32 s35, s35, 1024
buffer_load_dwordx4 v15, s[12:15], s34 offen lds
s_mov_b32 m0, s35
s_add_u32 s35, s35, 1024
buffer_load_dwordx4 v16, s[12:15], s34 offen lds
s_mov_b32 m0, s35
s_add_u32 s35, s35, 1024
buffer_load_dwordx4 v17, s[12:15], s34 offen lds
s_add_u32 s34, s34, 36864
s_mov_b32 m0, s35
s_add_u32 s35, s35, 1024
buffer_load_dwordx4 v12, s[12:15], s34 offen lds
s_mov_b32 m0, s35
s_add_u32 s35, s35, 1024
buffer_load_dwordx4 v13, s[12:15], s34 offen lds
s_mov_b32 m0, s35
s_add_u32 s35, s35, 1024
buffer_load_dwordx4 v14, s[12:15], s34 offen lds
s_mov_b32 m0, s35
s_add_u32 s35, s35, 1024
buffer_load_dwordx4 v15, s[12:15], s34 offen lds
s_mov_b32 m0, s35
s_add_u32 s35, s35, 1024
buffer_load_dwordx4 v16, s[12:15], s34 offen lds
s_mov_b32 m0, s35
s_add_u32 s35, s35, 1024
buffer_load_dwordx4 v17, s[12:15], s34 offen lds
s_add_u32 s34, s34, 36864
s_mov_b32 m0, s35
s_add_u32 s35, s35, 1024
buffer_load_dwordx4 v12, s[12:15], s34 offen lds
s_mov_b32 m0, s35
s_add_u32 s35, s35, 1024
buffer_load_dwordx4 v13, s[12:15], s34 offen lds
s_mov_b32 m0, s35
s_add_u32 s35, s35, 1024
buffer_load_dwordx4 v14, s[12:15], s34 offen lds
s_mov_b32 m0, s35
s_add_u32 s35, s35, 1024
buffer_load_dwordx4 v15, s[12:15], s34 offen lds
s_mov_b32 m0, s35
s_add_u32 s35, s35, 1024
buffer_load_dwordx4 v16, s[12:15], s34 offen lds
s_mov_b32 m0, s35
s_add_u32 s35, s35, 1024
buffer_load_dwordx4 v17, s[12:15], s34 offen lds
s_add_u32 s34, s34, 36864
s_mov_b32 m0, s35
s_add_u32 s35, s35, 1024
buffer_load_dwordx4 v12, s[12:15], s34 offen lds
s_mov_b32 m0, s35
s_add_u32 s35, s35, 1024
buffer_load_dwordx4 v13, s[12:15], s34 offen lds
s_mov_b32 m0, s35
s_add_u32 s35, s35, 1024
buffer_load_dwordx4 v14, s[12:15], s34 offen lds
s_mov_b32 m0, s35
s_add_u32 s35, s35, 1024
buffer_load_dwordx4 v15, s[12:15], s34 offen lds
s_mov_b32 m0, s35
s_add_u32 s35, s35, 1024
buffer_load_dwordx4 v16, s[12:15], s34 offen lds
s_mov_b32 m0, s35
s_add_u32 s35, s35, 1024
buffer_load_dwordx4 v17, s[12:15], s34 offen lds
s_add_u32 s34, s34, 36864
s_waitcnt vmcnt(30)
ds_read_b64_tr_b16 a[0:1], v6
ds_read_b64_tr_b16 a[2:3], v6 offset:3072
ds_read_b64_tr_b16 a[4:5], v6 offset:32
ds_read_b64_tr_b16 a[6:7], v6 offset:3104
ds_read_b64_tr_b16 a[8:9], v6 offset:64
ds_read_b64_tr_b16 a[10:11], v6 offset:3136
ds_read_b64_tr_b16 a[12:13], v6 offset:96
ds_read_b64_tr_b16 a[14:15], v6 offset:3168
ds_read_b64_tr_b16 a[16:17], v6 offset:128
ds_read_b64_tr_b16 a[18:19], v6 offset:3200
ds_read_b64_tr_b16 a[20:21], v6 offset:160
ds_read_b64_tr_b16 a[22:23], v6 offset:3232
s_waitcnt vmcnt(24)
ds_read_b64_tr_b16 a[24:25], v6 offset:6144
ds_read_b64_tr_b16 a[26:27], v6 offset:9216
ds_read_b64_tr_b16 a[28:29], v6 offset:6176
ds_read_b64_tr_b16 a[30:31], v6 offset:9248
ds_read_b64_tr_b16 a[32:33], v6 offset:6208
ds_read_b64_tr_b16 a[34:35], v6 offset:9280
ds_read_b64_tr_b16 a[36:37], v6 offset:6240
ds_read_b64_tr_b16 a[38:39], v6 offset:9312
ds_read_b64_tr_b16 a[40:41], v6 offset:6272
ds_read_b64_tr_b16 a[42:43], v6 offset:9344
ds_read_b64_tr_b16 a[44:45], v6 offset:6304
ds_read_b64_tr_b16 a[46:47], v6 offset:9376
s_waitcnt vmcnt(18)
ds_read_b64_tr_b16 a[48:49], v6 offset:12288
ds_read_b64_tr_b16 a[50:51], v6 offset:15360
ds_read_b64_tr_b16 a[52:53], v6 offset:12320
ds_read_b64_tr_b16 a[54:55], v6 offset:15392
ds_read_b64_tr_b16 a[56:57], v6 offset:12352
ds_read_b64_tr_b16 a[58:59], v6 offset:15424
ds_read_b64_tr_b16 a[60:61], v6 offset:12384
ds_read_b64_tr_b16 a[62:63], v6 offset:15456
ds_read_b64_tr_b16 a[64:65], v6 offset:12416
ds_read_b64_tr_b16 a[66:67], v6 offset:15488
ds_read_b64_tr_b16 a[68:69], v6 offset:12448
ds_read_b64_tr_b16 a[70:71], v6 offset:15520
s_waitcnt vmcnt(12)
ds_read_b64_tr_b16 a[72:73], v6 offset:18432
ds_read_b64_tr_b16 a[74:75], v6 offset:21504
ds_read_b64_tr_b16 a[76:77], v6 offset:18464
ds_read_b64_tr_b16 a[78:79], v6 offset:21536
ds_read_b64_tr_b16 a[80:81], v6 offset:18496
ds_read_b64_tr_b16 a[82:83], v6 offset:21568
ds_read_b64_tr_b16 a[84:85], v6 offset:18528
ds_read_b64_tr_b16 a[86:87], v6 offset:21600
ds_read_b64_tr_b16 a[88:89], v6 offset:18560
ds_read_b64_tr_b16 a[90:91], v6 offset:21632
ds_read_b64_tr_b16 a[92:93], v6 offset:18592
ds_read_b64_tr_b16 a[94:95], v6 offset:21664
s_waitcnt vmcnt(6)
ds_read_b64_tr_b16 a[96:97], v6 offset:24576
ds_read_b64_tr_b16 a[98:99], v6 offset:27648
ds_read_b64_tr_b16 a[100:101], v6 offset:24608
ds_read_b64_tr_b16 a[102:103], v6 offset:27680
ds_read_b64_tr_b16 a[104:105], v6 offset:24640
ds_read_b64_tr_b16 a[106:107], v6 offset:27712
ds_read_b64_tr_b16 a[108:109], v6 offset:24672
ds_read_b64_tr_b16 a[110:111], v6 offset:27744
ds_read_b64_tr_b16 a[112:113], v6 offset:24704
ds_read_b64_tr_b16 a[114:115], v6 offset:27776
ds_read_b64_tr_b16 a[116:117], v6 offset:24736
ds_read_b64_tr_b16 a[118:119], v6 offset:27808
s_waitcnt vmcnt(0)
ds_read_b64_tr_b16 a[120:121], v6 offset:30720
ds_read_b64_tr_b16 a[122:123], v6 offset:33792
ds_read_b64_tr_b16 a[124:125], v6 offset:30752
ds_read_b64_tr_b16 a[126:127], v6 offset:33824
ds_read_b64_tr_b16 a[128:129], v6 offset:30784
ds_read_b64_tr_b16 a[130:131], v6 offset:33856
ds_read_b64_tr_b16 a[132:133], v6 offset:30816
ds_read_b64_tr_b16 a[134:135], v6 offset:33888
ds_read_b64_tr_b16 a[136:137], v6 offset:30848
ds_read_b64_tr_b16 a[138:139], v6 offset:33920
ds_read_b64_tr_b16 a[140:141], v6 offset:30880
ds_read_b64_tr_b16 a[142:143], v6 offset:33952
s_waitcnt lgkmcnt(0)
s_mov_b32 s35, s33
s_mov_b32 m0, s35
s_add_u32 s35, s35, 1024
buffer_load_dwordx4 v12, s[12:15], s34 offen lds
s_mov_b32 m0, s35
s_add_u32 s35, s35, 1024
buffer_load_dwordx4 v13, s[12:15], s34 offen lds
s_mov_b32 m0, s35
s_add_u32 s35, s35, 1024
buffer_load_dwordx4 v14, s[12:15], s34 offen lds
s_mov_b32 m0, s35
s_add_u32 s35, s35, 1024
buffer_load_dwordx4 v15, s[12:15], s34 offen lds
s_mov_b32 m0, s35
s_add_u32 s35, s35, 1024
buffer_load_dwordx4 v16, s[12:15], s34 offen lds
s_mov_b32 m0, s35
s_add_u32 s35, s35, 1024
buffer_load_dwordx4 v17, s[12:15], s34 offen lds
s_add_u32 s34, s34, 36864
s_mov_b32 m0, s35
s_add_u32 s35, s35, 1024
buffer_load_dwordx4 v12, s[12:15], s34 offen lds
s_mov_b32 m0, s35
s_add_u32 s35, s35, 1024
buffer_load_dwordx4 v13, s[12:15], s34 offen lds
s_mov_b32 m0, s35
s_add_u32 s35, s35, 1024
buffer_load_dwordx4 v14, s[12:15], s34 offen lds
s_mov_b32 m0, s35
s_add_u32 s35, s35, 1024
buffer_load_dwordx4 v15, s[12:15], s34 offen lds
s_mov_b32 m0, s35
s_add_u32 s35, s35, 1024
buffer_load_dwordx4 v16, s[12:15], s34 offen lds
s_mov_b32 m0, s35
s_add_u32 s35, s35, 1024
buffer_load_dwordx4 v17, s[12:15], s34 offen lds
s_add_u32 s34, s34, 36864
s_mov_b32 m0, s35
s_add_u32 s35, s35, 1024
buffer_load_dwordx4 v12, s[12:15], s34 offen lds
s_mov_b32 m0, s35
s_add_u32 s35, s35, 1024
buffer_load_dwordx4 v13, s[12:15], s34 offen lds
s_mov_b32 m0, s35
s_add_u32 s35, s35, 1024
buffer_load_dwordx4 v14, s[12:15], s34 offen lds
s_mov_b32 m0, s35
s_add_u32 s35, s35, 1024
buffer_load_dwordx4 v15, s[12:15], s34 offen lds
s_mov_b32 m0, s35
s_add_u32 s35, s35, 1024
buffer_load_dwordx4 v16, s[12:15], s34 offen lds
s_mov_b32 m0, s35
s_add_u32 s35, s35, 1024
buffer_load_dwordx4 v17, s[12:15], s34 offen lds
s_add_u32 s34, s34, 36864
s_mov_b32 m0, s35
s_add_u32 s35, s35, 1024
buffer_load_dwordx4 v12, s[12:15], s34 offen lds
s_mov_b32 m0, s35
s_add_u32 s35, s35, 1024
buffer_load_dwordx4 v13, s[12:15], s34 offen lds
s_mov_b32 m0, s35
s_add_u32 s35, s35, 1024
buffer_load_dwordx4 v14, s[12:15], s34 offen lds
s_mov_b32 m0, s35
s_add_u32 s35, s35, 1024
buffer_load_dwordx4 v15, s[12:15], s34 offen lds
s_mov_b32 m0, s35
s_add_u32 s35, s35, 1024
buffer_load_dwordx4 v16, s[12:15], s34 offen lds
s_mov_b32 m0, s35
s_add_u32 s35, s35, 1024
buffer_load_dwordx4 v17, s[12:15], s34 offen lds
s_add_u32 s34, s34, 36864
s_mov_b32 m0, s35
s_add_u32 s35, s35, 1024
buffer_load_dwordx4 v12, s[12:15], s34 offen lds
s_mov_b32 m0, s35
s_add_u32 s35, s35, 1024
buffer_load_dwordx4 v13, s[12:15], s34 offen lds
s_mov_b32 m0, s35
s_add_u32 s35, s35, 1024
buffer_load_dwordx4 v14, s[12:15], s34 offen lds
s_mov_b32 m0, s35
s_add_u32 s35, s35, 1024
buffer_load_dwordx4 v15, s[12:15], s34 offen lds
s_mov_b32 m0, s35
s_add_u32 s35, s35, 1024
buffer_load_dwordx4 v16, s[12:15], s34 offen lds
s_mov_b32 m0, s35
s_add_u32 s35, s35, 1024
buffer_load_dwordx4 v17, s[12:15], s34 offen lds
s_add_u32 s34, s34, 36864
s_mov_b32 m0, s35
s_add_u32 s35, s35, 1024
buffer_load_dwordx4 v12, s[12:15], s34 offen lds
s_mov_b32 m0, s35
s_add_u32 s35, s35, 1024
buffer_load_dwordx4 v13, s[12:15], s34 offen lds
s_mov_b32 m0, s35
s_add_u32 s35, s35, 1024
buffer_load_dwordx4 v14, s[12:15], s34 offen lds
s_mov_b32 m0, s35
s_add_u32 s35, s35, 1024
buffer_load_dwordx4 v15, s[12:15], s34 offen lds
s_mov_b32 m0, s35
s_add_u32 s35, s35, 1024
buffer_load_dwordx4 v16, s[12:15], s34 offen lds
s_mov_b32 m0, s35
s_add_u32 s35, s35, 1024
buffer_load_dwordx4 v17, s[12:15], s34 offen lds
s_add_u32 s34, s34, 36864
s_waitcnt vmcnt(30)
ds_read_b64_tr_b16 a[144:145], v6
ds_read_b64_tr_b16 a[146:147], v6 offset:3072
ds_read_b64_tr_b16 a[148:149], v6 offset:32
ds_read_b64_tr_b16 a[150:151], v6 offset:3104
ds_read_b64_tr_b16 a[152:153], v6 offset:64
ds_read_b64_tr_b16 a[154:155], v6 offset:3136
ds_read_b64_tr_b16 a[156:157], v6 offset:96
ds_read_b64_tr_b16 a[158:159], v6 offset:3168
ds_read_b64_tr_b16 a[160:161], v6 offset:128
ds_read_b64_tr_b16 a[162:163], v6 offset:3200
ds_read_b64_tr_b16 a[164:165], v6 offset:160
ds_read_b64_tr_b16 a[166:167], v6 offset:3232
s_waitcnt vmcnt(24)
ds_read_b64_tr_b16 a[168:169], v6 offset:6144
ds_read_b64_tr_b16 a[170:171], v6 offset:9216
ds_read_b64_tr_b16 a[172:173], v6 offset:6176
ds_read_b64_tr_b16 a[174:175], v6 offset:9248
ds_read_b64_tr_b16 a[176:177], v6 offset:6208
ds_read_b64_tr_b16 a[178:179], v6 offset:9280
ds_read_b64_tr_b16 a[180:181], v6 offset:6240
ds_read_b64_tr_b16 a[182:183], v6 offset:9312
ds_read_b64_tr_b16 a[184:185], v6 offset:6272
ds_read_b64_tr_b16 a[186:187], v6 offset:9344
ds_read_b64_tr_b16 a[188:189], v6 offset:6304
ds_read_b64_tr_b16 a[190:191], v6 offset:9376
s_waitcnt vmcnt(18)
ds_read_b64_tr_b16 a[192:193], v6 offset:12288
ds_read_b64_tr_b16 a[194:195], v6 offset:15360
ds_read_b64_tr_b16 a[196:197], v6 offset:12320
ds_read_b64_tr_b16 a[198:199], v6 offset:15392
ds_read_b64_tr_b16 a[200:201], v6 offset:12352
ds_read_b64_tr_b16 a[202:203], v6 offset:15424
ds_read_b64_tr_b16 a[204:205], v6 offset:12384
ds_read_b64_tr_b16 a[206:207], v6 offset:15456
ds_read_b64_tr_b16 a[208:209], v6 offset:12416
ds_read_b64_tr_b16 a[210:211], v6 offset:15488
ds_read_b64_tr_b16 a[212:213], v6 offset:12448
ds_read_b64_tr_b16 a[214:215], v6 offset:15520
s_waitcnt vmcnt(12)
ds_read_b64_tr_b16 a[216:217], v6 offset:18432
ds_read_b64_tr_b16 a[218:219], v6 offset:21504
ds_read_b64_tr_b16 a[220:221], v6 offset:18464
ds_read_b64_tr_b16 a[222:223], v6 offset:21536
ds_read_b64_tr_b16 a[224:225], v6 offset:18496
ds_read_b64_tr_b16 a[226:227], v6 offset:21568
ds_read_b64_tr_b16 a[228:229], v6 offset:18528
ds_read_b64_tr_b16 a[230:231], v6 offset:21600
ds_read_b64_tr_b16 a[232:233], v6 offset:18560
ds_read_b64_tr_b16 a[234:235], v6 offset:21632
ds_read_b64_tr_b16 a[236:237], v6 offset:18592
ds_read_b64_tr_b16 a[238:239], v6 offset:21664
s_waitcnt vmcnt(6)
ds_read_b64_tr_b16 a[240:241], v6 offset:24576
ds_read_b64_tr_b16 a[242:243], v6 offset:27648
ds_read_b64_tr_b16 a[244:245], v6 offset:24608
ds_read_b64_tr_b16 a[246:247], v6 offset:27680
ds_read_b64_tr_b16 a[248:249], v6 offset:24640
ds_read_b64_tr_b16 a[250:251], v6 offset:27712
ds_read_b64_tr_b16 a[252:253], v6 offset:24672
ds_read_b64_tr_b16 a[254:255], v6 offset:27744
ds_read_b64_tr_b16 v[80:81], v6 offset:24704
ds_read_b64_tr_b16 v[82:83], v6 offset:27776
ds_read_b64_tr_b16 v[84:85], v6 offset:24736
ds_read_b64_tr_b16 v[86:87], v6 offset:27808
s_waitcnt vmcnt(0)
ds_read_b64_tr_b16 v[88:89], v6 offset:30720
ds_read_b64_tr_b16 v[90:91], v6 offset:33792
ds_read_b64_tr_b16 v[92:93], v6 offset:30752
ds_read_b64_tr_b16 v[94:95], v6 offset:33824
ds_read_b64_tr_b16 v[96:97], v6 offset:30784
ds_read_b64_tr_b16 v[98:99], v6 offset:33856
ds_read_b64_tr_b16 v[100:101], v6 offset:30816
ds_read_b64_tr_b16 v[102:103], v6 offset:33888
ds_read_b64_tr_b16 v[104:105], v6 offset:30848
ds_read_b64_tr_b16 v[106:107], v6 offset:33920
ds_read_b64_tr_b16 v[108:109], v6 offset:30880
ds_read_b64_tr_b16 v[110:111], v6 offset:33952
s_waitcnt lgkmcnt(0)
s_mov_b32 s35, s33
s_mov_b32 m0, s35
s_add_u32 s35, s35, 1024
buffer_load_dwordx4 v12, s[12:15], s34 offen lds
s_mov_b32 m0, s35
s_add_u32 s35, s35, 1024
buffer_load_dwordx4 v13, s[12:15], s34 offen lds
s_mov_b32 m0, s35
s_add_u32 s35, s35, 1024
buffer_load_dwordx4 v14, s[12:15], s34 offen lds
s_mov_b32 m0, s35
s_add_u32 s35, s35, 1024
buffer_load_dwordx4 v15, s[12:15], s34 offen lds
s_mov_b32 m0, s35
s_add_u32 s35, s35, 1024
buffer_load_dwordx4 v16, s[12:15], s34 offen lds
s_mov_b32 m0, s35
s_add_u32 s35, s35, 1024
buffer_load_dwordx4 v17, s[12:15], s34 offen lds
s_add_u32 s34, s34, 36864
s_mov_b32 m0, s35
s_add_u32 s35, s35, 1024
buffer_load_dwordx4 v12, s[12:15], s34 offen lds
s_mov_b32 m0, s35
s_add_u32 s35, s35, 1024
buffer_load_dwordx4 v13, s[12:15], s34 offen lds
s_mov_b32 m0, s35
s_add_u32 s35, s35, 1024
buffer_load_dwordx4 v14, s[12:15], s34 offen lds
s_mov_b32 m0, s35
s_add_u32 s35, s35, 1024
buffer_load_dwordx4 v15, s[12:15], s34 offen lds
s_mov_b32 m0, s35
s_add_u32 s35, s35, 1024
buffer_load_dwordx4 v16, s[12:15], s34 offen lds
s_mov_b32 m0, s35
s_add_u32 s35, s35, 1024
buffer_load_dwordx4 v17, s[12:15], s34 offen lds
s_add_u32 s34, s34, 36864
s_mov_b32 m0, s35
s_add_u32 s35, s35, 1024
buffer_load_dwordx4 v12, s[12:15], s34 offen lds
s_mov_b32 m0, s35
s_add_u32 s35, s35, 1024
buffer_load_dwordx4 v13, s[12:15], s34 offen lds
s_mov_b32 m0, s35
s_add_u32 s35, s35, 1024
buffer_load_dwordx4 v14, s[12:15], s34 offen lds
s_mov_b32 m0, s35
s_add_u32 s35, s35, 1024
buffer_load_dwordx4 v15, s[12:15], s34 offen lds
s_mov_b32 m0, s35
s_add_u32 s35, s35, 1024
buffer_load_dwordx4 v16, s[12:15], s34 offen lds
s_mov_b32 m0, s35
s_add_u32 s35, s35, 1024
buffer_load_dwordx4 v17, s[12:15], s34 offen lds
s_add_u32 s34, s34, 36864
s_mov_b32 m0, s35
s_add_u32 s35, s35, 1024
buffer_load_dwordx4 v12, s[12:15], s34 offen lds
s_mov_b32 m0, s35
s_add_u32 s35, s35, 1024
buffer_load_dwordx4 v13, s[12:15], s34 offen lds
s_mov_b32 m0, s35
s_add_u32 s35, s35, 1024
buffer_load_dwordx4 v14, s[12:15], s34 offen lds
s_mov_b32 m0, s35
s_add_u32 s35, s35, 1024
buffer_load_dwordx4 v15, s[12:15], s34 offen lds
s_mov_b32 m0, s35
s_add_u32 s35, s35, 1024
buffer_load_dwordx4 v16, s[12:15], s34 offen lds
s_mov_b32 m0, s35
s_add_u32 s35, s35, 1024
buffer_load_dwordx4 v17, s[12:15], s34 offen lds
s_add_u32 s34, s34, 36864
s_waitcnt vmcnt(18)
ds_read_b64_tr_b16 v[112:113], v6
ds_read_b64_tr_b16 v[114:115], v6 offset:3072
ds_read_b64_tr_b16 v[116:117], v6 offset:32
ds_read_b64_tr_b16 v[118:119], v6 offset:3104
ds_read_b64_tr_b16 v[120:121], v6 offset:64
ds_read_b64_tr_b16 v[122:123], v6 offset:3136
ds_read_b64_tr_b16 v[124:125], v6 offset:96
ds_read_b64_tr_b16 v[126:127], v6 offset:3168
ds_read_b64_tr_b16 v[128:129], v6 offset:128
ds_read_b64_tr_b16 v[130:131], v6 offset:3200
ds_read_b64_tr_b16 v[132:133], v6 offset:160
ds_read_b64_tr_b16 v[134:135], v6 offset:3232
s_waitcnt vmcnt(12)
ds_read_b64_tr_b16 v[136:137], v6 offset:6144
ds_read_b64_tr_b16 v[138:139], v6 offset:9216
ds_read_b64_tr_b16 v[140:141], v6 offset:6176
ds_read_b64_tr_b16 v[142:143], v6 offset:9248
ds_read_b64_tr_b16 v[144:145], v6 offset:6208
ds_read_b64_tr_b16 v[146:147], v6 offset:9280
ds_read_b64_tr_b16 v[148:149], v6 offset:6240
ds_read_b64_tr_b16 v[150:151], v6 offset:9312
ds_read_b64_tr_b16 v[152:153], v6 offset:6272
ds_read_b64_tr_b16 v[154:155], v6 offset:9344
ds_read_b64_tr_b16 v[156:157], v6 offset:6304
ds_read_b64_tr_b16 v[158:159], v6 offset:9376
s_waitcnt vmcnt(6)
ds_read_b64_tr_b16 v[160:161], v6 offset:12288
ds_read_b64_tr_b16 v[162:163], v6 offset:15360
ds_read_b64_tr_b16 v[164:165], v6 offset:12320
ds_read_b64_tr_b16 v[166:167], v6 offset:15392
ds_read_b64_tr_b16 v[168:169], v6 offset:12352
ds_read_b64_tr_b16 v[170:171], v6 offset:15424
ds_read_b64_tr_b16 v[172:173], v6 offset:12384
ds_read_b64_tr_b16 v[174:175], v6 offset:15456
ds_read_b64_tr_b16 v[176:177], v6 offset:12416
ds_read_b64_tr_b16 v[178:179], v6 offset:15488
ds_read_b64_tr_b16 v[180:181], v6 offset:12448
ds_read_b64_tr_b16 v[182:183], v6 offset:15520
s_waitcnt vmcnt(0)
ds_read_b64_tr_b16 v[184:185], v6 offset:18432
ds_read_b64_tr_b16 v[186:187], v6 offset:21504
ds_read_b64_tr_b16 v[188:189], v6 offset:18464
ds_read_b64_tr_b16 v[190:191], v6 offset:21536
ds_read_b64_tr_b16 v[192:193], v6 offset:18496
ds_read_b64_tr_b16 v[194:195], v6 offset:21568
ds_read_b64_tr_b16 v[196:197], v6 offset:18528
ds_read_b64_tr_b16 v[198:199], v6 offset:21600
ds_read_b64_tr_b16 v[200:201], v6 offset:18560
ds_read_b64_tr_b16 v[202:203], v6 offset:21632
ds_read_b64_tr_b16 v[204:205], v6 offset:18592
ds_read_b64_tr_b16 v[206:207], v6 offset:21664
s_waitcnt lgkmcnt(0)
s_barrier
s_cmp_eq_u32 s16, 0
s_cbranch_scc0 L_wdog1o
v_mov_b32 v8, 0
L_wd0g1o:
global_load_dword v9, v8, s[6:7] offset:100 sc1
s_waitcnt vmcnt(0)
v_cmp_gt_u32 vcc, 18, v9
s_cbranch_vccz L_wdn0g1o
s_sleep 24
s_add_u32 s21, s21, 1
s_cmp_ge_u32 s21, 4194304
s_cbranch_scc1 L_abort
s_branch L_wd0g1o
L_wdn0g1o:
L_wd1g1o:
global_load_dword v9, v8, s[6:7] offset:192 sc1
s_waitcnt vmcnt(0)
v_cmp_gt_u32 vcc, 16, v9
s_cbranch_vccz L_wdn1g1o
s_sleep 24
s_add_u32 s21, s21, 1
s_cmp_ge_u32 s21, 4194304
s_cbranch_scc1 L_abort
s_branch L_wd1g1o
L_wdn1g1o:
L_wd2g1o:
global_load_dword v9, v8, s[6:7] offset:104 sc1
s_waitcnt vmcnt(0)
v_cmp_gt_u32 vcc, 28, v9
s_cbranch_vccz L_wdn2g1o
s_sleep 24
s_add_u32 s21, s21, 1
s_cmp_ge_u32 s21, 4194304
s_cbranch_scc1 L_abort
s_branch L_wd2g1o
L_wdn2g1o:
L_wdog1o:
s_barrier
v_lshrrev_b32 v8, 4, v2
v_and_b32 v9, 15, v2
v_min_u32 v4, 3, v2
v_lshlrev_b32 v4, 2, v4
v_mov_b32 v7, 1
s_mul_i32 s19, s16, 6144
s_add_u32 s19, s19, 65536
v_add_u32 v5, s19, v0
s_min_u32 s19, s16, 3
s_lshl_b32 s19, s19, 10
s_add_u32 s19, s19, 65536
v_add_u32 v6, s19, v0
v_lshlrev_b32 v10, 5, v8
v_xor_b32 v5, v5, v10
v_xor_b32 v72, 128, v5
v_lshrrev_b32 v8, 3, v2
s_and_b32 s19, s16, 1
s_lshl_b32 s19, s19, 3
v_add_u32 v8, s19, v8
v_and_b32 v9, 7, v2
v_mul_u32_u24 v3, 2304, v8
v_lshl_add_u32 v3, v9, 4, v3
v_lshlrev_b32 v10, 1, v9
v_xor_b32 v8, v8, v10
v_lshlrev_b32 v8, 4, v8
v_lshl_add_u32 v8, v9, 8, v8
v_add_u32 v73, 69632, v8
s_lshr_b32 s19, s16, 1
s_lshl_b32 s60, s19, 7
s_lshl_b32 s19, s19, 11
s_add_u32 s19, s19, 65536
v_add_u32 v6, s19, v8
s_mul_i32 s33, s23, 384
s_lshr_b32 s19, s32, 2
s_mul_i32 s19, s19, 4718592
s_add_u32 s33, s33, s19
s_add_u32 s33, s33, 121634816
s_mul_i32 s28, s22, 131072
s_mul_i32 s19, s32, 16384
s_add_u32 s28, s28, s19
s_add_u32 s28, s28, 83886080
s_lshr_b32 s19, s22, 1
s_mul_i32 s29, s19, 128
s_mul_i32 s19, s32, 16
s_add_u32 s29, s29, s19
s_add_u32 s29, s29, 212992
s_mul_i32 s37, s16, 16384
v_add_u32 v1, s37, v0
s_mov_b32 s61, 0
v_mul_u32_u24 v70, 32, v2
v_lshrrev_b32 v70, 4, v70
v_lshlrev_b32 v70, 7, v70
v_add_u32 v70, 124, v70
s_mov_b32 s36, 1073741824
s_mov_b32 s38, 0
L_g2o:
s_cmp_eq_u32 s38, 0
s_cbranch_scc0 L_g2co
s_cmp_ge_u32 s22, 112
s_cbranch_scc0 L_g2fo
L_g2ro:
L_wpgo:
buffer_load_dword v78, v70, s[8:11], s28 offen sc1
s_waitcnt vmcnt(0)
buffer_store_dword v7, off, s[8:11], s36 sc1
s_mov_b32 s36, 1073741824
v_cmp_eq_u32 vcc, -1, v78
s_cbranch_vccz L_wpogo
s_add_u32 s21, s21, 1
s_cmp_ge_u32 s21, 4194304
s_cbranch_scc1 L_abort
s_branch L_wpgo
L_wpogo:
s_branch L_g2go
L_g2fo:
L_wvg3o:
buffer_load_dword v78, v4, s[8:11], s29 offen sc1
s_waitcnt vmcnt(0)
buffer_store_dword v7, off, s[8:11], s36 sc1
s_mov_b32 s36, 1073741824
v_cmp_eq_u32 vcc, 0, v78
s_cbranch_vccz L_wvog3o
s_sleep 2
s_add_u32 s21, s21, 1
s_cmp_ge_u32 s21, 4194304
s_cbranch_scc1 L_abort
s_branch L_wvg3o
L_wvog3o:
L_g2go:
s_add_u32 s19, s37, 0
s_mov_b32 m0, s19
s_add_u32 s20, s28, 0
buffer_load_dwordx4 v0, s[8:11], s20 offen sc1 lds
s_add_u32 s19, s37, 1024
s_mov_b32 m0, s19
s_add_u32 s20, s28, 1024
buffer_load_dwordx4 v0, s[8:11], s20 offen sc1 lds
s_add_u32 s19, s37, 2048
s_mov_b32 m0, s19
s_add_u32 s20, s28, 2048
buffer_load_dwordx4 v0, s[8:11], s20 offen sc1 lds
s_add_u32 s19, s37, 3072
s_mov_b32 m0, s19
s_add_u32 s20, s28, 3072
buffer_load_dwordx4 v0, s[8:11], s20 offen sc1 lds
s_add_u32 s19, s37, 4096
s_mov_b32 m0, s19
s_add_u32 s20, s28, 4096
buffer_load_dwordx4 v0, s[8:11], s20 offen sc1 lds
s_add_u32 s19, s37, 5120
s_mov_b32 m0, s19
s_add_u32 s20, s28, 5120
buffer_load_dwordx4 v0, s[8:11], s20 offen sc1 lds
s_add_u32 s19, s37, 6144
s_mov_b32 m0, s19
s_add_u32 s20, s28, 6144
buffer_load_dwordx4 v0, s[8:11], s20 offen sc1 lds
s_add_u32 s19, s37, 7168
s_mov_b32 m0, s19
s_add_u32 s20, s28, 7168
buffer_load_dwordx4 v0, s[8:11], s20 offen sc1 lds
s_add_u32 s19, s37, 8192
s_mov_b32 m0, s19
s_add_u32 s20, s28, 8192
buffer_load_dwordx4 v0, s[8:11], s20 offen sc1 lds
s_add_u32 s19, s37, 9216
s_mov_b32 m0, s19
s_add_u32 s20, s28, 9216
buffer_load_dwordx4 v0, s[8:11], s20 offen sc1 lds
L_g2co:
s_mul_i32 s31, s22, 36864
s_add_u32 s31, s31, s33
s_mov_b32 s35, s28
s_add_u32 s22, s22, 2
s_mul_i32 s28, s22, 131072
s_mul_i32 s19, s32, 16384
s_add_u32 s28, s28, s19
s_add_u32 s28, s28, 83886080
s_lshr_b32 s19, s22, 1
s_mul_i32 s29, s19, 128
s_mul_i32 s19, s32, 16
s_add_u32 s29, s29, s19
s_add_u32 s29, s29, 212992
buffer_load_dword v78, v4, s[8:11], s29 offen sc1
s_waitcnt vmcnt(10)
ds_read_b128 v[32:35], v1
s_waitcnt vmcnt(9)
ds_read_b128 v[36:39], v1 offset:1024
s_waitcnt vmcnt(8)
ds_read_b128 v[40:43], v1 offset:2048
s_waitcnt vmcnt(7)
ds_read_b128 v[44:47], v1 offset:3072
s_waitcnt lgkmcnt(3)
v_mfma_f32_16x16x32_bf16 v[8:11], a[0:3], v[32:35], 0
s_add_u32 s19, s37, 10240
s_mov_b32 m0, s19
s_add_u32 s20, s35, 10240
buffer_load_dwordx4 v0, s[8:11], s20 offen sc1 lds
v_mfma_f32_16x16x32_bf16 v[12:15], a[4:7], v[32:35], 0
v_mfma_f32_16x16x32_bf16 v[16:19], a[8:11], v[32:35], 0
v_mfma_f32_16x16x32_bf16 v[20:23], a[12:15], v[32:35], 0
v_mfma_f32_16x16x32_bf16 v[24:27], a[16:19], v[32:35], 0
v_mfma_f32_16x16x32_bf16 v[28:31], a[20:23], v[32:35], 0
s_waitcnt vmcnt(7)
ds_read_b128 v[32:35], v1 offset:4096
s_waitcnt lgkmcnt(3)
v_mfma_f32_16x16x32_bf16 v[8:11], a[24:27], v[36:39], v[8:11]
s_add_u32 s19, s37, 11264
s_mov_b32 m0, s19
s_add_u32 s20, s35, 11264
buffer_load_dwordx4 v0, s[8:11], s20 offen sc1 lds
v_mfma_f32_16x16x32_bf16 v[12:15], a[28:31], v[36:39], v[12:15]
v_mfma_f32_16x16x32_bf16 v[16:19], a[32:35], v[36:39], v[16:19]
v_mfma_f32_16x16x32_bf16 v[20:23], a[36:39], v[36:39], v[20:23]
v_mfma_f32_16x16x32_bf16 v[24:27], a[40:43], v[36:39], v[24:27]
v_mfma_f32_16x16x32_bf16 v[28:31], a[44:47], v[36:39], v[28:31]
s_waitcnt vmcnt(7)
ds_read_b128 v[36:39], v1 offset:5120
s_waitcnt lgkmcnt(3)
v_mfma_f32_16x16x32_bf16 v[8:11], a[48:51], v[40:43], v[8:11]
s_add_u32 s19, s37, 12288
s_mov_b32 m0, s19
s_add_u32 s20, s35, 12288
buffer_load_dwordx4 v0, s[8:11], s20 offen sc1 lds
v_mfma_f32_16x16x32_bf16 v[12:15], a[52:55], v[40:43], v[12:15]
v_mfma_f32_16x16x32_bf16 v[16:19], a[56:59], v[40:43], v[16:19]
v_mfma_f32_16x16x32_bf16 v[20:23], a[60:63], v[40:43], v[20:23]
v_mfma_f32_16x16x32_bf16 v[24:27], a[64:67], v[40:43], v[24:27]
v_mfma_f32_16x16x32_bf16 v[28:31], a[68:71], v[40:43], v[28:31]
s_waitcnt vmcnt(7)
ds_read_b128 v[40:43], v1 offset:6144
s_waitcnt lgkmcnt(3)
v_mfma_f32_16x16x32_bf16 v[8:11], a[72:75], v[44:47], v[8:11]
s_add_u32 s19, s37, 13312
s_mov_b32 m0, s19
s_add_u32 s20, s35, 13312
buffer_load_dwordx4 v0, s[8:11], s20 offen sc1 lds
v_mfma_f32_16x16x32_bf16 v[12:15], a[76:79], v[44:47], v[12:15]
v_mfma_f32_16x16x32_bf16 v[16:19], a[80:83], v[44:47], v[16:19]
v_mfma_f32_16x16x32_bf16 v[20:23], a[84:87], v[44:47], v[20:23]
v_mfma_f32_16x16x32_bf16 v[24:27], a[88:91], v[44:47], v[24:27]
v_mfma_f32_16x16x32_bf16 v[28:31], a[92:95], v[44:47], v[28:31]
s_waitcnt vmcnt(7)
ds_read_b128 v[44:47], v1 offset:7168
s_waitcnt lgkmcnt(3)
v_mfma_f32_16x16x32_bf16 v[8:11], a[96:99], v[32:35], v[8:11]
s_add_u32 s19, s37, 14336
s_mov_b32 m0, s19
s_add_u32 s20, s35, 14336
buffer_load_dwordx4 v0, s[8:11], s20 offen sc1 lds
v_mfma_f32_16x16x32_bf16 v[12:15], a[100:103], v[32:35], v[12:15]
v_mfma_f32_16x16x32_bf16 v[16:19], a[104:107], v[32:35], v[16:19]
v_mfma_f32_16x16x32_bf16 v[20:23], a[108:111], v[32:35], v[20:23]
v_mfma_f32_16x16x32_bf16 v[24:27], a[112:115], v[32:35], v[24:27]
v_mfma_f32_16x16x32_bf16 v[28:31], a[116:119], v[32:35], v[28:31]
s_waitcnt vmcnt(7)
ds_read_b128 v[32:35], v1 offset:8192
s_waitcnt lgkmcnt(3)
v_mfma_f32_16x16x32_bf16 v[8:11], a[120:123], v[36:39], v[8:11]
s_add_u32 s19, s37, 15360
s_mov_b32 m0, s19
s_add_u32 s20, s35, 15360
buffer_load_dwordx4 v0, s[8:11], s20 offen sc1 lds
v_mfma_f32_16x16x32_bf16 v[12:15], a[124:127], v[36:39], v[12:15]
v_mfma_f32_16x16x32_bf16 v[16:19], a[128:131], v[36:39], v[16:19]
v_mfma_f32_16x16x32_bf16 v[20:23], a[132:135], v[36:39], v[20:23]
v_mfma_f32_16x16x32_bf16 v[24:27], a[136:139], v[36:39], v[24:27]
v_mfma_f32_16x16x32_bf16 v[28:31], a[140:143], v[36:39], v[28:31]
s_waitcnt vmcnt(6)
buffer_store_dword v7, off, s[8:11], s36 sc1
v_cmp_eq_u32 vcc, 0, v78
s_mov_b32 s38, 0
s_cbranch_vccnz L_g2po
s_cmp_lt_u32 s22, 128
s_cbranch_scc0 L_g2po
s_mov_b32 s38, 1
s_waitcnt vmcnt(8)
ds_read_b128 v[36:39], v1 offset:9216
s_waitcnt lgkmcnt(3)
v_mfma_f32_16x16x32_bf16 v[8:11], a[144:147], v[40:43], v[8:11]
s_add_u32 s19, s37, 0
s_mov_b32 m0, s19
s_add_u32 s20, s28, 0
buffer_load_dwordx4 v0, s[8:11], s20 offen sc1 lds
v_mfma_f32_16x16x32_bf16 v[12:15], a[148:151], v[40:43], v[12:15]
v_mfma_f32_16x16x32_bf16 v[16:19], a[152:155], v[40:43], v[16:19]
v_mfma_f32_16x16x32_bf16 v[20:23], a[156:159], v[40:43], v[20:23]
v_mfma_f32_16x16x32_bf16 v[24:27], a[160:163], v[40:43], v[24:27]
v_mfma_f32_16x16x32_bf16 v[28:31], a[164:167], v[40:43], v[28:31]
s_waitcnt vmcnt(7)
ds_read_b128 v[40:43], v1 offset:10240
s_waitcnt lgkmcnt(3)
v_mfma_f32_16x16x32_bf16 v[8:11], a[168:171], v[44:47], v[8:11]
s_add_u32 s19, s37, 1024
s_mov_b32 m0, s19
s_add_u32 s20, s28, 1024
buffer_load_dwordx4 v0, s[8:11], s20 offen sc1 lds
v_mfma_f32_16x16x32_bf16 v[12:15], a[172:175], v[44:47], v[12:15]
v_mfma_f32_16x16x32_bf16 v[16:19], a[176:179], v[44:47], v[16:19]
v_mfma_f32_16x16x32_bf16 v[20:23], a[180:183], v[44:47], v[20:23]
v_mfma_f32_16x16x32_bf16 v[24:27], a[184:187], v[44:47], v[24:27]
v_mfma_f32_16x16x32_bf16 v[28:31], a[188:191], v[44:47], v[28:31]
s_waitcnt vmcnt(7)
ds_read_b128 v[44:47], v1 offset:11264
s_waitcnt lgkmcnt(3)
v_mfma_f32_16x16x32_bf16 v[8:11], a[192:195], v[32:35], v[8:11]
s_add_u32 s19, s37, 2048
s_mov_b32 m0, s19
s_add_u32 s20, s28, 2048
buffer_load_dwordx4 v0, s[8:11], s20 offen sc1 lds
v_mfma_f32_16x16x32_bf16 v[12:15], a[196:199], v[32:35], v[12:15]
v_mfma_f32_16x16x32_bf16 v[16:19], a[200:203], v[32:35], v[16:19]
v_mfma_f32_16x16x32_bf16 v[20:23], a[204:207], v[32:35], v[20:23]
v_mfma_f32_16x16x32_bf16 v[24:27], a[208:211], v[32:35], v[24:27]
v_mfma_f32_16x16x32_bf16 v[28:31], a[212:215], v[32:35], v[28:31]
s_waitcnt vmcnt(7)
ds_read_b128 v[32:35], v1 offset:12288
s_waitcnt lgkmcnt(3)
v_mfma_f32_16x16x32_bf16 v[8:11], a[216:219], v[36:39], v[8:11]
s_add_u32 s19, s37, 3072
s_mov_b32 m0, s19
s_add_u32 s20, s28, 3072
buffer_load_dwordx4 v0, s[8:11], s20 offen sc1 lds
v_mfma_f32_16x16x32_bf16 v[12:15], a[220:223], v[36:39], v[12:15]
v_mfma_f32_16x16x32_bf16 v[16:19], a[224:227], v[36:39], v[16:19]
v_mfma_f32_16x16x32_bf16 v[20:23], a[228:231], v[36:39], v[20:23]
v_mfma_f32_16x16x32_bf16 v[24:27], a[232:235], v[36:39], v[24:27]
v_mfma_f32_16x16x32_bf16 v[28:31], a[236:239], v[36:39], v[28:31]
s_waitcnt vmcnt(7)
ds_read_b128 v[36:39], v1 offset:13312
s_waitcnt lgkmcnt(3)
v_mfma_f32_16x16x32_bf16 v[8:11], a[240:243], v[40:43], v[8:11]
s_add_u32 s19, s37, 4096
s_mov_b32 m0, s19
s_add_u32 s20, s28, 4096
buffer_load_dwordx4 v0, s[8:11], s20 offen sc1 lds
v_mfma_f32_16x16x32_bf16 v[12:15], a[244:247], v[40:43], v[12:15]
v_mfma_f32_16x16x32_bf16 v[16:19], a[248:251], v[40:43], v[16:19]
v_mfma_f32_16x16x32_bf16 v[20:23], a[252:255], v[40:43], v[20:23]
v_mfma_f32_16x16x32_bf16 v[24:27], v[80:83], v[40:43], v[24:27]
v_mfma_f32_16x16x32_bf16 v[28:31], v[84:87], v[40:43], v[28:31]
s_waitcnt vmcnt(7)
ds_read_b128 v[40:43], v1 offset:14336
s_waitcnt lgkmcnt(3)
v_mfma_f32_16x16x32_bf16 v[8:11], v[88:91], v[44:47], v[8:11]
s_add_u32 s19, s37, 5120
s_mov_b32 m0, s19
s_add_u32 s20, s28, 5120
buffer_load_dwordx4 v0, s[8:11], s20 offen sc1 lds
v_mfma_f32_16x16x32_bf16 v[12:15], v[92:95], v[44:47], v[12:15]
v_mfma_f32_16x16x32_bf16 v[16:19], v[96:99], v[44:47], v[16:19]
v_mfma_f32_16x16x32_bf16 v[20:23], v[100:103], v[44:47], v[20:23]
v_mfma_f32_16x16x32_bf16 v[24:27], v[104:107], v[44:47], v[24:27]
v_mfma_f32_16x16x32_bf16 v[28:31], v[108:111], v[44:47], v[28:31]
s_waitcnt vmcnt(7)
ds_read_b128 v[44:47], v1 offset:15360
s_waitcnt lgkmcnt(3)
v_mfma_f32_16x16x32_bf16 v[8:11], v[112:115], v[32:35], v[8:11]
s_add_u32 s19, s37, 6144
s_mov_b32 m0, s19
s_add_u32 s20, s28, 6144
buffer_load_dwordx4 v0, s[8:11], s20 offen sc1 lds
v_mfma_f32_16x16x32_bf16 v[12:15], v[116:119], v[32:35], v[12:15]
v_mfma_f32_16x16x32_bf16 v[16:19], v[120:123], v[32:35], v[16:19]
v_mfma_f32_16x16x32_bf16 v[20:23], v[124:127], v[32:35], v[20:23]
v_mfma_f32_16x16x32_bf16 v[24:27], v[128:131], v[32:35], v[24:27]
v_mfma_f32_16x16x32_bf16 v[28:31], v[132:135], v[32:35], v[28:31]
s_waitcnt lgkmcnt(2)
v_mfma_f32_16x16x32_bf16 v[8:11], v[136:139], v[36:39], v[8:11]
s_add_u32 s19, s37, 7168
s_mov_b32 m0, s19
s_add_u32 s20, s28, 7168
buffer_load_dwordx4 v0, s[8:11], s20 offen sc1 lds
v_mfma_f32_16x16x32_bf16 v[12:15], v[140:143], v[36:39], v[12:15]
v_mfma_f32_16x16x32_bf16 v[16:19], v[144:147], v[36:39], v[16:19]
v_mfma_f32_16x16x32_bf16 v[20:23], v[148:151], v[36:39], v[20:23]
v_mfma_f32_16x16x32_bf16 v[24:27], v[152:155], v[36:39], v[24:27]
v_mfma_f32_16x16x32_bf16 v[28:31], v[156:159], v[36:39], v[28:31]
s_waitcnt lgkmcnt(1)
v_mfma_f32_16x16x32_bf16 v[8:11], v[160:163], v[40:43], v[8:11]
s_add_u32 s19, s37, 8192
s_mov_b32 m0, s19
s_add_u32 s20, s28, 8192
buffer_load_dwordx4 v0, s[8:11], s20 offen sc1 lds
v_mfma_f32_16x16x32_bf16 v[12:15], v[164:167], v[40:43], v[12:15]
v_mfma_f32_16x16x32_bf16 v[16:19], v[168:171], v[40:43], v[16:19]
v_mfma_f32_16x16x32_bf16 v[20:23], v[172:175], v[40:43], v[20:23]
v_mfma_f32_16x16x32_bf16 v[24:27], v[176:179], v[40:43], v[24:27]
v_mfma_f32_16x16x32_bf16 v[28:31], v[180:183], v[40:43], v[28:31]
s_waitcnt lgkmcnt(0)
v_mfma_f32_16x16x32_bf16 v[8:11], v[184:187], v[44:47], v[8:11]
s_add_u32 s19, s37, 9216
s_mov_b32 m0, s19
s_add_u32 s20, s28, 9216
buffer_load_dwordx4 v0, s[8:11], s20 offen sc1 lds
v_mfma_f32_16x16x32_bf16 v[12:15], v[188:191], v[44:47], v[12:15]
v_mfma_f32_16x16x32_bf16 v[16:19], v[192:195], v[44:47], v[16:19]
v_mfma_f32_16x16x32_bf16 v[20:23], v[196:199], v[44:47], v[20:23]
ds_write_b128 v5, v[8:11]
v_mfma_f32_16x16x32_bf16 v[24:27], v[200:203], v[44:47], v[24:27]
ds_write_b128 v72, v[12:15] offset:1024
v_mfma_f32_16x16x32_bf16 v[28:31], v[204:207], v[44:47], v[28:31]
ds_write_b128 v5, v[16:19] offset:2048
s_branch L_g2eo
L_g2po:
s_waitcnt vmcnt(8)
ds_read_b128 v[36:39], v1 offset:9216
s_waitcnt lgkmcnt(3)
v_mfma_f32_16x16x32_bf16 v[8:11], a[144:147], v[40:43], v[8:11]
v_mfma_f32_16x16x32_bf16 v[12:15], a[148:151], v[40:43], v[12:15]
v_mfma_f32_16x16x32_bf16 v[16:19], a[152:155], v[40:43], v[16:19]
v_mfma_f32_16x16x32_bf16 v[20:23], a[156:159], v[40:43], v[20:23]
v_mfma_f32_16x16x32_bf16 v[24:27], a[160:163], v[40:43], v[24:27]
v_mfma_f32_16x16x32_bf16 v[28:31], a[164:167], v[40:43], v[28:31]
s_waitcnt vmcnt(6)
ds_read_b128 v[40:43], v1 offset:10240
s_waitcnt lgkmcnt(3)
v_mfma_f32_16x16x32_bf16 v[8:11], a[168:171], v[44:47], v[8:11]
v_mfma_f32_16x16x32_bf16 v[12:15], a[172:175], v[44:47], v[12:15]
v_mfma_f32_16x16x32_bf16 v[16:19], a[176:179], v[44:47], v[16:19]
v_mfma_f32_16x16x32_bf16 v[20:23], a[180:183], v[44:47], v[20:23]
v_mfma_f32_16x16x32_bf16 v[24:27], a[184:187], v[44:47], v[24:27]
v_mfma_f32_16x16x32_bf16 v[28:31], a[188:191], v[44:47], v[28:31]
s_waitcnt vmcnt(5)
ds_read_b128 v[44:47], v1 offset:11264
s_waitcnt lgkmcnt(3)
v_mfma_f32_16x16x32_bf16 v[8:11], a[192:195], v[32:35], v[8:11]
v_mfma_f32_16x16x32_bf16 v[12:15], a[196:199], v[32:35], v[12:15]
v_mfma_f32_16x16x32_bf16 v[16:19], a[200:203], v[32:35], v[16:19]
v_mfma_f32_16x16x32_bf16 v[20:23], a[204:207], v[32:35], v[20:23]
v_mfma_f32_16x16x32_bf16 v[24:27], a[208:211], v[32:35], v[24:27]
v_mfma_f32_16x16x32_bf16 v[28:31], a[212:215], v[32:35], v[28:31]
s_waitcnt vmcnt(4)
ds_read_b128 v[32:35], v1 offset:12288
s_waitcnt lgkmcnt(3)
v_mfma_f32_16x16x32_bf16 v[8:11], a[216:219], v[36:39], v[8:11]
v_mfma_f32_16x16x32_bf16 v[12:15], a[220:223], v[36:39], v[12:15]
v_mfma_f32_16x16x32_bf16 v[16:19], a[224:227], v[36:39], v[16:19]
v_mfma_f32_16x16x32_bf16 v[20:23], a[228:231], v[36:39], v[20:23]
v_mfma_f32_16x16x32_bf16 v[24:27], a[232:235], v[36:39], v[24:27]
v_mfma_f32_16x16x32_bf16 v[28:31], a[236:239], v[36:39], v[28:31]
s_waitcnt vmcnt(3)
ds_read_b128 v[36:39], v1 offset:13312
s_waitcnt lgkmcnt(3)
v_mfma_f32_16x16x32_bf16 v[8:11], a[240:243], v[40:43], v[8:11]
v_mfma_f32_16x16x32_bf16 v[12:15], a[244:247], v[40:43], v[12:15]
v_mfma_f32_16x16x32_bf16 v[16:19], a[248:251], v[40:43], v[16:19]
v_mfma_f32_16x16x32_bf16 v[20:23], a[252:255], v[40:43], v[20:23]
v_mfma_f32_16x16x32_bf16 v[24:27], v[80:83], v[40:43], v[24:27]
v_mfma_f32_16x16x32_bf16 v[28:31], v[84:87], v[40:43], v[28:31]
s_waitcnt vmcnt(2)
ds_read_b128 v[40:43], v1 offset:14336
s_waitcnt lgkmcnt(3)
v_mfma_f32_16x16x32_bf16 v[8:11], v[88:91], v[44:47], v[8:11]
v_mfma_f32_16x16x32_bf16 v[12:15], v[92:95], v[44:47], v[12:15]
v_mfma_f32_16x16x32_bf16 v[16:19], v[96:99], v[44:47], v[16:19]
v_mfma_f32_16x16x32_bf16 v[20:23], v[100:103], v[44:47], v[20:23]
v_mfma_f32_16x16x32_bf16 v[24:27], v[104:107], v[44:47], v[24:27]
v_mfma_f32_16x16x32_bf16 v[28:31], v[108:111], v[44:47], v[28:31]
s_waitcnt vmcnt(1)
ds_read_b128 v[44:47], v1 offset:15360
s_waitcnt lgkmcnt(3)
v_mfma_f32_16x16x32_bf16 v[8:11], v[112:115], v[32:35], v[8:11]
v_mfma_f32_16x16x32_bf16 v[12:15], v[116:119], v[32:35], v[12:15]
v_mfma_f32_16x16x32_bf16 v[16:19], v[120:123], v[32:35], v[16:19]
v_mfma_f32_16x16x32_bf16 v[20:23], v[124:127], v[32:35], v[20:23]
v_mfma_f32_16x16x32_bf16 v[24:27], v[128:131], v[32:35], v[24:27]
v_mfma_f32_16x16x32_bf16 v[28:31], v[132:135], v[32:35], v[28:31]
s_waitcnt lgkmcnt(2)
v_mfma_f32_16x16x32_bf16 v[8:11], v[136:139], v[36:39], v[8:11]
v_mfma_f32_16x16x32_bf16 v[12:15], v[140:143], v[36:39], v[12:15]
v_mfma_f32_16x16x32_bf16 v[16:19], v[144:147], v[36:39], v[16:19]
v_mfma_f32_16x16x32_bf16 v[20:23], v[148:151], v[36:39], v[20:23]
v_mfma_f32_16x16x32_bf16 v[24:27], v[152:155], v[36:39], v[24:27]
v_mfma_f32_16x16x32_bf16 v[28:31], v[156:159], v[36:39], v[28:31]
s_waitcnt lgkmcnt(1)
v_mfma_f32_16x16x32_bf16 v[8:11], v[160:163], v[40:43], v[8:11]
v_mfma_f32_16x16x32_bf16 v[12:15], v[164:167], v[40:43], v[12:15]
v_mfma_f32_16x16x32_bf16 v[16:19], v[168:171], v[40:43], v[16:19]
v_mfma_f32_16x16x32_bf16 v[20:23], v[172:175], v[40:43], v[20:23]
v_mfma_f32_16x16x32_bf16 v[24:27], v[176:179], v[40:43], v[24:27]
v_mfma_f32_16x16x32_bf16 v[28:31], v[180:183], v[40:43], v[28:31]
s_waitcnt lgkmcnt(0)
v_mfma_f32_16x16x32_bf16 v[8:11], v[184:187], v[44:47], v[8:11]
v_mfma_f32_16x16x32_bf16 v[12:15], v[188:191], v[44:47], v[12:15]
v_mfma_f32_16x16x32_bf16 v[16:19], v[192:195], v[44:47], v[16:19]
v_mfma_f32_16x16x32_bf16 v[20:23], v[196:199], v[44:47], v[20:23]
ds_write_b128 v5, v[8:11]
v_mfma_f32_16x16x32_bf16 v[24:27], v[200:203], v[44:47], v[24:27]
ds_write_b128 v72, v[12:15] offset:1024
v_mfma_f32_16x16x32_bf16 v[28:31], v[204:207], v[44:47], v[28:31]
ds_write_b128 v5, v[16:19] offset:2048
L_g2eo:
v_cmp_u_f32 vcc, v8, v8
s_cbranch_vccnz L_g2xo
L_g2yo:
s_mov_b32 s61, 0
ds_write_b128 v72, v[20:23] offset:3072
ds_write_b128 v5, v[24:27] offset:4096
s_nop 1
ds_write_b128 v72, v[28:31] offset:5120
s_waitcnt lgkmcnt(0)
s_barrier
ds_read_b128 v[20:23], v6
ds_read_b128 v[24:27], v6 offset:6144
ds_read_b128 v[28:31], v6 offset:12288
ds_read_b128 v[32:35], v6 offset:18432
ds_read_b128 v[36:39], v73
ds_read_b128 v[40:43], v73 offset:6144
ds_read_b128 v[44:47], v73 offset:12288
ds_read_b128 v[48:51], v73 offset:18432
s_add_u32 s19, s60, s31
s_cmp_lt_u32 s16, 2
s_cselect_b32 s20, s31, 1073741824
s_waitcnt lgkmcnt(4)
v_pk_add_f32 v[20:21], v[20:21], v[24:25]
v_pk_add_f32 v[28:29], v[28:29], v[32:33]
v_pk_add_f32 v[22:23], v[22:23], v[26:27]
v_pk_add_f32 v[30:31], v[30:31], v[34:35]
v_pk_add_f32 v[20:21], v[20:21], v[28:29]
v_pk_add_f32 v[22:23], v[22:23], v[30:31]
buffer_store_dwordx4 v[20:23], v3, s[8:11], s19 offen sc1
s_waitcnt lgkmcnt(0)
v_pk_add_f32 v[36:37], v[36:37], v[40:41]
v_pk_add_f32 v[44:45], v[44:45], v[48:49]
v_pk_add_f32 v[38:39], v[38:39], v[42:43]
v_pk_add_f32 v[46:47], v[46:47], v[50:51]
v_pk_add_f32 v[36:37], v[36:37], v[44:45]
v_pk_add_f32 v[38:39], v[38:39], v[46:47]
buffer_store_dwordx4 v[36:39], v3, s[8:11], s20 offen offset:256 sc1
s_lshl_b32 s19, s59, 2
s_add_u32 s19, s19, s16
s_lshl_b32 s19, s19, 2
s_sub_u32 s20, s22, 2
s_lshl_b32 s20, s20, 8
s_add_u32 s19, s19, s20
s_add_u32 s36, s19, 221184
v_xor_b32 v5, 0x8000, v5
v_xor_b32 v72, 0x8000, v72
v_xor_b32 v6, 0x8000, v6
v_xor_b32 v73, 0x8000, v73
L_g2no:
s_cmp_lt_u32 s22, 128
s_cbranch_scc1 L_g2o
s_waitcnt vmcnt(0)
buffer_store_dword v7, off, s[8:11], s36 sc1
s_waitcnt vmcnt(0)
s_endpgm
L_g2xo:
s_add_u32 s61, s61, 1
s_cmp_ge_u32 s61, 3
s_cbranch_scc1 L_g2yo
s_cmp_lt_u32 s22, 114
s_cbranch_scc1 L_g2yo
s_sub_u32 s22, s22, 2
s_waitcnt vmcnt(0)
s_mul_i32 s28, s22, 131072
s_mul_i32 s19, s32, 16384
s_add_u32 s28, s28, s19
s_add_u32 s28, s28, 83886080
s_lshr_b32 s19, s22, 1
s_mul_i32 s29, s19, 128
s_mul_i32 s19, s32, 16
s_add_u32 s29, s29, s19
s_add_u32 s29, s29, 212992
s_branch L_g2ro
L_dn:
s_sub_u32 s17, s17, 28
s_mul_i32 s22, s17, 43
s_lshr_b32 s22, s22, 9
s_mul_i32 s19, s22, 12
s_sub_u32 s23, s17, s19
s_mov_b32 s59, s23
s_mov_b32 s32, s16
s_waitcnt vmcnt(0)
s_cmp_eq_u32 s16, 0
s_cbranch_scc0 L_wdog0d
v_mov_b32 v8, 0
L_wd0g0d:
global_load_dword v9, v8, s[6:7] offset:68 sc1
s_waitcnt vmcnt(0)
v_cmp_gt_u32 vcc, 32, v9
s_cbranch_vccz L_wdn0g0d
s_sleep 100
s_add_u32 s21, s21, 1
s_cmp_ge_u32 s21, 4194304
s_cbranch_scc1 L_abort
s_branch L_wd0g0d
L_wdn0g0d:
L_wdog0d:
s_barrier
s_load_dwordx2 s[4:5], s[0:1], 80
s_waitcnt lgkmcnt(0)
s_mov_b32 s12, s4
s_and_b32 s13, s5, 0xffff
s_mov_b32 s14, 5308416
s_mov_b32 s15, 0x20000
v_add_u32 v8, 0, v2
v_mul_u32_u24 v9, 171, v8
v_lshrrev_b32 v9, 10, v9
v_mul_u32_u24 v10, 6, v9
v_sub_u32 v8, v8, v10
v_mul_u32_u24 v9, 1152, v9
v_lshl_add_u32 v12, v8, 4, v9
v_add_u32 v8, 64, v2
v_mul_u32_u24 v9, 171, v8
v_lshrrev_b32 v9, 10, v9
v_mul_u32_u24 v10, 6, v9
v_sub_u32 v8, v8, v10
v_mul_u32_u24 v9, 1152, v9
v_lshl_add_u32 v13, v8, 4, v9
v_add_u32 v8, 128, v2
v_mul_u32_u24 v9, 171, v8
v_lshrrev_b32 v9, 10, v9
v_mul_u32_u24 v10, 6, v9
v_sub_u32 v8, v8, v10
v_mul_u32_u24 v9, 1152, v9
v_lshl_add_u32 v14, v8, 4, v9
v_lshrrev_b32 v8, 4, v2
v_lshlrev_b32 v8, 3, v8
v_bfe_u32 v9, v2, 2, 2
v_add_u32 v8, v8, v9
v_mul_u32_u24 v8, 96, v8
v_and_b32 v9, 3, v2
v_lshl_add_u32 v8, v9, 3, v8
s_mul_i32 s33, s16, 36864
v_add_u32 v6, s33, v8
s_mul_i32 s34, s32, 1327104
s_mul_i32 s19, s23, 96
s_add_u32 s34, s34, s19
s_mov_b32 s35, s33
s_mov_b32 m0, s35
s_add_u32 s35, s35, 1024
buffer_load_dwordx4 v12, s[12:15], s34 offen lds
s_mov_b32 m0, s35
s_add_u32 s35, s35, 1024
buffer_load_dwordx4 v13, s[12:15], s34 offen lds
s_mov_b32 m0, s35
s_add_u32 s35, s35, 1024
buffer_load_dwordx4 v14, s[12:15], s34 offen lds
s_add_u32 s34, s34, 36864
s_mov_b32 m0, s35
s_add_u32 s35, s35, 1024
buffer_load_dwordx4 v12, s[12:15], s34 offen lds
s_mov_b32 m0, s35
s_add_u32 s35, s35, 1024
buffer_load_dwordx4 v13, s[12:15], s34 offen lds
s_mov_b32 m0, s35
s_add_u32 s35, s35, 1024
buffer_load_dwordx4 v14, s[12:15], s34 offen lds
s_add_u32 s34, s34, 36864
s_mov_b32 m0, s35
s_add_u32 s35, s35, 1024
buffer_load_dwordx4 v12, s[12:15], s34 offen lds
s_mov_b32 m0, s35
s_add_u32 s35, s35, 1024
buffer_load_dwordx4 v13, s[12:15], s34 offen lds
s_mov_b32 m0, s35
s_add_u32 s35, s35, 1024
buffer_load_dwordx4 v14, s[12:15], s34 offen lds
s_add_u32 s34, s34, 36864
s_mov_b32 m0, s35
s_add_u32 s35, s35, 1024
buffer_load_dwordx4 v12, s[12:15], s34 offen lds
s_mov_b32 m0, s35
s_add_u32 s35, s35, 1024
buffer_load_dwordx4 v13, s[12:15], s34 offen lds
s_mov_b32 m0, s35
s_add_u32 s35, s35, 1024
buffer_load_dwordx4 v14, s[12:15], s34 offen lds
s_add_u32 s34, s34, 36864
s_mov_b32 m0, s35
s_add_u32 s35, s35, 1024
buffer_load_dwordx4 v12, s[12:15], s34 offen lds
s_mov_b32 m0, s35
s_add_u32 s35, s35, 1024
buffer_load_dwordx4 v13, s[12:15], s34 offen lds
s_mov_b32 m0, s35
s_add_u32 s35, s35, 1024
buffer_load_dwordx4 v14, s[12:15], s34 offen lds
s_add_u32 s34, s34, 36864
s_mov_b32 m0, s35
s_add_u32 s35, s35, 1024
buffer_load_dwordx4 v12, s[12:15], s34 offen lds
s_mov_b32 m0, s35
s_add_u32 s35, s35, 1024
buffer_load_dwordx4 v13, s[12:15], s34 offen lds
s_mov_b32 m0, s35
s_add_u32 s35, s35, 1024
buffer_load_dwordx4 v14, s[12:15], s34 offen lds
s_add_u32 s34, s34, 36864
s_mov_b32 m0, s35
s_add_u32 s35, s35, 1024
buffer_load_dwordx4 v12, s[12:15], s34 offen lds
s_mov_b32 m0, s35
s_add_u32 s35, s35, 1024
buffer_load_dwordx4 v13, s[12:15], s34 offen lds
s_mov_b32 m0, s35
s_add_u32 s35, s35, 1024
buffer_load_dwordx4 v14, s[12:15], s34 offen lds
s_add_u32 s34, s34, 36864
s_mov_b32 m0, s35
s_add_u32 s35, s35, 1024
buffer_load_dwordx4 v12, s[12:15], s34 offen lds
s_mov_b32 m0, s35
s_add_u32 s35, s35, 1024
buffer_load_dwordx4 v13, s[12:15], s34 offen lds
s_mov_b32 m0, s35
s_add_u32 s35, s35, 1024
buffer_load_dwordx4 v14, s[12:15], s34 offen lds
s_add_u32 s34, s34, 36864
s_mov_b32 m0, s35
s_add_u32 s35, s35, 1024
buffer_load_dwordx4 v12, s[12:15], s34 offen lds
s_mov_b32 m0, s35
s_add_u32 s35, s35, 1024
buffer_load_dwordx4 v13, s[12:15], s34 offen lds
s_mov_b32 m0, s35
s_add_u32 s35, s35, 1024
buffer_load_dwordx4 v14, s[12:15], s34 offen lds
s_add_u32 s34, s34, 36864
s_mov_b32 m0, s35
s_add_u32 s35, s35, 1024
buffer_load_dwordx4 v12, s[12:15], s34 offen lds
s_mov_b32 m0, s35
s_add_u32 s35, s35, 1024
buffer_load_dwordx4 v13, s[12:15], s34 offen lds
s_mov_b32 m0, s35
s_add_u32 s35, s35, 1024
buffer_load_dwordx4 v14, s[12:15], s34 offen lds
s_add_u32 s34, s34, 36864
s_mov_b32 m0, s35
s_add_u32 s35, s35, 1024
buffer_load_dwordx4 v12, s[12:15], s34 offen lds
s_mov_b32 m0, s35
s_add_u32 s35, s35, 1024
buffer_load_dwordx4 v13, s[12:15], s34 offen lds
s_mov_b32 m0, s35
s_add_u32 s35, s35, 1024
buffer_load_dwordx4 v14, s[12:15], s34 offen lds
s_add_u32 s34, s34, 36864
s_mov_b32 m0, s35
s_add_u32 s35, s35, 1024
buffer_load_dwordx4 v12, s[12:15], s34 offen lds
s_mov_b32 m0, s35
s_add_u32 s35, s35, 1024
buffer_load_dwordx4 v13, s[12:15], s34 offen lds
s_mov_b32 m0, s35
s_add_u32 s35, s35, 1024
buffer_load_dwordx4 v14, s[12:15], s34 offen lds
s_add_u32 s34, s34, 36864
s_waitcnt vmcnt(33)
ds_read_b64_tr_b16 a[0:1], v6
ds_read_b64_tr_b16 a[2:3], v6 offset:384
ds_read_b64_tr_b16 a[4:5], v6 offset:32
ds_read_b64_tr_b16 a[6:7], v6 offset:416
ds_read_b64_tr_b16 a[8:9], v6 offset:64
ds_read_b64_tr_b16 a[10:11], v6 offset:448
s_waitcnt vmcnt(30)
ds_read_b64_tr_b16 a[12:13], v6 offset:3072
ds_read_b64_tr_b16 a[14:15], v6 offset:3456
ds_read_b64_tr_b16 a[16:17], v6 offset:3104
ds_read_b64_tr_b16 a[18:19], v6 offset:3488
ds_read_b64_tr_b16 a[20:21], v6 offset:3136
ds_read_b64_tr_b16 a[22:23], v6 offset:3520
s_waitcnt vmcnt(27)
ds_read_b64_tr_b16 a[24:25], v6 offset:6144
ds_read_b64_tr_b16 a[26:27], v6 offset:6528
ds_read_b64_tr_b16 a[28:29], v6 offset:6176
ds_read_b64_tr_b16 a[30:31], v6 offset:6560
ds_read_b64_tr_b16 a[32:33], v6 offset:6208
ds_read_b64_tr_b16 a[34:35], v6 offset:6592
s_waitcnt vmcnt(24)
ds_read_b64_tr_b16 a[36:37], v6 offset:9216
ds_read_b64_tr_b16 a[38:39], v6 offset:9600
ds_read_b64_tr_b16 a[40:41], v6 offset:9248
ds_read_b64_tr_b16 a[42:43], v6 offset:9632
ds_read_b64_tr_b16 a[44:45], v6 offset:9280
ds_read_b64_tr_b16 a[46:47], v6 offset:9664
s_waitcnt vmcnt(21)
ds_read_b64_tr_b16 a[48:49], v6 offset:12288
ds_read_b64_tr_b16 a[50:51], v6 offset:12672
ds_read_b64_tr_b16 a[52:53], v6 offset:12320
ds_read_b64_tr_b16 a[54:55], v6 offset:12704
ds_read_b64_tr_b16 a[56:57], v6 offset:12352
ds_read_b64_tr_b16 a[58:59], v6 offset:12736
s_waitcnt vmcnt(18)
ds_read_b64_tr_b16 a[60:61], v6 offset:15360
ds_read_b64_tr_b16 a[62:63], v6 offset:15744
ds_read_b64_tr_b16 a[64:65], v6 offset:15392
ds_read_b64_tr_b16 a[66:67], v6 offset:15776
ds_read_b64_tr_b16 a[68:69], v6 offset:15424
ds_read_b64_tr_b16 a[70:71], v6 offset:15808
s_waitcnt vmcnt(15)
ds_read_b64_tr_b16 a[72:73], v6 offset:18432
ds_read_b64_tr_b16 a[74:75], v6 offset:18816
ds_read_b64_tr_b16 a[76:77], v6 offset:18464
ds_read_b64_tr_b16 a[78:79], v6 offset:18848
ds_read_b64_tr_b16 a[80:81], v6 offset:18496
ds_read_b64_tr_b16 a[82:83], v6 offset:18880
s_waitcnt vmcnt(12)
ds_read_b64_tr_b16 a[84:85], v6 offset:21504
ds_read_b64_tr_b16 a[86:87], v6 offset:21888
ds_read_b64_tr_b16 a[88:89], v6 offset:21536
ds_read_b64_tr_b16 a[90:91], v6 offset:21920
ds_read_b64_tr_b16 a[92:93], v6 offset:21568
ds_read_b64_tr_b16 a[94:95], v6 offset:21952
s_waitcnt vmcnt(9)
ds_read_b64_tr_b16 a[96:97], v6 offset:24576
ds_read_b64_tr_b16 a[98:99], v6 offset:24960
ds_read_b64_tr_b16 a[100:101], v6 offset:24608
ds_read_b64_tr_b16 a[102:103], v6 offset:24992
ds_read_b64_tr_b16 a[104:105], v6 offset:24640
ds_read_b64_tr_b16 a[106:107], v6 offset:25024
s_waitcnt vmcnt(6)
ds_read_b64_tr_b16 a[108:109], v6 offset:27648
ds_read_b64_tr_b16 a[110:111], v6 offset:28032
ds_read_b64_tr_b16 a[112:113], v6 offset:27680
ds_read_b64_tr_b16 a[114:115], v6 offset:28064
ds_read_b64_tr_b16 a[116:117], v6 offset:27712
ds_read_b64_tr_b16 a[118:119], v6 offset:28096
s_waitcnt vmcnt(3)
ds_read_b64_tr_b16 a[120:121], v6 offset:30720
ds_read_b64_tr_b16 a[122:123], v6 offset:31104
ds_read_b64_tr_b16 a[124:125], v6 offset:30752
ds_read_b64_tr_b16 a[126:127], v6 offset:31136
ds_read_b64_tr_b16 a[128:129], v6 offset:30784
ds_read_b64_tr_b16 a[130:131], v6 offset:31168
s_waitcnt vmcnt(0)
ds_read_b64_tr_b16 a[132:133], v6 offset:33792
ds_read_b64_tr_b16 a[134:135], v6 offset:34176
ds_read_b64_tr_b16 a[136:137], v6 offset:33824
ds_read_b64_tr_b16 a[138:139], v6 offset:34208
ds_read_b64_tr_b16 a[140:141], v6 offset:33856
ds_read_b64_tr_b16 a[142:143], v6 offset:34240
s_waitcnt lgkmcnt(0)
s_mov_b32 s35, s33
s_mov_b32 m0, s35
s_add_u32 s35, s35, 1024
buffer_load_dwordx4 v12, s[12:15], s34 offen lds
s_mov_b32 m0, s35
s_add_u32 s35, s35, 1024
buffer_load_dwordx4 v13, s[12:15], s34 offen lds
s_mov_b32 m0, s35
s_add_u32 s35, s35, 1024
buffer_load_dwordx4 v14, s[12:15], s34 offen lds
s_add_u32 s34, s34, 36864
s_mov_b32 m0, s35
s_add_u32 s35, s35, 1024
buffer_load_dwordx4 v12, s[12:15], s34 offen lds
s_mov_b32 m0, s35
s_add_u32 s35, s35, 1024
buffer_load_dwordx4 v13, s[12:15], s34 offen lds
s_mov_b32 m0, s35
s_add_u32 s35, s35, 1024
buffer_load_dwordx4 v14, s[12:15], s34 offen lds
s_add_u32 s34, s34, 36864
s_mov_b32 m0, s35
s_add_u32 s35, s35, 1024
buffer_load_dwordx4 v12, s[12:15], s34 offen lds
s_mov_b32 m0, s35
s_add_u32 s35, s35, 1024
buffer_load_dwordx4 v13, s[12:15], s34 offen lds
s_mov_b32 m0, s35
s_add_u32 s35, s35, 1024
buffer_load_dwordx4 v14, s[12:15], s34 offen lds
s_add_u32 s34, s34, 36864
s_mov_b32 m0, s35
s_add_u32 s35, s35, 1024
buffer_load_dwordx4 v12, s[12:15], s34 offen lds
s_mov_b32 m0, s35
s_add_u32 s35, s35, 1024
buffer_load_dwordx4 v13, s[12:15], s34 offen lds
s_mov_b32 m0, s35
s_add_u32 s35, s35, 1024
buffer_load_dwordx4 v14, s[12:15], s34 offen lds
s_add_u32 s34, s34, 36864
s_mov_b32 m0, s35
s_add_u32 s35, s35, 1024
buffer_load_dwordx4 v12, s[12:15], s34 offen lds
s_mov_b32 m0, s35
s_add_u32 s35, s35, 1024
buffer_load_dwordx4 v13, s[12:15], s34 offen lds
s_mov_b32 m0, s35
s_add_u32 s35, s35, 1024
buffer_load_dwordx4 v14, s[12:15], s34 offen lds
s_add_u32 s34, s34, 36864
s_mov_b32 m0, s35
s_add_u32 s35, s35, 1024
buffer_load_dwordx4 v12, s[12:15], s34 offen lds
s_mov_b32 m0, s35
s_add_u32 s35, s35, 1024
buffer_load_dwordx4 v13, s[12:15], s34 offen lds
s_mov_b32 m0, s35
s_add_u32 s35, s35, 1024
buffer_load_dwordx4 v14, s[12:15], s34 offen lds
s_add_u32 s34, s34, 36864
s_mov_b32 m0, s35
s_add_u32 s35, s35, 1024
buffer_load_dwordx4 v12, s[12:15], s34 offen lds
s_mov_b32 m0, s35
s_add_u32 s35, s35, 1024
buffer_load_dwordx4 v13, s[12:15], s34 offen lds
s_mov_b32 m0, s35
s_add_u32 s35, s35, 1024
buffer_load_dwordx4 v14, s[12:15], s34 offen lds
s_add_u32 s34, s34, 36864
s_mov_b32 m0, s35
s_add_u32 s35, s35, 1024
buffer_load_dwordx4 v12, s[12:15], s34 offen lds
s_mov_b32 m0, s35
s_add_u32 s35, s35, 1024
buffer_load_dwordx4 v13, s[12:15], s34 offen lds
s_mov_b32 m0, s35
s_add_u32 s35, s35, 1024
buffer_load_dwordx4 v14, s[12:15], s34 offen lds
s_add_u32 s34, s34, 36864
s_mov_b32 m0, s35
s_add_u32 s35, s35, 1024
buffer_load_dwordx4 v12, s[12:15], s34 offen lds
s_mov_b32 m0, s35
s_add_u32 s35, s35, 1024
buffer_load_dwordx4 v13, s[12:15], s34 offen lds
s_mov_b32 m0, s35
s_add_u32 s35, s35, 1024
buffer_load_dwordx4 v14, s[12:15], s34 offen lds
s_add_u32 s34, s34, 36864
s_mov_b32 m0, s35
s_add_u32 s35, s35, 1024
buffer_load_dwordx4 v12, s[12:15], s34 offen lds
s_mov_b32 m0, s35
s_add_u32 s35, s35, 1024
buffer_load_dwordx4 v13, s[12:15], s34 offen lds
s_mov_b32 m0, s35
s_add_u32 s35, s35, 1024
buffer_load_dwordx4 v14, s[12:15], s34 offen lds
s_add_u32 s34, s34, 36864
s_mov_b32 m0, s35
s_add_u32 s35, s35, 1024
buffer_load_dwordx4 v12, s[12:15], s34 offen lds
s_mov_b32 m0, s35
s_add_u32 s35, s35, 1024
buffer_load_dwordx4 v13, s[12:15], s34 offen lds
s_mov_b32 m0, s35
s_add_u32 s35, s35, 1024
buffer_load_dwordx4 v14, s[12:15], s34 offen lds
s_add_u32 s34, s34, 36864
s_mov_b32 m0, s35
s_add_u32 s35, s35, 1024
buffer_load_dwordx4 v12, s[12:15], s34 offen lds
s_mov_b32 m0, s35
s_add_u32 s35, s35, 1024
buffer_load_dwordx4 v13, s[12:15], s34 offen lds
s_mov_b32 m0, s35
s_add_u32 s35, s35, 1024
buffer_load_dwordx4 v14, s[12:15], s34 offen lds
s_add_u32 s34, s34, 36864
s_waitcnt vmcnt(33)
ds_read_b64_tr_b16 a[144:145], v6
ds_read_b64_tr_b16 a[146:147], v6 offset:384
ds_read_b64_tr_b16 a[148:149], v6 offset:32
ds_read_b64_tr_b16 a[150:151], v6 offset:416
ds_read_b64_tr_b16 a[152:153], v6 offset:64
ds_read_b64_tr_b16 a[154:155], v6 offset:448
s_waitcnt vmcnt(30)
ds_read_b64_tr_b16 a[156:157], v6 offset:3072
ds_read_b64_tr_b16 a[158:159], v6 offset:3456
ds_read_b64_tr_b16 a[160:161], v6 offset:3104
ds_read_b64_tr_b16 a[162:163], v6 offset:3488
ds_read_b64_tr_b16 a[164:165], v6 offset:3136
ds_read_b64_tr_b16 a[166:167], v6 offset:3520
s_waitcnt vmcnt(27)
ds_read_b64_tr_b16 a[168:169], v6 offset:6144
ds_read_b64_tr_b16 a[170:171], v6 offset:6528
ds_read_b64_tr_b16 a[172:173], v6 offset:6176
ds_read_b64_tr_b16 a[174:175], v6 offset:6560
ds_read_b64_tr_b16 a[176:177], v6 offset:6208
ds_read_b64_tr_b16 a[178:179], v6 offset:6592
s_waitcnt vmcnt(24)
ds_read_b64_tr_b16 a[180:181], v6 offset:9216
ds_read_b64_tr_b16 a[182:183], v6 offset:9600
ds_read_b64_tr_b16 a[184:185], v6 offset:9248
ds_read_b64_tr_b16 a[186:187], v6 offset:9632
ds_read_b64_tr_b16 a[188:189], v6 offset:9280
ds_read_b64_tr_b16 a[190:191], v6 offset:9664
s_waitcnt vmcnt(21)
ds_read_b64_tr_b16 a[192:193], v6 offset:12288
ds_read_b64_tr_b16 a[194:195], v6 offset:12672
ds_read_b64_tr_b16 a[196:197], v6 offset:12320
ds_read_b64_tr_b16 a[198:199], v6 offset:12704
ds_read_b64_tr_b16 a[200:201], v6 offset:12352
ds_read_b64_tr_b16 a[202:203], v6 offset:12736
s_waitcnt vmcnt(18)
ds_read_b64_tr_b16 a[204:205], v6 offset:15360
ds_read_b64_tr_b16 a[206:207], v6 offset:15744
ds_read_b64_tr_b16 a[208:209], v6 offset:15392
ds_read_b64_tr_b16 a[210:211], v6 offset:15776
ds_read_b64_tr_b16 a[212:213], v6 offset:15424
ds_read_b64_tr_b16 a[214:215], v6 offset:15808
s_waitcnt vmcnt(15)
ds_read_b64_tr_b16 a[216:217], v6 offset:18432
ds_read_b64_tr_b16 a[218:219], v6 offset:18816
ds_read_b64_tr_b16 a[220:221], v6 offset:18464
ds_read_b64_tr_b16 a[222:223], v6 offset:18848
ds_read_b64_tr_b16 a[224:225], v6 offset:18496
ds_read_b64_tr_b16 a[226:227], v6 offset:18880
s_waitcnt vmcnt(12)
ds_read_b64_tr_b16 a[228:229], v6 offset:21504
ds_read_b64_tr_b16 a[230:231], v6 offset:21888
ds_read_b64_tr_b16 a[232:233], v6 offset:21536
ds_read_b64_tr_b16 a[234:235], v6 offset:21920
ds_read_b64_tr_b16 a[236:237], v6 offset:21568
ds_read_b64_tr_b16 a[238:239], v6 offset:21952
s_waitcnt vmcnt(9)
ds_read_b64_tr_b16 a[240:241], v6 offset:24576
ds_read_b64_tr_b16 a[242:243], v6 offset:24960
ds_read_b64_tr_b16 a[244:245], v6 offset:24608
ds_read_b64_tr_b16 a[246:247], v6 offset:24992
ds_read_b64_tr_b16 a[248:249], v6 offset:24640
ds_read_b64_tr_b16 a[250:251], v6 offset:25024
s_waitcnt vmcnt(6)
ds_read_b64_tr_b16 a[252:253], v6 offset:27648
ds_read_b64_tr_b16 a[254:255], v6 offset:28032
ds_read_b64_tr_b16 v[80:81], v6 offset:27680
ds_read_b64_tr_b16 v[82:83], v6 offset:28064
ds_read_b64_tr_b16 v[84:85], v6 offset:27712
ds_read_b64_tr_b16 v[86:87], v6 offset:28096
s_waitcnt vmcnt(3)
ds_read_b64_tr_b16 v[88:89], v6 offset:30720
ds_read_b64_tr_b16 v[90:91], v6 offset:31104
ds_read_b64_tr_b16 v[92:93], v6 offset:30752
ds_read_b64_tr_b16 v[94:95], v6 offset:31136
ds_read_b64_tr_b16 v[96:97], v6 offset:30784
ds_read_b64_tr_b16 v[98:99], v6 offset:31168
s_waitcnt vmcnt(0)
ds_read_b64_tr_b16 v[100:101], v6 offset:33792
ds_read_b64_tr_b16 v[102:103], v6 offset:34176
ds_read_b64_tr_b16 v[104:105], v6 offset:33824
ds_read_b64_tr_b16 v[106:107], v6 offset:34208
ds_read_b64_tr_b16 v[108:109], v6 offset:33856
ds_read_b64_tr_b16 v[110:111], v6 offset:34240
s_waitcnt lgkmcnt(0)
s_mov_b32 s35, s33
s_mov_b32 m0, s35
s_add_u32 s35, s35, 1024
buffer_load_dwordx4 v12, s[12:15], s34 offen lds
s_mov_b32 m0, s35
s_add_u32 s35, s35, 1024
buffer_load_dwordx4 v13, s[12:15], s34 offen lds
s_mov_b32 m0, s35
s_add_u32 s35, s35, 1024
buffer_load_dwordx4 v14, s[12:15], s34 offen lds
s_add_u32 s34, s34, 36864
s_mov_b32 m0, s35
s_add_u32 s35, s35, 1024
buffer_load_dwordx4 v12, s[12:15], s34 offen lds
s_mov_b32 m0, s35
s_add_u32 s35, s35, 1024
buffer_load_dwordx4 v13, s[12:15], s34 offen lds
s_mov_b32 m0, s35
s_add_u32 s35, s35, 1024
buffer_load_dwordx4 v14, s[12:15], s34 offen lds
s_add_u32 s34, s34, 36864
s_mov_b32 m0, s35
s_add_u32 s35, s35, 1024
buffer_load_dwordx4 v12, s[12:15], s34 offen lds
s_mov_b32 m0, s35
s_add_u32 s35, s35, 1024
buffer_load_dwordx4 v13, s[12:15], s34 offen lds
s_mov_b32 m0, s35
s_add_u32 s35, s35, 1024
buffer_load_dwordx4 v14, s[12:15], s34 offen lds
s_add_u32 s34, s34, 36864
s_mov_b32 m0, s35
s_add_u32 s35, s35, 1024
buffer_load_dwordx4 v12, s[12:15], s34 offen lds
s_mov_b32 m0, s35
s_add_u32 s35, s35, 1024
buffer_load_dwordx4 v13, s[12:15], s34 offen lds
s_mov_b32 m0, s35
s_add_u32 s35, s35, 1024
buffer_load_dwordx4 v14, s[12:15], s34 offen lds
s_add_u32 s34, s34, 36864
s_mov_b32 m0, s35
s_add_u32 s35, s35, 1024
buffer_load_dwordx4 v12, s[12:15], s34 offen lds
s_mov_b32 m0, s35
s_add_u32 s35, s35, 1024
buffer_load_dwordx4 v13, s[12:15], s34 offen lds
s_mov_b32 m0, s35
s_add_u32 s35, s35, 1024
buffer_load_dwordx4 v14, s[12:15], s34 offen lds
s_add_u32 s34, s34, 36864
s_mov_b32 m0, s35
s_add_u32 s35, s35, 1024
buffer_load_dwordx4 v12, s[12:15], s34 offen lds
s_mov_b32 m0, s35
s_add_u32 s35, s35, 1024
buffer_load_dwordx4 v13, s[12:15], s34 offen lds
s_mov_b32 m0, s35
s_add_u32 s35, s35, 1024
buffer_load_dwordx4 v14, s[12:15], s34 offen lds
s_add_u32 s34, s34, 36864
s_mov_b32 m0, s35
s_add_u32 s35, s35, 1024
buffer_load_dwordx4 v12, s[12:15], s34 offen lds
s_mov_b32 m0, s35
s_add_u32 s35, s35, 1024
buffer_load_dwordx4 v13, s[12:15], s34 offen lds
s_mov_b32 m0, s35
s_add_u32 s35, s35, 1024
buffer_load_dwordx4 v14, s[12:15], s34 offen lds
s_add_u32 s34, s34, 36864
s_mov_b32 m0, s35
s_add_u32 s35, s35, 1024
buffer_load_dwordx4 v12, s[12:15], s34 offen lds
s_mov_b32 m0, s35
s_add_u32 s35, s35, 1024
buffer_load_dwordx4 v13, s[12:15], s34 offen lds
s_mov_b32 m0, s35
s_add_u32 s35, s35, 1024
buffer_load_dwordx4 v14, s[12:15], s34 offen lds
s_add_u32 s34, s34, 36864
s_mov_b32 m0, s35
s_add_u32 s35, s35, 1024
buffer_load_dwordx4 v12, s[12:15], s34 offen lds
s_mov_b32 m0, s35
s_add_u32 s35, s35, 1024
buffer_load_dwordx4 v13, s[12:15], s34 offen lds
s_mov_b32 m0, s35
s_add_u32 s35, s35, 1024
buffer_load_dwordx4 v14, s[12:15], s34 offen lds
s_add_u32 s34, s34, 36864
s_mov_b32 m0, s35
s_add_u32 s35, s35, 1024
buffer_load_dwordx4 v12, s[12:15], s34 offen lds
s_mov_b32 m0, s35
s_add_u32 s35, s35, 1024
buffer_load_dwordx4 v13, s[12:15], s34 offen lds
s_mov_b32 m0, s35
s_add_u32 s35, s35, 1024
buffer_load_dwordx4 v14, s[12:15], s34 offen lds
s_add_u32 s34, s34, 36864
s_mov_b32 m0, s35
s_add_u32 s35, s35, 1024
buffer_load_dwordx4 v12, s[12:15], s34 offen lds
s_mov_b32 m0, s35
s_add_u32 s35, s35, 1024
buffer_load_dwordx4 v13, s[12:15], s34 offen lds
s_mov_b32 m0, s35
s_add_u32 s35, s35, 1024
buffer_load_dwordx4 v14, s[12:15], s34 offen lds
s_add_u32 s34, s34, 36864
s_mov_b32 m0, s35
s_add_u32 s35, s35, 1024
buffer_load_dwordx4 v12, s[12:15], s34 offen lds
s_mov_b32 m0, s35
s_add_u32 s35, s35, 1024
buffer_load_dwordx4 v13, s[12:15], s34 offen lds
s_mov_b32 m0, s35
s_add_u32 s35, s35, 1024
buffer_load_dwordx4 v14, s[12:15], s34 offen lds
s_add_u32 s34, s34, 36864
s_waitcnt vmcnt(33)
ds_read_b64_tr_b16 v[112:113], v6
ds_read_b64_tr_b16 v[114:115], v6 offset:384
ds_read_b64_tr_b16 v[116:117], v6 offset:32
ds_read_b64_tr_b16 v[118:119], v6 offset:416
ds_read_b64_tr_b16 v[120:121], v6 offset:64
ds_read_b64_tr_b16 v[122:123], v6 offset:448
s_waitcnt vmcnt(30)
ds_read_b64_tr_b16 v[124:125], v6 offset:3072
ds_read_b64_tr_b16 v[126:127], v6 offset:3456
ds_read_b64_tr_b16 v[128:129], v6 offset:3104
ds_read_b64_tr_b16 v[130:131], v6 offset:3488
ds_read_b64_tr_b16 v[132:133], v6 offset:3136
ds_read_b64_tr_b16 v[134:135], v6 offset:3520
s_waitcnt vmcnt(27)
ds_read_b64_tr_b16 v[136:137], v6 offset:6144
ds_read_b64_tr_b16 v[138:139], v6 offset:6528
ds_read_b64_tr_b16 v[140:141], v6 offset:6176
ds_read_b64_tr_b16 v[142:143], v6 offset:6560
ds_read_b64_tr_b16 v[144:145], v6 offset:6208
ds_read_b64_tr_b16 v[146:147], v6 offset:6592
s_waitcnt vmcnt(24)
ds_read_b64_tr_b16 v[148:149], v6 offset:9216
ds_read_b64_tr_b16 v[150:151], v6 offset:9600
ds_read_b64_tr_b16 v[152:153], v6 offset:9248
ds_read_b64_tr_b16 v[154:155], v6 offset:9632
ds_read_b64_tr_b16 v[156:157], v6 offset:9280
ds_read_b64_tr_b16 v[158:159], v6 offset:9664
s_waitcnt vmcnt(21)
ds_read_b64_tr_b16 v[160:161], v6 offset:12288
ds_read_b64_tr_b16 v[162:163], v6 offset:12672
ds_read_b64_tr_b16 v[164:165], v6 offset:12320
ds_read_b64_tr_b16 v[166:167], v6 offset:12704
ds_read_b64_tr_b16 v[168:169], v6 offset:12352
ds_read_b64_tr_b16 v[170:171], v6 offset:12736
s_waitcnt vmcnt(18)
ds_read_b64_tr_b16 v[172:173], v6 offset:15360
ds_read_b64_tr_b16 v[174:175], v6 offset:15744
ds_read_b64_tr_b16 v[176:177], v6 offset:15392
ds_read_b64_tr_b16 v[178:179], v6 offset:15776
ds_read_b64_tr_b16 v[180:181], v6 offset:15424
ds_read_b64_tr_b16 v[182:183], v6 offset:15808
s_waitcnt vmcnt(15)
ds_read_b64_tr_b16 v[184:185], v6 offset:18432
ds_read_b64_tr_b16 v[186:187], v6 offset:18816
ds_read_b64_tr_b16 v[188:189], v6 offset:18464
ds_read_b64_tr_b16 v[190:191], v6 offset:18848
ds_read_b64_tr_b16 v[192:193], v6 offset:18496
ds_read_b64_tr_b16 v[194:195], v6 offset:18880
s_waitcnt vmcnt(12)
ds_read_b64_tr_b16 v[196:197], v6 offset:21504
ds_read_b64_tr_b16 v[198:199], v6 offset:21888
ds_read_b64_tr_b16 v[200:201], v6 offset:21536
ds_read_b64_tr_b16 v[202:203], v6 offset:21920
ds_read_b64_tr_b16 v[204:205], v6 offset:21568
ds_read_b64_tr_b16 v[206:207], v6 offset:21952
s_waitcnt vmcnt(9)
ds_read_b64_tr_b16 v[208:209], v6 offset:24576
ds_read_b64_tr_b16 v[210:211], v6 offset:24960
ds_read_b64_tr_b16 v[212:213], v6 offset:24608
ds_read_b64_tr_b16 v[214:215], v6 offset:24992
ds_read_b64_tr_b16 v[216:217], v6 offset:24640
ds_read_b64_tr_b16 v[218:219], v6 offset:25024
s_waitcnt vmcnt(6)
ds_read_b64_tr_b16 v[220:221], v6 offset:27648
ds_read_b64_tr_b16 v[222:223], v6 offset:28032
ds_read_b64_tr_b16 v[224:225], v6 offset:27680
ds_read_b64_tr_b16 v[226:227], v6 offset:28064
ds_read_b64_tr_b16 v[228:229], v6 offset:27712
ds_read_b64_tr_b16 v[230:231], v6 offset:28096
s_waitcnt vmcnt(3)
ds_read_b64_tr_b16 v[232:233], v6 offset:30720
ds_read_b64_tr_b16 v[234:235], v6 offset:31104
ds_read_b64_tr_b16 v[236:237], v6 offset:30752
ds_read_b64_tr_b16 v[238:239], v6 offset:31136
ds_read_b64_tr_b16 v[240:241], v6 offset:30784
ds_read_b64_tr_b16 v[242:243], v6 offset:31168
s_waitcnt vmcnt(0)
ds_read_b64_tr_b16 v[244:245], v6 offset:33792
ds_read_b64_tr_b16 v[246:247], v6 offset:34176
ds_read_b64_tr_b16 v[248:249], v6 offset:33824
ds_read_b64_tr_b16 v[250:251], v6 offset:34208
ds_read_b64_tr_b16 v[252:253], v6 offset:33856
ds_read_b64_tr_b16 v[254:255], v6 offset:34240
s_waitcnt lgkmcnt(0)
s_barrier
s_cmp_eq_u32 s16, 0
s_cbranch_scc0 L_wdog1d
v_mov_b32 v8, 0
L_wd0g1d:
global_load_dword v9, v8, s[6:7] offset:100 sc1
s_waitcnt vmcnt(0)
v_cmp_gt_u32 vcc, 18, v9
s_cbranch_vccz L_wdn0g1d
s_sleep 24
s_add_u32 s21, s21, 1
s_cmp_ge_u32 s21, 4194304
s_cbranch_scc1 L_abort
s_branch L_wd0g1d
L_wdn0g1d:
L_wd1g1d:
global_load_dword v9, v8, s[6:7] offset:192 sc1
s_waitcnt vmcnt(0)
v_cmp_gt_u32 vcc, 16, v9
s_cbranch_vccz L_wdn1g1d
s_sleep 24
s_add_u32 s21, s21, 1
s_cmp_ge_u32 s21, 4194304
s_cbranch_scc1 L_abort
s_branch L_wd1g1d
L_wdn1g1d:
L_wd2g1d:
global_load_dword v9, v8, s[6:7] offset:104 sc1
s_waitcnt vmcnt(0)
v_cmp_gt_u32 vcc, 28, v9
s_cbranch_vccz L_wdn2g1d
s_sleep 24
s_add_u32 s21, s21, 1
s_cmp_ge_u32 s21, 4194304
s_cbranch_scc1 L_abort
s_branch L_wd2g1d
L_wdn2g1d:
L_wdog1d:
s_barrier
v_lshrrev_b32 v8, 4, v2
v_and_b32 v9, 15, v2
v_min_u32 v4, 35, v2
v_lshlrev_b32 v4, 3, v4
v_mov_b32 v7, 1
s_mul_i32 s19, s16, 3072
s_add_u32 s19, s19, 147456
v_add_u32 v5, s19, v0
s_min_u32 s19, s16, 2
s_lshl_b32 s19, s19, 10
s_add_u32 s19, s19, 147456
v_add_u32 v6, s19, v0
s_load_dwordx2 s[4:5], s[0:1], 104
s_waitcnt lgkmcnt(0)
s_mov_b32 s24, s4
s_and_b32 s25, s5, 0xffff
s_mov_b32 s26, 2359296
s_mov_b32 s27, 0x20000
v_lshlrev_b32 v8, 3, v8
s_mul_i32 s33, s23, 96
s_min_u32 s19, s16, 2
s_lshl_b32 s19, s19, 5
s_add_u32 s33, s33, s19
s_add_u32 s19, s33, 1054336
buffer_load_dwordx2 v[74:75], v8, s[8:11], s19 offen sc1
v_mul_u32_u24 v9, 1152, v9
v_add_u32 v3, v8, v9
v_lshrrev_b32 v10, 5, v2
v_lshl_add_u32 v10, v10, 9, v9
v_and_b32 v11, 8, v8
v_add_u32 v10, v10, v11
s_lshr_b32 s60, s33, 1
s_cmp_lt_u32 s33, 1024
s_cselect_b32 s60, s60, s33
s_cselect_b64 vcc, -1, 0
v_cndmask_b32 v71, v3, v10, vcc
s_waitcnt vmcnt(0)
v_lshlrev_b32 v72, 16, v74
v_and_b32 v73, s18, v74
v_lshlrev_b32 v74, 16, v75
v_and_b32 v75, s18, v75
s_mul_i32 s28, s22, 147456
s_mul_i32 s19, s32, 36864
s_add_u32 s28, s28, s19
s_add_u32 s28, s28, 100663296
s_lshr_b32 s19, s22, 1
s_mul_i32 s29, s19, 1280
s_mul_i32 s19, s32, 288
s_add_u32 s29, s29, s19
s_add_u32 s29, s29, 131072
s_mul_i32 s37, s16, 36864
v_add_u32 v1, s37, v0
s_mov_b32 s61, 0
v_mul_u32_u24 v70, 72, v2
v_lshrrev_b32 v70, 4, v70
v_lshlrev_b32 v70, 7, v70
v_add_u32 v70, 508, v70
s_mov_b32 s36, 1073741824
s_mov_b32 s38, 0
L_g2d:
s_cmp_eq_u32 s38, 0
s_cbranch_scc0 L_g2cd
s_cmp_ge_u32 s22, 112
s_cbranch_scc0 L_g2fd
L_g2rd:
L_wpgd:
buffer_load_dword v78, v70, s[8:11], s28 offen sc1
s_waitcnt vmcnt(0)
v_cmp_eq_u32 vcc, -1, v78
s_cbranch_vccz L_wpogd
s_add_u32 s21, s21, 1
s_cmp_ge_u32 s21, 4194304
s_cbranch_scc1 L_abort
s_branch L_wpgd
L_wpogd:
s_branch L_g2gd
L_g2fd:
L_wvg3d:
buffer_load_dwordx2 v[78:79], v4, s[8:11], s29 offen sc1
s_waitcnt vmcnt(0)
v_min_u32 v78, v78, v79
v_cmp_eq_u32 vcc, 0, v78
s_cbranch_vccz L_wvog3d
s_sleep 2
s_add_u32 s21, s21, 1
s_cmp_ge_u32 s21, 4194304
s_cbranch_scc1 L_abort
s_branch L_wvg3d
L_wvog3d:
L_g2gd:
s_add_u32 s19, s37, 0
s_mov_b32 m0, s19
s_add_u32 s20, s28, 0
buffer_load_dwordx4 v0, s[8:11], s20 offen sc1 lds
s_add_u32 s19, s37, 1024
s_mov_b32 m0, s19
s_add_u32 s20, s28, 1024
buffer_load_dwordx4 v0, s[8:11], s20 offen sc1 lds
s_add_u32 s19, s37, 2048
s_mov_b32 m0, s19
s_add_u32 s20, s28, 2048
buffer_load_dwordx4 v0, s[8:11], s20 offen sc1 lds
s_add_u32 s19, s37, 3072
s_mov_b32 m0, s19
s_add_u32 s20, s28, 3072
buffer_load_dwordx4 v0, s[8:11], s20 offen sc1 lds
s_add_u32 s19, s37, 4096
s_mov_b32 m0, s19
s_add_u32 s20, s28, 4096
buffer_load_dwordx4 v0, s[8:11], s20 offen sc1 lds
s_add_u32 s19, s37, 5120
s_mov_b32 m0, s19
s_add_u32 s20, s28, 5120
buffer_load_dwordx4 v0, s[8:11], s20 offen sc1 lds
s_add_u32 s19, s37, 6144
s_mov_b32 m0, s19
s_add_u32 s20, s28, 6144
buffer_load_dwordx4 v0, s[8:11], s20 offen sc1 lds
s_add_u32 s19, s37, 7168
s_mov_b32 m0, s19
s_add_u32 s20, s28, 7168
buffer_load_dwordx4 v0, s[8:11], s20 offen sc1 lds
s_add_u32 s19, s37, 8192
s_mov_b32 m0, s19
s_add_u32 s20, s28, 8192
buffer_load_dwordx4 v0, s[8:11], s20 offen sc1 lds
s_add_u32 s19, s37, 9216
s_mov_b32 m0, s19
s_add_u32 s20, s28, 9216
buffer_load_dwordx4 v0, s[8:11], s20 offen sc1 lds
s_add_u32 s19, s37, 10240
s_mov_b32 m0, s19
s_add_u32 s20, s28, 10240
buffer_load_dwordx4 v0, s[8:11], s20 offen sc1 lds
s_add_u32 s19, s37, 11264
s_mov_b32 m0, s19
s_add_u32 s20, s28, 11264
buffer_load_dwordx4 v0, s[8:11], s20 offen sc1 lds
s_add_u32 s19, s37, 12288
s_mov_b32 m0, s19
s_add_u32 s20, s28, 12288
buffer_load_dwordx4 v0, s[8:11], s20 offen sc1 lds
s_add_u32 s19, s37, 13312
s_mov_b32 m0, s19
s_add_u32 s20, s28, 13312
buffer_load_dwordx4 v0, s[8:11], s20 offen sc1 lds
s_add_u32 s19, s37, 14336
s_mov_b32 m0, s19
s_add_u32 s20, s28, 14336
buffer_load_dwordx4 v0, s[8:11], s20 offen sc1 lds
s_add_u32 s19, s37, 15360
s_mov_b32 m0, s19
s_add_u32 s20, s28, 15360
buffer_load_dwordx4 v0, s[8:11], s20 offen sc1 lds
s_add_u32 s19, s37, 16384
s_mov_b32 m0, s19
s_add_u32 s20, s28, 16384
buffer_load_dwordx4 v0, s[8:11], s20 offen sc1 lds
s_add_u32 s19, s37, 17408
s_mov_b32 m0, s19
s_add_u32 s20, s28, 17408
buffer_load_dwordx4 v0, s[8:11], s20 offen sc1 lds
s_add_u32 s19, s37, 18432
s_mov_b32 m0, s19
s_add_u32 s20, s28, 18432
buffer_load_dwordx4 v0, s[8:11], s20 offen sc1 lds
s_add_u32 s19, s37, 19456
s_mov_b32 m0, s19
s_add_u32 s20, s28, 19456
buffer_load_dwordx4 v0, s[8:11], s20 offen sc1 lds
L_g2cd:
s_mul_i32 s31, s22, 18432
s_add_u32 s31, s31, s33
s_mov_b32 s35, s28
s_mul_i32 s30, s22, 18432
s_add_u32 s30, s30, s60
s_add_u32 s30, s30, 5242880
s_add_u32 s22, s22, 3
s_mul_i32 s28, s22, 147456
s_mul_i32 s19, s32, 36864
s_add_u32 s28, s28, s19
s_add_u32 s28, s28, 100663296
s_lshr_b32 s19, s22, 1
s_mul_i32 s29, s19, 1280
s_mul_i32 s19, s32, 288
s_add_u32 s29, s29, s19
s_add_u32 s29, s29, 131072
buffer_load_dwordx2 v[76:77], v71, s[8:11], s30 offen
buffer_load_dwordx2 v[78:79], v4, s[8:11], s29 offen sc1
s_waitcnt vmcnt(21)
ds_read_b128 v[20:23], v1
s_waitcnt vmcnt(20)
ds_read_b128 v[24:27], v1 offset:1024
s_waitcnt vmcnt(19)
ds_read_b128 v[28:31], v1 offset:2048
s_waitcnt vmcnt(18)
ds_read_b128 v[32:35], v1 offset:3072
s_waitcnt lgkmcnt(3)
v_mfma_f32_16x16x32_bf16 v[8:11], a[0:3], v[20:23], 0
s_add_u32 s19, s37, 20480
s_mov_b32 m0, s19
s_add_u32 s20, s35, 20480
buffer_load_dwordx4 v0, s[8:11], s20 offen sc1 lds
v_mfma_f32_16x16x32_bf16 v[12:15], a[4:7], v[20:23], 0
v_mfma_f32_16x16x32_bf16 v[16:19], a[8:11], v[20:23], 0
s_waitcnt vmcnt(18)
ds_read_b128 v[20:23], v1 offset:4096
s_waitcnt lgkmcnt(3)
v_mfma_f32_16x16x32_bf16 v[8:11], a[12:15], v[24:27], v[8:11]
s_add_u32 s19, s37, 21504
s_mov_b32 m0, s19
s_add_u32 s20, s35, 21504
buffer_load_dwordx4 v0, s[8:11], s20 offen sc1 lds
v_mfma_f32_16x16x32_bf16 v[12:15], a[16:19], v[24:27], v[12:15]
v_mfma_f32_16x16x32_bf16 v[16:19], a[20:23], v[24:27], v[16:19]
s_waitcnt vmcnt(18)
ds_read_b128 v[24:27], v1 offset:5120
s_waitcnt lgkmcnt(3)
v_mfma_f32_16x16x32_bf16 v[8:11], a[24:27], v[28:31], v[8:11]
s_add_u32 s19, s37, 22528
s_mov_b32 m0, s19
s_add_u32 s20, s35, 22528
buffer_load_dwordx4 v0, s[8:11], s20 offen sc1 lds
v_mfma_f32_16x16x32_bf16 v[12:15], a[28:31], v[28:31], v[12:15]
v_mfma_f32_16x16x32_bf16 v[16:19], a[32:35], v[28:31], v[16:19]
s_waitcnt vmcnt(18)
ds_read_b128 v[28:31], v1 offset:6144
s_waitcnt lgkmcnt(3)
v_mfma_f32_16x16x32_bf16 v[8:11], a[36:39], v[32:35], v[8:11]
s_add_u32 s19, s37, 23552
s_mov_b32 m0, s19
s_add_u32 s20, s35, 23552
buffer_load_dwordx4 v0, s[8:11], s20 offen sc1 lds
v_mfma_f32_16x16x32_bf16 v[12:15], a[40:43], v[32:35], v[12:15]
v_mfma_f32_16x16x32_bf16 v[16:19], a[44:47], v[32:35], v[16:19]
s_waitcnt vmcnt(18)
ds_read_b128 v[32:35], v1 offset:7168
s_waitcnt lgkmcnt(3)
v_mfma_f32_16x16x32_bf16 v[8:11], a[48:51], v[20:23], v[8:11]
s_add_u32 s19, s37, 24576
s_mov_b32 m0, s19
s_add_u32 s20, s35, 24576
buffer_load_dwordx4 v0, s[8:11], s20 offen sc1 lds
v_mfma_f32_16x16x32_bf16 v[12:15], a[52:55], v[20:23], v[12:15]
v_mfma_f32_16x16x32_bf16 v[16:19], a[56:59], v[20:23], v[16:19]
s_waitcnt vmcnt(18)
ds_read_b128 v[20:23], v1 offset:8192
s_waitcnt lgkmcnt(3)
v_mfma_f32_16x16x32_bf16 v[8:11], a[60:63], v[24:27], v[8:11]
s_add_u32 s19, s37, 25600
s_mov_b32 m0, s19
s_add_u32 s20, s35, 25600
buffer_load_dwordx4 v0, s[8:11], s20 offen sc1 lds
v_mfma_f32_16x16x32_bf16 v[12:15], a[64:67], v[24:27], v[12:15]
v_mfma_f32_16x16x32_bf16 v[16:19], a[68:71], v[24:27], v[16:19]
s_waitcnt vmcnt(18)
ds_read_b128 v[24:27], v1 offset:9216
s_waitcnt lgkmcnt(3)
v_mfma_f32_16x16x32_bf16 v[8:11], a[72:75], v[28:31], v[8:11]
s_add_u32 s19, s37, 26624
s_mov_b32 m0, s19
s_add_u32 s20, s35, 26624
buffer_load_dwordx4 v0, s[8:11], s20 offen sc1 lds
v_mfma_f32_16x16x32_bf16 v[12:15], a[76:79], v[28:31], v[12:15]
v_mfma_f32_16x16x32_bf16 v[16:19], a[80:83], v[28:31], v[16:19]
s_waitcnt vmcnt(18)
ds_read_b128 v[28:31], v1 offset:10240
s_waitcnt lgkmcnt(3)
v_mfma_f32_16x16x32_bf16 v[8:11], a[84:87], v[32:35], v[8:11]
s_add_u32 s19, s37, 27648
s_mov_b32 m0, s19
s_add_u32 s20, s35, 27648
buffer_load_dwordx4 v0, s[8:11], s20 offen sc1 lds
v_mfma_f32_16x16x32_bf16 v[12:15], a[88:91], v[32:35], v[12:15]
v_mfma_f32_16x16x32_bf16 v[16:19], a[92:95], v[32:35], v[16:19]
s_waitcnt vmcnt(18)
ds_read_b128 v[32:35], v1 offset:11264
s_waitcnt lgkmcnt(3)
v_mfma_f32_16x16x32_bf16 v[8:11], a[96:99], v[20:23], v[8:11]
s_add_u32 s19, s37, 28672
s_mov_b32 m0, s19
s_add_u32 s20, s35, 28672
buffer_load_dwordx4 v0, s[8:11], s20 offen sc1 lds
v_mfma_f32_16x16x32_bf16 v[12:15], a[100:103], v[20:23], v[12:15]
v_mfma_f32_16x16x32_bf16 v[16:19], a[104:107], v[20:23], v[16:19]
s_waitcnt vmcnt(18)
ds_read_b128 v[20:23], v1 offset:12288
s_waitcnt lgkmcnt(3)
v_mfma_f32_16x16x32_bf16 v[8:11], a[108:111], v[24:27], v[8:11]
s_add_u32 s19, s37, 29696
s_mov_b32 m0, s19
s_add_u32 s20, s35, 29696
buffer_load_dwordx4 v0, s[8:11], s20 offen sc1 lds
v_mfma_f32_16x16x32_bf16 v[12:15], a[112:115], v[24:27], v[12:15]
v_mfma_f32_16x16x32_bf16 v[16:19], a[116:119], v[24:27], v[16:19]
s_waitcnt vmcnt(18)
ds_read_b128 v[24:27], v1 offset:13312
s_waitcnt lgkmcnt(3)
v_mfma_f32_16x16x32_bf16 v[8:11], a[120:123], v[28:31], v[8:11]
s_add_u32 s19, s37, 30720
s_mov_b32 m0, s19
s_add_u32 s20, s35, 30720
buffer_load_dwordx4 v0, s[8:11], s20 offen sc1 lds
v_mfma_f32_16x16x32_bf16 v[12:15], a[124:127], v[28:31], v[12:15]
v_mfma_f32_16x16x32_bf16 v[16:19], a[128:131], v[28:31], v[16:19]
s_waitcnt vmcnt(18)
ds_read_b128 v[28:31], v1 offset:14336
s_waitcnt lgkmcnt(3)
v_mfma_f32_16x16x32_bf16 v[8:11], a[132:135], v[32:35], v[8:11]
s_add_u32 s19, s37, 31744
s_mov_b32 m0, s19
s_add_u32 s20, s35, 31744
buffer_load_dwordx4 v0, s[8:11], s20 offen sc1 lds
v_mfma_f32_16x16x32_bf16 v[12:15], a[136:139], v[32:35], v[12:15]
v_mfma_f32_16x16x32_bf16 v[16:19], a[140:143], v[32:35], v[16:19]
s_waitcnt vmcnt(18)
ds_read_b128 v[32:35], v1 offset:15360
s_waitcnt lgkmcnt(3)
v_mfma_f32_16x16x32_bf16 v[8:11], a[144:147], v[20:23], v[8:11]
s_add_u32 s19, s37, 32768
s_mov_b32 m0, s19
s_add_u32 s20, s35, 32768
buffer_load_dwordx4 v0, s[8:11], s20 offen sc1 lds
v_mfma_f32_16x16x32_bf16 v[12:15], a[148:151], v[20:23], v[12:15]
v_mfma_f32_16x16x32_bf16 v[16:19], a[152:155], v[20:23], v[16:19]
s_waitcnt vmcnt(18)
ds_read_b128 v[20:23], v1 offset:16384
s_waitcnt lgkmcnt(3)
v_mfma_f32_16x16x32_bf16 v[8:11], a[156:159], v[24:27], v[8:11]
s_add_u32 s19, s37, 33792
s_mov_b32 m0, s19
s_add_u32 s20, s35, 33792
buffer_load_dwordx4 v0, s[8:11], s20 offen sc1 lds
v_mfma_f32_16x16x32_bf16 v[12:15], a[160:163], v[24:27], v[12:15]
v_mfma_f32_16x16x32_bf16 v[16:19], a[164:167], v[24:27], v[16:19]
s_waitcnt vmcnt(18)
ds_read_b128 v[24:27], v1 offset:17408
s_waitcnt lgkmcnt(3)
v_mfma_f32_16x16x32_bf16 v[8:11], a[168:171], v[28:31], v[8:11]
s_add_u32 s19, s37, 34816
s_mov_b32 m0, s19
s_add_u32 s20, s35, 34816
buffer_load_dwordx4 v0, s[8:11], s20 offen sc1 lds
v_mfma_f32_16x16x32_bf16 v[12:15], a[172:175], v[28:31], v[12:15]
v_mfma_f32_16x16x32_bf16 v[16:19], a[176:179], v[28:31], v[16:19]
s_waitcnt vmcnt(18)
ds_read_b128 v[28:31], v1 offset:18432
s_waitcnt lgkmcnt(3)
v_mfma_f32_16x16x32_bf16 v[8:11], a[180:183], v[32:35], v[8:11]
s_add_u32 s19, s37, 35840
s_mov_b32 m0, s19
s_add_u32 s20, s35, 35840
buffer_load_dwordx4 v0, s[8:11], s20 offen sc1 lds
v_mfma_f32_16x16x32_bf16 v[12:15], a[184:187], v[32:35], v[12:15]
v_mfma_f32_16x16x32_bf16 v[16:19], a[188:191], v[32:35], v[16:19]
s_waitcnt vmcnt(16)
v_min_u32 v78, v78, v79
v_cmp_eq_u32 vcc, 0, v78
s_mov_b32 s38, 0
s_cbranch_vccnz L_g2pd
s_cmp_lt_u32 s22, 128
s_cbranch_scc0 L_g2pd
s_mov_b32 s38, 1
s_waitcnt vmcnt(18)
ds_read_b128 v[32:35], v1 offset:19456
s_waitcnt lgkmcnt(3)
v_mfma_f32_16x16x32_bf16 v[8:11], a[192:195], v[20:23], v[8:11]
s_add_u32 s19, s37, 0
s_mov_b32 m0, s19
s_add_u32 s20, s28, 0
buffer_load_dwordx4 v0, s[8:11], s20 offen sc1 lds
v_mfma_f32_16x16x32_bf16 v[12:15], a[196:199], v[20:23], v[12:15]
v_mfma_f32_16x16x32_bf16 v[16:19], a[200:203], v[20:23], v[16:19]
s_waitcnt vmcnt(16)
ds_read_b128 v[20:23], v1 offset:20480
s_waitcnt lgkmcnt(3)
v_mfma_f32_16x16x32_bf16 v[8:11], a[204:207], v[24:27], v[8:11]
s_add_u32 s19, s37, 1024
s_mov_b32 m0, s19
s_add_u32 s20, s28, 1024
buffer_load_dwordx4 v0, s[8:11], s20 offen sc1 lds
v_mfma_f32_16x16x32_bf16 v[12:15], a[208:211], v[24:27], v[12:15]
v_mfma_f32_16x16x32_bf16 v[16:19], a[212:215], v[24:27], v[16:19]
s_waitcnt vmcnt(16)
ds_read_b128 v[24:27], v1 offset:21504
s_waitcnt lgkmcnt(3)
v_mfma_f32_16x16x32_bf16 v[8:11], a[216:219], v[28:31], v[8:11]
s_add_u32 s19, s37, 2048
s_mov_b32 m0, s19
s_add_u32 s20, s28, 2048
buffer_load_dwordx4 v0, s[8:11], s20 offen sc1 lds
v_mfma_f32_16x16x32_bf16 v[12:15], a[220:223], v[28:31], v[12:15]
v_mfma_f32_16x16x32_bf16 v[16:19], a[224:227], v[28:31], v[16:19]
s_waitcnt vmcnt(16)
ds_read_b128 v[28:31], v1 offset:22528
s_waitcnt lgkmcnt(3)
v_mfma_f32_16x16x32_bf16 v[8:11], a[228:231], v[32:35], v[8:11]
s_add_u32 s19, s37, 3072
s_mov_b32 m0, s19
s_add_u32 s20, s28, 3072
buffer_load_dwordx4 v0, s[8:11], s20 offen sc1 lds
v_mfma_f32_16x16x32_bf16 v[12:15], a[232:235], v[32:35], v[12:15]
v_mfma_f32_16x16x32_bf16 v[16:19], a[236:239], v[32:35], v[16:19]
s_waitcnt vmcnt(16)
ds_read_b128 v[32:35], v1 offset:23552
s_waitcnt lgkmcnt(3)
v_mfma_f32_16x16x32_bf16 v[8:11], a[240:243], v[20:23], v[8:11]
s_add_u32 s19, s37, 4096
s_mov_b32 m0, s19
s_add_u32 s20, s28, 4096
buffer_load_dwordx4 v0, s[8:11], s20 offen sc1 lds
v_mfma_f32_16x16x32_bf16 v[12:15], a[244:247], v[20:23], v[12:15]
v_mfma_f32_16x16x32_bf16 v[16:19], a[248:251], v[20:23], v[16:19]
s_waitcnt vmcnt(16)
ds_read_b128 v[20:23], v1 offset:24576
s_waitcnt lgkmcnt(3)
v_mfma_f32_16x16x32_bf16 v[8:11], a[252:255], v[24:27], v[8:11]
s_add_u32 s19, s37, 5120
s_mov_b32 m0, s19
s_add_u32 s20, s28, 5120
buffer_load_dwordx4 v0, s[8:11], s20 offen sc1 lds
v_mfma_f32_16x16x32_bf16 v[12:15], v[80:83], v[24:27], v[12:15]
v_mfma_f32_16x16x32_bf16 v[16:19], v[84:87], v[24:27], v[16:19]
s_waitcnt vmcnt(16)
ds_read_b128 v[24:27], v1 offset:25600
s_waitcnt lgkmcnt(3)
v_mfma_f32_16x16x32_bf16 v[8:11], v[88:91], v[28:31], v[8:11]
s_add_u32 s19, s37, 6144
s_mov_b32 m0, s19
s_add_u32 s20, s28, 6144
buffer_load_dwordx4 v0, s[8:11], s20 offen sc1 lds
v_mfma_f32_16x16x32_bf16 v[12:15], v[92:95], v[28:31], v[12:15]
v_mfma_f32_16x16x32_bf16 v[16:19], v[96:99], v[28:31], v[16:19]
s_waitcnt vmcnt(16)
ds_read_b128 v[28:31], v1 offset:26624
s_waitcnt lgkmcnt(3)
v_mfma_f32_16x16x32_bf16 v[8:11], v[100:103], v[32:35], v[8:11]
s_add_u32 s19, s37, 7168
s_mov_b32 m0, s19
s_add_u32 s20, s28, 7168
buffer_load_dwordx4 v0, s[8:11], s20 offen sc1 lds
v_mfma_f32_16x16x32_bf16 v[12:15], v[104:107], v[32:35], v[12:15]
v_mfma_f32_16x16x32_bf16 v[16:19], v[108:111], v[32:35], v[16:19]
s_waitcnt vmcnt(16)
ds_read_b128 v[32:35], v1 offset:27648
s_waitcnt lgkmcnt(3)
v_mfma_f32_16x16x32_bf16 v[8:11], v[112:115], v[20:23], v[8:11]
s_add_u32 s19, s37, 8192
s_mov_b32 m0, s19
s_add_u32 s20, s28, 8192
buffer_load_dwordx4 v0, s[8:11], s20 offen sc1 lds
v_mfma_f32_16x16x32_bf16 v[12:15], v[116:119], v[20:23], v[12:15]
v_mfma_f32_16x16x32_bf16 v[16:19], v[120:123], v[20:23], v[16:19]
s_waitcnt vmcnt(16)
ds_read_b128 v[20:23], v1 offset:28672
s_waitcnt lgkmcnt(3)
v_mfma_f32_16x16x32_bf16 v[8:11], v[124:127], v[24:27], v[8:11]
s_add_u32 s19, s37, 9216
s_mov_b32 m0, s19
s_add_u32 s20, s28, 9216
buffer_load_dwordx4 v0, s[8:11], s20 offen sc1 lds
v_mfma_f32_16x16x32_bf16 v[12:15], v[128:131], v[24:27], v[12:15]
v_mfma_f32_16x16x32_bf16 v[16:19], v[132:135], v[24:27], v[16:19]
s_waitcnt vmcnt(16)
ds_read_b128 v[24:27], v1 offset:29696
s_waitcnt lgkmcnt(3)
v_mfma_f32_16x16x32_bf16 v[8:11], v[136:139], v[28:31], v[8:11]
s_add_u32 s19, s37, 10240
s_mov_b32 m0, s19
s_add_u32 s20, s28, 10240
buffer_load_dwordx4 v0, s[8:11], s20 offen sc1 lds
v_mfma_f32_16x16x32_bf16 v[12:15], v[140:143], v[28:31], v[12:15]
v_mfma_f32_16x16x32_bf16 v[16:19], v[144:147], v[28:31], v[16:19]
s_waitcnt vmcnt(16)
ds_read_b128 v[28:31], v1 offset:30720
s_waitcnt lgkmcnt(3)
v_mfma_f32_16x16x32_bf16 v[8:11], v[148:151], v[32:35], v[8:11]
s_add_u32 s19, s37, 11264
s_mov_b32 m0, s19
s_add_u32 s20, s28, 11264
buffer_load_dwordx4 v0, s[8:11], s20 offen sc1 lds
v_mfma_f32_16x16x32_bf16 v[12:15], v[152:155], v[32:35], v[12:15]
v_mfma_f32_16x16x32_bf16 v[16:19], v[156:159], v[32:35], v[16:19]
s_waitcnt vmcnt(16)
ds_read_b128 v[32:35], v1 offset:31744
s_waitcnt lgkmcnt(3)
v_mfma_f32_16x16x32_bf16 v[8:11], v[160:163], v[20:23], v[8:11]
s_add_u32 s19, s37, 12288
s_mov_b32 m0, s19
s_add_u32 s20, s28, 12288
buffer_load_dwordx4 v0, s[8:11], s20 offen sc1 lds
v_mfma_f32_16x16x32_bf16 v[12:15], v[164:167], v[20:23], v[12:15]
v_mfma_f32_16x16x32_bf16 v[16:19], v[168:171], v[20:23], v[16:19]
s_waitcnt vmcnt(16)
ds_read_b128 v[20:23], v1 offset:32768
s_waitcnt lgkmcnt(3)
v_mfma_f32_16x16x32_bf16 v[8:11], v[172:175], v[24:27], v[8:11]
s_add_u32 s19, s37, 13312
s_mov_b32 m0, s19
s_add_u32 s20, s28, 13312
buffer_load_dwordx4 v0, s[8:11], s20 offen sc1 lds
v_mfma_f32_16x16x32_bf16 v[12:15], v[176:179], v[24:27], v[12:15]
v_mfma_f32_16x16x32_bf16 v[16:19], v[180:183], v[24:27], v[16:19]
s_waitcnt vmcnt(16)
ds_read_b128 v[24:27], v1 offset:33792
s_waitcnt lgkmcnt(3)
v_mfma_f32_16x16x32_bf16 v[8:11], v[184:187], v[28:31], v[8:11]
s_add_u32 s19, s37, 14336
s_mov_b32 m0, s19
s_add_u32 s20, s28, 14336
buffer_load_dwordx4 v0, s[8:11], s20 offen sc1 lds
v_mfma_f32_16x16x32_bf16 v[12:15], v[188:191], v[28:31], v[12:15]
v_mfma_f32_16x16x32_bf16 v[16:19], v[192:195], v[28:31], v[16:19]
s_waitcnt vmcnt(16)
ds_read_b128 v[28:31], v1 offset:34816
s_waitcnt lgkmcnt(3)
v_mfma_f32_16x16x32_bf16 v[8:11], v[196:199], v[32:35], v[8:11]
s_add_u32 s19, s37, 15360
s_mov_b32 m0, s19
s_add_u32 s20, s28, 15360
buffer_load_dwordx4 v0, s[8:11], s20 offen sc1 lds
v_mfma_f32_16x16x32_bf16 v[12:15], v[200:203], v[32:35], v[12:15]
v_mfma_f32_16x16x32_bf16 v[16:19], v[204:207], v[32:35], v[16:19]
s_waitcnt vmcnt(16)
ds_read_b128 v[32:35], v1 offset:35840
s_waitcnt lgkmcnt(3)
v_mfma_f32_16x16x32_bf16 v[8:11], v[208:211], v[20:23], v[8:11]
s_add_u32 s19, s37, 16384
s_mov_b32 m0, s19
s_add_u32 s20, s28, 16384
buffer_load_dwordx4 v0, s[8:11], s20 offen sc1 lds
v_mfma_f32_16x16x32_bf16 v[12:15], v[212:215], v[20:23], v[12:15]
v_mfma_f32_16x16x32_bf16 v[16:19], v[216:219], v[20:23], v[16:19]
s_waitcnt lgkmcnt(2)
v_mfma_f32_16x16x32_bf16 v[8:11], v[220:223], v[24:27], v[8:11]
s_add_u32 s19, s37, 17408
s_mov_b32 m0, s19
s_add_u32 s20, s28, 17408
buffer_load_dwordx4 v0, s[8:11], s20 offen sc1 lds
v_mfma_f32_16x16x32_bf16 v[12:15], v[224:227], v[24:27], v[12:15]
v_mfma_f32_16x16x32_bf16 v[16:19], v[228:231], v[24:27], v[16:19]
s_waitcnt lgkmcnt(1)
v_mfma_f32_16x16x32_bf16 v[8:11], v[232:235], v[28:31], v[8:11]
s_add_u32 s19, s37, 18432
s_mov_b32 m0, s19
s_add_u32 s20, s28, 18432
buffer_load_dwordx4 v0, s[8:11], s20 offen sc1 lds
v_mfma_f32_16x16x32_bf16 v[12:15], v[236:239], v[28:31], v[12:15]
v_mfma_f32_16x16x32_bf16 v[16:19], v[240:243], v[28:31], v[16:19]
s_waitcnt lgkmcnt(0)
v_mfma_f32_16x16x32_bf16 v[8:11], v[244:247], v[32:35], v[8:11]
s_add_u32 s19, s37, 19456
s_mov_b32 m0, s19
s_add_u32 s20, s28, 19456
buffer_load_dwordx4 v0, s[8:11], s20 offen sc1 lds
v_mfma_f32_16x16x32_bf16 v[12:15], v[248:251], v[32:35], v[12:15]
v_mfma_f32_16x16x32_bf16 v[16:19], v[252:255], v[32:35], v[16:19]
s_branch L_g2ed
L_g2pd:
s_waitcnt vmcnt(18)
ds_read_b128 v[32:35], v1 offset:19456
s_waitcnt lgkmcnt(3)
v_mfma_f32_16x16x32_bf16 v[8:11], a[192:195], v[20:23], v[8:11]
v_mfma_f32_16x16x32_bf16 v[12:15], a[196:199], v[20:23], v[12:15]
v_mfma_f32_16x16x32_bf16 v[16:19], a[200:203], v[20:23], v[16:19]
s_waitcnt vmcnt(15)
ds_read_b128 v[20:23], v1 offset:20480
s_waitcnt lgkmcnt(3)
v_mfma_f32_16x16x32_bf16 v[8:11], a[204:207], v[24:27], v[8:11]
v_mfma_f32_16x16x32_bf16 v[12:15], a[208:211], v[24:27], v[12:15]
v_mfma_f32_16x16x32_bf16 v[16:19], a[212:215], v[24:27], v[16:19]
s_waitcnt vmcnt(14)
ds_read_b128 v[24:27], v1 offset:21504
s_waitcnt lgkmcnt(3)
v_mfma_f32_16x16x32_bf16 v[8:11], a[216:219], v[28:31], v[8:11]
v_mfma_f32_16x16x32_bf16 v[12:15], a[220:223], v[28:31], v[12:15]
v_mfma_f32_16x16x32_bf16 v[16:19], a[224:227], v[28:31], v[16:19]
s_waitcnt vmcnt(13)
ds_read_b128 v[28:31], v1 offset:22528
s_waitcnt lgkmcnt(3)
v_mfma_f32_16x16x32_bf16 v[8:11], a[228:231], v[32:35], v[8:11]
v_mfma_f32_16x16x32_bf16 v[12:15], a[232:235], v[32:35], v[12:15]
v_mfma_f32_16x16x32_bf16 v[16:19], a[236:239], v[32:35], v[16:19]
s_waitcnt vmcnt(12)
ds_read_b128 v[32:35], v1 offset:23552
s_waitcnt lgkmcnt(3)
v_mfma_f32_16x16x32_bf16 v[8:11], a[240:243], v[20:23], v[8:11]
v_mfma_f32_16x16x32_bf16 v[12:15], a[244:247], v[20:23], v[12:15]
v_mfma_f32_16x16x32_bf16 v[16:19], a[248:251], v[20:23], v[16:19]
s_waitcnt vmcnt(11)
ds_read_b128 v[20:23], v1 offset:24576
s_waitcnt lgkmcnt(3)
v_mfma_f32_16x16x32_bf16 v[8:11], a[252:255], v[24:27], v[8:11]
v_mfma_f32_16x16x32_bf16 v[12:15], v[80:83], v[24:27], v[12:15]
v_mfma_f32_16x16x32_bf16 v[16:19], v[84:87], v[24:27], v[16:19]
s_waitcnt vmcnt(10)
ds_read_b128 v[24:27], v1 offset:25600
s_waitcnt lgkmcnt(3)
v_mfma_f32_16x16x32_bf16 v[8:11], v[88:91], v[28:31], v[8:11]
v_mfma_f32_16x16x32_bf16 v[12:15], v[92:95], v[28:31], v[12:15]
v_mfma_f32_16x16x32_bf16 v[16:19], v[96:99], v[28:31], v[16:19]
s_waitcnt vmcnt(9)
ds_read_b128 v[28:31], v1 offset:26624
s_waitcnt lgkmcnt(3)
v_mfma_f32_16x16x32_bf16 v[8:11], v[100:103], v[32:35], v[8:11]
v_mfma_f32_16x16x32_bf16 v[12:15], v[104:107], v[32:35], v[12:15]
v_mfma_f32_16x16x32_bf16 v[16:19], v[108:111], v[32:35], v[16:19]
s_waitcnt vmcnt(8)
ds_read_b128 v[32:35], v1 offset:27648
s_waitcnt lgkmcnt(3)
v_mfma_f32_16x16x32_bf16 v[8:11], v[112:115], v[20:23], v[8:11]
v_mfma_f32_16x16x32_bf16 v[12:15], v[116:119], v[20:23], v[12:15]
v_mfma_f32_16x16x32_bf16 v[16:19], v[120:123], v[20:23], v[16:19]
s_waitcnt vmcnt(7)
ds_read_b128 v[20:23], v1 offset:28672
s_waitcnt lgkmcnt(3)
v_mfma_f32_16x16x32_bf16 v[8:11], v[124:127], v[24:27], v[8:11]
v_mfma_f32_16x16x32_bf16 v[12:15], v[128:131], v[24:27], v[12:15]
v_mfma_f32_16x16x32_bf16 v[16:19], v[132:135], v[24:27], v[16:19]
s_waitcnt vmcnt(6)
ds_read_b128 v[24:27], v1 offset:29696
s_waitcnt lgkmcnt(3)
v_mfma_f32_16x16x32_bf16 v[8:11], v[136:139], v[28:31], v[8:11]
v_mfma_f32_16x16x32_bf16 v[12:15], v[140:143], v[28:31], v[12:15]
v_mfma_f32_16x16x32_bf16 v[16:19], v[144:147], v[28:31], v[16:19]
s_waitcnt vmcnt(5)
ds_read_b128 v[28:31], v1 offset:30720
s_waitcnt lgkmcnt(3)
v_mfma_f32_16x16x32_bf16 v[8:11], v[148:151], v[32:35], v[8:11]
v_mfma_f32_16x16x32_bf16 v[12:15], v[152:155], v[32:35], v[12:15]
v_mfma_f32_16x16x32_bf16 v[16:19], v[156:159], v[32:35], v[16:19]
s_waitcnt vmcnt(4)
ds_read_b128 v[32:35], v1 offset:31744
s_waitcnt lgkmcnt(3)
v_mfma_f32_16x16x32_bf16 v[8:11], v[160:163], v[20:23], v[8:11]
v_mfma_f32_16x16x32_bf16 v[12:15], v[164:167], v[20:23], v[12:15]
v_mfma_f32_16x16x32_bf16 v[16:19], v[168:171], v[20:23], v[16:19]
s_waitcnt vmcnt(3)
ds_read_b128 v[20:23], v1 offset:32768
s_waitcnt lgkmcnt(3)
v_mfma_f32_16x16x32_bf16 v[8:11], v[172:175], v[24:27], v[8:11]
v_mfma_f32_16x16x32_bf16 v[12:15], v[176:179], v[24:27], v[12:15]
v_mfma_f32_16x16x32_bf16 v[16:19], v[180:183], v[24:27], v[16:19]
s_waitcnt vmcnt(2)
ds_read_b128 v[24:27], v1 offset:33792
s_waitcnt lgkmcnt(3)
v_mfma_f32_16x16x32_bf16 v[8:11], v[184:187], v[28:31], v[8:11]
v_mfma_f32_16x16x32_bf16 v[12:15], v[188:191], v[28:31], v[12:15]
v_mfma_f32_16x16x32_bf16 v[16:19], v[192:195], v[28:31], v[16:19]
s_waitcnt vmcnt(1)
ds_read_b128 v[28:31], v1 offset:34816
s_waitcnt lgkmcnt(3)
v_mfma_f32_16x16x32_bf16 v[8:11], v[196:199], v[32:35], v[8:11]
v_mfma_f32_16x16x32_bf16 v[12:15], v[200:203], v[32:35], v[12:15]
v_mfma_f32_16x16x32_bf16 v[16:19], v[204:207], v[32:35], v[16:19]
s_waitcnt vmcnt(0)
ds_read_b128 v[32:35], v1 offset:35840
s_waitcnt lgkmcnt(3)
v_mfma_f32_16x16x32_bf16 v[8:11], v[208:211], v[20:23], v[8:11]
v_mfma_f32_16x16x32_bf16 v[12:15], v[212:215], v[20:23], v[12:15]
v_mfma_f32_16x16x32_bf16 v[16:19], v[216:219], v[20:23], v[16:19]
s_waitcnt lgkmcnt(2)
v_mfma_f32_16x16x32_bf16 v[8:11], v[220:223], v[24:27], v[8:11]
v_mfma_f32_16x16x32_bf16 v[12:15], v[224:227], v[24:27], v[12:15]
v_mfma_f32_16x16x32_bf16 v[16:19], v[228:231], v[24:27], v[16:19]
s_waitcnt lgkmcnt(1)
v_mfma_f32_16x16x32_bf16 v[8:11], v[232:235], v[28:31], v[8:11]
v_mfma_f32_16x16x32_bf16 v[12:15], v[236:239], v[28:31], v[12:15]
v_mfma_f32_16x16x32_bf16 v[16:19], v[240:243], v[28:31], v[16:19]
s_waitcnt lgkmcnt(0)
v_mfma_f32_16x16x32_bf16 v[8:11], v[244:247], v[32:35], v[8:11]
v_mfma_f32_16x16x32_bf16 v[12:15], v[248:251], v[32:35], v[12:15]
v_mfma_f32_16x16x32_bf16 v[16:19], v[252:255], v[32:35], v[16:19]
L_g2ed:
v_cmp_u_f32 vcc, v8, v8
s_cbranch_vccnz L_g2xd
L_g2yd:
s_mov_b32 s61, 0
ds_write_b128 v5, v[8:11]
ds_write_b128 v5, v[12:15] offset:1024
s_nop 2
ds_write_b128 v5, v[16:19] offset:2048
s_waitcnt lgkmcnt(0)
s_barrier
ds_read_b128 v[20:23], v6
ds_read_b128 v[24:27], v6 offset:3072
ds_read_b128 v[28:31], v6 offset:6144
ds_read_b128 v[32:35], v6 offset:9216
v_lshlrev_b32 v36, 16, v76
v_and_b32 v37, s18, v76
v_lshlrev_b32 v38, 16, v77
v_and_b32 v39, s18, v77
s_waitcnt lgkmcnt(0)
s_barrier
s_cmp_eq_u32 s16, 3
s_cbranch_scc1 L_g2nd
v_pk_add_f32 v[20:21], v[20:21], v[24:25]
v_pk_add_f32 v[28:29], v[28:29], v[32:33]
v_pk_add_f32 v[22:23], v[22:23], v[26:27]
v_pk_add_f32 v[30:31], v[30:31], v[34:35]
v_pk_add_f32 v[20:21], v[20:21], v[28:29]
v_pk_add_f32 v[22:23], v[22:23], v[30:31]
v_cvt_pk_bf16_f32 v24, v20, v21
v_lshlrev_b32 v20, 16, v24
v_and_b32 v21, s18, v24
v_cvt_pk_bf16_f32 v25, v22, v23
v_lshlrev_b32 v22, 16, v25
v_and_b32 v23, s18, v25
v_pk_mul_f32 v[20:21], v[20:21], v[72:73]
v_pk_mul_f32 v[22:23], v[22:23], v[74:75]
v_cvt_pk_bf16_f32 v24, v20, v21
v_lshlrev_b32 v20, 16, v24
v_and_b32 v21, s18, v24
v_cvt_pk_bf16_f32 v25, v22, v23
v_lshlrev_b32 v22, 16, v25
v_and_b32 v23, s18, v25
v_pk_add_f32 v[20:21], v[20:21], v[36:37]
v_pk_add_f32 v[22:23], v[22:23], v[38:39]
v_cvt_pk_bf16_f32 v24, v20, v21
v_cvt_pk_bf16_f32 v25, v22, v23
buffer_store_dwordx2 v[24:25], v3, s[24:27], s31 offen
L_g2nd:
s_cmp_lt_u32 s22, 128
s_cbranch_scc1 L_g2d
s_waitcnt vmcnt(0)
s_endpgm
L_g2xd:
s_add_u32 s61, s61, 1
s_cmp_ge_u32 s61, 3
s_cbranch_scc1 L_g2yd
s_cmp_lt_u32 s22, 115
s_cbranch_scc1 L_g2yd
s_sub_u32 s22, s22, 3
s_waitcnt vmcnt(0)
s_mul_i32 s28, s22, 147456
s_mul_i32 s19, s32, 36864
s_add_u32 s28, s28, s19
s_add_u32 s28, s28, 100663296
s_lshr_b32 s19, s22, 1
s_mul_i32 s29, s19, 1280
s_mul_i32 s19, s32, 288
s_add_u32 s29, s29, s19
s_add_u32 s29, s29, 131072
s_branch L_g2rd
L_abort:
v_mov_b32 v8, 128
v_mov_b32 v9, 1
global_atomic_add v8, v9, s[6:7]
s_waitcnt vmcnt(0)
L_end:
s_endpgm
L_over:
v_mov_b32 v1, 0
L_ov1:
global_load_dwordx4 v[4:7], v1, s[6:7] sc1
global_load_dwordx4 v[8:11], v1, s[6:7] offset:144 sc1
s_waitcnt vmcnt(0)
v_add3_u32 v12, v4, v5, v6
v_add3_u32 v12, v12, v7, v8
v_add3_u32 v12, v12, v9, v10
v_add_u32 v12, v12, v11
v_cmp_gt_u32 vcc, 256, v12
s_cbranch_vccz L_ov2
s_sleep 16
s_add_u32 s21, s21, 1
s_cmp_ge_u32 s21, 0x400000
s_cbranch_scc1 L_abort
s_branch L_ov1
L_ov2:
v_cmp_eq_u32 vcc, 0, v0
s_nop 0
s_and_saveexec_b64 s[22:23], vcc
s_cbranch_execz L_ov3
v_mov_b32 v2, 1
global_atomic_add v3, v1, v2, s[6:7] offset:36 sc0
s_waitcnt vmcnt(0)
ds_write_b32 v1, v3
s_waitcnt lgkmcnt(0)
L_ov3:
s_mov_b64 exec, s[22:23]
s_barrier
ds_read_b32 v3, v1
s_waitcnt lgkmcnt(0)
v_readfirstlane_b32 s19, v3
s_barrier
v_readfirstlane_b32 s17, v4
s_nop 0
s_min_u32 s17, s17, 32
s_sub_u32 s20, 32, s17
s_mov_b32 s18, 0
s_cmp_lt_u32 s19, s20
s_cbranch_scc1 L_ov4
s_sub_u32 s19, s19, s20
v_readfirstlane_b32 s17, v5
s_nop 0
s_min_u32 s17, s17, 32
s_sub_u32 s20, 32, s17
s_mov_b32 s18, 1
s_cmp_lt_u32 s19, s20
s_cbranch_scc1 L_ov4
s_sub_u32 s19, s19, s20
v_readfirstlane_b32 s17, v6
s_nop 0
s_min_u32 s17, s17, 32
s_sub_u32 s20, 32, s17
s_mov_b32 s18, 2
s_cmp_lt_u32 s19, s20
s_cbranch_scc1 L_ov4
s_sub_u32 s19, s19, s20
v_readfirstlane_b32 s17, v7
s_nop 0
s_min_u32 s17, s17, 32
s_sub_u32 s20, 32, s17
s_mov_b32 s18, 3
s_cmp_lt_u32 s19, s20
s_cbranch_scc1 L_ov4
s_sub_u32 s19, s19, s20
v_readfirstlane_b32 s17, v8
s_nop 0
s_min_u32 s17, s17, 32
s_sub_u32 s20, 32, s17
s_mov_b32 s18, 4
s_cmp_lt_u32 s19, s20
s_cbranch_scc1 L_ov4
s_sub_u32 s19, s19, s20
v_readfirstlane_b32 s17, v9
s_nop 0
s_min_u32 s17, s17, 32
s_sub_u32 s20, 32, s17
s_mov_b32 s18, 5
s_cmp_lt_u32 s19, s20
s_cbranch_scc1 L_ov4
s_sub_u32 s19, s19, s20
v_readfirstlane_b32 s17, v10
s_nop 0
s_min_u32 s17, s17, 32
s_sub_u32 s20, 32, s17
s_mov_b32 s18, 6
s_cmp_lt_u32 s19, s20
s_cbranch_scc1 L_ov4
s_sub_u32 s19, s19, s20
v_readfirstlane_b32 s17, v11
s_nop 0
s_min_u32 s17, s17, 32
s_sub_u32 s20, 32, s17
s_mov_b32 s18, 7
s_cmp_lt_u32 s19, s20
s_cbranch_scc1 L_ov4
s_sub_u32 s19, s19, s20
s_branch L_abort
L_ov4:
s_add_u32 s17, s17, s19
s_cmp_eq_u32 s18, 0
s_cbranch_scc0 L_role
v_mov_b32 v2, 1
s_mov_b64 exec, 1
global_atomic_add v1, v2, s[6:7] offset:32
s_waitcnt vmcnt(0)
s_mov_b64 exec, -1
L_chain:
v_lshrrev_b32 v8, 6, v0
v_and_b32 v9, 63, v0
s_nop 0
v_readfirstlane_b32 s16, v8
v_lshlrev_b32 v0, 4, v9
s_mov_b32 s36, 0x05040100
s_mov_b32 s37, 0x07060302
s_mov_b32 s30, 1040356334
s_mov_b32 s31, s30
s_mov_b32 s21, 0
v_and_b32 v10, 15, v9
v_lshrrev_b32 v11, 4, v9
s_lshl_b32 s25, s17, 12
s_add_u32 s25, s25, 11534336
s_lshr_b32 s34, s17, 2
s_lshl_b32 s34, s34, 9
s_and_b32 s20, s17, 3
s_lshl_b32 s20, s20, 6
s_add_u32 s34, s34, s20
s_lshl_b32 s24, s16, 14
s_lshl_b32 s20, s17, 7
s_add_u32 s24, s24, s20
s_add_u32 s24, s24, 11534336
v_lshrrev_b32 v12, 3, v10
v_lshlrev_b32 v12, 2, v12
v_add_u32 v12, v12, v11
v_lshlrev_b32 v12, 7, v12
v_and_b32 v13, 7, v10
v_lshl_add_u32 v78, v13, 4, v12
v_lshrrev_b32 v12, 2, v13
v_lshlrev_b32 v12, 1, v12
v_and_b32 v14, 1, v11
v_add_u32 v12, v12, v14
v_lshlrev_b32 v12, 4, v12
v_and_b32 v14, 3, v13
v_lshl_add_u32 v12, v14, 2, v12
v_lshrrev_b32 v14, 1, v11
v_lshl_add_u32 v76, v14, 8, v12
v_mov_b64 v[72:73], 0
v_mov_b64 v[74:75], 0
v_mov_b32 v79, -1
s_cmp_eq_u32 s16, 3
s_cbranch_scc0 Lc_noinitsc1
s_add_u32 s19, s25, 0
buffer_store_dwordx4 v[72:75], v78, s[8:11], s19 offen sc1
buffer_store_dwordx4 v[72:75], v78, s[8:11], s19 offen offset:1024 sc1
buffer_store_dwordx4 v[72:75], v78, s[8:11], s19 offen offset:2048 sc1
buffer_store_dwordx4 v[72:75], v78, s[8:11], s19 offen offset:3072 sc1
s_add_u32 s19, s34, 12592128
buffer_store_dword v79, v76, s[8:11], s19 offen sc1
s_add_u32 s19, s25, 294912
buffer_store_dwordx4 v[72:75], v78, s[8:11], s19 offen sc1
buffer_store_dwordx4 v[72:75], v78, s[8:11], s19 offen offset:1024 sc1
buffer_store_dwordx4 v[72:75], v78, s[8:11], s19 offen offset:2048 sc1
buffer_store_dwordx4 v[72:75], v78, s[8:11], s19 offen offset:3072 sc1
s_add_u32 s19, s34, 12601344
buffer_store_dword v79, v76, s[8:11], s19 offen sc1
s_add_u32 s19, s25, 131072
buffer_store_dwordx4 v[72:75], v78, s[8:11], s19 offen sc1
buffer_store_dwordx4 v[72:75], v78, s[8:11], s19 offen offset:1024 sc1
buffer_store_dwordx4 v[72:75], v78, s[8:11], s19 offen offset:2048 sc1
buffer_store_dwordx4 v[72:75], v78, s[8:11], s19 offen offset:3072 sc1
s_add_u32 s19, s34, 12596224
buffer_store_dword v79, v76, s[8:11], s19 offen sc1
s_add_u32 s19, s25, 425984
buffer_store_dwordx4 v[72:75], v78, s[8:11], s19 offen sc1
buffer_store_dwordx4 v[72:75], v78, s[8:11], s19 offen offset:1024 sc1
buffer_store_dwordx4 v[72:75], v78, s[8:11], s19 offen offset:2048 sc1
buffer_store_dwordx4 v[72:75], v78, s[8:11], s19 offen offset:3072 sc1
s_add_u32 s19, s34, 12605440
buffer_store_dword v79, v76, s[8:11], s19 offen sc1
s_cmp_lt_u32 s17, 8
s_cbranch_scc0 Lc_noinitsc1
s_add_u32 s19, s25, 262144
buffer_store_dwordx4 v[72:75], v78, s[8:11], s19 offen sc1
buffer_store_dwordx4 v[72:75], v78, s[8:11], s19 offen offset:1024 sc1
buffer_store_dwordx4 v[72:75], v78, s[8:11], s19 offen offset:2048 sc1
buffer_store_dwordx4 v[72:75], v78, s[8:11], s19 offen offset:3072 sc1
s_add_u32 s19, s34, 12600320
buffer_store_dword v79, v76, s[8:11], s19 offen sc1
s_add_u32 s19, s25, 557056
buffer_store_dwordx4 v[72:75], v78, s[8:11], s19 offen sc1
buffer_store_dwordx4 v[72:75], v78, s[8:11], s19 offen offset:1024 sc1
buffer_store_dwordx4 v[72:75], v78, s[8:11], s19 offen offset:2048 sc1
buffer_store_dwordx4 v[72:75], v78, s[8:11], s19 offen offset:3072 sc1
s_add_u32 s19, s34, 12609536
buffer_store_dword v79, v76, s[8:11], s19 offen sc1
Lc_noinitsc1:
s_waitcnt vmcnt(8)
s_load_dwordx2 s[4:5], s[0:1], 8
s_waitcnt lgkmcnt(0)
s_mov_b32 s12, s4
s_and_b32 s13, s5, 0xffff
s_mov_b32 s14, 9216
s_mov_b32 s15, 0x20000
s_cmp_eq_u32 s17, 0
s_cbranch_scc0 Lc_nomemsc1
s_cmp_eq_u32 s16, 2
s_cbranch_scc0 Lc_nomemsc1
v_lshrrev_b32 v12, 2, v10
v_lshlrev_b32 v12, 1, v12
v_and_b32 v13, 1, v10
v_add_u32 v12, v12, v13
v_mul_u32_u24 v12, 1152, v12
v_bfe_u32 v13, v9, 1, 1
v_lshl_add_u32 v14, v11, 8, v12
v_lshl_add_u32 v14, v13, 7, v14
v_lshl_add_u32 v15, v11, 5, v12
v_lshl_add_u32 v15, v13, 4, v15
buffer_load_dwordx4 v[16:19], v14, s[12:15], 0 offen
buffer_load_dwordx4 v[20:23], v14, s[12:15], 0 offen offset:16
buffer_load_dwordx4 v[24:27], v14, s[12:15], 0 offen offset:32
buffer_load_dwordx4 v[28:31], v14, s[12:15], 0 offen offset:48
buffer_load_dwordx4 v[32:35], v14, s[12:15], 0 offen offset:64
buffer_load_dwordx4 v[36:39], v14, s[12:15], 0 offen offset:80
buffer_load_dwordx4 v[40:43], v14, s[12:15], 0 offen offset:96
buffer_load_dwordx4 v[44:47], v14, s[12:15], 0 offen offset:112
buffer_load_dwordx4 v[112:115], v15, s[12:15], 0 offen offset:1024
s_waitcnt vmcnt(0)
v_perm_b32 v80, v20, v16, s36
v_perm_b32 v81, v28, v24, s36
v_perm_b32 v82, v36, v32, s36
v_perm_b32 v83, v44, v40, s36
v_perm_b32 v84, v20, v16, s37
v_perm_b32 v85, v28, v24, s37
v_perm_b32 v86, v36, v32, s37
v_perm_b32 v87, v44, v40, s37
v_perm_b32 v88, v21, v17, s36
v_perm_b32 v89, v29, v25, s36
v_perm_b32 v90, v37, v33, s36
v_perm_b32 v91, v45, v41, s36
v_perm_b32 v92, v21, v17, s37
v_perm_b32 v93, v29, v25, s37
v_perm_b32 v94, v37, v33, s37
v_perm_b32 v95, v45, v41, s37
v_perm_b32 v96, v22, v18, s36
v_perm_b32 v97, v30, v26, s36
v_perm_b32 v98, v38, v34, s36
v_perm_b32 v99, v46, v42, s36
v_perm_b32 v100, v22, v18, s37
v_perm_b32 v101, v30, v26, s37
v_perm_b32 v102, v38, v34, s37
v_perm_b32 v103, v46, v42, s37
v_perm_b32 v104, v23, v19, s36
v_perm_b32 v105, v31, v27, s36
v_perm_b32 v106, v39, v35, s36
v_perm_b32 v107, v47, v43, s36
v_perm_b32 v108, v23, v19, s37
v_perm_b32 v109, v31, v27, s37
v_perm_b32 v110, v39, v35, s37
v_perm_b32 v111, v47, v43, s37
s_mov_b32 s19, 12582912
buffer_store_dwordx4 v[80:83], v0, s[8:11], s19 offen sc1
buffer_store_dwordx4 v[84:87], v0, s[8:11], s19 offen offset:1024 sc1
buffer_store_dwordx4 v[88:91], v0, s[8:11], s19 offen offset:2048 sc1
buffer_store_dwordx4 v[92:95], v0, s[8:11], s19 offen offset:3072 sc1
s_add_u32 s19, s19, 4096
buffer_store_dwordx4 v[96:99], v0, s[8:11], s19 offen sc1
buffer_store_dwordx4 v[100:103], v0, s[8:11], s19 offen offset:1024 sc1
buffer_store_dwordx4 v[104:107], v0, s[8:11], s19 offen offset:2048 sc1
buffer_store_dwordx4 v[108:111], v0, s[8:11], s19 offen offset:3072 sc1
s_add_u32 s19, s19, 4096
buffer_store_dwordx4 v[112:115], v0, s[8:11], s19 offen sc1
s_waitcnt vmcnt(0)
Lc_nomemsc1:
s_load_dwordx2 s[4:5], s[0:1], 32
s_waitcnt lgkmcnt(0)
s_mov_b32 s12, s4
s_and_b32 s13, s5, 0xffff
s_mov_b32 s14, 4718592
s_mov_b32 s15, 0x20000
v_lshlrev_b32 v12, 13, v11
v_lshl_add_u32 v12, v10, 4, v12
s_mul_i32 s19, s16, 1179648
s_lshl_b32 s20, s17, 8
s_add_u32 s19, s19, s20
s_mul_i32 s20, s16, 36864
s_mov_b32 m0, s20
s_add_u32 s20, s20, 1024
buffer_load_dwordx4 v12, s[12:15], s19 offen lds
s_add_u32 s19, s19, 32768
s_mov_b32 m0, s20
s_add_u32 s20, s20, 1024
buffer_load_dwordx4 v12, s[12:15], s19 offen lds
s_add_u32 s19, s19, 32768
s_mov_b32 m0, s20
s_add_u32 s20, s20, 1024
buffer_load_dwordx4 v12, s[12:15], s19 offen lds
s_add_u32 s19, s19, 32768
s_mov_b32 m0, s20
s_add_u32 s20, s20, 1024
buffer_load_dwordx4 v12, s[12:15], s19 offen lds
s_add_u32 s19, s19, 32768
s_mov_b32 m0, s20
s_add_u32 s20, s20, 1024
buffer_load_dwordx4 v12, s[12:15], s19 offen lds
s_add_u32 s19, s19, 32768
s_mov_b32 m0, s20
s_add_u32 s20, s20, 1024
buffer_load_dwordx4 v12, s[12:15], s19 offen lds
s_add_u32 s19, s19, 32768
s_mov_b32 m0, s20
s_add_u32 s20, s20, 1024
buffer_load_dwordx4 v12, s[12:15], s19 offen lds
s_add_u32 s19, s19, 32768
s_mov_b32 m0, s20
s_add_u32 s20, s20, 1024
buffer_load_dwordx4 v12, s[12:15], s19 offen lds
s_add_u32 s19, s19, 32768
s_mov_b32 m0, s20
s_add_u32 s20, s20, 1024
buffer_load_dwordx4 v12, s[12:15], s19 offen lds
s_add_u32 s19, s19, 32768
s_mov_b32 m0, s20
s_add_u32 s20, s20, 1024
buffer_load_dwordx4 v12, s[12:15], s19 offen lds
s_add_u32 s19, s19, 32768
s_mov_b32 m0, s20
s_add_u32 s20, s20, 1024
buffer_load_dwordx4 v12, s[12:15], s19 offen lds
s_add_u32 s19, s19, 32768
s_mov_b32 m0, s20
s_add_u32 s20, s20, 1024
buffer_load_dwordx4 v12, s[12:15], s19 offen lds
s_add_u32 s19, s19, 32768
s_mov_b32 m0, s20
s_add_u32 s20, s20, 1024
buffer_load_dwordx4 v12, s[12:15], s19 offen lds
s_add_u32 s19, s19, 32768
s_mov_b32 m0, s20
s_add_u32 s20, s20, 1024
buffer_load_dwordx4 v12, s[12:15], s19 offen lds
s_add_u32 s19, s19, 32768
s_mov_b32 m0, s20
s_add_u32 s20, s20, 1024
buffer_load_dwordx4 v12, s[12:15], s19 offen lds
s_add_u32 s19, s19, 32768
s_mov_b32 m0, s20
s_add_u32 s20, s20, 1024
buffer_load_dwordx4 v12, s[12:15], s19 offen lds
s_add_u32 s19, s19, 32768
s_mov_b32 m0, s20
s_add_u32 s20, s20, 1024
buffer_load_dwordx4 v12, s[12:15], s19 offen lds
s_add_u32 s19, s19, 32768
s_mov_b32 m0, s20
s_add_u32 s20, s20, 1024
buffer_load_dwordx4 v12, s[12:15], s19 offen lds
s_add_u32 s19, s19, 32768
s_mov_b32 m0, s20
s_add_u32 s20, s20, 1024
buffer_load_dwordx4 v12, s[12:15], s19 offen lds
s_add_u32 s19, s19, 32768
s_mov_b32 m0, s20
s_add_u32 s20, s20, 1024
buffer_load_dwordx4 v12, s[12:15], s19 offen lds
s_add_u32 s19, s19, 32768
s_mov_b32 m0, s20
s_add_u32 s20, s20, 1024
buffer_load_dwordx4 v12, s[12:15], s19 offen lds
s_add_u32 s19, s19, 32768
s_mov_b32 m0, s20
s_add_u32 s20, s20, 1024
buffer_load_dwordx4 v12, s[12:15], s19 offen lds
s_add_u32 s19, s19, 32768
s_mov_b32 m0, s20
s_add_u32 s20, s20, 1024
buffer_load_dwordx4 v12, s[12:15], s19 offen lds
s_add_u32 s19, s19, 32768
s_mov_b32 m0, s20
s_add_u32 s20, s20, 1024
buffer_load_dwordx4 v12, s[12:15], s19 offen lds
s_add_u32 s19, s19, 32768
s_mov_b32 m0, s20
s_add_u32 s20, s20, 1024
buffer_load_dwordx4 v12, s[12:15], s19 offen lds
s_add_u32 s19, s19, 32768
s_mov_b32 m0, s20
s_add_u32 s20, s20, 1024
buffer_load_dwordx4 v12, s[12:15], s19 offen lds
s_add_u32 s19, s19, 32768
s_mov_b32 m0, s20
s_add_u32 s20, s20, 1024
buffer_load_dwordx4 v12, s[12:15], s19 offen lds
s_add_u32 s19, s19, 32768
s_mov_b32 m0, s20
s_add_u32 s20, s20, 1024
buffer_load_dwordx4 v12, s[12:15], s19 offen lds
s_add_u32 s19, s19, 32768
s_mov_b32 m0, s20
s_add_u32 s20, s20, 1024
buffer_load_dwordx4 v12, s[12:15], s19 offen lds
s_add_u32 s19, s19, 32768
s_mov_b32 m0, s20
s_add_u32 s20, s20, 1024
buffer_load_dwordx4 v12, s[12:15], s19 offen lds
s_add_u32 s19, s19, 32768
s_mov_b32 m0, s20
s_add_u32 s20, s20, 1024
buffer_load_dwordx4 v12, s[12:15], s19 offen lds
s_add_u32 s19, s19, 32768
s_mov_b32 m0, s20
s_add_u32 s20, s20, 1024
buffer_load_dwordx4 v12, s[12:15], s19 offen lds
s_add_u32 s19, s19, 32768
s_mov_b32 m0, s20
s_add_u32 s20, s20, 1024
buffer_load_dwordx4 v12, s[12:15], s19 offen lds
s_add_u32 s19, s19, 32768
s_mov_b32 m0, s20
s_add_u32 s20, s20, 1024
buffer_load_dwordx4 v12, s[12:15], s19 offen lds
s_add_u32 s19, s19, 32768
s_mov_b32 m0, s20
s_add_u32 s20, s20, 1024
buffer_load_dwordx4 v12, s[12:15], s19 offen lds
s_add_u32 s19, s19, 32768
s_mov_b32 m0, s20
s_add_u32 s20, s20, 1024
buffer_load_dwordx4 v12, s[12:15], s19 offen lds
s_add_u32 s19, s19, 32768
s_load_dwordx2 s[4:5], s[0:1], 16
s_load_dwordx2 s[52:53], s[0:1], 24
s_waitcnt lgkmcnt(0)
s_cmp_ge_u32 s16, 2
s_cselect_b32 s12, s4, s52
s_cselect_b32 s13, s5, s53
s_and_b32 s13, s13, 0xffff
s_and_b32 s19, s16, 1
s_lshl_b32 s19, s19, 7
s_lshl_b32 s20, s17, 8
s_add_u32 s54, s19, s20
v_lshrrev_b32 v4, 1, v11
v_and_b32 v5, 1, v11
v_lshlrev_b32 v6, 7, v4
v_lshl_add_u32 v6, v5, 5, v6
v_lshlrev_b32 v7, 4, v4
v_lshl_add_u32 v7, v5, 2, v7
v_lshlrev_b32 v1, 13, v6
v_lshl_add_u32 v1, v10, 3, v1
v_lshlrev_b32 v2, 13, v7
v_lshl_add_u32 v2, v10, 3, v2
v_lshrrev_b32 v3, 2, v10
v_and_b32 v8, 3, v10
v_lshrrev_b32 v79, 1, v3
v_and_b32 v3, 1, v3
v_lshl_add_u32 v6, v79, 6, v6
v_lshl_add_u32 v6, v3, 3, v6
v_lshl_add_u32 v7, v79, 3, v7
v_add_u32 v7, v7, v3
s_lshl_b32 s19, s16, 6
v_lshlrev_b32 v8, 3, v8
v_add_u32 v8, s19, v8
v_lshl_add_u32 v6, v6, 8, v8
v_lshl_add_u32 v7, v7, 8, v8
v_add_u32 v7, 131072, v7
v_add_u32 v3, 65536, v6
s_add_u32 s19, s54, 0
buffer_load_dwordx2 v[12:13], v1, s[12:15], s19 offen
s_add_u32 s19, s54, 65536
buffer_load_dwordx2 v[14:15], v1, s[12:15], s19 offen
s_add_u32 s19, s54, 524288
buffer_load_dwordx2 v[16:17], v1, s[12:15], s19 offen
s_add_u32 s19, s54, 589824
buffer_load_dwordx2 v[18:19], v1, s[12:15], s19 offen
s_add_u32 s19, s54, 131072
buffer_load_dwordx2 v[20:21], v1, s[12:15], s19 offen
s_add_u32 s19, s54, 196608
buffer_load_dwordx2 v[22:23], v1, s[12:15], s19 offen
s_add_u32 s19, s54, 655360
buffer_load_dwordx2 v[24:25], v1, s[12:15], s19 offen
s_add_u32 s19, s54, 720896
buffer_load_dwordx2 v[26:27], v1, s[12:15], s19 offen
s_add_u32 s19, s54, 2097152
buffer_load_dwordx2 v[28:29], v1, s[12:15], s19 offen
s_add_u32 s19, s54, 2162688
buffer_load_dwordx2 v[30:31], v1, s[12:15], s19 offen
s_add_u32 s19, s54, 2621440
buffer_load_dwordx2 v[32:33], v1, s[12:15], s19 offen
s_add_u32 s19, s54, 2686976
buffer_load_dwordx2 v[34:35], v1, s[12:15], s19 offen
s_add_u32 s19, s54, 2228224
buffer_load_dwordx2 v[36:37], v1, s[12:15], s19 offen
s_add_u32 s19, s54, 2293760
buffer_load_dwordx2 v[38:39], v1, s[12:15], s19 offen
s_add_u32 s19, s54, 2752512
buffer_load_dwordx2 v[40:41], v1, s[12:15], s19 offen
s_add_u32 s19, s54, 2818048
buffer_load_dwordx2 v[42:43], v1, s[12:15], s19 offen
s_waitcnt vmcnt(47)
s_add_u32 s19, s54, 8192
buffer_load_dwordx2 v[44:45], v1, s[12:15], s19 offen
s_add_u32 s19, s54, 73728
buffer_load_dwordx2 v[46:47], v1, s[12:15], s19 offen
s_add_u32 s19, s54, 532480
buffer_load_dwordx2 v[48:49], v1, s[12:15], s19 offen
s_add_u32 s19, s54, 598016
buffer_load_dwordx2 v[50:51], v1, s[12:15], s19 offen
s_add_u32 s19, s54, 139264
buffer_load_dwordx2 v[52:53], v1, s[12:15], s19 offen
s_add_u32 s19, s54, 204800
buffer_load_dwordx2 v[54:55], v1, s[12:15], s19 offen
s_add_u32 s19, s54, 663552
buffer_load_dwordx2 v[56:57], v1, s[12:15], s19 offen
s_add_u32 s19, s54, 729088
buffer_load_dwordx2 v[58:59], v1, s[12:15], s19 offen
s_add_u32 s19, s54, 2105344
buffer_load_dwordx2 v[60:61], v1, s[12:15], s19 offen
s_add_u32 s19, s54, 2170880
buffer_load_dwordx2 v[62:63], v1, s[12:15], s19 offen
s_add_u32 s19, s54, 2629632
buffer_load_dwordx2 v[64:65], v1, s[12:15], s19 offen
s_add_u32 s19, s54, 2695168
buffer_load_dwordx2 v[66:67], v1, s[12:15], s19 offen
s_add_u32 s19, s54, 2236416
buffer_load_dwordx2 v[68:69], v1, s[12:15], s19 offen
s_add_u32 s19, s54, 2301952
buffer_load_dwordx2 v[70:71], v1, s[12:15], s19 offen
s_add_u32 s19, s54, 2760704
buffer_load_dwordx2 v[72:73], v1, s[12:15], s19 offen
s_add_u32 s19, s54, 2826240
buffer_load_dwordx2 v[74:75], v1, s[12:15], s19 offen
s_waitcnt vmcnt(47)
s_add_u32 s19, s54, 16384
buffer_load_dwordx2 v[224:225], v1, s[12:15], s19 offen
s_add_u32 s19, s54, 81920
buffer_load_dwordx2 v[226:227], v1, s[12:15], s19 offen
s_add_u32 s19, s54, 540672
buffer_load_dwordx2 v[228:229], v1, s[12:15], s19 offen
s_add_u32 s19, s54, 606208
buffer_load_dwordx2 v[230:231], v1, s[12:15], s19 offen
s_add_u32 s19, s54, 147456
buffer_load_dwordx2 v[232:233], v1, s[12:15], s19 offen
s_add_u32 s19, s54, 212992
buffer_load_dwordx2 v[234:235], v1, s[12:15], s19 offen
s_add_u32 s19, s54, 671744
buffer_load_dwordx2 v[236:237], v1, s[12:15], s19 offen
s_add_u32 s19, s54, 737280
buffer_load_dwordx2 v[238:239], v1, s[12:15], s19 offen
s_add_u32 s19, s54, 2113536
buffer_load_dwordx2 v[240:241], v1, s[12:15], s19 offen
s_add_u32 s19, s54, 2179072
buffer_load_dwordx2 v[242:243], v1, s[12:15], s19 offen
s_add_u32 s19, s54, 2637824
buffer_load_dwordx2 v[244:245], v1, s[12:15], s19 offen
s_add_u32 s19, s54, 2703360
buffer_load_dwordx2 v[246:247], v1, s[12:15], s19 offen
s_add_u32 s19, s54, 2244608
buffer_load_dwordx2 v[248:249], v1, s[12:15], s19 offen
s_add_u32 s19, s54, 2310144
buffer_load_dwordx2 v[250:251], v1, s[12:15], s19 offen
s_add_u32 s19, s54, 2768896
buffer_load_dwordx2 v[252:253], v1, s[12:15], s19 offen
s_add_u32 s19, s54, 2834432
buffer_load_dwordx2 v[254:255], v1, s[12:15], s19 offen
s_waitcnt vmcnt(48)
s_barrier
s_cmp_eq_u32 s16, 0
s_cbranch_scc0 Lc_noarrsc1
s_mov_b64 exec, 1
v_mov_b32 v8, 64
v_mov_b32 v9, 1
global_atomic_add v8, v9, s[6:7]
s_mov_b64 exec, -1
Lc_noarrsc1:
ds_read_b64_tr_b16 v[80:81], v6
ds_read_b64_tr_b16 v[82:83], v6 offset:4096
ds_read_b64_tr_b16 v[84:85], v3
ds_read_b64_tr_b16 v[86:87], v3 offset:4096
ds_read_b64_tr_b16 v[88:89], v6 offset:32
ds_read_b64_tr_b16 v[90:91], v6 offset:4128
ds_read_b64_tr_b16 v[92:93], v3 offset:32
ds_read_b64_tr_b16 v[94:95], v3 offset:4128
ds_read_b64_tr_b16 v[96:97], v6 offset:256
ds_read_b64_tr_b16 v[98:99], v6 offset:4352
ds_read_b64_tr_b16 v[100:101], v3 offset:256
ds_read_b64_tr_b16 v[102:103], v3 offset:4352
ds_read_b64_tr_b16 v[104:105], v6 offset:288
ds_read_b64_tr_b16 v[106:107], v6 offset:4384
ds_read_b64_tr_b16 v[108:109], v3 offset:288
ds_read_b64_tr_b16 v[110:111], v3 offset:4384
ds_read_b64_tr_b16 v[112:113], v6 offset:512
ds_read_b64_tr_b16 v[114:115], v6 offset:4608
ds_read_b64_tr_b16 v[116:117], v3 offset:512
ds_read_b64_tr_b16 v[118:119], v3 offset:4608
ds_read_b64_tr_b16 v[120:121], v6 offset:544
ds_read_b64_tr_b16 v[122:123], v6 offset:4640
ds_read_b64_tr_b16 v[124:125], v3 offset:544
ds_read_b64_tr_b16 v[126:127], v3 offset:4640
ds_read_b64_tr_b16 v[128:129], v6 offset:768
ds_read_b64_tr_b16 v[130:131], v6 offset:4864
ds_read_b64_tr_b16 v[132:133], v3 offset:768
ds_read_b64_tr_b16 v[134:135], v3 offset:4864
ds_read_b64_tr_b16 v[136:137], v6 offset:800
ds_read_b64_tr_b16 v[138:139], v6 offset:4896
ds_read_b64_tr_b16 v[140:141], v3 offset:800
ds_read_b64_tr_b16 v[142:143], v3 offset:4896
ds_read_b64_tr_b16 v[144:145], v6 offset:1024
ds_read_b64_tr_b16 v[146:147], v6 offset:5120
ds_read_b64_tr_b16 v[148:149], v3 offset:1024
ds_read_b64_tr_b16 v[150:151], v3 offset:5120
ds_read_b64_tr_b16 v[152:153], v6 offset:1056
ds_read_b64_tr_b16 v[154:155], v6 offset:5152
ds_read_b64_tr_b16 v[156:157], v3 offset:1056
ds_read_b64_tr_b16 v[158:159], v3 offset:5152
ds_read_b64_tr_b16 v[160:161], v6 offset:1280
ds_read_b64_tr_b16 v[162:163], v6 offset:5376
ds_read_b64_tr_b16 v[164:165], v3 offset:1280
ds_read_b64_tr_b16 v[166:167], v3 offset:5376
ds_read_b64_tr_b16 v[168:169], v6 offset:1312
ds_read_b64_tr_b16 v[170:171], v6 offset:5408
ds_read_b64_tr_b16 v[172:173], v3 offset:1312
ds_read_b64_tr_b16 v[174:175], v3 offset:5408
ds_read_b64_tr_b16 v[176:177], v6 offset:1536
ds_read_b64_tr_b16 v[178:179], v6 offset:5632
ds_read_b64_tr_b16 v[180:181], v3 offset:1536
ds_read_b64_tr_b16 v[182:183], v3 offset:5632
ds_read_b64_tr_b16 v[184:185], v6 offset:1568
ds_read_b64_tr_b16 v[186:187], v6 offset:5664
ds_read_b64_tr_b16 v[188:189], v3 offset:1568
ds_read_b64_tr_b16 v[190:191], v3 offset:5664
ds_read_b64_tr_b16 v[192:193], v6 offset:1792
ds_read_b64_tr_b16 v[194:195], v6 offset:5888
ds_read_b64_tr_b16 v[196:197], v3 offset:1792
ds_read_b64_tr_b16 v[198:199], v3 offset:5888
ds_read_b64_tr_b16 v[200:201], v6 offset:1824
ds_read_b64_tr_b16 v[202:203], v6 offset:5920
ds_read_b64_tr_b16 v[204:205], v3 offset:1824
ds_read_b64_tr_b16 v[206:207], v3 offset:5920
ds_read_b64_tr_b16 v[208:209], v7
ds_read_b64_tr_b16 v[210:211], v7 offset:512
ds_read_b64_tr_b16 v[212:213], v7 offset:8192
ds_read_b64_tr_b16 v[214:215], v7 offset:8704
ds_read_b64_tr_b16 v[216:217], v7 offset:32
ds_read_b64_tr_b16 v[218:219], v7 offset:544
ds_read_b64_tr_b16 v[220:221], v7 offset:8224
ds_read_b64_tr_b16 v[222:223], v7 offset:8736
s_waitcnt lgkmcnt(0)
s_barrier
s_load_dwordx2 s[4:5], s[0:1], 40
s_waitcnt lgkmcnt(0)
s_mov_b32 s56, s4
s_and_b32 s57, s5, 0xffff
s_mov_b32 s58, 4718592
s_mov_b32 s59, 0x20000
s_waitcnt vmcnt(32)
v_perm_b32 v8, v14, v12, s36
v_accvgpr_write_b32 a0, v8
v_perm_b32 v9, v14, v12, s37
v_accvgpr_write_b32 a8, v9
v_perm_b32 v10, v15, v13, s36
v_accvgpr_write_b32 a16, v10
v_perm_b32 v11, v15, v13, s37
v_accvgpr_write_b32 a24, v11
v_perm_b32 v8, v18, v16, s36
v_accvgpr_write_b32 a1, v8
v_perm_b32 v9, v18, v16, s37
v_accvgpr_write_b32 a9, v9
v_perm_b32 v10, v19, v17, s36
v_accvgpr_write_b32 a17, v10
v_perm_b32 v11, v19, v17, s37
v_accvgpr_write_b32 a25, v11
v_perm_b32 v8, v22, v20, s36
v_accvgpr_write_b32 a2, v8
v_perm_b32 v9, v22, v20, s37
v_accvgpr_write_b32 a10, v9
v_perm_b32 v10, v23, v21, s36
v_accvgpr_write_b32 a18, v10
v_perm_b32 v11, v23, v21, s37
v_accvgpr_write_b32 a26, v11
v_perm_b32 v8, v26, v24, s36
v_accvgpr_write_b32 a3, v8
v_perm_b32 v9, v26, v24, s37
v_accvgpr_write_b32 a11, v9
v_perm_b32 v10, v27, v25, s36
v_accvgpr_write_b32 a19, v10
v_perm_b32 v11, v27, v25, s37
v_accvgpr_write_b32 a27, v11
v_perm_b32 v8, v30, v28, s36
v_accvgpr_write_b32 a4, v8
v_perm_b32 v9, v30, v28, s37
v_accvgpr_write_b32 a12, v9
v_perm_b32 v10, v31, v29, s36
v_accvgpr_write_b32 a20, v10
v_perm_b32 v11, v31, v29, s37
v_accvgpr_write_b32 a28, v11
v_perm_b32 v8, v34, v32, s36
v_accvgpr_write_b32 a5, v8
v_perm_b32 v9, v34, v32, s37
v_accvgpr_write_b32 a13, v9
v_perm_b32 v10, v35, v33, s36
v_accvgpr_write_b32 a21, v10
v_perm_b32 v11, v35, v33, s37
v_accvgpr_write_b32 a29, v11
v_perm_b32 v8, v38, v36, s36
v_accvgpr_write_b32 a6, v8
v_perm_b32 v9, v38, v36, s37
v_accvgpr_write_b32 a14, v9
v_perm_b32 v10, v39, v37, s36
v_accvgpr_write_b32 a22, v10
v_perm_b32 v11, v39, v37, s37
v_accvgpr_write_b32 a30, v11
v_perm_b32 v8, v42, v40, s36
v_accvgpr_write_b32 a7, v8
v_perm_b32 v9, v42, v40, s37
v_accvgpr_write_b32 a15, v9
v_perm_b32 v10, v43, v41, s36
v_accvgpr_write_b32 a23, v10
v_perm_b32 v11, v43, v41, s37
v_accvgpr_write_b32 a31, v11
s_add_u32 s19, s54, 24576
buffer_load_dwordx2 v[12:13], v1, s[12:15], s19 offen
s_add_u32 s19, s54, 90112
buffer_load_dwordx2 v[14:15], v1, s[12:15], s19 offen
s_add_u32 s19, s54, 548864
buffer_load_dwordx2 v[16:17], v1, s[12:15], s19 offen
s_add_u32 s19, s54, 614400
buffer_load_dwordx2 v[18:19], v1, s[12:15], s19 offen
s_add_u32 s19, s54, 155648
buffer_load_dwordx2 v[20:21], v1, s[12:15], s19 offen
s_add_u32 s19, s54, 221184
buffer_load_dwordx2 v[22:23], v1, s[12:15], s19 offen
s_add_u32 s19, s54, 679936
buffer_load_dwordx2 v[24:25], v1, s[12:15], s19 offen
s_add_u32 s19, s54, 745472
buffer_load_dwordx2 v[26:27], v1, s[12:15], s19 offen
s_add_u32 s19, s54, 2121728
buffer_load_dwordx2 v[28:29], v1, s[12:15], s19 offen
s_add_u32 s19, s54, 2187264
buffer_load_dwordx2 v[30:31], v1, s[12:15], s19 offen
s_add_u32 s19, s54, 2646016
buffer_load_dwordx2 v[32:33], v1, s[12:15], s19 offen
s_add_u32 s19, s54, 2711552
buffer_load_dwordx2 v[34:35], v1, s[12:15], s19 offen
s_add_u32 s19, s54, 2252800
buffer_load_dwordx2 v[36:37], v1, s[12:15], s19 offen
s_add_u32 s19, s54, 2318336
buffer_load_dwordx2 v[38:39], v1, s[12:15], s19 offen
s_add_u32 s19, s54, 2777088
buffer_load_dwordx2 v[40:41], v1, s[12:15], s19 offen
s_add_u32 s19, s54, 2842624
buffer_load_dwordx2 v[42:43], v1, s[12:15], s19 offen
s_waitcnt vmcnt(32)
v_perm_b32 v8, v46, v44, s36
v_accvgpr_write_b32 a32, v8
v_perm_b32 v9, v46, v44, s37
v_accvgpr_write_b32 a40, v9
v_perm_b32 v10, v47, v45, s36
v_accvgpr_write_b32 a48, v10
v_perm_b32 v11, v47, v45, s37
v_accvgpr_write_b32 a56, v11
v_perm_b32 v8, v50, v48, s36
v_accvgpr_write_b32 a33, v8
v_perm_b32 v9, v50, v48, s37
v_accvgpr_write_b32 a41, v9
v_perm_b32 v10, v51, v49, s36
v_accvgpr_write_b32 a49, v10
v_perm_b32 v11, v51, v49, s37
v_accvgpr_write_b32 a57, v11
v_perm_b32 v8, v54, v52, s36
v_accvgpr_write_b32 a34, v8
v_perm_b32 v9, v54, v52, s37
v_accvgpr_write_b32 a42, v9
v_perm_b32 v10, v55, v53, s36
v_accvgpr_write_b32 a50, v10
v_perm_b32 v11, v55, v53, s37
v_accvgpr_write_b32 a58, v11
v_perm_b32 v8, v58, v56, s36
v_accvgpr_write_b32 a35, v8
v_perm_b32 v9, v58, v56, s37
v_accvgpr_write_b32 a43, v9
v_perm_b32 v10, v59, v57, s36
v_accvgpr_write_b32 a51, v10
v_perm_b32 v11, v59, v57, s37
v_accvgpr_write_b32 a59, v11
v_perm_b32 v8, v62, v60, s36
v_accvgpr_write_b32 a36, v8
v_perm_b32 v9, v62, v60, s37
v_accvgpr_write_b32 a44, v9
v_perm_b32 v10, v63, v61, s36
v_accvgpr_write_b32 a52, v10
v_perm_b32 v11, v63, v61, s37
v_accvgpr_write_b32 a60, v11
v_perm_b32 v8, v66, v64, s36
v_accvgpr_write_b32 a37, v8
v_perm_b32 v9, v66, v64, s37
v_accvgpr_write_b32 a45, v9
v_perm_b32 v10, v67, v65, s36
v_accvgpr_write_b32 a53, v10
v_perm_b32 v11, v67, v65, s37
v_accvgpr_write_b32 a61, v11
v_perm_b32 v8, v70, v68, s36
v_accvgpr_write_b32 a38, v8
v_perm_b32 v9, v70, v68, s37
v_accvgpr_write_b32 a46, v9
v_perm_b32 v10, v71, v69, s36
v_accvgpr_write_b32 a54, v10
v_perm_b32 v11, v71, v69, s37
v_accvgpr_write_b32 a62, v11
v_perm_b32 v8, v74, v72, s36
v_accvgpr_write_b32 a39, v8
v_perm_b32 v9, v74, v72, s37
v_accvgpr_write_b32 a47, v9
v_perm_b32 v10, v75, v73, s36
v_accvgpr_write_b32 a55, v10
v_perm_b32 v11, v75, v73, s37
v_accvgpr_write_b32 a63, v11
s_add_u32 s19, s54, 32768
buffer_load_dwordx2 v[44:45], v1, s[12:15], s19 offen
s_add_u32 s19, s54, 98304
buffer_load_dwordx2 v[46:47], v1, s[12:15], s19 offen
s_add_u32 s19, s54, 557056
buffer_load_dwordx2 v[48:49], v1, s[12:15], s19 offen
s_add_u32 s19, s54, 622592
buffer_load_dwordx2 v[50:51], v1, s[12:15], s19 offen
s_add_u32 s19, s54, 163840
buffer_load_dwordx2 v[52:53], v1, s[12:15], s19 offen
s_add_u32 s19, s54, 229376
buffer_load_dwordx2 v[54:55], v1, s[12:15], s19 offen
s_add_u32 s19, s54, 688128
buffer_load_dwordx2 v[56:57], v1, s[12:15], s19 offen
s_add_u32 s19, s54, 753664
buffer_load_dwordx2 v[58:59], v1, s[12:15], s19 offen
s_add_u32 s19, s54, 2129920
buffer_load_dwordx2 v[60:61], v1, s[12:15], s19 offen
s_add_u32 s19, s54, 2195456
buffer_load_dwordx2 v[62:63], v1, s[12:15], s19 offen
s_add_u32 s19, s54, 2654208
buffer_load_dwordx2 v[64:65], v1, s[12:15], s19 offen
s_add_u32 s19, s54, 2719744
buffer_load_dwordx2 v[66:67], v1, s[12:15], s19 offen
s_add_u32 s19, s54, 2260992
buffer_load_dwordx2 v[68:69], v1, s[12:15], s19 offen
s_add_u32 s19, s54, 2326528
buffer_load_dwordx2 v[70:71], v1, s[12:15], s19 offen
s_add_u32 s19, s54, 2785280
buffer_load_dwordx2 v[72:73], v1, s[12:15], s19 offen
s_add_u32 s19, s54, 2850816
buffer_load_dwordx2 v[74:75], v1, s[12:15], s19 offen
s_waitcnt vmcnt(32)
v_perm_b32 v8, v226, v224, s36
v_accvgpr_write_b32 a64, v8
v_perm_b32 v9, v226, v224, s37
v_accvgpr_write_b32 a72, v9
v_perm_b32 v10, v227, v225, s36
v_accvgpr_write_b32 a80, v10
v_perm_b32 v11, v227, v225, s37
v_accvgpr_write_b32 a88, v11
v_perm_b32 v8, v230, v228, s36
v_accvgpr_write_b32 a65, v8
v_perm_b32 v9, v230, v228, s37
v_accvgpr_write_b32 a73, v9
v_perm_b32 v10, v231, v229, s36
v_accvgpr_write_b32 a81, v10
v_perm_b32 v11, v231, v229, s37
v_accvgpr_write_b32 a89, v11
v_perm_b32 v8, v234, v232, s36
v_accvgpr_write_b32 a66, v8
v_perm_b32 v9, v234, v232, s37
v_accvgpr_write_b32 a74, v9
v_perm_b32 v10, v235, v233, s36
v_accvgpr_write_b32 a82, v10
v_perm_b32 v11, v235, v233, s37
v_accvgpr_write_b32 a90, v11
v_perm_b32 v8, v238, v236, s36
v_accvgpr_write_b32 a67, v8
v_perm_b32 v9, v238, v236, s37
v_accvgpr_write_b32 a75, v9
v_perm_b32 v10, v239, v237, s36
v_accvgpr_write_b32 a83, v10
v_perm_b32 v11, v239, v237, s37
v_accvgpr_write_b32 a91, v11
v_perm_b32 v8, v242, v240, s36
v_accvgpr_write_b32 a68, v8
v_perm_b32 v9, v242, v240, s37
v_accvgpr_write_b32 a76, v9
v_perm_b32 v10, v243, v241, s36
v_accvgpr_write_b32 a84, v10
v_perm_b32 v11, v243, v241, s37
v_accvgpr_write_b32 a92, v11
v_perm_b32 v8, v246, v244, s36
v_accvgpr_write_b32 a69, v8
v_perm_b32 v9, v246, v244, s37
v_accvgpr_write_b32 a77, v9
v_perm_b32 v10, v247, v245, s36
v_accvgpr_write_b32 a85, v10
v_perm_b32 v11, v247, v245, s37
v_accvgpr_write_b32 a93, v11
v_perm_b32 v8, v250, v248, s36
v_accvgpr_write_b32 a70, v8
v_perm_b32 v9, v250, v248, s37
v_accvgpr_write_b32 a78, v9
v_perm_b32 v10, v251, v249, s36
v_accvgpr_write_b32 a86, v10
v_perm_b32 v11, v251, v249, s37
v_accvgpr_write_b32 a94, v11
v_perm_b32 v8, v254, v252, s36
v_accvgpr_write_b32 a71, v8
v_perm_b32 v9, v254, v252, s37
v_accvgpr_write_b32 a79, v9
v_perm_b32 v10, v255, v253, s36
v_accvgpr_write_b32 a87, v10
v_perm_b32 v11, v255, v253, s37
v_accvgpr_write_b32 a95, v11
s_add_u32 s19, s54, 40960
buffer_load_dwordx2 v[224:225], v1, s[12:15], s19 offen
s_add_u32 s19, s54, 106496
buffer_load_dwordx2 v[226:227], v1, s[12:15], s19 offen
s_add_u32 s19, s54, 565248
buffer_load_dwordx2 v[228:229], v1, s[12:15], s19 offen
s_add_u32 s19, s54, 630784
buffer_load_dwordx2 v[230:231], v1, s[12:15], s19 offen
s_add_u32 s19, s54, 172032
buffer_load_dwordx2 v[232:233], v1, s[12:15], s19 offen
s_add_u32 s19, s54, 237568
buffer_load_dwordx2 v[234:235], v1, s[12:15], s19 offen
s_add_u32 s19, s54, 696320
buffer_load_dwordx2 v[236:237], v1, s[12:15], s19 offen
s_add_u32 s19, s54, 761856
buffer_load_dwordx2 v[238:239], v1, s[12:15], s19 offen
s_add_u32 s19, s54, 2138112
buffer_load_dwordx2 v[240:241], v1, s[12:15], s19 offen
s_add_u32 s19, s54, 2203648
buffer_load_dwordx2 v[242:243], v1, s[12:15], s19 offen
s_add_u32 s19, s54, 2662400
buffer_load_dwordx2 v[244:245], v1, s[12:15], s19 offen
s_add_u32 s19, s54, 2727936
buffer_load_dwordx2 v[246:247], v1, s[12:15], s19 offen
s_add_u32 s19, s54, 2269184
buffer_load_dwordx2 v[248:249], v1, s[12:15], s19 offen
s_add_u32 s19, s54, 2334720
buffer_load_dwordx2 v[250:251], v1, s[12:15], s19 offen
s_add_u32 s19, s54, 2793472
buffer_load_dwordx2 v[252:253], v1, s[12:15], s19 offen
s_add_u32 s19, s54, 2859008
buffer_load_dwordx2 v[254:255], v1, s[12:15], s19 offen
s_waitcnt vmcnt(32)
v_perm_b32 v8, v14, v12, s36
v_accvgpr_write_b32 a96, v8
v_perm_b32 v9, v14, v12, s37
v_accvgpr_write_b32 a104, v9
v_perm_b32 v10, v15, v13, s36
v_accvgpr_write_b32 a112, v10
v_perm_b32 v11, v15, v13, s37
v_accvgpr_write_b32 a120, v11
v_perm_b32 v8, v18, v16, s36
v_accvgpr_write_b32 a97, v8
v_perm_b32 v9, v18, v16, s37
v_accvgpr_write_b32 a105, v9
v_perm_b32 v10, v19, v17, s36
v_accvgpr_write_b32 a113, v10
v_perm_b32 v11, v19, v17, s37
v_accvgpr_write_b32 a121, v11
v_perm_b32 v8, v22, v20, s36
v_accvgpr_write_b32 a98, v8
v_perm_b32 v9, v22, v20, s37
v_accvgpr_write_b32 a106, v9
v_perm_b32 v10, v23, v21, s36
v_accvgpr_write_b32 a114, v10
v_perm_b32 v11, v23, v21, s37
v_accvgpr_write_b32 a122, v11
v_perm_b32 v8, v26, v24, s36
v_accvgpr_write_b32 a99, v8
v_perm_b32 v9, v26, v24, s37
v_accvgpr_write_b32 a107, v9
v_perm_b32 v10, v27, v25, s36
v_accvgpr_write_b32 a115, v10
v_perm_b32 v11, v27, v25, s37
v_accvgpr_write_b32 a123, v11
v_perm_b32 v8, v30, v28, s36
v_accvgpr_write_b32 a100, v8
v_perm_b32 v9, v30, v28, s37
v_accvgpr_write_b32 a108, v9
v_perm_b32 v10, v31, v29, s36
v_accvgpr_write_b32 a116, v10
v_perm_b32 v11, v31, v29, s37
v_accvgpr_write_b32 a124, v11
v_perm_b32 v8, v34, v32, s36
v_accvgpr_write_b32 a101, v8
v_perm_b32 v9, v34, v32, s37
v_accvgpr_write_b32 a109, v9
v_perm_b32 v10, v35, v33, s36
v_accvgpr_write_b32 a117, v10
v_perm_b32 v11, v35, v33, s37
v_accvgpr_write_b32 a125, v11
v_perm_b32 v8, v38, v36, s36
v_accvgpr_write_b32 a102, v8
v_perm_b32 v9, v38, v36, s37
v_accvgpr_write_b32 a110, v9
v_perm_b32 v10, v39, v37, s36
v_accvgpr_write_b32 a118, v10
v_perm_b32 v11, v39, v37, s37
v_accvgpr_write_b32 a126, v11
v_perm_b32 v8, v42, v40, s36
v_accvgpr_write_b32 a103, v8
v_perm_b32 v9, v42, v40, s37
v_accvgpr_write_b32 a111, v9
v_perm_b32 v10, v43, v41, s36
v_accvgpr_write_b32 a119, v10
v_perm_b32 v11, v43, v41, s37
v_accvgpr_write_b32 a127, v11
s_add_u32 s19, s54, 49152
buffer_load_dwordx2 v[12:13], v1, s[12:15], s19 offen
s_add_u32 s19, s54, 114688
buffer_load_dwordx2 v[14:15], v1, s[12:15], s19 offen
s_add_u32 s19, s54, 573440
buffer_load_dwordx2 v[16:17], v1, s[12:15], s19 offen
s_add_u32 s19, s54, 638976
buffer_load_dwordx2 v[18:19], v1, s[12:15], s19 offen
s_add_u32 s19, s54, 180224
buffer_load_dwordx2 v[20:21], v1, s[12:15], s19 offen
s_add_u32 s19, s54, 245760
buffer_load_dwordx2 v[22:23], v1, s[12:15], s19 offen
s_add_u32 s19, s54, 704512
buffer_load_dwordx2 v[24:25], v1, s[12:15], s19 offen
s_add_u32 s19, s54, 770048
buffer_load_dwordx2 v[26:27], v1, s[12:15], s19 offen
s_add_u32 s19, s54, 2146304
buffer_load_dwordx2 v[28:29], v1, s[12:15], s19 offen
s_add_u32 s19, s54, 2211840
buffer_load_dwordx2 v[30:31], v1, s[12:15], s19 offen
s_add_u32 s19, s54, 2670592
buffer_load_dwordx2 v[32:33], v1, s[12:15], s19 offen
s_add_u32 s19, s54, 2736128
buffer_load_dwordx2 v[34:35], v1, s[12:15], s19 offen
s_add_u32 s19, s54, 2277376
buffer_load_dwordx2 v[36:37], v1, s[12:15], s19 offen
s_add_u32 s19, s54, 2342912
buffer_load_dwordx2 v[38:39], v1, s[12:15], s19 offen
s_add_u32 s19, s54, 2801664
buffer_load_dwordx2 v[40:41], v1, s[12:15], s19 offen
s_add_u32 s19, s54, 2867200
buffer_load_dwordx2 v[42:43], v1, s[12:15], s19 offen
s_waitcnt vmcnt(32)
v_perm_b32 v8, v46, v44, s36
v_accvgpr_write_b32 a128, v8
v_perm_b32 v9, v46, v44, s37
v_accvgpr_write_b32 a136, v9
v_perm_b32 v10, v47, v45, s36
v_accvgpr_write_b32 a144, v10
v_perm_b32 v11, v47, v45, s37
v_accvgpr_write_b32 a152, v11
v_perm_b32 v8, v50, v48, s36
v_accvgpr_write_b32 a129, v8
v_perm_b32 v9, v50, v48, s37
v_accvgpr_write_b32 a137, v9
v_perm_b32 v10, v51, v49, s36
v_accvgpr_write_b32 a145, v10
v_perm_b32 v11, v51, v49, s37
v_accvgpr_write_b32 a153, v11
v_perm_b32 v8, v54, v52, s36
v_accvgpr_write_b32 a130, v8
v_perm_b32 v9, v54, v52, s37
v_accvgpr_write_b32 a138, v9
v_perm_b32 v10, v55, v53, s36
v_accvgpr_write_b32 a146, v10
v_perm_b32 v11, v55, v53, s37
v_accvgpr_write_b32 a154, v11
v_perm_b32 v8, v58, v56, s36
v_accvgpr_write_b32 a131, v8
v_perm_b32 v9, v58, v56, s37
v_accvgpr_write_b32 a139, v9
v_perm_b32 v10, v59, v57, s36
v_accvgpr_write_b32 a147, v10
v_perm_b32 v11, v59, v57, s37
v_accvgpr_write_b32 a155, v11
v_perm_b32 v8, v62, v60, s36
v_accvgpr_write_b32 a132, v8
v_perm_b32 v9, v62, v60, s37
v_accvgpr_write_b32 a140, v9
v_perm_b32 v10, v63, v61, s36
v_accvgpr_write_b32 a148, v10
v_perm_b32 v11, v63, v61, s37
v_accvgpr_write_b32 a156, v11
v_perm_b32 v8, v66, v64, s36
v_accvgpr_write_b32 a133, v8
v_perm_b32 v9, v66, v64, s37
v_accvgpr_write_b32 a141, v9
v_perm_b32 v10, v67, v65, s36
v_accvgpr_write_b32 a149, v10
v_perm_b32 v11, v67, v65, s37
v_accvgpr_write_b32 a157, v11
v_perm_b32 v8, v70, v68, s36
v_accvgpr_write_b32 a134, v8
v_perm_b32 v9, v70, v68, s37
v_accvgpr_write_b32 a142, v9
v_perm_b32 v10, v71, v69, s36
v_accvgpr_write_b32 a150, v10
v_perm_b32 v11, v71, v69, s37
v_accvgpr_write_b32 a158, v11
v_perm_b32 v8, v74, v72, s36
v_accvgpr_write_b32 a135, v8
v_perm_b32 v9, v74, v72, s37
v_accvgpr_write_b32 a143, v9
v_perm_b32 v10, v75, v73, s36
v_accvgpr_write_b32 a151, v10
v_perm_b32 v11, v75, v73, s37
v_accvgpr_write_b32 a159, v11
s_add_u32 s19, s54, 57344
buffer_load_dwordx2 v[44:45], v1, s[12:15], s19 offen
s_add_u32 s19, s54, 122880
buffer_load_dwordx2 v[46:47], v1, s[12:15], s19 offen
s_add_u32 s19, s54, 581632
buffer_load_dwordx2 v[48:49], v1, s[12:15], s19 offen
s_add_u32 s19, s54, 647168
buffer_load_dwordx2 v[50:51], v1, s[12:15], s19 offen
s_add_u32 s19, s54, 188416
buffer_load_dwordx2 v[52:53], v1, s[12:15], s19 offen
s_add_u32 s19, s54, 253952
buffer_load_dwordx2 v[54:55], v1, s[12:15], s19 offen
s_add_u32 s19, s54, 712704
buffer_load_dwordx2 v[56:57], v1, s[12:15], s19 offen
s_add_u32 s19, s54, 778240
buffer_load_dwordx2 v[58:59], v1, s[12:15], s19 offen
s_add_u32 s19, s54, 2154496
buffer_load_dwordx2 v[60:61], v1, s[12:15], s19 offen
s_add_u32 s19, s54, 2220032
buffer_load_dwordx2 v[62:63], v1, s[12:15], s19 offen
s_add_u32 s19, s54, 2678784
buffer_load_dwordx2 v[64:65], v1, s[12:15], s19 offen
s_add_u32 s19, s54, 2744320
buffer_load_dwordx2 v[66:67], v1, s[12:15], s19 offen
s_add_u32 s19, s54, 2285568
buffer_load_dwordx2 v[68:69], v1, s[12:15], s19 offen
s_add_u32 s19, s54, 2351104
buffer_load_dwordx2 v[70:71], v1, s[12:15], s19 offen
s_add_u32 s19, s54, 2809856
buffer_load_dwordx2 v[72:73], v1, s[12:15], s19 offen
s_add_u32 s19, s54, 2875392
buffer_load_dwordx2 v[74:75], v1, s[12:15], s19 offen
s_waitcnt vmcnt(32)
v_perm_b32 v8, v226, v224, s36
v_accvgpr_write_b32 a160, v8
v_perm_b32 v9, v226, v224, s37
v_accvgpr_write_b32 a168, v9
v_perm_b32 v10, v227, v225, s36
v_accvgpr_write_b32 a176, v10
v_perm_b32 v11, v227, v225, s37
v_accvgpr_write_b32 a184, v11
v_perm_b32 v8, v230, v228, s36
v_accvgpr_write_b32 a161, v8
v_perm_b32 v9, v230, v228, s37
v_accvgpr_write_b32 a169, v9
v_perm_b32 v10, v231, v229, s36
v_accvgpr_write_b32 a177, v10
v_perm_b32 v11, v231, v229, s37
v_accvgpr_write_b32 a185, v11
v_perm_b32 v8, v234, v232, s36
v_accvgpr_write_b32 a162, v8
v_perm_b32 v9, v234, v232, s37
v_accvgpr_write_b32 a170, v9
v_perm_b32 v10, v235, v233, s36
v_accvgpr_write_b32 a178, v10
v_perm_b32 v11, v235, v233, s37
v_accvgpr_write_b32 a186, v11
v_perm_b32 v8, v238, v236, s36
v_accvgpr_write_b32 a163, v8
v_perm_b32 v9, v238, v236, s37
v_accvgpr_write_b32 a171, v9
v_perm_b32 v10, v239, v237, s36
v_accvgpr_write_b32 a179, v10
v_perm_b32 v11, v239, v237, s37
v_accvgpr_write_b32 a187, v11
v_perm_b32 v8, v242, v240, s36
v_accvgpr_write_b32 a164, v8
v_perm_b32 v9, v242, v240, s37
v_accvgpr_write_b32 a172, v9
v_perm_b32 v10, v243, v241, s36
v_accvgpr_write_b32 a180, v10
v_perm_b32 v11, v243, v241, s37
v_accvgpr_write_b32 a188, v11
v_perm_b32 v8, v246, v244, s36
v_accvgpr_write_b32 a165, v8
v_perm_b32 v9, v246, v244, s37
v_accvgpr_write_b32 a173, v9
v_perm_b32 v10, v247, v245, s36
v_accvgpr_write_b32 a181, v10
v_perm_b32 v11, v247, v245, s37
v_accvgpr_write_b32 a189, v11
v_perm_b32 v8, v250, v248, s36
v_accvgpr_write_b32 a166, v8
v_perm_b32 v9, v250, v248, s37
v_accvgpr_write_b32 a174, v9
v_perm_b32 v10, v251, v249, s36
v_accvgpr_write_b32 a182, v10
v_perm_b32 v11, v251, v249, s37
v_accvgpr_write_b32 a190, v11
v_perm_b32 v8, v254, v252, s36
v_accvgpr_write_b32 a167, v8
v_perm_b32 v9, v254, v252, s37
v_accvgpr_write_b32 a175, v9
v_perm_b32 v10, v255, v253, s36
v_accvgpr_write_b32 a183, v10
v_perm_b32 v11, v255, v253, s37
v_accvgpr_write_b32 a191, v11
s_waitcnt vmcnt(16)
v_perm_b32 v8, v14, v12, s36
v_accvgpr_write_b32 a192, v8
v_perm_b32 v9, v14, v12, s37
v_accvgpr_write_b32 a200, v9
v_perm_b32 v10, v15, v13, s36
v_accvgpr_write_b32 a208, v10
v_perm_b32 v11, v15, v13, s37
v_accvgpr_write_b32 a216, v11
v_perm_b32 v8, v18, v16, s36
v_accvgpr_write_b32 a193, v8
v_perm_b32 v9, v18, v16, s37
v_accvgpr_write_b32 a201, v9
v_perm_b32 v10, v19, v17, s36
v_accvgpr_write_b32 a209, v10
v_perm_b32 v11, v19, v17, s37
v_accvgpr_write_b32 a217, v11
v_perm_b32 v8, v22, v20, s36
v_accvgpr_write_b32 a194, v8
v_perm_b32 v9, v22, v20, s37
v_accvgpr_write_b32 a202, v9
v_perm_b32 v10, v23, v21, s36
v_accvgpr_write_b32 a210, v10
v_perm_b32 v11, v23, v21, s37
v_accvgpr_write_b32 a218, v11
v_perm_b32 v8, v26, v24, s36
v_accvgpr_write_b32 a195, v8
v_perm_b32 v9, v26, v24, s37
v_accvgpr_write_b32 a203, v9
v_perm_b32 v10, v27, v25, s36
v_accvgpr_write_b32 a211, v10
v_perm_b32 v11, v27, v25, s37
v_accvgpr_write_b32 a219, v11
v_perm_b32 v8, v30, v28, s36
v_accvgpr_write_b32 a196, v8
v_perm_b32 v9, v30, v28, s37
v_accvgpr_write_b32 a204, v9
v_perm_b32 v10, v31, v29, s36
v_accvgpr_write_b32 a212, v10
v_perm_b32 v11, v31, v29, s37
v_accvgpr_write_b32 a220, v11
v_perm_b32 v8, v34, v32, s36
v_accvgpr_write_b32 a197, v8
v_perm_b32 v9, v34, v32, s37
v_accvgpr_write_b32 a205, v9
v_perm_b32 v10, v35, v33, s36
v_accvgpr_write_b32 a213, v10
v_perm_b32 v11, v35, v33, s37
v_accvgpr_write_b32 a221, v11
v_perm_b32 v8, v38, v36, s36
v_accvgpr_write_b32 a198, v8
v_perm_b32 v9, v38, v36, s37
v_accvgpr_write_b32 a206, v9
v_perm_b32 v10, v39, v37, s36
v_accvgpr_write_b32 a214, v10
v_perm_b32 v11, v39, v37, s37
v_accvgpr_write_b32 a222, v11
v_perm_b32 v8, v42, v40, s36
v_accvgpr_write_b32 a199, v8
v_perm_b32 v9, v42, v40, s37
v_accvgpr_write_b32 a207, v9
v_perm_b32 v10, v43, v41, s36
v_accvgpr_write_b32 a215, v10
v_perm_b32 v11, v43, v41, s37
v_accvgpr_write_b32 a223, v11
s_add_u32 s19, s54, 4194304
buffer_load_dwordx2 v[12:13], v2, s[12:15], s19 offen
s_add_u32 s19, s54, 4202496
buffer_load_dwordx2 v[14:15], v2, s[12:15], s19 offen
s_add_u32 s19, s54, 4259840
buffer_load_dwordx2 v[16:17], v2, s[12:15], s19 offen
s_add_u32 s19, s54, 4268032
buffer_load_dwordx2 v[18:19], v2, s[12:15], s19 offen
s_add_u32 s19, s54, 4210688
buffer_load_dwordx2 v[20:21], v2, s[12:15], s19 offen
s_add_u32 s19, s54, 4218880
buffer_load_dwordx2 v[22:23], v2, s[12:15], s19 offen
s_add_u32 s19, s54, 4276224
buffer_load_dwordx2 v[24:25], v2, s[12:15], s19 offen
s_add_u32 s19, s54, 4284416
buffer_load_dwordx2 v[26:27], v2, s[12:15], s19 offen
s_add_u32 s19, s54, 4456448
buffer_load_dwordx2 v[28:29], v2, s[12:15], s19 offen
s_add_u32 s19, s54, 4464640
buffer_load_dwordx2 v[30:31], v2, s[12:15], s19 offen
s_add_u32 s19, s54, 4521984
buffer_load_dwordx2 v[32:33], v2, s[12:15], s19 offen
s_add_u32 s19, s54, 4530176
buffer_load_dwordx2 v[34:35], v2, s[12:15], s19 offen
s_add_u32 s19, s54, 4472832
buffer_load_dwordx2 v[36:37], v2, s[12:15], s19 offen
s_add_u32 s19, s54, 4481024
buffer_load_dwordx2 v[38:39], v2, s[12:15], s19 offen
s_add_u32 s19, s54, 4538368
buffer_load_dwordx2 v[40:41], v2, s[12:15], s19 offen
s_add_u32 s19, s54, 4546560
buffer_load_dwordx2 v[42:43], v2, s[12:15], s19 offen
s_waitcnt vmcnt(16)
v_perm_b32 v8, v46, v44, s36
v_accvgpr_write_b32 a224, v8
v_perm_b32 v9, v46, v44, s37
v_accvgpr_write_b32 a232, v9
v_perm_b32 v10, v47, v45, s36
v_accvgpr_write_b32 a240, v10
v_perm_b32 v11, v47, v45, s37
v_accvgpr_write_b32 a248, v11
v_perm_b32 v8, v50, v48, s36
v_accvgpr_write_b32 a225, v8
v_perm_b32 v9, v50, v48, s37
v_accvgpr_write_b32 a233, v9
v_perm_b32 v10, v51, v49, s36
v_accvgpr_write_b32 a241, v10
v_perm_b32 v11, v51, v49, s37
v_accvgpr_write_b32 a249, v11
v_perm_b32 v8, v54, v52, s36
v_accvgpr_write_b32 a226, v8
v_perm_b32 v9, v54, v52, s37
v_accvgpr_write_b32 a234, v9
v_perm_b32 v10, v55, v53, s36
v_accvgpr_write_b32 a242, v10
v_perm_b32 v11, v55, v53, s37
v_accvgpr_write_b32 a250, v11
v_perm_b32 v8, v58, v56, s36
v_accvgpr_write_b32 a227, v8
v_perm_b32 v9, v58, v56, s37
v_accvgpr_write_b32 a235, v9
v_perm_b32 v10, v59, v57, s36
v_accvgpr_write_b32 a243, v10
v_perm_b32 v11, v59, v57, s37
v_accvgpr_write_b32 a251, v11
v_perm_b32 v8, v62, v60, s36
v_accvgpr_write_b32 a228, v8
v_perm_b32 v9, v62, v60, s37
v_accvgpr_write_b32 a236, v9
v_perm_b32 v10, v63, v61, s36
v_accvgpr_write_b32 a244, v10
v_perm_b32 v11, v63, v61, s37
v_accvgpr_write_b32 a252, v11
v_perm_b32 v8, v66, v64, s36
v_accvgpr_write_b32 a229, v8
v_perm_b32 v9, v66, v64, s37
v_accvgpr_write_b32 a237, v9
v_perm_b32 v10, v67, v65, s36
v_accvgpr_write_b32 a245, v10
v_perm_b32 v11, v67, v65, s37
v_accvgpr_write_b32 a253, v11
v_perm_b32 v8, v70, v68, s36
v_accvgpr_write_b32 a230, v8
v_perm_b32 v9, v70, v68, s37
v_accvgpr_write_b32 a238, v9
v_perm_b32 v10, v71, v69, s36
v_accvgpr_write_b32 a246, v10
v_perm_b32 v11, v71, v69, s37
v_accvgpr_write_b32 a254, v11
v_perm_b32 v8, v74, v72, s36
v_accvgpr_write_b32 a231, v8
v_perm_b32 v9, v74, v72, s37
v_accvgpr_write_b32 a239, v9
v_perm_b32 v10, v75, v73, s36
v_accvgpr_write_b32 a247, v10
v_perm_b32 v11, v75, v73, s37
v_accvgpr_write_b32 a255, v11
v_lshrrev_b32 v11, 8, v0
v_bfe_u32 v10, v0, 4, 4
v_and_b32 v8, 1, v11
v_lshlrev_b32 v8, 5, v8
v_lshrrev_b32 v9, 1, v11
v_lshl_add_u32 v8, v9, 2, v8
v_mul_u32_u24 v8, 1152, v8
s_lshl_b32 s19, s16, 8
v_lshl_add_u32 v4, v10, 4, v8
v_add_u32 v4, s19, v4
s_lshl_b32 s19, s16, 5
s_add_u32 s19, s19, 1024
v_lshl_add_u32 v5, v10, 1, v8
v_add_u32 v5, s19, v5
v_mul_u32_u24 v8, 4608, v11
v_lshl_add_u32 v2, v10, 1, v8
v_add_u32 v2, s19, v2
s_lshl_b32 s19, s16, 8
v_lshl_add_u32 v1, v10, 4, v8
v_add_u32 v1, s19, v1
s_mul_i32 s60, s17, 147456
v_add_u32 v6, 65536, v0
v_add_u32 v7, 131072, v0
s_add_u32 s19, s60, 0
buffer_load_dwordx4 v[44:47], v1, s[56:59], s19 offen
buffer_load_ushort v60, v2, s[56:59], s19 offen
s_add_u32 s19, s60, 1152
buffer_load_dwordx4 v[48:51], v1, s[56:59], s19 offen
buffer_load_ushort v61, v2, s[56:59], s19 offen
s_add_u32 s19, s60, 2304
buffer_load_dwordx4 v[52:55], v1, s[56:59], s19 offen
buffer_load_ushort v62, v2, s[56:59], s19 offen
s_add_u32 s19, s60, 3456
buffer_load_dwordx4 v[56:59], v1, s[56:59], s19 offen
buffer_load_ushort v63, v2, s[56:59], s19 offen
s_waitcnt vmcnt(8)
v_perm_b32 v224, v14, v12, s36
v_perm_b32 v232, v14, v12, s37
v_perm_b32 v240, v15, v13, s36
v_perm_b32 v248, v15, v13, s37
v_perm_b32 v225, v18, v16, s36
v_perm_b32 v233, v18, v16, s37
v_perm_b32 v241, v19, v17, s36
v_perm_b32 v249, v19, v17, s37
v_perm_b32 v226, v22, v20, s36
v_perm_b32 v234, v22, v20, s37
v_perm_b32 v242, v23, v21, s36
v_perm_b32 v250, v23, v21, s37
v_perm_b32 v227, v26, v24, s36
v_perm_b32 v235, v26, v24, s37
v_perm_b32 v243, v27, v25, s36
v_perm_b32 v251, v27, v25, s37
v_perm_b32 v228, v30, v28, s36
v_perm_b32 v236, v30, v28, s37
v_perm_b32 v244, v31, v29, s36
v_perm_b32 v252, v31, v29, s37
v_perm_b32 v229, v34, v32, s36
v_perm_b32 v237, v34, v32, s37
v_perm_b32 v245, v35, v33, s36
v_perm_b32 v253, v35, v33, s37
v_perm_b32 v230, v38, v36, s36
v_perm_b32 v238, v38, v36, s37
v_perm_b32 v246, v39, v37, s36
v_perm_b32 v254, v39, v37, s37
v_perm_b32 v231, v42, v40, s36
v_perm_b32 v239, v42, v40, s37
v_perm_b32 v247, v43, v41, s36
v_perm_b32 v255, v43, v41, s37
s_add_u32 s19, s60, 18432
buffer_load_dwordx4 v[12:15], v1, s[56:59], s19 offen
buffer_load_ushort v28, v2, s[56:59], s19 offen
s_add_u32 s19, s60, 19584
buffer_load_dwordx4 v[16:19], v1, s[56:59], s19 offen
buffer_load_ushort v29, v2, s[56:59], s19 offen
s_add_u32 s19, s60, 20736
buffer_load_dwordx4 v[20:23], v1, s[56:59], s19 offen
buffer_load_ushort v30, v2, s[56:59], s19 offen
s_add_u32 s19, s60, 21888
buffer_load_dwordx4 v[24:27], v1, s[56:59], s19 offen
buffer_load_ushort v31, v2, s[56:59], s19 offen
s_add_u32 s19, s60, 36864
buffer_load_dwordx4 v[32:35], v1, s[56:59], s19 offen
buffer_load_ushort v68, v2, s[56:59], s19 offen
s_add_u32 s19, s60, 38016
buffer_load_dwordx4 v[36:39], v1, s[56:59], s19 offen
buffer_load_ushort v69, v2, s[56:59], s19 offen
s_add_u32 s19, s60, 39168
buffer_load_dwordx4 v[40:43], v1, s[56:59], s19 offen
buffer_load_ushort v70, v2, s[56:59], s19 offen
s_add_u32 s19, s60, 40320
buffer_load_dwordx4 v[64:67], v1, s[56:59], s19 offen
buffer_load_ushort v71, v2, s[56:59], s19 offen
s_cmp_eq_u32 s16, 0
s_cbranch_scc0 Lc_wo1sc1
s_waitcnt vmcnt(16)
v_perm_b32 v8, v48, v44, s36
v_perm_b32 v9, v56, v52, s36
ds_write_b64 v0, v[8:9]
s_waitcnt lgkmcnt(1)
v_perm_b32 v10, v48, v44, s37
v_perm_b32 v11, v56, v52, s37
ds_write_b64 v0, v[10:11] offset:4096
s_waitcnt lgkmcnt(1)
v_perm_b32 v8, v49, v45, s36
v_perm_b32 v9, v57, v53, s36
ds_write_b64 v6, v[8:9] offset:10240
s_waitcnt lgkmcnt(1)
v_perm_b32 v10, v49, v45, s37
v_perm_b32 v11, v57, v53, s37
ds_write_b64 v0, v[10:11] offset:36864
s_waitcnt lgkmcnt(1)
v_perm_b32 v8, v50, v46, s36
v_perm_b32 v9, v58, v54, s36
ds_write_b64 v7, v[8:9]
s_waitcnt lgkmcnt(1)
v_perm_b32 v10, v50, v46, s37
v_perm_b32 v11, v58, v54, s37
ds_write_b64 v6, v[10:11] offset:26624
s_waitcnt lgkmcnt(1)
v_perm_b32 v8, v51, v47, s36
v_perm_b32 v9, v59, v55, s36
ds_write_b64 v0, v[8:9] offset:53248
s_waitcnt lgkmcnt(1)
v_perm_b32 v10, v51, v47, s37
v_perm_b32 v11, v59, v55, s37
ds_write_b64 v7, v[10:11] offset:16384
s_waitcnt lgkmcnt(1)
v_perm_b32 v8, v61, v60, s36
v_perm_b32 v9, v63, v62, s36
ds_write_b64 v6, v[8:9] offset:43008
s_waitcnt lgkmcnt(1)
s_waitcnt lgkmcnt(0)
s_add_u32 s19, s60, 55296
buffer_load_dwordx4 v[44:47], v1, s[56:59], s19 offen
buffer_load_ushort v60, v2, s[56:59], s19 offen
s_add_u32 s19, s60, 56448
buffer_load_dwordx4 v[48:51], v1, s[56:59], s19 offen
buffer_load_ushort v61, v2, s[56:59], s19 offen
s_add_u32 s19, s60, 57600
buffer_load_dwordx4 v[52:55], v1, s[56:59], s19 offen
buffer_load_ushort v62, v2, s[56:59], s19 offen
s_add_u32 s19, s60, 58752
buffer_load_dwordx4 v[56:59], v1, s[56:59], s19 offen
buffer_load_ushort v63, v2, s[56:59], s19 offen
s_waitcnt vmcnt(16)
v_perm_b32 v8, v16, v12, s36
v_perm_b32 v9, v24, v20, s36
ds_write_b64 v0, v[8:9] offset:8
s_waitcnt lgkmcnt(1)
v_perm_b32 v10, v16, v12, s37
v_perm_b32 v11, v24, v20, s37
ds_write_b64 v0, v[10:11] offset:4104
s_waitcnt lgkmcnt(1)
v_perm_b32 v8, v17, v13, s36
v_perm_b32 v9, v25, v21, s36
ds_write_b64 v6, v[8:9] offset:10248
s_waitcnt lgkmcnt(1)
v_perm_b32 v10, v17, v13, s37
v_perm_b32 v11, v25, v21, s37
ds_write_b64 v0, v[10:11] offset:36872
s_waitcnt lgkmcnt(1)
v_perm_b32 v8, v18, v14, s36
v_perm_b32 v9, v26, v22, s36
ds_write_b64 v7, v[8:9] offset:8
s_waitcnt lgkmcnt(1)
v_perm_b32 v10, v18, v14, s37
v_perm_b32 v11, v26, v22, s37
ds_write_b64 v6, v[10:11] offset:26632
s_waitcnt lgkmcnt(1)
v_perm_b32 v8, v19, v15, s36
v_perm_b32 v9, v27, v23, s36
ds_write_b64 v0, v[8:9] offset:53256
s_waitcnt lgkmcnt(1)
v_perm_b32 v10, v19, v15, s37
v_perm_b32 v11, v27, v23, s37
ds_write_b64 v7, v[10:11] offset:16392
s_waitcnt lgkmcnt(1)
v_perm_b32 v8, v29, v28, s36
v_perm_b32 v9, v31, v30, s36
ds_write_b64 v6, v[8:9] offset:43016
s_waitcnt lgkmcnt(1)
s_waitcnt lgkmcnt(0)
s_add_u32 s19, s60, 73728
buffer_load_dwordx4 v[12:15], v4, s[56:59], s19 offen
buffer_load_ushort v28, v5, s[56:59], s19 offen
s_add_u32 s19, s60, 74880
buffer_load_dwordx4 v[16:19], v4, s[56:59], s19 offen
buffer_load_ushort v29, v5, s[56:59], s19 offen
s_add_u32 s19, s60, 92160
buffer_load_dwordx4 v[20:23], v4, s[56:59], s19 offen
buffer_load_ushort v30, v5, s[56:59], s19 offen
s_add_u32 s19, s60, 93312
buffer_load_dwordx4 v[24:27], v4, s[56:59], s19 offen
buffer_load_ushort v31, v5, s[56:59], s19 offen
s_waitcnt vmcnt(16)
v_perm_b32 v8, v36, v32, s36
v_perm_b32 v9, v64, v40, s36
ds_write_b64 v0, v[8:9] offset:1024
s_waitcnt lgkmcnt(1)
v_perm_b32 v10, v36, v32, s37
v_perm_b32 v11, v64, v40, s37
ds_write_b64 v0, v[10:11] offset:5120
s_waitcnt lgkmcnt(1)
v_perm_b32 v8, v37, v33, s36
v_perm_b32 v9, v65, v41, s36
ds_write_b64 v6, v[8:9] offset:11264
s_waitcnt lgkmcnt(1)
v_perm_b32 v10, v37, v33, s37
v_perm_b32 v11, v65, v41, s37
ds_write_b64 v0, v[10:11] offset:37888
s_waitcnt lgkmcnt(1)
v_perm_b32 v8, v38, v34, s36
v_perm_b32 v9, v66, v42, s36
ds_write_b64 v7, v[8:9] offset:1024
s_waitcnt lgkmcnt(1)
v_perm_b32 v10, v38, v34, s37
v_perm_b32 v11, v66, v42, s37
ds_write_b64 v6, v[10:11] offset:27648
s_waitcnt lgkmcnt(1)
v_perm_b32 v8, v39, v35, s36
v_perm_b32 v9, v67, v43, s36
ds_write_b64 v0, v[8:9] offset:54272
s_waitcnt lgkmcnt(1)
v_perm_b32 v10, v39, v35, s37
v_perm_b32 v11, v67, v43, s37
ds_write_b64 v7, v[10:11] offset:17408
s_waitcnt lgkmcnt(1)
v_perm_b32 v8, v69, v68, s36
v_perm_b32 v9, v71, v70, s36
ds_write_b64 v6, v[8:9] offset:44032
s_waitcnt lgkmcnt(1)
s_waitcnt lgkmcnt(0)
s_add_u32 s19, s60, 76032
buffer_load_dwordx4 v[32:35], v4, s[56:59], s19 offen
buffer_load_ushort v68, v5, s[56:59], s19 offen
s_add_u32 s19, s60, 77184
buffer_load_dwordx4 v[36:39], v4, s[56:59], s19 offen
buffer_load_ushort v69, v5, s[56:59], s19 offen
s_add_u32 s19, s60, 94464
buffer_load_dwordx4 v[40:43], v4, s[56:59], s19 offen
buffer_load_ushort v70, v5, s[56:59], s19 offen
s_add_u32 s19, s60, 95616
buffer_load_dwordx4 v[64:67], v4, s[56:59], s19 offen
buffer_load_ushort v71, v5, s[56:59], s19 offen
s_waitcnt vmcnt(16)
v_perm_b32 v8, v48, v44, s36
v_perm_b32 v9, v56, v52, s36
ds_write_b64 v0, v[8:9] offset:1032
s_waitcnt lgkmcnt(1)
v_perm_b32 v10, v48, v44, s37
v_perm_b32 v11, v56, v52, s37
ds_write_b64 v0, v[10:11] offset:5128
s_waitcnt lgkmcnt(1)
v_perm_b32 v8, v49, v45, s36
v_perm_b32 v9, v57, v53, s36
ds_write_b64 v6, v[8:9] offset:11272
s_waitcnt lgkmcnt(1)
v_perm_b32 v10, v49, v45, s37
v_perm_b32 v11, v57, v53, s37
ds_write_b64 v0, v[10:11] offset:37896
s_waitcnt lgkmcnt(1)
v_perm_b32 v8, v50, v46, s36
v_perm_b32 v9, v58, v54, s36
ds_write_b64 v7, v[8:9] offset:1032
s_waitcnt lgkmcnt(1)
v_perm_b32 v10, v50, v46, s37
v_perm_b32 v11, v58, v54, s37
ds_write_b64 v6, v[10:11] offset:27656
s_waitcnt lgkmcnt(1)
v_perm_b32 v8, v51, v47, s36
v_perm_b32 v9, v59, v55, s36
ds_write_b64 v0, v[8:9] offset:54280
s_waitcnt lgkmcnt(1)
v_perm_b32 v10, v51, v47, s37
v_perm_b32 v11, v59, v55, s37
ds_write_b64 v7, v[10:11] offset:17416
s_waitcnt lgkmcnt(1)
v_perm_b32 v8, v61, v60, s36
v_perm_b32 v9, v63, v62, s36
ds_write_b64 v6, v[8:9] offset:44040
s_waitcnt lgkmcnt(1)
s_waitcnt lgkmcnt(0)
s_add_u32 s19, s60, 82944
buffer_load_dwordx4 v[44:47], v4, s[56:59], s19 offen
buffer_load_ushort v60, v5, s[56:59], s19 offen
s_add_u32 s19, s60, 84096
buffer_load_dwordx4 v[48:51], v4, s[56:59], s19 offen
buffer_load_ushort v61, v5, s[56:59], s19 offen
s_add_u32 s19, s60, 101376
buffer_load_dwordx4 v[52:55], v4, s[56:59], s19 offen
buffer_load_ushort v62, v5, s[56:59], s19 offen
s_add_u32 s19, s60, 102528
buffer_load_dwordx4 v[56:59], v4, s[56:59], s19 offen
buffer_load_ushort v63, v5, s[56:59], s19 offen
s_waitcnt vmcnt(16)
v_perm_b32 v8, v16, v12, s36
v_perm_b32 v9, v24, v20, s36
ds_write_b64 v0, v[8:9] offset:22528
s_waitcnt lgkmcnt(1)
v_perm_b32 v10, v16, v12, s37
v_perm_b32 v11, v24, v20, s37
ds_write_b64 v6, v[10:11] offset:51200
s_waitcnt lgkmcnt(1)
v_perm_b32 v8, v17, v13, s36
v_perm_b32 v9, v25, v21, s36
ds_write_b64 v6, v[8:9] offset:12288
s_waitcnt lgkmcnt(1)
v_perm_b32 v10, v17, v13, s37
v_perm_b32 v11, v25, v21, s37
ds_write_b64 v0, v[10:11] offset:38912
s_waitcnt lgkmcnt(1)
v_perm_b32 v8, v18, v14, s36
v_perm_b32 v9, v26, v22, s36
ds_write_b64 v7, v[8:9] offset:2048
s_waitcnt lgkmcnt(1)
v_perm_b32 v10, v18, v14, s37
v_perm_b32 v11, v26, v22, s37
ds_write_b64 v6, v[10:11] offset:28672
s_waitcnt lgkmcnt(1)
v_perm_b32 v8, v19, v15, s36
v_perm_b32 v9, v27, v23, s36
ds_write_b64 v0, v[8:9] offset:55296
s_waitcnt lgkmcnt(1)
v_perm_b32 v10, v19, v15, s37
v_perm_b32 v11, v27, v23, s37
ds_write_b64 v7, v[10:11] offset:18432
s_waitcnt lgkmcnt(1)
v_perm_b32 v8, v29, v28, s36
v_perm_b32 v9, v31, v30, s36
ds_write_b64 v6, v[8:9] offset:45056
s_waitcnt lgkmcnt(1)
s_waitcnt lgkmcnt(0)
s_add_u32 s19, s60, 85248
buffer_load_dwordx4 v[12:15], v4, s[56:59], s19 offen
buffer_load_ushort v28, v5, s[56:59], s19 offen
s_add_u32 s19, s60, 86400
buffer_load_dwordx4 v[16:19], v4, s[56:59], s19 offen
buffer_load_ushort v29, v5, s[56:59], s19 offen
s_add_u32 s19, s60, 103680
buffer_load_dwordx4 v[20:23], v4, s[56:59], s19 offen
buffer_load_ushort v30, v5, s[56:59], s19 offen
s_add_u32 s19, s60, 104832
buffer_load_dwordx4 v[24:27], v4, s[56:59], s19 offen
buffer_load_ushort v31, v5, s[56:59], s19 offen
s_waitcnt vmcnt(16)
v_perm_b32 v8, v36, v32, s36
v_perm_b32 v9, v64, v40, s36
ds_write_b64 v0, v[8:9] offset:22536
s_waitcnt lgkmcnt(1)
v_perm_b32 v10, v36, v32, s37
v_perm_b32 v11, v64, v40, s37
ds_write_b64 v6, v[10:11] offset:51208
s_waitcnt lgkmcnt(1)
v_perm_b32 v8, v37, v33, s36
v_perm_b32 v9, v65, v41, s36
ds_write_b64 v6, v[8:9] offset:12296
s_waitcnt lgkmcnt(1)
v_perm_b32 v10, v37, v33, s37
v_perm_b32 v11, v65, v41, s37
ds_write_b64 v0, v[10:11] offset:38920
s_waitcnt lgkmcnt(1)
v_perm_b32 v8, v38, v34, s36
v_perm_b32 v9, v66, v42, s36
ds_write_b64 v7, v[8:9] offset:2056
s_waitcnt lgkmcnt(1)
v_perm_b32 v10, v38, v34, s37
v_perm_b32 v11, v66, v42, s37
ds_write_b64 v6, v[10:11] offset:28680
s_waitcnt lgkmcnt(1)
v_perm_b32 v8, v39, v35, s36
v_perm_b32 v9, v67, v43, s36
ds_write_b64 v0, v[8:9] offset:55304
s_waitcnt lgkmcnt(1)
v_perm_b32 v10, v39, v35, s37
v_perm_b32 v11, v67, v43, s37
ds_write_b64 v7, v[10:11] offset:18440
s_waitcnt lgkmcnt(1)
v_perm_b32 v8, v69, v68, s36
v_perm_b32 v9, v71, v70, s36
ds_write_b64 v6, v[8:9] offset:45064
s_waitcnt lgkmcnt(1)
s_waitcnt lgkmcnt(0)
s_waitcnt vmcnt(8)
v_perm_b32 v8, v48, v44, s36
v_perm_b32 v9, v56, v52, s36
ds_write_b64 v0, v[8:9] offset:23552
s_waitcnt lgkmcnt(1)
v_perm_b32 v10, v48, v44, s37
v_perm_b32 v11, v56, v52, s37
ds_write_b64 v6, v[10:11] offset:52224
s_waitcnt lgkmcnt(1)
v_perm_b32 v8, v49, v45, s36
v_perm_b32 v9, v57, v53, s36
ds_write_b64 v6, v[8:9] offset:13312
s_waitcnt lgkmcnt(1)
v_perm_b32 v10, v49, v45, s37
v_perm_b32 v11, v57, v53, s37
ds_write_b64 v0, v[10:11] offset:39936
s_waitcnt lgkmcnt(1)
v_perm_b32 v8, v50, v46, s36
v_perm_b32 v9, v58, v54, s36
ds_write_b64 v7, v[8:9] offset:3072
s_waitcnt lgkmcnt(1)
v_perm_b32 v10, v50, v46, s37
v_perm_b32 v11, v58, v54, s37
ds_write_b64 v6, v[10:11] offset:29696
s_waitcnt lgkmcnt(1)
v_perm_b32 v8, v51, v47, s36
v_perm_b32 v9, v59, v55, s36
ds_write_b64 v0, v[8:9] offset:56320
s_waitcnt lgkmcnt(1)
v_perm_b32 v10, v51, v47, s37
v_perm_b32 v11, v59, v55, s37
ds_write_b64 v7, v[10:11] offset:19456
s_waitcnt lgkmcnt(1)
v_perm_b32 v8, v61, v60, s36
v_perm_b32 v9, v63, v62, s36
ds_write_b64 v6, v[8:9] offset:46080
s_waitcnt lgkmcnt(1)
s_waitcnt lgkmcnt(0)
s_waitcnt vmcnt(0)
v_perm_b32 v8, v16, v12, s36
v_perm_b32 v9, v24, v20, s36
ds_write_b64 v0, v[8:9] offset:23560
s_waitcnt lgkmcnt(1)
v_perm_b32 v10, v16, v12, s37
v_perm_b32 v11, v24, v20, s37
ds_write_b64 v6, v[10:11] offset:52232
s_waitcnt lgkmcnt(1)
v_perm_b32 v8, v17, v13, s36
v_perm_b32 v9, v25, v21, s36
ds_write_b64 v6, v[8:9] offset:13320
s_waitcnt lgkmcnt(1)
v_perm_b32 v10, v17, v13, s37
v_perm_b32 v11, v25, v21, s37
ds_write_b64 v0, v[10:11] offset:39944
s_waitcnt lgkmcnt(1)
v_perm_b32 v8, v18, v14, s36
v_perm_b32 v9, v26, v22, s36
ds_write_b64 v7, v[8:9] offset:3080
s_waitcnt lgkmcnt(1)
v_perm_b32 v10, v18, v14, s37
v_perm_b32 v11, v26, v22, s37
ds_write_b64 v6, v[10:11] offset:29704
s_waitcnt lgkmcnt(1)
v_perm_b32 v8, v19, v15, s36
v_perm_b32 v9, v27, v23, s36
ds_write_b64 v0, v[8:9] offset:56328
s_waitcnt lgkmcnt(1)
v_perm_b32 v10, v19, v15, s37
v_perm_b32 v11, v27, v23, s37
ds_write_b64 v7, v[10:11] offset:19464
s_waitcnt lgkmcnt(1)
v_perm_b32 v8, v29, v28, s36
v_perm_b32 v9, v31, v30, s36
ds_write_b64 v6, v[8:9] offset:46088
s_waitcnt lgkmcnt(1)
s_waitcnt lgkmcnt(0)
s_branch Lc_wo4sc1
Lc_wo1sc1:
s_cmp_eq_u32 s16, 1
s_cbranch_scc0 Lc_wo2sc1
s_waitcnt vmcnt(16)
v_perm_b32 v8, v48, v44, s36
v_perm_b32 v9, v56, v52, s36
ds_write_b64 v0, v[8:9] offset:24576
s_waitcnt lgkmcnt(1)
v_perm_b32 v10, v48, v44, s37
v_perm_b32 v11, v56, v52, s37
ds_write_b64 v6, v[10:11] offset:53248
s_waitcnt lgkmcnt(1)
v_perm_b32 v8, v49, v45, s36
v_perm_b32 v9, v57, v53, s36
ds_write_b64 v6, v[8:9] offset:14336
s_waitcnt lgkmcnt(1)
v_perm_b32 v10, v49, v45, s37
v_perm_b32 v11, v57, v53, s37
ds_write_b64 v0, v[10:11] offset:40960
s_waitcnt lgkmcnt(1)
v_perm_b32 v8, v50, v46, s36
v_perm_b32 v9, v58, v54, s36
ds_write_b64 v7, v[8:9] offset:4096
s_waitcnt lgkmcnt(1)
v_perm_b32 v10, v50, v46, s37
v_perm_b32 v11, v58, v54, s37
ds_write_b64 v6, v[10:11] offset:30720
s_waitcnt lgkmcnt(1)
v_perm_b32 v8, v51, v47, s36
v_perm_b32 v9, v59, v55, s36
ds_write_b64 v0, v[8:9] offset:57344
s_waitcnt lgkmcnt(1)
v_perm_b32 v10, v51, v47, s37
v_perm_b32 v11, v59, v55, s37
ds_write_b64 v7, v[10:11] offset:20480
s_waitcnt lgkmcnt(1)
v_perm_b32 v8, v61, v60, s36
v_perm_b32 v9, v63, v62, s36
ds_write_b64 v6, v[8:9] offset:47104
s_waitcnt lgkmcnt(1)
s_waitcnt lgkmcnt(0)
s_add_u32 s19, s60, 55296
buffer_load_dwordx4 v[44:47], v1, s[56:59], s19 offen
buffer_load_ushort v60, v2, s[56:59], s19 offen
s_add_u32 s19, s60, 56448
buffer_load_dwordx4 v[48:51], v1, s[56:59], s19 offen
buffer_load_ushort v61, v2, s[56:59], s19 offen
s_add_u32 s19, s60, 57600
buffer_load_dwordx4 v[52:55], v1, s[56:59], s19 offen
buffer_load_ushort v62, v2, s[56:59], s19 offen
s_add_u32 s19, s60, 58752
buffer_load_dwordx4 v[56:59], v1, s[56:59], s19 offen
buffer_load_ushort v63, v2, s[56:59], s19 offen
s_waitcnt vmcnt(16)
v_perm_b32 v8, v16, v12, s36
v_perm_b32 v9, v24, v20, s36
ds_write_b64 v0, v[8:9] offset:24584
s_waitcnt lgkmcnt(1)
v_perm_b32 v10, v16, v12, s37
v_perm_b32 v11, v24, v20, s37
ds_write_b64 v6, v[10:11] offset:53256
s_waitcnt lgkmcnt(1)
v_perm_b32 v8, v17, v13, s36
v_perm_b32 v9, v25, v21, s36
ds_write_b64 v6, v[8:9] offset:14344
s_waitcnt lgkmcnt(1)
v_perm_b32 v10, v17, v13, s37
v_perm_b32 v11, v25, v21, s37
ds_write_b64 v0, v[10:11] offset:40968
s_waitcnt lgkmcnt(1)
v_perm_b32 v8, v18, v14, s36
v_perm_b32 v9, v26, v22, s36
ds_write_b64 v7, v[8:9] offset:4104
s_waitcnt lgkmcnt(1)
v_perm_b32 v10, v18, v14, s37
v_perm_b32 v11, v26, v22, s37
ds_write_b64 v6, v[10:11] offset:30728
s_waitcnt lgkmcnt(1)
v_perm_b32 v8, v19, v15, s36
v_perm_b32 v9, v27, v23, s36
ds_write_b64 v0, v[8:9] offset:57352
s_waitcnt lgkmcnt(1)
v_perm_b32 v10, v19, v15, s37
v_perm_b32 v11, v27, v23, s37
ds_write_b64 v7, v[10:11] offset:20488
s_waitcnt lgkmcnt(1)
v_perm_b32 v8, v29, v28, s36
v_perm_b32 v9, v31, v30, s36
ds_write_b64 v6, v[8:9] offset:47112
s_waitcnt lgkmcnt(1)
s_waitcnt lgkmcnt(0)
s_add_u32 s19, s60, 73728
buffer_load_dwordx4 v[12:15], v4, s[56:59], s19 offen
buffer_load_ushort v28, v5, s[56:59], s19 offen
s_add_u32 s19, s60, 74880
buffer_load_dwordx4 v[16:19], v4, s[56:59], s19 offen
buffer_load_ushort v29, v5, s[56:59], s19 offen
s_add_u32 s19, s60, 92160
buffer_load_dwordx4 v[20:23], v4, s[56:59], s19 offen
buffer_load_ushort v30, v5, s[56:59], s19 offen
s_add_u32 s19, s60, 93312
buffer_load_dwordx4 v[24:27], v4, s[56:59], s19 offen
buffer_load_ushort v31, v5, s[56:59], s19 offen
s_waitcnt vmcnt(16)
v_perm_b32 v8, v36, v32, s36
v_perm_b32 v9, v64, v40, s36
ds_write_b64 v0, v[8:9] offset:25600
s_waitcnt lgkmcnt(1)
v_perm_b32 v10, v36, v32, s37
v_perm_b32 v11, v64, v40, s37
ds_write_b64 v6, v[10:11] offset:54272
s_waitcnt lgkmcnt(1)
v_perm_b32 v8, v37, v33, s36
v_perm_b32 v9, v65, v41, s36
ds_write_b64 v6, v[8:9] offset:15360
s_waitcnt lgkmcnt(1)
v_perm_b32 v10, v37, v33, s37
v_perm_b32 v11, v65, v41, s37
ds_write_b64 v0, v[10:11] offset:41984
s_waitcnt lgkmcnt(1)
v_perm_b32 v8, v38, v34, s36
v_perm_b32 v9, v66, v42, s36
ds_write_b64 v7, v[8:9] offset:5120
s_waitcnt lgkmcnt(1)
v_perm_b32 v10, v38, v34, s37
v_perm_b32 v11, v66, v42, s37
ds_write_b64 v6, v[10:11] offset:31744
s_waitcnt lgkmcnt(1)
v_perm_b32 v8, v39, v35, s36
v_perm_b32 v9, v67, v43, s36
ds_write_b64 v0, v[8:9] offset:58368
s_waitcnt lgkmcnt(1)
v_perm_b32 v10, v39, v35, s37
v_perm_b32 v11, v67, v43, s37
ds_write_b64 v7, v[10:11] offset:21504
s_waitcnt lgkmcnt(1)
v_perm_b32 v8, v69, v68, s36
v_perm_b32 v9, v71, v70, s36
ds_write_b64 v6, v[8:9] offset:48128
s_waitcnt lgkmcnt(1)
s_waitcnt lgkmcnt(0)
s_add_u32 s19, s60, 76032
buffer_load_dwordx4 v[32:35], v4, s[56:59], s19 offen
buffer_load_ushort v68, v5, s[56:59], s19 offen
s_add_u32 s19, s60, 77184
buffer_load_dwordx4 v[36:39], v4, s[56:59], s19 offen
buffer_load_ushort v69, v5, s[56:59], s19 offen
s_add_u32 s19, s60, 94464
buffer_load_dwordx4 v[40:43], v4, s[56:59], s19 offen
buffer_load_ushort v70, v5, s[56:59], s19 offen
s_add_u32 s19, s60, 95616
buffer_load_dwordx4 v[64:67], v4, s[56:59], s19 offen
buffer_load_ushort v71, v5, s[56:59], s19 offen
s_waitcnt vmcnt(16)
v_perm_b32 v8, v48, v44, s36
v_perm_b32 v9, v56, v52, s36
ds_write_b64 v0, v[8:9] offset:25608
s_waitcnt lgkmcnt(1)
v_perm_b32 v10, v48, v44, s37
v_perm_b32 v11, v56, v52, s37
ds_write_b64 v6, v[10:11] offset:54280
s_waitcnt lgkmcnt(1)
v_perm_b32 v8, v49, v45, s36
v_perm_b32 v9, v57, v53, s36
ds_write_b64 v6, v[8:9] offset:15368
s_waitcnt lgkmcnt(1)
v_perm_b32 v10, v49, v45, s37
v_perm_b32 v11, v57, v53, s37
ds_write_b64 v0, v[10:11] offset:41992
s_waitcnt lgkmcnt(1)
v_perm_b32 v8, v50, v46, s36
v_perm_b32 v9, v58, v54, s36
ds_write_b64 v7, v[8:9] offset:5128
s_waitcnt lgkmcnt(1)
v_perm_b32 v10, v50, v46, s37
v_perm_b32 v11, v58, v54, s37
ds_write_b64 v6, v[10:11] offset:31752
s_waitcnt lgkmcnt(1)
v_perm_b32 v8, v51, v47, s36
v_perm_b32 v9, v59, v55, s36
ds_write_b64 v0, v[8:9] offset:58376
s_waitcnt lgkmcnt(1)
v_perm_b32 v10, v51, v47, s37
v_perm_b32 v11, v59, v55, s37
ds_write_b64 v7, v[10:11] offset:21512
s_waitcnt lgkmcnt(1)
v_perm_b32 v8, v61, v60, s36
v_perm_b32 v9, v63, v62, s36
ds_write_b64 v6, v[8:9] offset:48136
s_waitcnt lgkmcnt(1)
s_waitcnt lgkmcnt(0)
s_add_u32 s19, s60, 82944
buffer_load_dwordx4 v[44:47], v4, s[56:59], s19 offen
buffer_load_ushort v60, v5, s[56:59], s19 offen
s_add_u32 s19, s60, 84096
buffer_load_dwordx4 v[48:51], v4, s[56:59], s19 offen
buffer_load_ushort v61, v5, s[56:59], s19 offen
s_add_u32 s19, s60, 101376
buffer_load_dwordx4 v[52:55], v4, s[56:59], s19 offen
buffer_load_ushort v62, v5, s[56:59], s19 offen
s_add_u32 s19, s60, 102528
buffer_load_dwordx4 v[56:59], v4, s[56:59], s19 offen
buffer_load_ushort v63, v5, s[56:59], s19 offen
s_waitcnt vmcnt(16)
v_perm_b32 v8, v16, v12, s36
v_perm_b32 v9, v24, v20, s36
ds_write_b64 v0, v[8:9] offset:26624
s_waitcnt lgkmcnt(1)
v_perm_b32 v10, v16, v12, s37
v_perm_b32 v11, v24, v20, s37
ds_write_b64 v6, v[10:11] offset:55296
s_waitcnt lgkmcnt(1)
v_perm_b32 v8, v17, v13, s36
v_perm_b32 v9, v25, v21, s36
ds_write_b64 v6, v[8:9] offset:16384
s_waitcnt lgkmcnt(1)
v_perm_b32 v10, v17, v13, s37
v_perm_b32 v11, v25, v21, s37
ds_write_b64 v0, v[10:11] offset:43008
s_waitcnt lgkmcnt(1)
v_perm_b32 v8, v18, v14, s36
v_perm_b32 v9, v26, v22, s36
ds_write_b64 v7, v[8:9] offset:6144
s_waitcnt lgkmcnt(1)
v_perm_b32 v10, v18, v14, s37
v_perm_b32 v11, v26, v22, s37
ds_write_b64 v6, v[10:11] offset:32768
s_waitcnt lgkmcnt(1)
v_perm_b32 v8, v19, v15, s36
v_perm_b32 v9, v27, v23, s36
ds_write_b64 v0, v[8:9] offset:59392
s_waitcnt lgkmcnt(1)
v_perm_b32 v10, v19, v15, s37
v_perm_b32 v11, v27, v23, s37
ds_write_b64 v7, v[10:11] offset:22528
s_waitcnt lgkmcnt(1)
v_perm_b32 v8, v29, v28, s36
v_perm_b32 v9, v31, v30, s36
ds_write_b64 v6, v[8:9] offset:49152
s_waitcnt lgkmcnt(1)
s_waitcnt lgkmcnt(0)
s_add_u32 s19, s60, 85248
buffer_load_dwordx4 v[12:15], v4, s[56:59], s19 offen
buffer_load_ushort v28, v5, s[56:59], s19 offen
s_add_u32 s19, s60, 86400
buffer_load_dwordx4 v[16:19], v4, s[56:59], s19 offen
buffer_load_ushort v29, v5, s[56:59], s19 offen
s_add_u32 s19, s60, 103680
buffer_load_dwordx4 v[20:23], v4, s[56:59], s19 offen
buffer_load_ushort v30, v5, s[56:59], s19 offen
s_add_u32 s19, s60, 104832
buffer_load_dwordx4 v[24:27], v4, s[56:59], s19 offen
buffer_load_ushort v31, v5, s[56:59], s19 offen
s_waitcnt vmcnt(16)
v_perm_b32 v8, v36, v32, s36
v_perm_b32 v9, v64, v40, s36
ds_write_b64 v0, v[8:9] offset:26632
s_waitcnt lgkmcnt(1)
v_perm_b32 v10, v36, v32, s37
v_perm_b32 v11, v64, v40, s37
ds_write_b64 v6, v[10:11] offset:55304
s_waitcnt lgkmcnt(1)
v_perm_b32 v8, v37, v33, s36
v_perm_b32 v9, v65, v41, s36
ds_write_b64 v6, v[8:9] offset:16392
s_waitcnt lgkmcnt(1)
v_perm_b32 v10, v37, v33, s37
v_perm_b32 v11, v65, v41, s37
ds_write_b64 v0, v[10:11] offset:43016
s_waitcnt lgkmcnt(1)
v_perm_b32 v8, v38, v34, s36
v_perm_b32 v9, v66, v42, s36
ds_write_b64 v7, v[8:9] offset:6152
s_waitcnt lgkmcnt(1)
v_perm_b32 v10, v38, v34, s37
v_perm_b32 v11, v66, v42, s37
ds_write_b64 v6, v[10:11] offset:32776
s_waitcnt lgkmcnt(1)
v_perm_b32 v8, v39, v35, s36
v_perm_b32 v9, v67, v43, s36
ds_write_b64 v0, v[8:9] offset:59400
s_waitcnt lgkmcnt(1)
v_perm_b32 v10, v39, v35, s37
v_perm_b32 v11, v67, v43, s37
ds_write_b64 v7, v[10:11] offset:22536
s_waitcnt lgkmcnt(1)
v_perm_b32 v8, v69, v68, s36
v_perm_b32 v9, v71, v70, s36
ds_write_b64 v6, v[8:9] offset:49160
s_waitcnt lgkmcnt(1)
s_waitcnt lgkmcnt(0)
s_waitcnt vmcnt(8)
v_perm_b32 v8, v48, v44, s36
v_perm_b32 v9, v56, v52, s36
ds_write_b64 v0, v[8:9] offset:27648
s_waitcnt lgkmcnt(1)
v_perm_b32 v10, v48, v44, s37
v_perm_b32 v11, v56, v52, s37
ds_write_b64 v6, v[10:11] offset:56320
s_waitcnt lgkmcnt(1)
v_perm_b32 v8, v49, v45, s36
v_perm_b32 v9, v57, v53, s36
ds_write_b64 v6, v[8:9] offset:17408
s_waitcnt lgkmcnt(1)
v_perm_b32 v10, v49, v45, s37
v_perm_b32 v11, v57, v53, s37
ds_write_b64 v0, v[10:11] offset:44032
s_waitcnt lgkmcnt(1)
v_perm_b32 v8, v50, v46, s36
v_perm_b32 v9, v58, v54, s36
ds_write_b64 v7, v[8:9] offset:7168
s_waitcnt lgkmcnt(1)
v_perm_b32 v10, v50, v46, s37
v_perm_b32 v11, v58, v54, s37
ds_write_b64 v6, v[10:11] offset:33792
s_waitcnt lgkmcnt(1)
v_perm_b32 v8, v51, v47, s36
v_perm_b32 v9, v59, v55, s36
ds_write_b64 v0, v[8:9] offset:60416
s_waitcnt lgkmcnt(1)
v_perm_b32 v10, v51, v47, s37
v_perm_b32 v11, v59, v55, s37
ds_write_b64 v7, v[10:11] offset:23552
s_waitcnt lgkmcnt(1)
v_perm_b32 v8, v61, v60, s36
v_perm_b32 v9, v63, v62, s36
ds_write_b64 v6, v[8:9] offset:50176
s_waitcnt lgkmcnt(1)
s_waitcnt lgkmcnt(0)
s_waitcnt vmcnt(0)
v_perm_b32 v8, v16, v12, s36
v_perm_b32 v9, v24, v20, s36
ds_write_b64 v0, v[8:9] offset:27656
s_waitcnt lgkmcnt(1)
v_perm_b32 v10, v16, v12, s37
v_perm_b32 v11, v24, v20, s37
ds_write_b64 v6, v[10:11] offset:56328
s_waitcnt lgkmcnt(1)
v_perm_b32 v8, v17, v13, s36
v_perm_b32 v9, v25, v21, s36
ds_write_b64 v6, v[8:9] offset:17416
s_waitcnt lgkmcnt(1)
v_perm_b32 v10, v17, v13, s37
v_perm_b32 v11, v25, v21, s37
ds_write_b64 v0, v[10:11] offset:44040
s_waitcnt lgkmcnt(1)
v_perm_b32 v8, v18, v14, s36
v_perm_b32 v9, v26, v22, s36
ds_write_b64 v7, v[8:9] offset:7176
s_waitcnt lgkmcnt(1)
v_perm_b32 v10, v18, v14, s37
v_perm_b32 v11, v26, v22, s37
ds_write_b64 v6, v[10:11] offset:33800
s_waitcnt lgkmcnt(1)
v_perm_b32 v8, v19, v15, s36
v_perm_b32 v9, v27, v23, s36
ds_write_b64 v0, v[8:9] offset:60424
s_waitcnt lgkmcnt(1)
v_perm_b32 v10, v19, v15, s37
v_perm_b32 v11, v27, v23, s37
ds_write_b64 v7, v[10:11] offset:23560
s_waitcnt lgkmcnt(1)
v_perm_b32 v8, v29, v28, s36
v_perm_b32 v9, v31, v30, s36
ds_write_b64 v6, v[8:9] offset:50184
s_waitcnt lgkmcnt(1)
s_waitcnt lgkmcnt(0)
s_branch Lc_wo4sc1
Lc_wo2sc1:
s_cmp_eq_u32 s16, 2
s_cbranch_scc0 Lc_wo3sc1
s_waitcnt vmcnt(16)
v_perm_b32 v8, v48, v44, s36
v_perm_b32 v9, v56, v52, s36
ds_write_b64 v0, v[8:9] offset:2048
s_waitcnt lgkmcnt(1)
v_perm_b32 v10, v48, v44, s37
v_perm_b32 v11, v56, v52, s37
ds_write_b64 v0, v[10:11] offset:28672
s_waitcnt lgkmcnt(1)
v_perm_b32 v8, v49, v45, s36
v_perm_b32 v9, v57, v53, s36
ds_write_b64 v6, v[8:9] offset:57344
s_waitcnt lgkmcnt(1)
v_perm_b32 v10, v49, v45, s37
v_perm_b32 v11, v57, v53, s37
ds_write_b64 v6, v[10:11] offset:18432
s_waitcnt lgkmcnt(1)
v_perm_b32 v8, v50, v46, s36
v_perm_b32 v9, v58, v54, s36
ds_write_b64 v0, v[8:9] offset:45056
s_waitcnt lgkmcnt(1)
v_perm_b32 v10, v50, v46, s37
v_perm_b32 v11, v58, v54, s37
ds_write_b64 v7, v[10:11] offset:8192
s_waitcnt lgkmcnt(1)
v_perm_b32 v8, v51, v47, s36
v_perm_b32 v9, v59, v55, s36
ds_write_b64 v6, v[8:9] offset:34816
s_waitcnt lgkmcnt(1)
v_perm_b32 v10, v51, v47, s37
v_perm_b32 v11, v59, v55, s37
ds_write_b64 v0, v[10:11] offset:61440
s_waitcnt lgkmcnt(1)
v_perm_b32 v8, v61, v60, s36
v_perm_b32 v9, v63, v62, s36
ds_write_b64 v7, v[8:9] offset:24576
s_waitcnt lgkmcnt(1)
s_waitcnt lgkmcnt(0)
s_add_u32 s19, s60, 55296
buffer_load_dwordx4 v[44:47], v1, s[56:59], s19 offen
buffer_load_ushort v60, v2, s[56:59], s19 offen
s_add_u32 s19, s60, 56448
buffer_load_dwordx4 v[48:51], v1, s[56:59], s19 offen
buffer_load_ushort v61, v2, s[56:59], s19 offen
s_add_u32 s19, s60, 57600
buffer_load_dwordx4 v[52:55], v1, s[56:59], s19 offen
buffer_load_ushort v62, v2, s[56:59], s19 offen
s_add_u32 s19, s60, 58752
buffer_load_dwordx4 v[56:59], v1, s[56:59], s19 offen
buffer_load_ushort v63, v2, s[56:59], s19 offen
s_waitcnt vmcnt(16)
v_perm_b32 v8, v16, v12, s36
v_perm_b32 v9, v24, v20, s36
ds_write_b64 v0, v[8:9] offset:2056
s_waitcnt lgkmcnt(1)
v_perm_b32 v10, v16, v12, s37
v_perm_b32 v11, v24, v20, s37
ds_write_b64 v0, v[10:11] offset:28680
s_waitcnt lgkmcnt(1)
v_perm_b32 v8, v17, v13, s36
v_perm_b32 v9, v25, v21, s36
ds_write_b64 v6, v[8:9] offset:57352
s_waitcnt lgkmcnt(1)
v_perm_b32 v10, v17, v13, s37
v_perm_b32 v11, v25, v21, s37
ds_write_b64 v6, v[10:11] offset:18440
s_waitcnt lgkmcnt(1)
v_perm_b32 v8, v18, v14, s36
v_perm_b32 v9, v26, v22, s36
ds_write_b64 v0, v[8:9] offset:45064
s_waitcnt lgkmcnt(1)
v_perm_b32 v10, v18, v14, s37
v_perm_b32 v11, v26, v22, s37
ds_write_b64 v7, v[10:11] offset:8200
s_waitcnt lgkmcnt(1)
v_perm_b32 v8, v19, v15, s36
v_perm_b32 v9, v27, v23, s36
ds_write_b64 v6, v[8:9] offset:34824
s_waitcnt lgkmcnt(1)
v_perm_b32 v10, v19, v15, s37
v_perm_b32 v11, v27, v23, s37
ds_write_b64 v0, v[10:11] offset:61448
s_waitcnt lgkmcnt(1)
v_perm_b32 v8, v29, v28, s36
v_perm_b32 v9, v31, v30, s36
ds_write_b64 v7, v[8:9] offset:24584
s_waitcnt lgkmcnt(1)
s_waitcnt lgkmcnt(0)
s_add_u32 s19, s60, 73728
buffer_load_dwordx4 v[12:15], v4, s[56:59], s19 offen
buffer_load_ushort v28, v5, s[56:59], s19 offen
s_add_u32 s19, s60, 74880
buffer_load_dwordx4 v[16:19], v4, s[56:59], s19 offen
buffer_load_ushort v29, v5, s[56:59], s19 offen
s_add_u32 s19, s60, 92160
buffer_load_dwordx4 v[20:23], v4, s[56:59], s19 offen
buffer_load_ushort v30, v5, s[56:59], s19 offen
s_add_u32 s19, s60, 93312
buffer_load_dwordx4 v[24:27], v4, s[56:59], s19 offen
buffer_load_ushort v31, v5, s[56:59], s19 offen
s_waitcnt vmcnt(16)
v_perm_b32 v8, v36, v32, s36
v_perm_b32 v9, v64, v40, s36
ds_write_b64 v0, v[8:9] offset:3072
s_waitcnt lgkmcnt(1)
v_perm_b32 v10, v36, v32, s37
v_perm_b32 v11, v64, v40, s37
ds_write_b64 v0, v[10:11] offset:29696
s_waitcnt lgkmcnt(1)
v_perm_b32 v8, v37, v33, s36
v_perm_b32 v9, v65, v41, s36
ds_write_b64 v6, v[8:9] offset:58368
s_waitcnt lgkmcnt(1)
v_perm_b32 v10, v37, v33, s37
v_perm_b32 v11, v65, v41, s37
ds_write_b64 v6, v[10:11] offset:19456
s_waitcnt lgkmcnt(1)
v_perm_b32 v8, v38, v34, s36
v_perm_b32 v9, v66, v42, s36
ds_write_b64 v0, v[8:9] offset:46080
s_waitcnt lgkmcnt(1)
v_perm_b32 v10, v38, v34, s37
v_perm_b32 v11, v66, v42, s37
ds_write_b64 v7, v[10:11] offset:9216
s_waitcnt lgkmcnt(1)
v_perm_b32 v8, v39, v35, s36
v_perm_b32 v9, v67, v43, s36
ds_write_b64 v6, v[8:9] offset:35840
s_waitcnt lgkmcnt(1)
v_perm_b32 v10, v39, v35, s37
v_perm_b32 v11, v67, v43, s37
ds_write_b64 v0, v[10:11] offset:62464
s_waitcnt lgkmcnt(1)
v_perm_b32 v8, v69, v68, s36
v_perm_b32 v9, v71, v70, s36
ds_write_b64 v7, v[8:9] offset:25600
s_waitcnt lgkmcnt(1)
s_waitcnt lgkmcnt(0)
s_add_u32 s19, s60, 76032
buffer_load_dwordx4 v[32:35], v4, s[56:59], s19 offen
buffer_load_ushort v68, v5, s[56:59], s19 offen
s_add_u32 s19, s60, 77184
buffer_load_dwordx4 v[36:39], v4, s[56:59], s19 offen
buffer_load_ushort v69, v5, s[56:59], s19 offen
s_add_u32 s19, s60, 94464
buffer_load_dwordx4 v[40:43], v4, s[56:59], s19 offen
buffer_load_ushort v70, v5, s[56:59], s19 offen
s_add_u32 s19, s60, 95616
buffer_load_dwordx4 v[64:67], v4, s[56:59], s19 offen
buffer_load_ushort v71, v5, s[56:59], s19 offen
s_waitcnt vmcnt(16)
v_perm_b32 v8, v48, v44, s36
v_perm_b32 v9, v56, v52, s36
ds_write_b64 v0, v[8:9] offset:3080
s_waitcnt lgkmcnt(1)
v_perm_b32 v10, v48, v44, s37
v_perm_b32 v11, v56, v52, s37
ds_write_b64 v0, v[10:11] offset:29704
s_waitcnt lgkmcnt(1)
v_perm_b32 v8, v49, v45, s36
v_perm_b32 v9, v57, v53, s36
ds_write_b64 v6, v[8:9] offset:58376
s_waitcnt lgkmcnt(1)
v_perm_b32 v10, v49, v45, s37
v_perm_b32 v11, v57, v53, s37
ds_write_b64 v6, v[10:11] offset:19464
s_waitcnt lgkmcnt(1)
v_perm_b32 v8, v50, v46, s36
v_perm_b32 v9, v58, v54, s36
ds_write_b64 v0, v[8:9] offset:46088
s_waitcnt lgkmcnt(1)
v_perm_b32 v10, v50, v46, s37
v_perm_b32 v11, v58, v54, s37
ds_write_b64 v7, v[10:11] offset:9224
s_waitcnt lgkmcnt(1)
v_perm_b32 v8, v51, v47, s36
v_perm_b32 v9, v59, v55, s36
ds_write_b64 v6, v[8:9] offset:35848
s_waitcnt lgkmcnt(1)
v_perm_b32 v10, v51, v47, s37
v_perm_b32 v11, v59, v55, s37
ds_write_b64 v0, v[10:11] offset:62472
s_waitcnt lgkmcnt(1)
v_perm_b32 v8, v61, v60, s36
v_perm_b32 v9, v63, v62, s36
ds_write_b64 v7, v[8:9] offset:25608
s_waitcnt lgkmcnt(1)
s_waitcnt lgkmcnt(0)
s_add_u32 s19, s60, 82944
buffer_load_dwordx4 v[44:47], v4, s[56:59], s19 offen
buffer_load_ushort v60, v5, s[56:59], s19 offen
s_add_u32 s19, s60, 84096
buffer_load_dwordx4 v[48:51], v4, s[56:59], s19 offen
buffer_load_ushort v61, v5, s[56:59], s19 offen
s_add_u32 s19, s60, 101376
buffer_load_dwordx4 v[52:55], v4, s[56:59], s19 offen
buffer_load_ushort v62, v5, s[56:59], s19 offen
s_add_u32 s19, s60, 102528
buffer_load_dwordx4 v[56:59], v4, s[56:59], s19 offen
buffer_load_ushort v63, v5, s[56:59], s19 offen
s_waitcnt vmcnt(16)
v_perm_b32 v8, v16, v12, s36
v_perm_b32 v9, v24, v20, s36
ds_write_b64 v6, v[8:9] offset:4096
s_waitcnt lgkmcnt(1)
v_perm_b32 v10, v16, v12, s37
v_perm_b32 v11, v24, v20, s37
ds_write_b64 v0, v[10:11] offset:30720
s_waitcnt lgkmcnt(1)
v_perm_b32 v8, v17, v13, s36
v_perm_b32 v9, v25, v21, s36
ds_write_b64 v6, v[8:9] offset:59392
s_waitcnt lgkmcnt(1)
v_perm_b32 v10, v17, v13, s37
v_perm_b32 v11, v25, v21, s37
ds_write_b64 v6, v[10:11] offset:20480
s_waitcnt lgkmcnt(1)
v_perm_b32 v8, v18, v14, s36
v_perm_b32 v9, v26, v22, s36
ds_write_b64 v0, v[8:9] offset:47104
s_waitcnt lgkmcnt(1)
v_perm_b32 v10, v18, v14, s37
v_perm_b32 v11, v26, v22, s37
ds_write_b64 v7, v[10:11] offset:10240
s_waitcnt lgkmcnt(1)
v_perm_b32 v8, v19, v15, s36
v_perm_b32 v9, v27, v23, s36
ds_write_b64 v6, v[8:9] offset:36864
s_waitcnt lgkmcnt(1)
v_perm_b32 v10, v19, v15, s37
v_perm_b32 v11, v27, v23, s37
ds_write_b64 v0, v[10:11] offset:63488
s_waitcnt lgkmcnt(1)
v_perm_b32 v8, v29, v28, s36
v_perm_b32 v9, v31, v30, s36
ds_write_b64 v7, v[8:9] offset:26624
s_waitcnt lgkmcnt(1)
s_waitcnt lgkmcnt(0)
s_add_u32 s19, s60, 85248
buffer_load_dwordx4 v[12:15], v4, s[56:59], s19 offen
buffer_load_ushort v28, v5, s[56:59], s19 offen
s_add_u32 s19, s60, 86400
buffer_load_dwordx4 v[16:19], v4, s[56:59], s19 offen
buffer_load_ushort v29, v5, s[56:59], s19 offen
s_add_u32 s19, s60, 103680
buffer_load_dwordx4 v[20:23], v4, s[56:59], s19 offen
buffer_load_ushort v30, v5, s[56:59], s19 offen
s_add_u32 s19, s60, 104832
buffer_load_dwordx4 v[24:27], v4, s[56:59], s19 offen
buffer_load_ushort v31, v5, s[56:59], s19 offen
s_waitcnt vmcnt(16)
v_perm_b32 v8, v36, v32, s36
v_perm_b32 v9, v64, v40, s36
ds_write_b64 v6, v[8:9] offset:4104
s_waitcnt lgkmcnt(1)
v_perm_b32 v10, v36, v32, s37
v_perm_b32 v11, v64, v40, s37
ds_write_b64 v0, v[10:11] offset:30728
s_waitcnt lgkmcnt(1)
v_perm_b32 v8, v37, v33, s36
v_perm_b32 v9, v65, v41, s36
ds_write_b64 v6, v[8:9] offset:59400
s_waitcnt lgkmcnt(1)
v_perm_b32 v10, v37, v33, s37
v_perm_b32 v11, v65, v41, s37
ds_write_b64 v6, v[10:11] offset:20488
s_waitcnt lgkmcnt(1)
v_perm_b32 v8, v38, v34, s36
v_perm_b32 v9, v66, v42, s36
ds_write_b64 v0, v[8:9] offset:47112
s_waitcnt lgkmcnt(1)
v_perm_b32 v10, v38, v34, s37
v_perm_b32 v11, v66, v42, s37
ds_write_b64 v7, v[10:11] offset:10248
s_waitcnt lgkmcnt(1)
v_perm_b32 v8, v39, v35, s36
v_perm_b32 v9, v67, v43, s36
ds_write_b64 v6, v[8:9] offset:36872
s_waitcnt lgkmcnt(1)
v_perm_b32 v10, v39, v35, s37
v_perm_b32 v11, v67, v43, s37
ds_write_b64 v0, v[10:11] offset:63496
s_waitcnt lgkmcnt(1)
v_perm_b32 v8, v69, v68, s36
v_perm_b32 v9, v71, v70, s36
ds_write_b64 v7, v[8:9] offset:26632
s_waitcnt lgkmcnt(1)
s_waitcnt lgkmcnt(0)
s_waitcnt vmcnt(8)
v_perm_b32 v8, v48, v44, s36
v_perm_b32 v9, v56, v52, s36
ds_write_b64 v6, v[8:9] offset:5120
s_waitcnt lgkmcnt(1)
v_perm_b32 v10, v48, v44, s37
v_perm_b32 v11, v56, v52, s37
ds_write_b64 v0, v[10:11] offset:31744
s_waitcnt lgkmcnt(1)
v_perm_b32 v8, v49, v45, s36
v_perm_b32 v9, v57, v53, s36
ds_write_b64 v6, v[8:9] offset:60416
s_waitcnt lgkmcnt(1)
v_perm_b32 v10, v49, v45, s37
v_perm_b32 v11, v57, v53, s37
ds_write_b64 v6, v[10:11] offset:21504
s_waitcnt lgkmcnt(1)
v_perm_b32 v8, v50, v46, s36
v_perm_b32 v9, v58, v54, s36
ds_write_b64 v0, v[8:9] offset:48128
s_waitcnt lgkmcnt(1)
v_perm_b32 v10, v50, v46, s37
v_perm_b32 v11, v58, v54, s37
ds_write_b64 v7, v[10:11] offset:11264
s_waitcnt lgkmcnt(1)
v_perm_b32 v8, v51, v47, s36
v_perm_b32 v9, v59, v55, s36
ds_write_b64 v6, v[8:9] offset:37888
s_waitcnt lgkmcnt(1)
v_perm_b32 v10, v51, v47, s37
v_perm_b32 v11, v59, v55, s37
ds_write_b64 v0, v[10:11] offset:64512
s_waitcnt lgkmcnt(1)
v_perm_b32 v8, v61, v60, s36
v_perm_b32 v9, v63, v62, s36
ds_write_b64 v7, v[8:9] offset:27648
s_waitcnt lgkmcnt(1)
s_waitcnt lgkmcnt(0)
s_waitcnt vmcnt(0)
v_perm_b32 v8, v16, v12, s36
v_perm_b32 v9, v24, v20, s36
ds_write_b64 v6, v[8:9] offset:5128
s_waitcnt lgkmcnt(1)
v_perm_b32 v10, v16, v12, s37
v_perm_b32 v11, v24, v20, s37
ds_write_b64 v0, v[10:11] offset:31752
s_waitcnt lgkmcnt(1)
v_perm_b32 v8, v17, v13, s36
v_perm_b32 v9, v25, v21, s36
ds_write_b64 v6, v[8:9] offset:60424
s_waitcnt lgkmcnt(1)
v_perm_b32 v10, v17, v13, s37
v_perm_b32 v11, v25, v21, s37
ds_write_b64 v6, v[10:11] offset:21512
s_waitcnt lgkmcnt(1)
v_perm_b32 v8, v18, v14, s36
v_perm_b32 v9, v26, v22, s36
ds_write_b64 v0, v[8:9] offset:48136
s_waitcnt lgkmcnt(1)
v_perm_b32 v10, v18, v14, s37
v_perm_b32 v11, v26, v22, s37
ds_write_b64 v7, v[10:11] offset:11272
s_waitcnt lgkmcnt(1)
v_perm_b32 v8, v19, v15, s36
v_perm_b32 v9, v27, v23, s36
ds_write_b64 v6, v[8:9] offset:37896
s_waitcnt lgkmcnt(1)
v_perm_b32 v10, v19, v15, s37
v_perm_b32 v11, v27, v23, s37
ds_write_b64 v0, v[10:11] offset:64520
s_waitcnt lgkmcnt(1)
v_perm_b32 v8, v29, v28, s36
v_perm_b32 v9, v31, v30, s36
ds_write_b64 v7, v[8:9] offset:27656
s_waitcnt lgkmcnt(1)
s_waitcnt lgkmcnt(0)
s_branch Lc_wo4sc1
Lc_wo3sc1:
s_waitcnt vmcnt(16)
v_perm_b32 v8, v48, v44, s36
v_perm_b32 v9, v56, v52, s36
ds_write_b64 v6, v[8:9] offset:6144
s_waitcnt lgkmcnt(1)
v_perm_b32 v10, v48, v44, s37
v_perm_b32 v11, v56, v52, s37
ds_write_b64 v0, v[10:11] offset:32768
s_waitcnt lgkmcnt(1)
v_perm_b32 v8, v49, v45, s36
v_perm_b32 v9, v57, v53, s36
ds_write_b64 v6, v[8:9] offset:61440
s_waitcnt lgkmcnt(1)
v_perm_b32 v10, v49, v45, s37
v_perm_b32 v11, v57, v53, s37
ds_write_b64 v6, v[10:11] offset:22528
s_waitcnt lgkmcnt(1)
v_perm_b32 v8, v50, v46, s36
v_perm_b32 v9, v58, v54, s36
ds_write_b64 v0, v[8:9] offset:49152
s_waitcnt lgkmcnt(1)
v_perm_b32 v10, v50, v46, s37
v_perm_b32 v11, v58, v54, s37
ds_write_b64 v7, v[10:11] offset:12288
s_waitcnt lgkmcnt(1)
v_perm_b32 v8, v51, v47, s36
v_perm_b32 v9, v59, v55, s36
ds_write_b64 v6, v[8:9] offset:38912
s_waitcnt lgkmcnt(1)
v_perm_b32 v10, v51, v47, s37
v_perm_b32 v11, v59, v55, s37
ds_write_b64 v6, v[10:11]
s_waitcnt lgkmcnt(1)
v_perm_b32 v8, v61, v60, s36
v_perm_b32 v9, v63, v62, s36
ds_write_b64 v7, v[8:9] offset:28672
s_waitcnt lgkmcnt(1)
s_waitcnt lgkmcnt(0)
s_add_u32 s19, s60, 55296
buffer_load_dwordx4 v[44:47], v1, s[56:59], s19 offen
buffer_load_ushort v60, v2, s[56:59], s19 offen
s_add_u32 s19, s60, 56448
buffer_load_dwordx4 v[48:51], v1, s[56:59], s19 offen
buffer_load_ushort v61, v2, s[56:59], s19 offen
s_add_u32 s19, s60, 57600
buffer_load_dwordx4 v[52:55], v1, s[56:59], s19 offen
buffer_load_ushort v62, v2, s[56:59], s19 offen
s_add_u32 s19, s60, 58752
buffer_load_dwordx4 v[56:59], v1, s[56:59], s19 offen
buffer_load_ushort v63, v2, s[56:59], s19 offen
s_waitcnt vmcnt(16)
v_perm_b32 v8, v16, v12, s36
v_perm_b32 v9, v24, v20, s36
ds_write_b64 v6, v[8:9] offset:6152
s_waitcnt lgkmcnt(1)
v_perm_b32 v10, v16, v12, s37
v_perm_b32 v11, v24, v20, s37
ds_write_b64 v0, v[10:11] offset:32776
s_waitcnt lgkmcnt(1)
v_perm_b32 v8, v17, v13, s36
v_perm_b32 v9, v25, v21, s36
ds_write_b64 v6, v[8:9] offset:61448
s_waitcnt lgkmcnt(1)
v_perm_b32 v10, v17, v13, s37
v_perm_b32 v11, v25, v21, s37
ds_write_b64 v6, v[10:11] offset:22536
s_waitcnt lgkmcnt(1)
v_perm_b32 v8, v18, v14, s36
v_perm_b32 v9, v26, v22, s36
ds_write_b64 v0, v[8:9] offset:49160
s_waitcnt lgkmcnt(1)
v_perm_b32 v10, v18, v14, s37
v_perm_b32 v11, v26, v22, s37
ds_write_b64 v7, v[10:11] offset:12296
s_waitcnt lgkmcnt(1)
v_perm_b32 v8, v19, v15, s36
v_perm_b32 v9, v27, v23, s36
ds_write_b64 v6, v[8:9] offset:38920
s_waitcnt lgkmcnt(1)
v_perm_b32 v10, v19, v15, s37
v_perm_b32 v11, v27, v23, s37
ds_write_b64 v6, v[10:11] offset:8
s_waitcnt lgkmcnt(1)
v_perm_b32 v8, v29, v28, s36
v_perm_b32 v9, v31, v30, s36
ds_write_b64 v7, v[8:9] offset:28680
s_waitcnt lgkmcnt(1)
s_waitcnt lgkmcnt(0)
s_add_u32 s19, s60, 73728
buffer_load_dwordx4 v[12:15], v4, s[56:59], s19 offen
buffer_load_ushort v28, v5, s[56:59], s19 offen
s_add_u32 s19, s60, 74880
buffer_load_dwordx4 v[16:19], v4, s[56:59], s19 offen
buffer_load_ushort v29, v5, s[56:59], s19 offen
s_add_u32 s19, s60, 92160
buffer_load_dwordx4 v[20:23], v4, s[56:59], s19 offen
buffer_load_ushort v30, v5, s[56:59], s19 offen
s_add_u32 s19, s60, 93312
buffer_load_dwordx4 v[24:27], v4, s[56:59], s19 offen
buffer_load_ushort v31, v5, s[56:59], s19 offen
s_waitcnt vmcnt(16)
v_perm_b32 v8, v36, v32, s36
v_perm_b32 v9, v64, v40, s36
ds_write_b64 v6, v[8:9] offset:7168
s_waitcnt lgkmcnt(1)
v_perm_b32 v10, v36, v32, s37
v_perm_b32 v11, v64, v40, s37
ds_write_b64 v0, v[10:11] offset:33792
s_waitcnt lgkmcnt(1)
v_perm_b32 v8, v37, v33, s36
v_perm_b32 v9, v65, v41, s36
ds_write_b64 v6, v[8:9] offset:62464
s_waitcnt lgkmcnt(1)
v_perm_b32 v10, v37, v33, s37
v_perm_b32 v11, v65, v41, s37
ds_write_b64 v6, v[10:11] offset:23552
s_waitcnt lgkmcnt(1)
v_perm_b32 v8, v38, v34, s36
v_perm_b32 v9, v66, v42, s36
ds_write_b64 v0, v[8:9] offset:50176
s_waitcnt lgkmcnt(1)
v_perm_b32 v10, v38, v34, s37
v_perm_b32 v11, v66, v42, s37
ds_write_b64 v7, v[10:11] offset:13312
s_waitcnt lgkmcnt(1)
v_perm_b32 v8, v39, v35, s36
v_perm_b32 v9, v67, v43, s36
ds_write_b64 v6, v[8:9] offset:39936
s_waitcnt lgkmcnt(1)
v_perm_b32 v10, v39, v35, s37
v_perm_b32 v11, v67, v43, s37
ds_write_b64 v6, v[10:11] offset:1024
s_waitcnt lgkmcnt(1)
v_perm_b32 v8, v69, v68, s36
v_perm_b32 v9, v71, v70, s36
ds_write_b64 v7, v[8:9] offset:29696
s_waitcnt lgkmcnt(1)
s_waitcnt lgkmcnt(0)
s_add_u32 s19, s60, 76032
buffer_load_dwordx4 v[32:35], v4, s[56:59], s19 offen
buffer_load_ushort v68, v5, s[56:59], s19 offen
s_add_u32 s19, s60, 77184
buffer_load_dwordx4 v[36:39], v4, s[56:59], s19 offen
buffer_load_ushort v69, v5, s[56:59], s19 offen
s_add_u32 s19, s60, 94464
buffer_load_dwordx4 v[40:43], v4, s[56:59], s19 offen
buffer_load_ushort v70, v5, s[56:59], s19 offen
s_add_u32 s19, s60, 95616
buffer_load_dwordx4 v[64:67], v4, s[56:59], s19 offen
buffer_load_ushort v71, v5, s[56:59], s19 offen
s_waitcnt vmcnt(16)
v_perm_b32 v8, v48, v44, s36
v_perm_b32 v9, v56, v52, s36
ds_write_b64 v6, v[8:9] offset:7176
s_waitcnt lgkmcnt(1)
v_perm_b32 v10, v48, v44, s37
v_perm_b32 v11, v56, v52, s37
ds_write_b64 v0, v[10:11] offset:33800
s_waitcnt lgkmcnt(1)
v_perm_b32 v8, v49, v45, s36
v_perm_b32 v9, v57, v53, s36
ds_write_b64 v6, v[8:9] offset:62472
s_waitcnt lgkmcnt(1)
v_perm_b32 v10, v49, v45, s37
v_perm_b32 v11, v57, v53, s37
ds_write_b64 v6, v[10:11] offset:23560
s_waitcnt lgkmcnt(1)
v_perm_b32 v8, v50, v46, s36
v_perm_b32 v9, v58, v54, s36
ds_write_b64 v0, v[8:9] offset:50184
s_waitcnt lgkmcnt(1)
v_perm_b32 v10, v50, v46, s37
v_perm_b32 v11, v58, v54, s37
ds_write_b64 v7, v[10:11] offset:13320
s_waitcnt lgkmcnt(1)
v_perm_b32 v8, v51, v47, s36
v_perm_b32 v9, v59, v55, s36
ds_write_b64 v6, v[8:9] offset:39944
s_waitcnt lgkmcnt(1)
v_perm_b32 v10, v51, v47, s37
v_perm_b32 v11, v59, v55, s37
ds_write_b64 v6, v[10:11] offset:1032
s_waitcnt lgkmcnt(1)
v_perm_b32 v8, v61, v60, s36
v_perm_b32 v9, v63, v62, s36
ds_write_b64 v7, v[8:9] offset:29704
s_waitcnt lgkmcnt(1)
s_waitcnt lgkmcnt(0)
s_add_u32 s19, s60, 82944
buffer_load_dwordx4 v[44:47], v4, s[56:59], s19 offen
buffer_load_ushort v60, v5, s[56:59], s19 offen
s_add_u32 s19, s60, 84096
buffer_load_dwordx4 v[48:51], v4, s[56:59], s19 offen
buffer_load_ushort v61, v5, s[56:59], s19 offen
s_add_u32 s19, s60, 101376
buffer_load_dwordx4 v[52:55], v4, s[56:59], s19 offen
buffer_load_ushort v62, v5, s[56:59], s19 offen
s_add_u32 s19, s60, 102528
buffer_load_dwordx4 v[56:59], v4, s[56:59], s19 offen
buffer_load_ushort v63, v5, s[56:59], s19 offen
s_waitcnt vmcnt(16)
v_perm_b32 v8, v16, v12, s36
v_perm_b32 v9, v24, v20, s36
ds_write_b64 v6, v[8:9] offset:8192
s_waitcnt lgkmcnt(1)
v_perm_b32 v10, v16, v12, s37
v_perm_b32 v11, v24, v20, s37
ds_write_b64 v0, v[10:11] offset:34816
s_waitcnt lgkmcnt(1)
v_perm_b32 v8, v17, v13, s36
v_perm_b32 v9, v25, v21, s36
ds_write_b64 v6, v[8:9] offset:63488
s_waitcnt lgkmcnt(1)
v_perm_b32 v10, v17, v13, s37
v_perm_b32 v11, v25, v21, s37
ds_write_b64 v6, v[10:11] offset:24576
s_waitcnt lgkmcnt(1)
v_perm_b32 v8, v18, v14, s36
v_perm_b32 v9, v26, v22, s36
ds_write_b64 v0, v[8:9] offset:51200
s_waitcnt lgkmcnt(1)
v_perm_b32 v10, v18, v14, s37
v_perm_b32 v11, v26, v22, s37
ds_write_b64 v7, v[10:11] offset:14336
s_waitcnt lgkmcnt(1)
v_perm_b32 v8, v19, v15, s36
v_perm_b32 v9, v27, v23, s36
ds_write_b64 v6, v[8:9] offset:40960
s_waitcnt lgkmcnt(1)
v_perm_b32 v10, v19, v15, s37
v_perm_b32 v11, v27, v23, s37
ds_write_b64 v6, v[10:11] offset:2048
s_waitcnt lgkmcnt(1)
v_perm_b32 v8, v29, v28, s36
v_perm_b32 v9, v31, v30, s36
ds_write_b64 v7, v[8:9] offset:30720
s_waitcnt lgkmcnt(1)
s_waitcnt lgkmcnt(0)
s_add_u32 s19, s60, 85248
buffer_load_dwordx4 v[12:15], v4, s[56:59], s19 offen
buffer_load_ushort v28, v5, s[56:59], s19 offen
s_add_u32 s19, s60, 86400
buffer_load_dwordx4 v[16:19], v4, s[56:59], s19 offen
buffer_load_ushort v29, v5, s[56:59], s19 offen
s_add_u32 s19, s60, 103680
buffer_load_dwordx4 v[20:23], v4, s[56:59], s19 offen
buffer_load_ushort v30, v5, s[56:59], s19 offen
s_add_u32 s19, s60, 104832
buffer_load_dwordx4 v[24:27], v4, s[56:59], s19 offen
buffer_load_ushort v31, v5, s[56:59], s19 offen
s_waitcnt vmcnt(16)
v_perm_b32 v8, v36, v32, s36
v_perm_b32 v9, v64, v40, s36
ds_write_b64 v6, v[8:9] offset:8200
s_waitcnt lgkmcnt(1)
v_perm_b32 v10, v36, v32, s37
v_perm_b32 v11, v64, v40, s37
ds_write_b64 v0, v[10:11] offset:34824
s_waitcnt lgkmcnt(1)
v_perm_b32 v8, v37, v33, s36
v_perm_b32 v9, v65, v41, s36
ds_write_b64 v6, v[8:9] offset:63496
s_waitcnt lgkmcnt(1)
v_perm_b32 v10, v37, v33, s37
v_perm_b32 v11, v65, v41, s37
ds_write_b64 v6, v[10:11] offset:24584
s_waitcnt lgkmcnt(1)
v_perm_b32 v8, v38, v34, s36
v_perm_b32 v9, v66, v42, s36
ds_write_b64 v0, v[8:9] offset:51208
s_waitcnt lgkmcnt(1)
v_perm_b32 v10, v38, v34, s37
v_perm_b32 v11, v66, v42, s37
ds_write_b64 v7, v[10:11] offset:14344
s_waitcnt lgkmcnt(1)
v_perm_b32 v8, v39, v35, s36
v_perm_b32 v9, v67, v43, s36
ds_write_b64 v6, v[8:9] offset:40968
s_waitcnt lgkmcnt(1)
v_perm_b32 v10, v39, v35, s37
v_perm_b32 v11, v67, v43, s37
ds_write_b64 v6, v[10:11] offset:2056
s_waitcnt lgkmcnt(1)
v_perm_b32 v8, v69, v68, s36
v_perm_b32 v9, v71, v70, s36
ds_write_b64 v7, v[8:9] offset:30728
s_waitcnt lgkmcnt(1)
s_waitcnt lgkmcnt(0)
s_waitcnt vmcnt(8)
v_perm_b32 v8, v48, v44, s36
v_perm_b32 v9, v56, v52, s36
ds_write_b64 v6, v[8:9] offset:9216
s_waitcnt lgkmcnt(1)
v_perm_b32 v10, v48, v44, s37
v_perm_b32 v11, v56, v52, s37
ds_write_b64 v0, v[10:11] offset:35840
s_waitcnt lgkmcnt(1)
v_perm_b32 v8, v49, v45, s36
v_perm_b32 v9, v57, v53, s36
ds_write_b64 v6, v[8:9] offset:64512
s_waitcnt lgkmcnt(1)
v_perm_b32 v10, v49, v45, s37
v_perm_b32 v11, v57, v53, s37
ds_write_b64 v6, v[10:11] offset:25600
s_waitcnt lgkmcnt(1)
v_perm_b32 v8, v50, v46, s36
v_perm_b32 v9, v58, v54, s36
ds_write_b64 v0, v[8:9] offset:52224
s_waitcnt lgkmcnt(1)
v_perm_b32 v10, v50, v46, s37
v_perm_b32 v11, v58, v54, s37
ds_write_b64 v7, v[10:11] offset:15360
s_waitcnt lgkmcnt(1)
v_perm_b32 v8, v51, v47, s36
v_perm_b32 v9, v59, v55, s36
ds_write_b64 v6, v[8:9] offset:41984
s_waitcnt lgkmcnt(1)
v_perm_b32 v10, v51, v47, s37
v_perm_b32 v11, v59, v55, s37
ds_write_b64 v6, v[10:11] offset:3072
s_waitcnt lgkmcnt(1)
v_perm_b32 v8, v61, v60, s36
v_perm_b32 v9, v63, v62, s36
ds_write_b64 v7, v[8:9] offset:31744
s_waitcnt lgkmcnt(1)
s_waitcnt lgkmcnt(0)
s_waitcnt vmcnt(0)
v_perm_b32 v8, v16, v12, s36
v_perm_b32 v9, v24, v20, s36
ds_write_b64 v6, v[8:9] offset:9224
s_waitcnt lgkmcnt(1)
v_perm_b32 v10, v16, v12, s37
v_perm_b32 v11, v24, v20, s37
ds_write_b64 v0, v[10:11] offset:35848
s_waitcnt lgkmcnt(1)
v_perm_b32 v8, v17, v13, s36
v_perm_b32 v9, v25, v21, s36
ds_write_b64 v6, v[8:9] offset:64520
s_waitcnt lgkmcnt(1)
v_perm_b32 v10, v17, v13, s37
v_perm_b32 v11, v25, v21, s37
ds_write_b64 v6, v[10:11] offset:25608
s_waitcnt lgkmcnt(1)
v_perm_b32 v8, v18, v14, s36
v_perm_b32 v9, v26, v22, s36
ds_write_b64 v0, v[8:9] offset:52232
s_waitcnt lgkmcnt(1)
v_perm_b32 v10, v18, v14, s37
v_perm_b32 v11, v26, v22, s37
ds_write_b64 v7, v[10:11] offset:15368
s_waitcnt lgkmcnt(1)
v_perm_b32 v8, v19, v15, s36
v_perm_b32 v9, v27, v23, s36
ds_write_b64 v6, v[8:9] offset:41992
s_waitcnt lgkmcnt(1)
v_perm_b32 v10, v19, v15, s37
v_perm_b32 v11, v27, v23, s37
ds_write_b64 v6, v[10:11] offset:3080
s_waitcnt lgkmcnt(1)
v_perm_b32 v8, v29, v28, s36
v_perm_b32 v9, v31, v30, s36
ds_write_b64 v7, v[8:9] offset:31752
s_waitcnt lgkmcnt(1)
s_waitcnt lgkmcnt(0)
Lc_wo4sc1:
s_barrier
v_mov_b32 v7, v78
s_mul_i32 s19, s16, 47104
s_cmp_eq_u32 s16, 3
s_cselect_b32 s19, 0, s19
s_add_u32 s19, s19, 22528
v_add_u32 v1, s19, v0
v_bfe_u32 v9, v0, 6, 2
v_lshlrev_b32 v9, 1, v9
v_bfe_u32 v10, v0, 4, 1
v_add_u32 v9, v9, v10
v_lshrrev_b32 v10, 8, v0
v_lshl_add_u32 v9, v10, 3, v9
v_lshlrev_b32 v9, 4, v9
v_bfe_u32 v10, v0, 5, 1
v_lshl_add_u32 v12, v10, 3, v9
s_cmp_eq_u32 s16, 3
s_cbranch_scc1 Lc_selsc1
s_lshl_b32 s19, s16, 11
v_add_u32 v8, s19, v0
ds_read_b128 v[72:75], v8
ds_read_b128 v[76:79], v8 offset:1024
v_mov_b32 v7, v12
s_waitcnt lgkmcnt(0)
s_branch Lc_seldsc1
Lc_selsc1:
v_mov_b32 v77, v12
v_bfe_u32 v9, v0, 4, 4
v_lshrrev_b32 v10, 2, v9
v_and_b32 v11, 1, v9
v_lshl_add_u32 v10, v11, 2, v10
v_and_b32 v11, 1, v10
v_lshlrev_b32 v11, 4, v11
v_mov_b32 v3, 0x3f80
v_lshlrev_b32 v11, v11, v3
v_and_b32 v9, 2, v9
v_cmp_eq_u32 vcc, 0, v9
s_nop 1
v_cndmask_b32 v11, 0, v11, vcc
v_lshrrev_b32 v10, 1, v10
v_cmp_eq_u32 vcc, 0, v10
s_nop 1
v_cndmask_b32 v72, 0, v11, vcc
v_cmp_eq_u32 vcc, 1, v10
s_nop 1
v_cndmask_b32 v73, 0, v11, vcc
v_cmp_eq_u32 vcc, 2, v10
s_nop 1
v_cndmask_b32 v74, 0, v11, vcc
v_cmp_eq_u32 vcc, 3, v10
s_nop 1
v_cndmask_b32 v75, 0, v11, vcc
Lc_seldsc1:
s_barrier
s_cmp_eq_u32 s16, 0
s_cbranch_scc0 Lc_noqsc1
s_mov_b64 exec, 1
v_mov_b32 v8, 68
v_mov_b32 v9, 1
global_atomic_add v8, v9, s[6:7]
s_mov_b64 exec, -1
Lc_noqsc1:
v_lshrrev_b32 v11, 8, v0
v_bfe_u32 v10, v0, 4, 4
v_mov_b32 v8, 0x4444
v_mov_b32 v9, 0xeeee
v_and_b32 v12, 2, v10
v_cmp_eq_u32 vcc, 0, v12
s_nop 1
v_cndmask_b32 v2, v9, v8, vcc
v_mov_b32 v8, 0x7f800000
v_cndmask_b32 v5, v8, 0, vcc
v_xor_b32 v8, v10, v11
v_lshlrev_b32 v8, 4, v8
v_lshl_add_u32 v4, v11, 8, v8
v_lshlrev_b32 v8, 3, v10
v_lshl_add_u32 v6, v11, 12, v8
s_and_b32 s19, s16, 2
s_xor_b32 s19, s19, 2
v_lshlrev_b32 v8, 2, v11
v_add_u32 v8, s19, v8
v_bfe_u32 v9, v10, 1, 2
v_xor_b32 v8, v8, v9
v_lshrrev_b32 v12, 3, v10
v_lshlrev_b32 v13, 2, v12
v_xor_b32 v8, v8, v13
v_lshlrev_b32 v8, 4, v8
v_lshl_add_u32 v8, v9, 8, v8
v_lshl_add_u32 v8, v12, 10, v8
v_and_b32 v9, 1, v10
v_lshl_add_u32 v8, v9, 3, v8
s_and_b32 s19, s16, 1
s_lshl_b32 s19, s19, 11
v_add_u32 v3, s19, v8
v_mov_b32 v8, 0x3f803f80
v_mov_b32 v9, 0x3f803f80
v_mov_b32 v10, 0x3f803f80
v_mov_b32 v11, 0x3f803f80
s_waitcnt lgkmcnt(0)
s_mov_b32 s18, 0
s_lshl_b32 s26, s17, 14
s_lshl_b32 s19, s16, 12
s_add_u32 s26, s26, s19
s_add_u32 s26, s26, 33554432
s_mov_b32 s27, 12648448
s_mov_b32 s22, 12582912
s_mov_b32 s23, 12592128
s_mov_b32 s33, 294912
s_mov_b32 s48, -1
s_mul_i32 s19, s16, 3
s_sub_u32 s96, s17, s19
s_lshl_b32 s20, s17, 10
s_add_u32 s27, s27, s20
s_lshl_b32 s20, s17, 2
s_cmp_lt_u32 s96, 3
s_cselect_b32 s20, s20, 0x40000000
s_add_u32 s38, s20, 262144
v_mov_b32 v48, 0
Lc_wci:
global_load_dword v49, v48, s[6:7] offset:192 sc1
s_waitcnt vmcnt(0)
v_cmp_gt_u32 vcc, 16, v49
s_cbranch_vccz Lc_wcoi
s_sleep 4
s_add_u32 s21, s21, 1
s_cmp_ge_u32 s21, 4194304
s_cbranch_scc1 L_abort
s_branch Lc_wci
Lc_wcoi:
s_lshl_b32 s35, s18, 10
s_lshl_b32 s19, s17, 5
s_add_u32 s35, s35, s19
s_add_u32 s35, s35, 0
v_bfe_u32 v48, v0, 4, 3
v_lshlrev_b32 v48, 2, v48
Lc_wkva:
buffer_load_dword v49, v48, s[8:11], s35 offen sc1
s_waitcnt vmcnt(0)
v_cmp_eq_u32 vcc, 0, v49
s_cbranch_vccz Lc_wkv_oka
s_sleep 4
s_add_u32 s21, s21, 1
s_cmp_ge_u32 s21, 4194304
s_cbranch_scc1 L_abort
s_branch Lc_wkva
Lc_wkv_oka:
s_lshl_b32 s19, s16, 12
s_mov_b32 m0, s19
s_nop 0
buffer_load_dwordx4 v0, s[8:11], s26 offen lds
buffer_load_dwordx4 v0, s[8:11], s26 offen offset:1024 lds
buffer_load_dwordx4 v0, s[8:11], s26 offen offset:2048 lds
buffer_load_dwordx4 v0, s[8:11], s26 offen offset:3072 lds
s_add_u32 s26, s26, 524288
s_mov_b32 s20, 1
s_lshl_b32 s35, s20, 10
s_lshl_b32 s19, s17, 5
s_add_u32 s35, s35, s19
s_add_u32 s35, s35, 0
v_bfe_u32 v48, v0, 4, 3
v_lshlrev_b32 v48, 2, v48
Lc_wkvb:
buffer_load_dword v49, v48, s[8:11], s35 offen sc1
s_waitcnt vmcnt(0)
v_cmp_eq_u32 vcc, 0, v49
s_cbranch_vccz Lc_wkv_okb
s_sleep 4
s_add_u32 s21, s21, 1
s_cmp_ge_u32 s21, 4194304
s_cbranch_scc1 L_abort
s_branch Lc_wkvb
Lc_wkv_okb:
v_lshlrev_b32 v50, 2, v0
buffer_load_dword v51, v50, s[8:11], s26 offen
s_lshl_b32 s19, s16, 12
s_sub_u32 s26, s26, s19
s_mov_b32 s39, s26
s_mov_b32 s97, 1048576
s_add_u32 s35, s35, 2048
v_mov_b32 v48, 0
Lc_wcs:
global_load_dword v49, v48, s[6:7] offset:64 sc1
s_waitcnt vmcnt(0)
v_cmp_gt_u32 vcc, 32, v49
s_cbranch_vccz Lc_wcos
s_sleep 4
s_add_u32 s21, s21, 1
s_cmp_ge_u32 s21, 4194304
s_cbranch_scc1 L_abort
s_branch Lc_wcs
Lc_wcos:
global_load_dword v49, v48, s[6:7] offset:32 sc1
s_waitcnt vmcnt(0)
v_readfirstlane_b32 s98, v49
s_lshl_b32 s19, s16, 10
s_add_u32 s20, s19, 16384
s_mov_b32 m0, s20
s_add_u32 s19, s19, 12582912
buffer_load_dwordx4 v0, s[8:11], s19 offen sc1 lds
s_mov_b32 m0, 16384
s_waitcnt vmcnt(0)
s_barrier
v_mov_b64 v[48:49], 0
v_mov_b64 v[50:51], 0
v_mov_b64 v[52:53], 0
v_mov_b64 v[54:55], 0
v_mov_b64 v[56:57], 0
v_mov_b64 v[58:59], 0
v_mov_b64 v[60:61], 0
v_mov_b64 v[62:63], 0
v_mov_b64 v[64:65], 0
v_mov_b64 v[66:67], 0
v_mov_b64 v[68:69], 0
v_mov_b64 v[70:71], 0
s_add_u32 s51, s22, 4096
s_add_u32 s52, s22, 8192
s_add_u32 s55, s34, 12601344
s_cmp_eq_u32 s16, 2
s_cselect_b32 s74, 14, 14
s_mov_b32 s75, 1
s_cmp_eq_u32 s16, 3
s_cbranch_scc0 Lc_go
v_mov_b32 v79, -1
s_lshr_b32 s19, s17, 2
s_lshl_b32 s19, s19, 2
s_lshr_b32 s19, 2286174208, s19
s_and_b32 s19, s19, 15
s_add_u32 s74, s19, 17
Lc_go:
s_cmp_eq_u32 s98, 0
s_cbranch_scc0 Lc_gosc1
Lc_gox:
s_cmp_eq_u32 s16, 0
s_cbranch_scc1 Lc_top0
s_cmp_eq_u32 s16, 1
s_cbranch_scc1 Lc_top1
s_cmp_eq_u32 s16, 2
s_cbranch_scc1 Lc_top2
s_cmp_lt_u32 s17, 8
s_cbranch_scc1 Lc_top3c
s_branch Lc_top3b
.p2align 6
s_nop 0
s_nop 0
Lc_top0:
buffer_load_dwordx4 v0, s[8:11], s22 offen sc1 lds
ds_read_b128 v[12:15], v0 offset:16384
ds_read_b128 v[16:19], v0 offset:17408
s_add_u32 s21, s21, 1
s_cmp_ge_u32 s21, 4194304
s_cbranch_scc1 L_abort
s_waitcnt lgkmcnt(0)
v_max_u32 v43, v12, v16
v_cmp_eq_u32 vcc, -1, v43
s_cbranch_vccnz Lc_top0
v_smfmac_f32_16x16x64_bf16 v[48:51], v[12:15], a[0:7], v2
v_smfmac_f32_16x16x64_bf16 v[52:55], v[12:15], a[8:15], v2
v_smfmac_f32_16x16x64_bf16 v[56:59], v[12:15], a[16:23], v2
buffer_load_dwordx4 v[28:31], v0, s[8:11], s51 offen sc1
v_smfmac_f32_16x16x64_bf16 v[60:63], v[12:15], a[24:31], v2
v_smfmac_f32_16x16x64_bf16 v[64:67], v[12:15], v[80:87], v2
ds_read_b128 v[20:23], v0 offset:18432
v_smfmac_f32_16x16x64_bf16 v[68:71], v[12:15], v[88:95], v2
v_smfmac_f32_16x16x64_bf16 v[48:51], v[16:19], a[32:39], v2
buffer_load_dwordx4 v[32:35], v0, s[8:11], s51 offen offset:1024 sc1
v_smfmac_f32_16x16x64_bf16 v[52:55], v[16:19], a[40:47], v2
v_smfmac_f32_16x16x64_bf16 v[56:59], v[16:19], a[48:55], v2
v_smfmac_f32_16x16x64_bf16 v[60:63], v[16:19], a[56:63], v2
ds_read_b128 v[24:27], v0 offset:19456
s_waitcnt lgkmcnt(1)
v_cmp_eq_u32 vcc, -1, v20
v_smfmac_f32_16x16x64_bf16 v[64:67], v[16:19], v[96:103], v2
buffer_load_dwordx4 v[36:39], v0, s[8:11], s51 offen offset:2048 sc1
v_smfmac_f32_16x16x64_bf16 v[68:71], v[16:19], v[104:111], v2
s_cbranch_vccnz Lc_retry20
Lc_back20:
v_smfmac_f32_16x16x64_bf16 v[48:51], v[20:23], a[64:71], v2
v_smfmac_f32_16x16x64_bf16 v[52:55], v[20:23], a[72:79], v2
v_smfmac_f32_16x16x64_bf16 v[56:59], v[20:23], a[80:87], v2
buffer_load_dwordx4 v[40:43], v0, s[8:11], s51 offen offset:3072 sc1
v_smfmac_f32_16x16x64_bf16 v[60:63], v[20:23], a[88:95], v2
s_waitcnt lgkmcnt(0)
v_cmp_eq_u32 vcc, -1, v24
v_smfmac_f32_16x16x64_bf16 v[64:67], v[20:23], v[112:119], v2
v_smfmac_f32_16x16x64_bf16 v[68:71], v[20:23], v[120:127], v2
buffer_load_dwordx4 v[44:47], v0, s[8:11], s52 offen sc1
s_cbranch_vccnz Lc_retry30
Lc_back30:
v_smfmac_f32_16x16x64_bf16 v[48:51], v[24:27], a[96:103], v2
s_waitcnt vmcnt(5)
s_barrier
v_smfmac_f32_16x16x64_bf16 v[52:55], v[24:27], a[104:111], v2
s_waitcnt vmcnt(4)
v_cmp_eq_u32 vcc, -1, v28
v_smfmac_f32_16x16x64_bf16 v[56:59], v[24:27], a[112:119], v2
v_smfmac_f32_16x16x64_bf16 v[60:63], v[24:27], a[120:127], v2
s_cbranch_vccnz Lc_retry40
Lc_back40:
v_smfmac_f32_16x16x64_bf16 v[48:51], v[28:31], a[128:135], v2
v_smfmac_f32_16x16x64_bf16 v[52:55], v[28:31], a[136:143], v2
s_waitcnt vmcnt(3)
v_cmp_eq_u32 vcc, -1, v32
v_smfmac_f32_16x16x64_bf16 v[56:59], v[28:31], a[144:151], v2
v_smfmac_f32_16x16x64_bf16 v[60:63], v[28:31], a[152:159], v2
s_cbranch_vccnz Lc_retry50
Lc_back50:
v_smfmac_f32_16x16x64_bf16 v[48:51], v[32:35], a[160:167], v2
v_smfmac_f32_16x16x64_bf16 v[52:55], v[32:35], a[168:175], v2
s_waitcnt vmcnt(2)
v_cmp_eq_u32 vcc, -1, v36
v_smfmac_f32_16x16x64_bf16 v[56:59], v[32:35], a[176:183], v2
v_smfmac_f32_16x16x64_bf16 v[60:63], v[32:35], a[184:191], v2
s_cbranch_vccnz Lc_retry60
Lc_back60:
v_smfmac_f32_16x16x64_bf16 v[48:51], v[36:39], a[192:199], v2
v_smfmac_f32_16x16x64_bf16 v[52:55], v[36:39], a[200:207], v2
s_waitcnt vmcnt(1)
v_cmp_eq_u32 vcc, -1, v40
v_smfmac_f32_16x16x64_bf16 v[56:59], v[36:39], a[208:215], v2
v_smfmac_f32_16x16x64_bf16 v[60:63], v[36:39], a[216:223], v2
s_cbranch_vccnz Lc_retry70
Lc_back70:
v_smfmac_f32_16x16x64_bf16 v[48:51], v[40:43], a[224:231], v2
v_smfmac_f32_16x16x64_bf16 v[52:55], v[40:43], a[232:239], v2
s_waitcnt vmcnt(0)
v_cmp_eq_u32 vcc, -1, v44
v_smfmac_f32_16x16x64_bf16 v[56:59], v[40:43], a[240:247], v2
v_smfmac_f32_16x16x64_bf16 v[60:63], v[40:43], a[248:255], v2
s_cbranch_vccnz Lc_retry80
Lc_back80:
v_smfmac_f32_16x16x64_bf16 v[48:51], v[44:47], v[224:231], v2
v_smfmac_f32_16x16x64_bf16 v[52:55], v[44:47], v[232:239], v2
v_smfmac_f32_16x16x64_bf16 v[56:59], v[44:47], v[240:247], v2
v_add_f32 v48, v48, v50
v_smfmac_f32_16x16x64_bf16 v[60:63], v[44:47], v[248:255], v2
v_add_f32 v49, v49, v51
v_smfmac_f32_16x16x64_bf16 v[64:67], v[24:27], v[128:135], v2
v_add_f32 v52, v52, v54
v_smfmac_f32_16x16x64_bf16 v[68:71], v[24:27], v[136:143], v2
v_add_f32 v53, v53, v55
Lc_post0:
v_add_f32 v56, v56, v58
v_add_f32 v60, v60, v62
v_cvt_pk_bf16_f32 v50, v48, v52
v_cvt_pk_bf16_f32 v51, v56, v60
v_xor_b32 v58, 16, v3
ds_write_b64 v3, v[50:51] offset:16384
v_add_f32 v57, v57, v59
v_add_f32 v61, v61, v63
v_cvt_pk_bf16_f32 v54, v49, v53
v_cvt_pk_bf16_f32 v55, v57, v61
ds_write_b64 v58, v[54:55] offset:16384
v_cmp_u_f32 vcc, v48, v49
v_smfmac_f32_16x16x64_bf16 v[64:67], v[28:31], v[144:151], v2
v_smfmac_f32_16x16x64_bf16 v[68:71], v[28:31], v[152:159], v2
s_cbranch_vccnz Lc_redo0
Lc_redoback0:
v_smfmac_f32_16x16x64_bf16 v[64:67], v[32:35], v[160:167], v2
s_cmp_lt_u32 s96, 3
v_smfmac_f32_16x16x64_bf16 v[68:71], v[32:35], v[168:175], v2
s_cbranch_scc1 Lc_hist0
Lc_histback0:
ds_read_b128 v[12:15], v0
ds_read_b128 v[16:19], v0 offset:4096
ds_read_b128 v[20:23], v0 offset:1024
v_xor_b32 v32, 64, v4
s_waitcnt lgkmcnt(3)
s_barrier
ds_read_b128 v[28:31], v4 offset:16384
ds_read_b128 v[32:35], v32 offset:17408
ds_read_b128 v[56:59], v0 offset:5120
v_smfmac_f32_16x16x64_bf16 v[64:67], v[36:39], v[176:183], v2
s_cmp_eq_u32 s18, 62
v_smfmac_f32_16x16x64_bf16 v[68:71], v[36:39], v[184:191], v2
s_cbranch_scc1 Lc_km0
Lc_kmb0:
ds_read_b128 v[36:39], v4 offset:18432
ds_read_b128 v[60:63], v0 offset:2048
ds_read_b128 v[24:27], v0 offset:6144
v_smfmac_f32_16x16x64_bf16 v[64:67], v[40:43], v[192:199], v2
v_smfmac_f32_16x16x64_bf16 v[68:71], v[40:43], v[200:207], v2
v_xor_b32 v40, 64, v4
ds_read_b128 v[40:43], v40 offset:19456
v_smfmac_f32_16x16x64_bf16 v[64:67], v[44:47], v[208:215], v2
v_smfmac_f32_16x16x64_bf16 v[68:71], v[44:47], v[216:223], v2
s_waitcnt lgkmcnt(6)
v_mfma_f32_16x16x32_bf16 v[48:51], v[12:15], v[28:31], 0
ds_read_b128 v[12:15], v0 offset:3072
v_mfma_f32_16x16x32_bf16 v[52:55], v[16:19], v[28:31], 0
ds_read_b128 v[16:19], v0 offset:7168
v_mfma_f32_16x16x32_bf16 v[44:47], v[28:31], v[28:31], 0
s_waitcnt lgkmcnt(6)
v_mfma_f32_16x16x32_bf16 v[48:51], v[20:23], v[32:35], v[48:51]
v_add_f32 v64, v64, v66
v_add_f32 v65, v65, v67
v_mfma_f32_16x16x32_bf16 v[52:55], v[56:59], v[32:35], v[52:55]
v_add_f32 v68, v68, v70
ds_read_b128 v[56:59], v0 offset:8192
v_mfma_f32_16x16x32_bf16 v[44:47], v[32:35], v[32:35], v[44:47]
v_add_f32 v69, v69, v71
v_cvt_pk_bf16_f32 v66, v64, v65
s_waitcnt lgkmcnt(4)
v_mfma_f32_16x16x32_bf16 v[48:51], v[60:63], v[36:39], v[48:51]
v_cvt_pk_bf16_f32 v67, v68, v69
ds_read_b128 v[60:63], v0 offset:9216
v_mfma_f32_16x16x32_bf16 v[52:55], v[24:27], v[36:39], v[52:55]
ds_read_b128 v[28:31], v1
s_cmp_eq_u32 s18, 62
v_mfma_f32_16x16x32_bf16 v[44:47], v[36:39], v[36:39], v[44:47]
ds_read_b128 v[32:35], v1 offset:1024
s_cbranch_scc1 Lc_vm0
Lc_vmb0:
s_waitcnt lgkmcnt(4)
v_mfma_f32_16x16x32_bf16 v[44:47], v[40:43], v[40:43], v[44:47]
s_barrier
v_mfma_f32_16x16x32_bf16 v[48:51], v[12:15], v[40:43], v[48:51]
ds_read_b128 v[20:23], v1 offset:2048
v_mfma_f32_16x16x32_bf16 v[52:55], v[16:19], v[40:43], v[52:55]
ds_read_b128 v[24:27], v1 offset:3072
v_mov_b32 v36, -1
v_mov_b32 v37, -1
v_mov_b32 v38, -1
v_max3_f32 v64, v46, v47, v48
v_max3_f32 v64, v64, v49, v50
v_mov_b32 v39, -1
s_nop 0
v_max3_f32 v65, v51, v52, v53
v_max3_f32 v65, v65, v54, v55
v_max_f32 v44, v64, v65
v_max_f32 v65, v64, v65
ds_read_b128 v[12:15], v1 offset:4096
ds_read_b128 v[16:19], v1 offset:5120
v_permlane32_swap_b32 v44, v65
v_max_f32 v64, v44, v65
v_max_f32 v65, v44, v65
s_mov_b32 s20, s24
s_bitcmp0_b32 s18, 1
v_permlane16_swap_b32 v64, v65
v_max_f32 v64, v64, v65
v_fma_f32 v64, v64, s30, v5
v_pk_fma_f32 v[46:47], v[46:47], s[30:31], v[64:65] op_sel_hi:[1,1,0] neg_lo:[0,0,1] neg_hi:[0,0,1]
v_pk_fma_f32 v[48:49], v[48:49], s[30:31], v[64:65] op_sel_hi:[1,1,0] neg_lo:[0,0,1] neg_hi:[0,0,1]
v_pk_fma_f32 v[50:51], v[50:51], s[30:31], v[64:65] op_sel_hi:[1,1,0] neg_lo:[0,0,1] neg_hi:[0,0,1]
v_pk_fma_f32 v[52:53], v[52:53], s[30:31], v[64:65] op_sel_hi:[1,1,0] neg_lo:[0,0,1] neg_hi:[0,0,1]
v_pk_fma_f32 v[54:55], v[54:55], s[30:31], v[64:65] op_sel_hi:[1,1,0] neg_lo:[0,0,1] neg_hi:[0,0,1]
v_exp_f32 v46, v46
v_exp_f32 v47, v47
v_exp_f32 v48, v48
v_cvt_pk_bf16_f32 v44, v46, v47
v_exp_f32 v49, v49
v_exp_f32 v50, v50
v_mov_b32_dpp v45, v44 quad_perm:[2,3,0,1] row_mask:0xf bank_mask:0xf
v_exp_f32 v51, v51
v_cvt_pk_bf16_f32 v48, v48, v49
v_mfma_f32_16x16x16_bf16 v[40:43], v[66:67], v[44:45], 0
ds_write_b128 v0, v[36:39] offset:16384
v_exp_f32 v52, v52
v_mfma_f32_16x16x16_bf16 v[68:71], v[8:9], v[44:45], 0
v_exp_f32 v53, v53
v_cvt_pk_bf16_f32 v49, v50, v51
v_exp_f32 v54, v54
v_exp_f32 v55, v55
v_cvt_pk_bf16_f32 v50, v52, v53
v_mov_b32_dpp v52, v48 quad_perm:[2,3,0,1] row_mask:0xf bank_mask:0xf
v_cvt_pk_bf16_f32 v51, v54, v55
v_mov_b32_dpp v53, v49 quad_perm:[2,3,0,1] row_mask:0xf bank_mask:0xf
s_cselect_b32 s32, -1, 0
s_waitcnt lgkmcnt(7)
v_mfma_f32_16x16x32_bf16 v[68:71], v[8:11], v[48:51], v[68:71]
v_mov_b32_dpp v54, v50 quad_perm:[2,3,0,1] row_mask:0xf bank_mask:0xf
v_mov_b32_dpp v55, v51 quad_perm:[2,3,0,1] row_mask:0xf bank_mask:0xf
v_mfma_f32_16x16x32_bf16 v[40:43], v[56:59], v[48:51], v[40:43]
s_mov_b32 s53, s25
s_add_u32 s55, s22, s34
v_mfma_f32_16x16x32_bf16 v[40:43], v[60:63], v[52:55], v[40:43]
s_add_u32 s49, s23, s34
s_add_u32 s38, s38, 64
ds_read_b128 v[44:47], v1 offset:6144
ds_read_b128 v[48:51], v1 offset:7168
v_rcp_f32 v56, v68
s_add_u32 s18, s18, 1
s_add_u32 s27, s27, 9216
v_mov_b32_dpp v56, v56 quad_perm:[0,1,0,1] row_mask:0xf bank_mask:0xf
v_pk_mul_f32 v[40:41], v[40:41], v[56:57] op_sel_hi:[1,0]
v_pk_mul_f32 v[42:43], v[42:43], v[56:57] op_sel_hi:[1,0]
v_cvt_pk_bf16_f32 v40, v40, v41
v_cvt_pk_bf16_f32 v41, v42, v43
ds_write_b64 v7, v[40:41] offset:20480
v_or_b32 v36, v7, v5
ds_read_b128 v[64:67], v1 offset:8192
ds_read_b128 v[68:71], v1 offset:9216
s_mov_b32 s22, s23
s_add_u32 s23, s23, 9216
s_waitcnt lgkmcnt(2)
s_barrier
ds_read_b128 v[8:11], v36 offset:20992
ds_read_b128 v[36:39], v36 offset:20480
ds_read_b128 v[40:43], v0 offset:21504
s_cmp_eq_u32 s23, 12610560
s_cselect_b32 s23, 12582912, s23
s_add_u32 s24, s24, s33
s_add_u32 s25, s25, s33
s_sub_u32 s33, 0, s33
s_add_u32 s51, s22, 4096
s_add_u32 s52, s22, 8192
s_waitcnt lgkmcnt(1)
v_mfma_f32_16x16x32_bf16 v[52:55], v[36:39], v[72:75], 0
v_mfma_f32_16x16x32_bf16 v[52:55], v[8:11], v[76:79], v[52:55]
s_waitcnt lgkmcnt(0)
v_smfmac_f32_16x16x64_bf16 v[52:55], v[40:43], v[28:35], v2
ds_read_b128 v[28:31], v1 offset:10240
ds_read_b128 v[32:35], v1 offset:11264
v_mfma_f32_16x16x32_bf16 v[56:59], v[36:39], v[20:23], 0
v_mfma_f32_16x16x32_bf16 v[56:59], v[8:11], v[24:27], v[56:59]
ds_read_b128 v[20:23], v1 offset:12288
v_add_f32 v52, v52, v54
v_smfmac_f32_16x16x64_bf16 v[56:59], v[40:43], v[12:19], v2
ds_read_b128 v[24:27], v1 offset:13312
ds_read_b128 v[12:15], v1 offset:14336
v_add_f32 v53, v53, v55
v_cvt_pk_bf16_f32 v54, v52, v53
v_bfi_b32 v54, -2, v54, s32
s_nop 2
v_add_f32 v56, v56, v58
v_add_f32 v57, v57, v59
v_cvt_pk_bf16_f32 v55, v56, v57
buffer_store_dwordx2 v[54:55], v6, s[8:11], s20 offen
s_add_u32 s20, s20, 49152
v_mfma_f32_16x16x32_bf16 v[60:63], v[36:39], v[44:47], 0
ds_read_b128 v[16:19], v1 offset:15360
v_mfma_f32_16x16x32_bf16 v[60:63], v[8:11], v[48:51], v[60:63]
ds_read_b128 v[44:47], v1 offset:16384
v_smfmac_f32_16x16x64_bf16 v[60:63], v[40:43], v[64:71], v2
ds_read_b128 v[48:51], v1 offset:17408
ds_read_b128 v[64:67], v1 offset:18432
s_waitcnt lgkmcnt(7)
v_mfma_f32_16x16x32_bf16 v[52:55], v[36:39], v[28:31], 0
ds_read_b128 v[68:71], v1 offset:19456
v_mfma_f32_16x16x32_bf16 v[52:55], v[8:11], v[32:35], v[52:55]
ds_read_b128 v[28:31], v1 offset:20480
s_waitcnt lgkmcnt(7)
v_smfmac_f32_16x16x64_bf16 v[52:55], v[40:43], v[20:27], v2
ds_read_b128 v[32:35], v1 offset:21504
ds_read_b128 v[20:23], v1 offset:22528
s_waitcnt lgkmcnt(7)
v_mfma_f32_16x16x32_bf16 v[56:59], v[36:39], v[12:15], 0
ds_read_b128 v[24:27], v1 offset:23552
v_add_f32 v60, v60, v62
v_mfma_f32_16x16x32_bf16 v[56:59], v[8:11], v[16:19], v[56:59]
ds_read_b128 v[12:15], v1 offset:24576
v_add_f32 v61, v61, v63
s_waitcnt lgkmcnt(7)
v_smfmac_f32_16x16x64_bf16 v[56:59], v[40:43], v[44:51], v2
ds_read_b128 v[16:19], v1 offset:25600
ds_read_b128 v[44:47], v1 offset:26624
v_add_f32 v52, v52, v54
v_cvt_pk_bf16_f32 v54, v60, v61
v_add_f32 v53, v53, v55
s_waitcnt lgkmcnt(7)
v_mfma_f32_16x16x32_bf16 v[60:63], v[36:39], v[64:67], 0
ds_read_b128 v[48:51], v1 offset:27648
v_bfi_b32 v54, -2, v54, s32
v_mfma_f32_16x16x32_bf16 v[60:63], v[8:11], v[68:71], v[60:63]
ds_read_b128 v[64:67], v1 offset:28672
v_cvt_pk_bf16_f32 v55, v52, v53
s_waitcnt lgkmcnt(7)
v_smfmac_f32_16x16x64_bf16 v[60:63], v[40:43], v[28:35], v2
ds_read_b128 v[68:71], v1 offset:29696
ds_read_b128 v[28:31], v1 offset:30720
buffer_store_dwordx2 v[54:55], v6, s[8:11], s20 offen
s_add_u32 s20, s20, 49152
s_waitcnt lgkmcnt(7)
v_mfma_f32_16x16x32_bf16 v[52:55], v[36:39], v[20:23], 0
ds_read_b128 v[32:35], v1 offset:31744
v_add_f32 v56, v56, v58
v_mfma_f32_16x16x32_bf16 v[52:55], v[8:11], v[24:27], v[52:55]
ds_read_b128 v[20:23], v1 offset:32768
v_add_f32 v57, v57, v59
s_waitcnt lgkmcnt(7)
v_smfmac_f32_16x16x64_bf16 v[52:55], v[40:43], v[12:19], v2
ds_read_b128 v[24:27], v1 offset:33792
ds_read_b128 v[12:15], v1 offset:34816
v_add_f32 v60, v60, v62
v_cvt_pk_bf16_f32 v62, v56, v57
v_add_f32 v61, v61, v63
s_waitcnt lgkmcnt(7)
v_mfma_f32_16x16x32_bf16 v[56:59], v[36:39], v[44:47], 0
ds_read_b128 v[16:19], v1 offset:35840
v_bfi_b32 v62, -2, v62, s32
v_mfma_f32_16x16x32_bf16 v[56:59], v[8:11], v[48:51], v[56:59]
ds_read_b128 v[44:47], v1 offset:36864
v_cvt_pk_bf16_f32 v63, v60, v61
s_waitcnt lgkmcnt(7)
v_smfmac_f32_16x16x64_bf16 v[56:59], v[40:43], v[64:71], v2
ds_read_b128 v[48:51], v1 offset:37888
ds_read_b128 v[64:67], v1 offset:38912
buffer_store_dwordx2 v[62:63], v6, s[8:11], s20 offen
s_add_u32 s20, s20, 49152
s_waitcnt lgkmcnt(7)
v_mfma_f32_16x16x32_bf16 v[60:63], v[36:39], v[28:31], 0
ds_read_b128 v[68:71], v1 offset:39936
v_add_f32 v52, v52, v54
v_mfma_f32_16x16x32_bf16 v[60:63], v[8:11], v[32:35], v[60:63]
ds_read_b128 v[28:31], v1 offset:40960
v_add_f32 v53, v53, v55
s_waitcnt lgkmcnt(7)
v_smfmac_f32_16x16x64_bf16 v[60:63], v[40:43], v[20:27], v2
ds_read_b128 v[32:35], v1 offset:41984
ds_read_b128 v[20:23], v1 offset:43008
v_add_f32 v56, v56, v58
v_cvt_pk_bf16_f32 v58, v52, v53
v_add_f32 v57, v57, v59
s_waitcnt lgkmcnt(7)
v_mfma_f32_16x16x32_bf16 v[52:55], v[36:39], v[12:15], 0
ds_read_b128 v[24:27], v1 offset:44032
v_bfi_b32 v58, -2, v58, s32
v_mfma_f32_16x16x32_bf16 v[52:55], v[8:11], v[16:19], v[52:55]
ds_read_b128 v[12:15], v1 offset:45056
v_cvt_pk_bf16_f32 v59, v56, v57
s_waitcnt lgkmcnt(7)
v_smfmac_f32_16x16x64_bf16 v[52:55], v[40:43], v[44:51], v2
ds_read_b128 v[16:19], v1 offset:46080
buffer_store_dwordx2 v[58:59], v6, s[8:11], s20 offen
s_add_u32 s20, s20, 49152
s_waitcnt lgkmcnt(6)
v_mfma_f32_16x16x32_bf16 v[56:59], v[36:39], v[64:67], 0
v_add_f32 v60, v60, v62
v_mfma_f32_16x16x32_bf16 v[56:59], v[8:11], v[68:71], v[56:59]
v_add_f32 v61, v61, v63
s_waitcnt lgkmcnt(4)
v_smfmac_f32_16x16x64_bf16 v[56:59], v[40:43], v[28:35], v2
v_add_f32 v52, v52, v54
v_cvt_pk_bf16_f32 v54, v60, v61
v_add_f32 v53, v53, v55
s_waitcnt lgkmcnt(2)
v_mfma_f32_16x16x32_bf16 v[60:63], v[36:39], v[20:23], 0
v_bfi_b32 v54, -2, v54, s32
v_mfma_f32_16x16x32_bf16 v[60:63], v[8:11], v[24:27], v[60:63]
v_cvt_pk_bf16_f32 v55, v52, v53
s_waitcnt lgkmcnt(0)
v_smfmac_f32_16x16x64_bf16 v[60:63], v[40:43], v[12:19], v2
buffer_store_dwordx2 v[54:55], v6, s[8:11], s20 offen
s_add_u32 s20, s20, 49152
s_add_u32 s26, s26, 524288
s_mov_b32 m0, 16384
v_mov_b64 v[48:49], 0
v_mov_b64 v[50:51], 0
v_mov_b64 v[52:53], 0
v_mov_b64 v[54:55], 0
v_mov_b64 v[64:65], 0
v_mov_b64 v[66:67], 0
v_mov_b64 v[68:69], 0
v_mov_b64 v[70:71], 0
v_add_f32 v56, v56, v58
v_add_f32 v57, v57, v59
v_add_f32 v60, v60, v62
v_cvt_pk_bf16_f32 v62, v56, v57
v_add_f32 v61, v61, v63
v_bfi_b32 v62, -2, v62, s32
v_cvt_pk_bf16_f32 v63, v60, v61
buffer_store_dwordx2 v[62:63], v6, s[8:11], s20 offen
v_mov_b32 v8, 0x3f803f80
v_mov_b32 v9, v8
v_mov_b64 v[10:11], v[8:9]
v_mov_b64 v[56:57], 0
v_mov_b64 v[58:59], 0
v_mov_b64 v[60:61], 0
v_mov_b64 v[62:63], 0
s_cmp_eq_u32 s18, 40
s_cbranch_scc1 Lc_pre0
Lc_preb0:
s_mov_b32 s75, 0
s_mov_b32 s19, s74
Lc_dl0:
s_sub_u32 s19, s19, 1
s_cbranch_scc0 Lc_dl0
s_cmp_eq_u32 s18, 63
s_cbranch_scc0 Lc_top0
s_waitcnt vmcnt(0)
s_lshl_b32 s19, s17, 5
s_add_u32 s19, s19, 129024
buffer_store_dword v2, off, s[8:11], s19 sc1
buffer_store_dword v2, off, s[8:11], s19 offset:4 sc1
s_branch Lc_topL0
Lc_hist0:
s_cmp_eq_u32 s96, 0
s_cbranch_scc0 Lc_hist10
buffer_store_dwordx4 v[12:15], v0, s[8:11], s27 offen sc1
s_nop 0
s_branch Lc_histback0
Lc_hist10:
s_cmp_eq_u32 s96, 1
s_cbranch_scc0 Lc_hist20
buffer_store_dwordx4 v[16:19], v0, s[8:11], s27 offen sc1
s_nop 0
s_branch Lc_histback0
Lc_hist20:
buffer_store_dwordx4 v[20:23], v0, s[8:11], s27 offen sc1
s_nop 0
s_branch Lc_histback0
Lc_km0:
v_bfe_u32 v48, v0, 7, 1
v_lshlrev_b32 v48, 9, v48
v_bfe_u32 v49, v0, 5, 2
v_lshl_add_u32 v48, v49, 7, v48
v_lshrrev_b32 v49, 8, v0
v_lshl_add_u32 v48, v49, 5, v48
v_bfe_u32 v49, v0, 4, 1
v_lshl_add_u32 v48, v49, 3, v48
s_mul_i32 s19, s17, 4096
s_add_u32 s19, s19, 24903680
buffer_store_dwordx2 v[50:51], v48, s[8:11], s19 offen sc1
buffer_store_dwordx2 v[54:55], v48, s[8:11], s19 offen offset:16 sc1
s_branch Lc_kmb0
Lc_vm0:
v_lshrrev_b32 v64, 1, v0
s_mul_i32 s19, s17, 4096
s_add_u32 s19, s19, 24905728
buffer_store_dwordx2 v[66:67], v64, s[8:11], s19 offen sc1
s_branch Lc_vmb0
Lc_pre0:
v_mov_b32 v12, 0
global_load_dword v13, v12, s[6:7] offset:104 sc1
s_waitcnt vmcnt(0)
v_cmp_gt_u32 vcc, 28, v13
s_cbranch_vccz Lc_preb0
s_add_u32 s21, s21, 1
s_cmp_ge_u32 s21, 4194304
s_cbranch_scc1 L_abort
s_branch Lc_pre0
Lc_retry20:
buffer_load_dwordx4 v0, s[8:11], s22 offen offset:2048 sc1 lds
ds_read_b128 v[20:23], v0 offset:18432
s_add_u32 s21, s21, 1
s_cmp_ge_u32 s21, 4194304
s_cbranch_scc1 L_abort
s_waitcnt lgkmcnt(0)
v_cmp_eq_u32 vcc, -1, v20
s_cbranch_vccnz Lc_retry20
s_waitcnt vmcnt(0)
s_branch Lc_back20
Lc_retry30:
buffer_load_dwordx4 v0, s[8:11], s22 offen offset:3072 sc1 lds
ds_read_b128 v[24:27], v0 offset:19456
s_add_u32 s21, s21, 1
s_cmp_ge_u32 s21, 4194304
s_cbranch_scc1 L_abort
s_waitcnt lgkmcnt(0)
v_cmp_eq_u32 vcc, -1, v24
s_cbranch_vccnz Lc_retry30
s_waitcnt vmcnt(0)
s_branch Lc_back30
Lc_retry40:
buffer_load_dwordx4 v[28:31], v0, s[8:11], s51 offen sc1
s_waitcnt vmcnt(0)
v_cmp_eq_u32 vcc, -1, v28
s_cbranch_vccz Lc_back40
s_add_u32 s21, s21, 1
s_cmp_ge_u32 s21, 4194304
s_cbranch_scc1 L_abort
s_branch Lc_retry40
Lc_retry50:
buffer_load_dwordx4 v[32:35], v0, s[8:11], s51 offen offset:1024 sc1
s_waitcnt vmcnt(0)
v_cmp_eq_u32 vcc, -1, v32
s_cbranch_vccz Lc_back50
s_add_u32 s21, s21, 1
s_cmp_ge_u32 s21, 4194304
s_cbranch_scc1 L_abort
s_branch Lc_retry50
Lc_retry60:
buffer_load_dwordx4 v[36:39], v0, s[8:11], s51 offen offset:2048 sc1
s_waitcnt vmcnt(0)
v_cmp_eq_u32 vcc, -1, v36
s_cbranch_vccz Lc_back60
s_add_u32 s21, s21, 1
s_cmp_ge_u32 s21, 4194304
s_cbranch_scc1 L_abort
s_branch Lc_retry60
Lc_retry70:
buffer_load_dwordx4 v[40:43], v0, s[8:11], s51 offen offset:3072 sc1
s_waitcnt vmcnt(0)
v_cmp_eq_u32 vcc, -1, v40
s_cbranch_vccz Lc_back70
s_add_u32 s21, s21, 1
s_cmp_ge_u32 s21, 4194304
s_cbranch_scc1 L_abort
s_branch Lc_retry70
Lc_retry80:
buffer_load_dwordx4 v[44:47], v0, s[8:11], s52 offen sc1
s_waitcnt vmcnt(0)
v_cmp_eq_u32 vcc, -1, v44
s_cbranch_vccz Lc_back80
s_add_u32 s21, s21, 1
s_cmp_ge_u32 s21, 4194304
s_cbranch_scc1 L_abort
s_branch Lc_retry80
Lc_redo0:
s_cmp_eq_u32 s48, s18
s_cbranch_scc1 Lc_redoback0
s_mov_b32 s48, s18
s_waitcnt lgkmcnt(0)
s_nop 15
Lc_redo20:
buffer_load_dwordx4 v[12:15], v0, s[8:11], s22 offen sc1
buffer_load_dwordx4 v[16:19], v0, s[8:11], s22 offen offset:1024 sc1
buffer_load_dwordx4 v[20:23], v0, s[8:11], s22 offen offset:2048 sc1
buffer_load_dwordx4 v[24:27], v0, s[8:11], s22 offen offset:3072 sc1
buffer_load_dwordx4 v[28:31], v0, s[8:11], s51 offen sc1
buffer_load_dwordx4 v[32:35], v0, s[8:11], s51 offen offset:1024 sc1
buffer_load_dwordx4 v[36:39], v0, s[8:11], s51 offen offset:2048 sc1
buffer_load_dwordx4 v[40:43], v0, s[8:11], s51 offen offset:3072 sc1
buffer_load_dwordx4 v[44:47], v0, s[8:11], s52 offen sc1
v_mov_b64 v[48:49], 0
v_mov_b64 v[50:51], 0
v_mov_b64 v[52:53], 0
v_mov_b64 v[54:55], 0
v_mov_b64 v[56:57], 0
v_mov_b64 v[58:59], 0
v_mov_b64 v[60:61], 0
v_mov_b64 v[62:63], 0
v_mov_b64 v[64:65], 0
v_mov_b64 v[66:67], 0
v_mov_b64 v[68:69], 0
v_mov_b64 v[70:71], 0
s_waitcnt vmcnt(0)
v_max_u32 v48, v12, v13
v_max3_u32 v48, v48, v14, v15
v_max3_u32 v48, v48, v16, v17
v_max3_u32 v48, v48, v18, v19
v_max3_u32 v48, v48, v20, v21
v_max3_u32 v48, v48, v22, v23
v_max3_u32 v48, v48, v24, v25
v_max3_u32 v48, v48, v26, v27
v_max3_u32 v48, v48, v28, v29
v_max3_u32 v48, v48, v30, v31
v_max3_u32 v48, v48, v32, v33
v_max3_u32 v48, v48, v34, v35
v_max3_u32 v48, v48, v36, v37
v_max3_u32 v48, v48, v38, v39
v_max3_u32 v48, v48, v40, v41
v_max3_u32 v48, v48, v42, v43
v_max3_u32 v48, v48, v44, v45
v_max3_u32 v48, v48, v46, v47
v_cmp_eq_u32 vcc, -1, v48
v_mov_b32 v48, 0
s_cbranch_vccnz Lc_redo30
s_nop 0
v_smfmac_f32_16x16x64_bf16 v[48:51], v[12:15], a[0:7], v2
v_smfmac_f32_16x16x64_bf16 v[52:55], v[12:15], a[8:15], v2
v_smfmac_f32_16x16x64_bf16 v[56:59], v[12:15], a[16:23], v2
v_smfmac_f32_16x16x64_bf16 v[60:63], v[12:15], a[24:31], v2
v_smfmac_f32_16x16x64_bf16 v[64:67], v[12:15], v[80:87], v2
v_smfmac_f32_16x16x64_bf16 v[68:71], v[12:15], v[88:95], v2
v_smfmac_f32_16x16x64_bf16 v[48:51], v[16:19], a[32:39], v2
v_smfmac_f32_16x16x64_bf16 v[52:55], v[16:19], a[40:47], v2
v_smfmac_f32_16x16x64_bf16 v[56:59], v[16:19], a[48:55], v2
v_smfmac_f32_16x16x64_bf16 v[60:63], v[16:19], a[56:63], v2
v_smfmac_f32_16x16x64_bf16 v[64:67], v[16:19], v[96:103], v2
v_smfmac_f32_16x16x64_bf16 v[68:71], v[16:19], v[104:111], v2
v_smfmac_f32_16x16x64_bf16 v[48:51], v[20:23], a[64:71], v2
v_smfmac_f32_16x16x64_bf16 v[52:55], v[20:23], a[72:79], v2
v_smfmac_f32_16x16x64_bf16 v[56:59], v[20:23], a[80:87], v2
v_smfmac_f32_16x16x64_bf16 v[60:63], v[20:23], a[88:95], v2
v_smfmac_f32_16x16x64_bf16 v[64:67], v[20:23], v[112:119], v2
v_smfmac_f32_16x16x64_bf16 v[68:71], v[20:23], v[120:127], v2
v_smfmac_f32_16x16x64_bf16 v[48:51], v[24:27], a[96:103], v2
v_smfmac_f32_16x16x64_bf16 v[52:55], v[24:27], a[104:111], v2
v_smfmac_f32_16x16x64_bf16 v[56:59], v[24:27], a[112:119], v2
v_smfmac_f32_16x16x64_bf16 v[60:63], v[24:27], a[120:127], v2
v_smfmac_f32_16x16x64_bf16 v[64:67], v[24:27], v[128:135], v2
v_smfmac_f32_16x16x64_bf16 v[68:71], v[24:27], v[136:143], v2
v_smfmac_f32_16x16x64_bf16 v[48:51], v[28:31], a[128:135], v2
v_smfmac_f32_16x16x64_bf16 v[52:55], v[28:31], a[136:143], v2
v_smfmac_f32_16x16x64_bf16 v[56:59], v[28:31], a[144:151], v2
v_smfmac_f32_16x16x64_bf16 v[60:63], v[28:31], a[152:159], v2
v_smfmac_f32_16x16x64_bf16 v[48:51], v[32:35], a[160:167], v2
v_smfmac_f32_16x16x64_bf16 v[52:55], v[32:35], a[168:175], v2
v_smfmac_f32_16x16x64_bf16 v[56:59], v[32:35], a[176:183], v2
v_smfmac_f32_16x16x64_bf16 v[60:63], v[32:35], a[184:191], v2
v_smfmac_f32_16x16x64_bf16 v[48:51], v[36:39], a[192:199], v2
v_smfmac_f32_16x16x64_bf16 v[52:55], v[36:39], a[200:207], v2
v_smfmac_f32_16x16x64_bf16 v[56:59], v[36:39], a[208:215], v2
v_smfmac_f32_16x16x64_bf16 v[60:63], v[36:39], a[216:223], v2
v_smfmac_f32_16x16x64_bf16 v[48:51], v[40:43], a[224:231], v2
v_smfmac_f32_16x16x64_bf16 v[52:55], v[40:43], a[232:239], v2
v_smfmac_f32_16x16x64_bf16 v[56:59], v[40:43], a[240:247], v2
v_smfmac_f32_16x16x64_bf16 v[60:63], v[40:43], a[248:255], v2
v_smfmac_f32_16x16x64_bf16 v[48:51], v[44:47], v[224:231], v2
v_smfmac_f32_16x16x64_bf16 v[52:55], v[44:47], v[232:239], v2
v_smfmac_f32_16x16x64_bf16 v[56:59], v[44:47], v[240:247], v2
v_smfmac_f32_16x16x64_bf16 v[60:63], v[44:47], v[248:255], v2
s_nop 7
v_add_f32 v48, v48, v50
v_add_f32 v49, v49, v51
v_add_f32 v52, v52, v54
v_add_f32 v53, v53, v55
s_branch Lc_post0
Lc_redo30:
s_add_u32 s21, s21, 1
s_cmp_ge_u32 s21, 4194304
s_cbranch_scc1 L_abort
s_branch Lc_redo20
.p2align 6
s_nop 0
s_nop 0
Lc_top1:
buffer_load_dwordx4 v0, s[8:11], s22 offen offset:1024 sc1 lds
ds_read_b128 v[12:15], v0 offset:16384
ds_read_b128 v[16:19], v0 offset:17408
s_add_u32 s21, s21, 1
s_cmp_ge_u32 s21, 4194304
s_cbranch_scc1 L_abort
s_waitcnt lgkmcnt(0)
v_max_u32 v43, v12, v16
v_cmp_eq_u32 vcc, -1, v43
s_cbranch_vccnz Lc_top1
v_smfmac_f32_16x16x64_bf16 v[48:51], v[12:15], a[0:7], v2
v_smfmac_f32_16x16x64_bf16 v[52:55], v[12:15], a[8:15], v2
v_smfmac_f32_16x16x64_bf16 v[56:59], v[12:15], a[16:23], v2
buffer_load_dwordx4 v[28:31], v0, s[8:11], s51 offen sc1
v_smfmac_f32_16x16x64_bf16 v[60:63], v[12:15], a[24:31], v2
v_smfmac_f32_16x16x64_bf16 v[64:67], v[12:15], v[80:87], v2
ds_read_b128 v[20:23], v0 offset:18432
v_smfmac_f32_16x16x64_bf16 v[68:71], v[12:15], v[88:95], v2
v_smfmac_f32_16x16x64_bf16 v[48:51], v[16:19], a[32:39], v2
buffer_load_dwordx4 v[32:35], v0, s[8:11], s51 offen offset:1024 sc1
v_smfmac_f32_16x16x64_bf16 v[52:55], v[16:19], a[40:47], v2
v_smfmac_f32_16x16x64_bf16 v[56:59], v[16:19], a[48:55], v2
v_smfmac_f32_16x16x64_bf16 v[60:63], v[16:19], a[56:63], v2
ds_read_b128 v[24:27], v0 offset:19456
s_waitcnt lgkmcnt(1)
v_cmp_eq_u32 vcc, -1, v20
v_smfmac_f32_16x16x64_bf16 v[64:67], v[16:19], v[96:103], v2
buffer_load_dwordx4 v[36:39], v0, s[8:11], s51 offen offset:2048 sc1
v_smfmac_f32_16x16x64_bf16 v[68:71], v[16:19], v[104:111], v2
s_cbranch_vccnz Lc_retry21
Lc_back21:
v_smfmac_f32_16x16x64_bf16 v[48:51], v[20:23], a[64:71], v2
v_smfmac_f32_16x16x64_bf16 v[52:55], v[20:23], a[72:79], v2
v_smfmac_f32_16x16x64_bf16 v[56:59], v[20:23], a[80:87], v2
buffer_load_dwordx4 v[40:43], v0, s[8:11], s51 offen offset:3072 sc1
v_smfmac_f32_16x16x64_bf16 v[60:63], v[20:23], a[88:95], v2
s_waitcnt lgkmcnt(0)
v_cmp_eq_u32 vcc, -1, v24
v_smfmac_f32_16x16x64_bf16 v[64:67], v[20:23], v[112:119], v2
v_smfmac_f32_16x16x64_bf16 v[68:71], v[20:23], v[120:127], v2
buffer_load_dwordx4 v[44:47], v0, s[8:11], s52 offen sc1
s_cbranch_vccnz Lc_retry31
Lc_back31:
v_smfmac_f32_16x16x64_bf16 v[48:51], v[24:27], a[96:103], v2
s_waitcnt vmcnt(5)
s_barrier
v_smfmac_f32_16x16x64_bf16 v[52:55], v[24:27], a[104:111], v2
s_waitcnt vmcnt(4)
v_cmp_eq_u32 vcc, -1, v28
v_smfmac_f32_16x16x64_bf16 v[56:59], v[24:27], a[112:119], v2
ds_read_b128 v[12:15], v0
v_smfmac_f32_16x16x64_bf16 v[60:63], v[24:27], a[120:127], v2
ds_read_b128 v[16:19], v0 offset:4096
s_cbranch_vccnz Lc_retry41
Lc_back41:
v_smfmac_f32_16x16x64_bf16 v[48:51], v[28:31], a[128:135], v2
ds_read_b128 v[20:23], v0 offset:1024
v_smfmac_f32_16x16x64_bf16 v[52:55], v[28:31], a[136:143], v2
s_waitcnt vmcnt(3)
v_cmp_eq_u32 vcc, -1, v32
v_smfmac_f32_16x16x64_bf16 v[56:59], v[28:31], a[144:151], v2
v_smfmac_f32_16x16x64_bf16 v[60:63], v[28:31], a[152:159], v2
s_cbranch_vccnz Lc_retry51
Lc_back51:
v_smfmac_f32_16x16x64_bf16 v[48:51], v[32:35], a[160:167], v2
v_smfmac_f32_16x16x64_bf16 v[52:55], v[32:35], a[168:175], v2
s_waitcnt vmcnt(2)
v_cmp_eq_u32 vcc, -1, v36
v_smfmac_f32_16x16x64_bf16 v[56:59], v[32:35], a[176:183], v2
v_smfmac_f32_16x16x64_bf16 v[60:63], v[32:35], a[184:191], v2
s_cbranch_vccnz Lc_retry61
Lc_back61:
v_smfmac_f32_16x16x64_bf16 v[48:51], v[36:39], a[192:199], v2
v_smfmac_f32_16x16x64_bf16 v[52:55], v[36:39], a[200:207], v2
s_waitcnt vmcnt(1)
v_cmp_eq_u32 vcc, -1, v40
v_smfmac_f32_16x16x64_bf16 v[56:59], v[36:39], a[208:215], v2
v_smfmac_f32_16x16x64_bf16 v[60:63], v[36:39], a[216:223], v2
s_cbranch_vccnz Lc_retry71
Lc_back71:
v_smfmac_f32_16x16x64_bf16 v[48:51], v[40:43], a[224:231], v2
v_smfmac_f32_16x16x64_bf16 v[52:55], v[40:43], a[232:239], v2
s_waitcnt vmcnt(0)
v_cmp_eq_u32 vcc, -1, v44
v_smfmac_f32_16x16x64_bf16 v[56:59], v[40:43], a[240:247], v2
v_smfmac_f32_16x16x64_bf16 v[60:63], v[40:43], a[248:255], v2
s_cbranch_vccnz Lc_retry81
Lc_back81:
v_smfmac_f32_16x16x64_bf16 v[48:51], v[44:47], v[224:231], v2
v_smfmac_f32_16x16x64_bf16 v[52:55], v[44:47], v[232:239], v2
v_smfmac_f32_16x16x64_bf16 v[56:59], v[44:47], v[240:247], v2
v_add_f32 v48, v48, v50
v_smfmac_f32_16x16x64_bf16 v[60:63], v[44:47], v[248:255], v2
v_add_f32 v49, v49, v51
v_smfmac_f32_16x16x64_bf16 v[64:67], v[24:27], v[128:135], v2
v_add_f32 v52, v52, v54
v_smfmac_f32_16x16x64_bf16 v[68:71], v[24:27], v[136:143], v2
v_add_f32 v53, v53, v55
Lc_post1:
v_add_f32 v56, v56, v58
v_add_f32 v60, v60, v62
v_cvt_pk_bf16_f32 v50, v48, v52
v_cvt_pk_bf16_f32 v51, v56, v60
v_xor_b32 v58, 16, v3
ds_write_b64 v3, v[50:51] offset:16384
v_add_f32 v57, v57, v59
v_add_f32 v61, v61, v63
v_cvt_pk_bf16_f32 v54, v49, v53
v_cvt_pk_bf16_f32 v55, v57, v61
ds_write_b64 v58, v[54:55] offset:16384
v_cmp_u_f32 vcc, v48, v49
v_smfmac_f32_16x16x64_bf16 v[64:67], v[28:31], v[144:151], v2
v_smfmac_f32_16x16x64_bf16 v[68:71], v[28:31], v[152:159], v2
s_cbranch_vccnz Lc_redo1
Lc_redoback1:
v_smfmac_f32_16x16x64_bf16 v[64:67], v[32:35], v[160:167], v2
s_cmp_lt_u32 s96, 3
v_smfmac_f32_16x16x64_bf16 v[68:71], v[32:35], v[168:175], v2
s_cbranch_scc1 Lc_hist1
Lc_histback1:
v_xor_b32 v32, 64, v4
s_waitcnt lgkmcnt(0)
s_barrier
ds_read_b128 v[28:31], v4 offset:16384
ds_read_b128 v[32:35], v32 offset:17408
ds_read_b128 v[56:59], v0 offset:5120
v_smfmac_f32_16x16x64_bf16 v[64:67], v[36:39], v[176:183], v2
s_cmp_eq_u32 s18, 62
v_smfmac_f32_16x16x64_bf16 v[68:71], v[36:39], v[184:191], v2
s_cbranch_scc1 Lc_km1
Lc_kmb1:
ds_read_b128 v[36:39], v4 offset:18432
ds_read_b128 v[60:63], v0 offset:2048
ds_read_b128 v[24:27], v0 offset:6144
v_smfmac_f32_16x16x64_bf16 v[64:67], v[40:43], v[192:199], v2
v_smfmac_f32_16x16x64_bf16 v[68:71], v[40:43], v[200:207], v2
v_xor_b32 v40, 64, v4
ds_read_b128 v[40:43], v40 offset:19456
v_smfmac_f32_16x16x64_bf16 v[64:67], v[44:47], v[208:215], v2
v_smfmac_f32_16x16x64_bf16 v[68:71], v[44:47], v[216:223], v2
s_waitcnt lgkmcnt(6)
v_mfma_f32_16x16x32_bf16 v[48:51], v[12:15], v[28:31], 0
ds_read_b128 v[12:15], v0 offset:3072
v_mfma_f32_16x16x32_bf16 v[52:55], v[16:19], v[28:31], 0
ds_read_b128 v[16:19], v0 offset:7168
v_mfma_f32_16x16x32_bf16 v[44:47], v[28:31], v[28:31], 0
s_waitcnt lgkmcnt(6)
v_mfma_f32_16x16x32_bf16 v[48:51], v[20:23], v[32:35], v[48:51]
v_add_f32 v64, v64, v66
v_add_f32 v65, v65, v67
v_mfma_f32_16x16x32_bf16 v[52:55], v[56:59], v[32:35], v[52:55]
v_add_f32 v68, v68, v70
ds_read_b128 v[56:59], v0 offset:10240
v_mfma_f32_16x16x32_bf16 v[44:47], v[32:35], v[32:35], v[44:47]
v_add_f32 v69, v69, v71
v_cvt_pk_bf16_f32 v66, v64, v65
s_waitcnt lgkmcnt(4)
v_mfma_f32_16x16x32_bf16 v[48:51], v[60:63], v[36:39], v[48:51]
v_cvt_pk_bf16_f32 v67, v68, v69
ds_read_b128 v[60:63], v0 offset:11264
v_mfma_f32_16x16x32_bf16 v[52:55], v[24:27], v[36:39], v[52:55]
ds_read_b128 v[28:31], v1
s_cmp_eq_u32 s18, 62
v_mfma_f32_16x16x32_bf16 v[44:47], v[36:39], v[36:39], v[44:47]
ds_read_b128 v[32:35], v1 offset:1024
s_cbranch_scc1 Lc_vm1
Lc_vmb1:
s_waitcnt lgkmcnt(4)
v_mfma_f32_16x16x32_bf16 v[44:47], v[40:43], v[40:43], v[44:47]
s_barrier
v_mfma_f32_16x16x32_bf16 v[48:51], v[12:15], v[40:43], v[48:51]
ds_read_b128 v[20:23], v1 offset:2048
v_mfma_f32_16x16x32_bf16 v[52:55], v[16:19], v[40:43], v[52:55]
ds_read_b128 v[24:27], v1 offset:3072
v_mov_b32 v36, -1
v_mov_b32 v37, -1
v_mov_b32 v38, -1
v_max3_f32 v64, v46, v47, v48
v_max3_f32 v64, v64, v49, v50
v_mov_b32 v39, -1
s_nop 0
v_max3_f32 v65, v51, v52, v53
v_max3_f32 v65, v65, v54, v55
v_max_f32 v44, v64, v65
v_max_f32 v65, v64, v65
ds_read_b128 v[12:15], v1 offset:4096
ds_read_b128 v[16:19], v1 offset:5120
v_permlane32_swap_b32 v44, v65
v_max_f32 v64, v44, v65
v_max_f32 v65, v44, v65
s_mov_b32 s20, s24
s_bitcmp0_b32 s18, 1
v_permlane16_swap_b32 v64, v65
v_max_f32 v64, v64, v65
v_fma_f32 v64, v64, s30, v5
v_pk_fma_f32 v[46:47], v[46:47], s[30:31], v[64:65] op_sel_hi:[1,1,0] neg_lo:[0,0,1] neg_hi:[0,0,1]
v_pk_fma_f32 v[48:49], v[48:49], s[30:31], v[64:65] op_sel_hi:[1,1,0] neg_lo:[0,0,1] neg_hi:[0,0,1]
v_pk_fma_f32 v[50:51], v[50:51], s[30:31], v[64:65] op_sel_hi:[1,1,0] neg_lo:[0,0,1] neg_hi:[0,0,1]
v_pk_fma_f32 v[52:53], v[52:53], s[30:31], v[64:65] op_sel_hi:[1,1,0] neg_lo:[0,0,1] neg_hi:[0,0,1]
v_pk_fma_f32 v[54:55], v[54:55], s[30:31], v[64:65] op_sel_hi:[1,1,0] neg_lo:[0,0,1] neg_hi:[0,0,1]
v_exp_f32 v46, v46
v_exp_f32 v47, v47
v_exp_f32 v48, v48
v_cvt_pk_bf16_f32 v44, v46, v47
v_exp_f32 v49, v49
v_exp_f32 v50, v50
v_mov_b32_dpp v45, v44 quad_perm:[2,3,0,1] row_mask:0xf bank_mask:0xf
v_exp_f32 v51, v51
v_cvt_pk_bf16_f32 v48, v48, v49
v_mfma_f32_16x16x16_bf16 v[40:43], v[66:67], v[44:45], 0
ds_write_b128 v0, v[36:39] offset:17408
v_exp_f32 v52, v52
v_mfma_f32_16x16x16_bf16 v[68:71], v[8:9], v[44:45], 0
v_exp_f32 v53, v53
v_cvt_pk_bf16_f32 v49, v50, v51
v_exp_f32 v54, v54
v_exp_f32 v55, v55
v_cvt_pk_bf16_f32 v50, v52, v53
v_mov_b32_dpp v52, v48 quad_perm:[2,3,0,1] row_mask:0xf bank_mask:0xf
v_cvt_pk_bf16_f32 v51, v54, v55
v_mov_b32_dpp v53, v49 quad_perm:[2,3,0,1] row_mask:0xf bank_mask:0xf
s_cselect_b32 s32, -1, 0
s_waitcnt lgkmcnt(7)
v_mfma_f32_16x16x32_bf16 v[68:71], v[8:11], v[48:51], v[68:71]
v_mov_b32_dpp v54, v50 quad_perm:[2,3,0,1] row_mask:0xf bank_mask:0xf
v_mov_b32_dpp v55, v51 quad_perm:[2,3,0,1] row_mask:0xf bank_mask:0xf
v_mfma_f32_16x16x32_bf16 v[40:43], v[56:59], v[48:51], v[40:43]
s_mov_b32 s53, s25
s_add_u32 s55, s22, s34
v_mfma_f32_16x16x32_bf16 v[40:43], v[60:63], v[52:55], v[40:43]
s_add_u32 s49, s23, s34
s_add_u32 s38, s38, 64
ds_read_b128 v[44:47], v1 offset:6144
ds_read_b128 v[48:51], v1 offset:7168
v_rcp_f32 v56, v68
s_add_u32 s18, s18, 1
s_add_u32 s27, s27, 9216
v_mov_b32_dpp v56, v56 quad_perm:[0,1,0,1] row_mask:0xf bank_mask:0xf
v_pk_mul_f32 v[40:41], v[40:41], v[56:57] op_sel_hi:[1,0]
v_pk_mul_f32 v[42:43], v[42:43], v[56:57] op_sel_hi:[1,0]
v_cvt_pk_bf16_f32 v40, v40, v41
v_cvt_pk_bf16_f32 v41, v42, v43
ds_write_b64 v7, v[40:41] offset:20992
v_or_b32 v36, v7, v5
ds_read_b128 v[64:67], v1 offset:8192
ds_read_b128 v[68:71], v1 offset:9216
s_mov_b32 s22, s23
s_add_u32 s23, s23, 9216
s_waitcnt lgkmcnt(2)
s_barrier
ds_read_b128 v[8:11], v36 offset:20992
ds_read_b128 v[36:39], v36 offset:20480
ds_read_b128 v[40:43], v0 offset:21504
s_cmp_eq_u32 s23, 12610560
s_cselect_b32 s23, 12582912, s23
s_add_u32 s24, s24, s33
s_add_u32 s25, s25, s33
s_sub_u32 s33, 0, s33
s_add_u32 s51, s22, 4096
s_add_u32 s52, s22, 8192
s_waitcnt lgkmcnt(1)
v_mfma_f32_16x16x32_bf16 v[52:55], v[36:39], v[72:75], 0
v_mfma_f32_16x16x32_bf16 v[52:55], v[8:11], v[76:79], v[52:55]
s_waitcnt lgkmcnt(0)
v_smfmac_f32_16x16x64_bf16 v[52:55], v[40:43], v[28:35], v2
ds_read_b128 v[28:31], v1 offset:10240
ds_read_b128 v[32:35], v1 offset:11264
v_mfma_f32_16x16x32_bf16 v[56:59], v[36:39], v[20:23], 0
v_mfma_f32_16x16x32_bf16 v[56:59], v[8:11], v[24:27], v[56:59]
ds_read_b128 v[20:23], v1 offset:12288
v_add_f32 v52, v52, v54
v_smfmac_f32_16x16x64_bf16 v[56:59], v[40:43], v[12:19], v2
ds_read_b128 v[24:27], v1 offset:13312
ds_read_b128 v[12:15], v1 offset:14336
v_add_f32 v53, v53, v55
v_cvt_pk_bf16_f32 v54, v52, v53
v_bfi_b32 v54, -2, v54, s32
s_nop 2
v_add_f32 v56, v56, v58
v_add_f32 v57, v57, v59
v_cvt_pk_bf16_f32 v55, v56, v57
buffer_store_dwordx2 v[54:55], v6, s[8:11], s20 offen
s_add_u32 s20, s20, 49152
v_mfma_f32_16x16x32_bf16 v[60:63], v[36:39], v[44:47], 0
ds_read_b128 v[16:19], v1 offset:15360
v_mfma_f32_16x16x32_bf16 v[60:63], v[8:11], v[48:51], v[60:63]
ds_read_b128 v[44:47], v1 offset:16384
v_smfmac_f32_16x16x64_bf16 v[60:63], v[40:43], v[64:71], v2
ds_read_b128 v[48:51], v1 offset:17408
ds_read_b128 v[64:67], v1 offset:18432
s_waitcnt lgkmcnt(7)
v_mfma_f32_16x16x32_bf16 v[52:55], v[36:39], v[28:31], 0
ds_read_b128 v[68:71], v1 offset:19456
v_mfma_f32_16x16x32_bf16 v[52:55], v[8:11], v[32:35], v[52:55]
ds_read_b128 v[28:31], v1 offset:20480
s_waitcnt lgkmcnt(7)
v_smfmac_f32_16x16x64_bf16 v[52:55], v[40:43], v[20:27], v2
ds_read_b128 v[32:35], v1 offset:21504
ds_read_b128 v[20:23], v1 offset:22528
s_waitcnt lgkmcnt(7)
v_mfma_f32_16x16x32_bf16 v[56:59], v[36:39], v[12:15], 0
ds_read_b128 v[24:27], v1 offset:23552
v_add_f32 v60, v60, v62
v_mfma_f32_16x16x32_bf16 v[56:59], v[8:11], v[16:19], v[56:59]
ds_read_b128 v[12:15], v1 offset:24576
v_add_f32 v61, v61, v63
s_waitcnt lgkmcnt(7)
v_smfmac_f32_16x16x64_bf16 v[56:59], v[40:43], v[44:51], v2
ds_read_b128 v[16:19], v1 offset:25600
ds_read_b128 v[44:47], v1 offset:26624
v_add_f32 v52, v52, v54
v_cvt_pk_bf16_f32 v54, v60, v61
v_add_f32 v53, v53, v55
s_waitcnt lgkmcnt(7)
v_mfma_f32_16x16x32_bf16 v[60:63], v[36:39], v[64:67], 0
ds_read_b128 v[48:51], v1 offset:27648
v_bfi_b32 v54, -2, v54, s32
v_mfma_f32_16x16x32_bf16 v[60:63], v[8:11], v[68:71], v[60:63]
ds_read_b128 v[64:67], v1 offset:28672
v_cvt_pk_bf16_f32 v55, v52, v53
s_waitcnt lgkmcnt(7)
v_smfmac_f32_16x16x64_bf16 v[60:63], v[40:43], v[28:35], v2
ds_read_b128 v[68:71], v1 offset:29696
ds_read_b128 v[28:31], v1 offset:30720
buffer_store_dwordx2 v[54:55], v6, s[8:11], s20 offen
s_add_u32 s20, s20, 49152
s_waitcnt lgkmcnt(7)
v_mfma_f32_16x16x32_bf16 v[52:55], v[36:39], v[20:23], 0
ds_read_b128 v[32:35], v1 offset:31744
v_add_f32 v56, v56, v58
v_mfma_f32_16x16x32_bf16 v[52:55], v[8:11], v[24:27], v[52:55]
ds_read_b128 v[20:23], v1 offset:32768
v_add_f32 v57, v57, v59
s_waitcnt lgkmcnt(7)
v_smfmac_f32_16x16x64_bf16 v[52:55], v[40:43], v[12:19], v2
ds_read_b128 v[24:27], v1 offset:33792
ds_read_b128 v[12:15], v1 offset:34816
v_add_f32 v60, v60, v62
v_cvt_pk_bf16_f32 v62, v56, v57
v_add_f32 v61, v61, v63
s_waitcnt lgkmcnt(7)
v_mfma_f32_16x16x32_bf16 v[56:59], v[36:39], v[44:47], 0
ds_read_b128 v[16:19], v1 offset:35840
v_bfi_b32 v62, -2, v62, s32
v_mfma_f32_16x16x32_bf16 v[56:59], v[8:11], v[48:51], v[56:59]
ds_read_b128 v[44:47], v1 offset:36864
v_cvt_pk_bf16_f32 v63, v60, v61
s_waitcnt lgkmcnt(7)
v_smfmac_f32_16x16x64_bf16 v[56:59], v[40:43], v[64:71], v2
ds_read_b128 v[48:51], v1 offset:37888
ds_read_b128 v[64:67], v1 offset:38912
buffer_store_dwordx2 v[62:63], v6, s[8:11], s20 offen
s_add_u32 s20, s20, 49152
s_waitcnt lgkmcnt(7)
v_mfma_f32_16x16x32_bf16 v[60:63], v[36:39], v[28:31], 0
ds_read_b128 v[68:71], v1 offset:39936
v_add_f32 v52, v52, v54
v_mfma_f32_16x16x32_bf16 v[60:63], v[8:11], v[32:35], v[60:63]
ds_read_b128 v[28:31], v1 offset:40960
v_add_f32 v53, v53, v55
s_waitcnt lgkmcnt(7)
v_smfmac_f32_16x16x64_bf16 v[60:63], v[40:43], v[20:27], v2
ds_read_b128 v[32:35], v1 offset:41984
ds_read_b128 v[20:23], v1 offset:43008
v_add_f32 v56, v56, v58
v_cvt_pk_bf16_f32 v58, v52, v53
v_add_f32 v57, v57, v59
s_waitcnt lgkmcnt(7)
v_mfma_f32_16x16x32_bf16 v[52:55], v[36:39], v[12:15], 0
ds_read_b128 v[24:27], v1 offset:44032
v_bfi_b32 v58, -2, v58, s32
v_mfma_f32_16x16x32_bf16 v[52:55], v[8:11], v[16:19], v[52:55]
ds_read_b128 v[12:15], v1 offset:45056
v_cvt_pk_bf16_f32 v59, v56, v57
s_waitcnt lgkmcnt(7)
v_smfmac_f32_16x16x64_bf16 v[52:55], v[40:43], v[44:51], v2
ds_read_b128 v[16:19], v1 offset:46080
buffer_store_dwordx2 v[58:59], v6, s[8:11], s20 offen
s_add_u32 s20, s20, 49152
s_waitcnt lgkmcnt(6)
v_mfma_f32_16x16x32_bf16 v[56:59], v[36:39], v[64:67], 0
v_add_f32 v60, v60, v62
v_mfma_f32_16x16x32_bf16 v[56:59], v[8:11], v[68:71], v[56:59]
v_add_f32 v61, v61, v63
s_waitcnt lgkmcnt(4)
v_smfmac_f32_16x16x64_bf16 v[56:59], v[40:43], v[28:35], v2
v_add_f32 v52, v52, v54
v_cvt_pk_bf16_f32 v54, v60, v61
v_add_f32 v53, v53, v55
s_waitcnt lgkmcnt(2)
v_mfma_f32_16x16x32_bf16 v[60:63], v[36:39], v[20:23], 0
v_bfi_b32 v54, -2, v54, s32
v_mfma_f32_16x16x32_bf16 v[60:63], v[8:11], v[24:27], v[60:63]
v_cvt_pk_bf16_f32 v55, v52, v53
s_waitcnt lgkmcnt(0)
v_smfmac_f32_16x16x64_bf16 v[60:63], v[40:43], v[12:19], v2
buffer_store_dwordx2 v[54:55], v6, s[8:11], s20 offen
s_add_u32 s20, s20, 49152
s_add_u32 s26, s26, 524288
s_mov_b32 m0, 16384
v_mov_b64 v[48:49], 0
v_mov_b64 v[50:51], 0
v_mov_b64 v[52:53], 0
v_mov_b64 v[54:55], 0
v_mov_b64 v[64:65], 0
v_mov_b64 v[66:67], 0
v_mov_b64 v[68:69], 0
v_mov_b64 v[70:71], 0
v_add_f32 v56, v56, v58
v_add_f32 v57, v57, v59
v_add_f32 v60, v60, v62
v_cvt_pk_bf16_f32 v62, v56, v57
v_add_f32 v61, v61, v63
v_bfi_b32 v62, -2, v62, s32
v_cvt_pk_bf16_f32 v63, v60, v61
buffer_store_dwordx2 v[62:63], v6, s[8:11], s20 offen
v_mov_b32 v8, 0x3f803f80
v_mov_b32 v9, v8
v_mov_b64 v[10:11], v[8:9]
v_mov_b64 v[56:57], 0
v_mov_b64 v[58:59], 0
v_mov_b64 v[60:61], 0
v_mov_b64 v[62:63], 0
s_cmp_eq_u32 s18, 40
s_cbranch_scc1 Lc_pre1
Lc_preb1:
s_mov_b32 s75, 0
s_mov_b32 s19, s74
Lc_dl1:
s_sub_u32 s19, s19, 1
s_cbranch_scc0 Lc_dl1
s_cmp_eq_u32 s18, 63
s_cbranch_scc0 Lc_top1
s_waitcnt vmcnt(0)
s_lshl_b32 s19, s17, 5
s_add_u32 s19, s19, 129032
buffer_store_dword v2, off, s[8:11], s19 sc1
buffer_store_dword v2, off, s[8:11], s19 offset:4 sc1
s_branch Lc_topL1
Lc_hist1:
s_cmp_eq_u32 s96, 0
s_cbranch_scc0 Lc_hist11
buffer_store_dwordx4 v[24:27], v0, s[8:11], s27 offen sc1
s_nop 0
s_branch Lc_histback1
Lc_hist11:
s_cmp_eq_u32 s96, 1
s_cbranch_scc0 Lc_hist21
buffer_store_dwordx4 v[28:31], v0, s[8:11], s27 offen sc1
s_nop 0
s_branch Lc_histback1
Lc_hist21:
buffer_store_dwordx4 v[32:35], v0, s[8:11], s27 offen sc1
s_nop 0
s_branch Lc_histback1
Lc_km1:
v_bfe_u32 v48, v0, 7, 1
v_lshlrev_b32 v48, 9, v48
v_bfe_u32 v49, v0, 5, 2
v_lshl_add_u32 v48, v49, 7, v48
v_lshrrev_b32 v49, 8, v0
v_lshl_add_u32 v48, v49, 5, v48
v_bfe_u32 v49, v0, 4, 1
v_lshl_add_u32 v48, v49, 3, v48
s_mul_i32 s19, s17, 4096
s_add_u32 s19, s19, 24904704
buffer_store_dwordx2 v[50:51], v48, s[8:11], s19 offen sc1
buffer_store_dwordx2 v[54:55], v48, s[8:11], s19 offen offset:16 sc1
s_branch Lc_kmb1
Lc_vm1:
v_lshrrev_b32 v64, 1, v0
s_mul_i32 s19, s17, 4096
s_add_u32 s19, s19, 24906240
buffer_store_dwordx2 v[66:67], v64, s[8:11], s19 offen sc1
s_branch Lc_vmb1
Lc_pre1:
v_mov_b32 v12, 0
global_load_dword v13, v12, s[6:7] offset:104 sc1
s_waitcnt vmcnt(0)
v_cmp_gt_u32 vcc, 28, v13
s_cbranch_vccz Lc_preb1
s_add_u32 s21, s21, 1
s_cmp_ge_u32 s21, 4194304
s_cbranch_scc1 L_abort
s_branch Lc_pre1
Lc_retry21:
buffer_load_dwordx4 v0, s[8:11], s22 offen offset:2048 sc1 lds
ds_read_b128 v[20:23], v0 offset:18432
s_add_u32 s21, s21, 1
s_cmp_ge_u32 s21, 4194304
s_cbranch_scc1 L_abort
s_waitcnt lgkmcnt(0)
v_cmp_eq_u32 vcc, -1, v20
s_cbranch_vccnz Lc_retry21
s_waitcnt vmcnt(0)
s_branch Lc_back21
Lc_retry31:
buffer_load_dwordx4 v0, s[8:11], s22 offen offset:3072 sc1 lds
ds_read_b128 v[24:27], v0 offset:19456
s_add_u32 s21, s21, 1
s_cmp_ge_u32 s21, 4194304
s_cbranch_scc1 L_abort
s_waitcnt lgkmcnt(0)
v_cmp_eq_u32 vcc, -1, v24
s_cbranch_vccnz Lc_retry31
s_waitcnt vmcnt(0)
s_branch Lc_back31
Lc_retry41:
buffer_load_dwordx4 v[28:31], v0, s[8:11], s51 offen sc1
s_waitcnt vmcnt(0)
v_cmp_eq_u32 vcc, -1, v28
s_cbranch_vccz Lc_back41
s_add_u32 s21, s21, 1
s_cmp_ge_u32 s21, 4194304
s_cbranch_scc1 L_abort
s_branch Lc_retry41
Lc_retry51:
buffer_load_dwordx4 v[32:35], v0, s[8:11], s51 offen offset:1024 sc1
s_waitcnt vmcnt(0)
v_cmp_eq_u32 vcc, -1, v32
s_cbranch_vccz Lc_back51
s_add_u32 s21, s21, 1
s_cmp_ge_u32 s21, 4194304
s_cbranch_scc1 L_abort
s_branch Lc_retry51
Lc_retry61:
buffer_load_dwordx4 v[36:39], v0, s[8:11], s51 offen offset:2048 sc1
s_waitcnt vmcnt(0)
v_cmp_eq_u32 vcc, -1, v36
s_cbranch_vccz Lc_back61
s_add_u32 s21, s21, 1
s_cmp_ge_u32 s21, 4194304
s_cbranch_scc1 L_abort
s_branch Lc_retry61
Lc_retry71:
buffer_load_dwordx4 v[40:43], v0, s[8:11], s51 offen offset:3072 sc1
s_waitcnt vmcnt(0)
v_cmp_eq_u32 vcc, -1, v40
s_cbranch_vccz Lc_back71
s_add_u32 s21, s21, 1
s_cmp_ge_u32 s21, 4194304
s_cbranch_scc1 L_abort
s_branch Lc_retry71
Lc_retry81:
buffer_load_dwordx4 v[44:47], v0, s[8:11], s52 offen sc1
s_waitcnt vmcnt(0)
v_cmp_eq_u32 vcc, -1, v44
s_cbranch_vccz Lc_back81
s_add_u32 s21, s21, 1
s_cmp_ge_u32 s21, 4194304
s_cbranch_scc1 L_abort
s_branch Lc_retry81
Lc_redo1:
s_cmp_eq_u32 s48, s18
s_cbranch_scc1 Lc_redoback1
s_mov_b32 s48, s18
s_waitcnt lgkmcnt(0)
s_nop 15
Lc_redo21:
buffer_load_dwordx4 v[12:15], v0, s[8:11], s22 offen sc1
buffer_load_dwordx4 v[16:19], v0, s[8:11], s22 offen offset:1024 sc1
buffer_load_dwordx4 v[20:23], v0, s[8:11], s22 offen offset:2048 sc1
buffer_load_dwordx4 v[24:27], v0, s[8:11], s22 offen offset:3072 sc1
buffer_load_dwordx4 v[28:31], v0, s[8:11], s51 offen sc1
buffer_load_dwordx4 v[32:35], v0, s[8:11], s51 offen offset:1024 sc1
buffer_load_dwordx4 v[36:39], v0, s[8:11], s51 offen offset:2048 sc1
buffer_load_dwordx4 v[40:43], v0, s[8:11], s51 offen offset:3072 sc1
buffer_load_dwordx4 v[44:47], v0, s[8:11], s52 offen sc1
v_mov_b64 v[48:49], 0
v_mov_b64 v[50:51], 0
v_mov_b64 v[52:53], 0
v_mov_b64 v[54:55], 0
v_mov_b64 v[56:57], 0
v_mov_b64 v[58:59], 0
v_mov_b64 v[60:61], 0
v_mov_b64 v[62:63], 0
v_mov_b64 v[64:65], 0
v_mov_b64 v[66:67], 0
v_mov_b64 v[68:69], 0
v_mov_b64 v[70:71], 0
s_waitcnt vmcnt(0)
v_max_u32 v48, v12, v13
v_max3_u32 v48, v48, v14, v15
v_max3_u32 v48, v48, v16, v17
v_max3_u32 v48, v48, v18, v19
v_max3_u32 v48, v48, v20, v21
v_max3_u32 v48, v48, v22, v23
v_max3_u32 v48, v48, v24, v25
v_max3_u32 v48, v48, v26, v27
v_max3_u32 v48, v48, v28, v29
v_max3_u32 v48, v48, v30, v31
v_max3_u32 v48, v48, v32, v33
v_max3_u32 v48, v48, v34, v35
v_max3_u32 v48, v48, v36, v37
v_max3_u32 v48, v48, v38, v39
v_max3_u32 v48, v48, v40, v41
v_max3_u32 v48, v48, v42, v43
v_max3_u32 v48, v48, v44, v45
v_max3_u32 v48, v48, v46, v47
v_cmp_eq_u32 vcc, -1, v48
v_mov_b32 v48, 0
s_cbranch_vccnz Lc_redo31
s_nop 0
v_smfmac_f32_16x16x64_bf16 v[48:51], v[12:15], a[0:7], v2
v_smfmac_f32_16x16x64_bf16 v[52:55], v[12:15], a[8:15], v2
v_smfmac_f32_16x16x64_bf16 v[56:59], v[12:15], a[16:23], v2
v_smfmac_f32_16x16x64_bf16 v[60:63], v[12:15], a[24:31], v2
v_smfmac_f32_16x16x64_bf16 v[64:67], v[12:15], v[80:87], v2
v_smfmac_f32_16x16x64_bf16 v[68:71], v[12:15], v[88:95], v2
v_smfmac_f32_16x16x64_bf16 v[48:51], v[16:19], a[32:39], v2
v_smfmac_f32_16x16x64_bf16 v[52:55], v[16:19], a[40:47], v2
v_smfmac_f32_16x16x64_bf16 v[56:59], v[16:19], a[48:55], v2
v_smfmac_f32_16x16x64_bf16 v[60:63], v[16:19], a[56:63], v2
v_smfmac_f32_16x16x64_bf16 v[64:67], v[16:19], v[96:103], v2
v_smfmac_f32_16x16x64_bf16 v[68:71], v[16:19], v[104:111], v2
v_smfmac_f32_16x16x64_bf16 v[48:51], v[20:23], a[64:71], v2
v_smfmac_f32_16x16x64_bf16 v[52:55], v[20:23], a[72:79], v2
v_smfmac_f32_16x16x64_bf16 v[56:59], v[20:23], a[80:87], v2
v_smfmac_f32_16x16x64_bf16 v[60:63], v[20:23], a[88:95], v2
v_smfmac_f32_16x16x64_bf16 v[64:67], v[20:23], v[112:119], v2
v_smfmac_f32_16x16x64_bf16 v[68:71], v[20:23], v[120:127], v2
v_smfmac_f32_16x16x64_bf16 v[48:51], v[24:27], a[96:103], v2
v_smfmac_f32_16x16x64_bf16 v[52:55], v[24:27], a[104:111], v2
v_smfmac_f32_16x16x64_bf16 v[56:59], v[24:27], a[112:119], v2
v_smfmac_f32_16x16x64_bf16 v[60:63], v[24:27], a[120:127], v2
v_smfmac_f32_16x16x64_bf16 v[64:67], v[24:27], v[128:135], v2
v_smfmac_f32_16x16x64_bf16 v[68:71], v[24:27], v[136:143], v2
v_smfmac_f32_16x16x64_bf16 v[48:51], v[28:31], a[128:135], v2
v_smfmac_f32_16x16x64_bf16 v[52:55], v[28:31], a[136:143], v2
v_smfmac_f32_16x16x64_bf16 v[56:59], v[28:31], a[144:151], v2
v_smfmac_f32_16x16x64_bf16 v[60:63], v[28:31], a[152:159], v2
v_smfmac_f32_16x16x64_bf16 v[48:51], v[32:35], a[160:167], v2
v_smfmac_f32_16x16x64_bf16 v[52:55], v[32:35], a[168:175], v2
v_smfmac_f32_16x16x64_bf16 v[56:59], v[32:35], a[176:183], v2
v_smfmac_f32_16x16x64_bf16 v[60:63], v[32:35], a[184:191], v2
v_smfmac_f32_16x16x64_bf16 v[48:51], v[36:39], a[192:199], v2
v_smfmac_f32_16x16x64_bf16 v[52:55], v[36:39], a[200:207], v2
v_smfmac_f32_16x16x64_bf16 v[56:59], v[36:39], a[208:215], v2
v_smfmac_f32_16x16x64_bf16 v[60:63], v[36:39], a[216:223], v2
v_smfmac_f32_16x16x64_bf16 v[48:51], v[40:43], a[224:231], v2
v_smfmac_f32_16x16x64_bf16 v[52:55], v[40:43], a[232:239], v2
v_smfmac_f32_16x16x64_bf16 v[56:59], v[40:43], a[240:247], v2
v_smfmac_f32_16x16x64_bf16 v[60:63], v[40:43], a[248:255], v2
v_smfmac_f32_16x16x64_bf16 v[48:51], v[44:47], v[224:231], v2
v_smfmac_f32_16x16x64_bf16 v[52:55], v[44:47], v[232:239], v2
v_smfmac_f32_16x16x64_bf16 v[56:59], v[44:47], v[240:247], v2
v_smfmac_f32_16x16x64_bf16 v[60:63], v[44:47], v[248:255], v2
ds_read_b128 v[12:15], v0
ds_read_b128 v[16:19], v0 offset:4096
ds_read_b128 v[20:23], v0 offset:1024
s_nop 7
v_add_f32 v48, v48, v50
v_add_f32 v49, v49, v51
v_add_f32 v52, v52, v54
v_add_f32 v53, v53, v55
s_branch Lc_post1
Lc_redo31:
s_add_u32 s21, s21, 1
s_cmp_ge_u32 s21, 4194304
s_cbranch_scc1 L_abort
s_branch Lc_redo21
.p2align 6
s_nop 0
s_nop 0
Lc_top2:
buffer_load_dwordx4 v0, s[8:11], s22 offen offset:2048 sc1 lds
buffer_load_dwordx4 v0, s[8:11], s22 offen offset:3072 sc1 lds
ds_read_b128 v[12:15], v0 offset:16384
ds_read_b128 v[16:19], v0 offset:17408
s_add_u32 s21, s21, 1
s_cmp_ge_u32 s21, 4194304
s_cbranch_scc1 L_abort
s_waitcnt lgkmcnt(0)
v_max_u32 v43, v12, v16
v_cmp_eq_u32 vcc, -1, v43
s_cbranch_vccnz Lc_top2
v_smfmac_f32_16x16x64_bf16 v[48:51], v[12:15], a[0:7], v2
buffer_load_dwordx4 v0, s[8:11], s22 offen offset:2048 sc1 lds
buffer_load_dwordx4 v0, s[8:11], s22 offen offset:3072 sc1 lds
v_smfmac_f32_16x16x64_bf16 v[52:55], v[12:15], a[8:15], v2
v_smfmac_f32_16x16x64_bf16 v[56:59], v[12:15], a[16:23], v2
buffer_load_dwordx4 v[28:31], v0, s[8:11], s51 offen sc1
v_smfmac_f32_16x16x64_bf16 v[60:63], v[12:15], a[24:31], v2
v_smfmac_f32_16x16x64_bf16 v[64:67], v[12:15], v[80:87], v2
ds_read_b128 v[20:23], v0 offset:18432
v_smfmac_f32_16x16x64_bf16 v[68:71], v[12:15], v[88:95], v2
v_smfmac_f32_16x16x64_bf16 v[48:51], v[16:19], a[32:39], v2
buffer_load_dwordx4 v[32:35], v0, s[8:11], s51 offen offset:1024 sc1
v_smfmac_f32_16x16x64_bf16 v[52:55], v[16:19], a[40:47], v2
v_smfmac_f32_16x16x64_bf16 v[56:59], v[16:19], a[48:55], v2
v_smfmac_f32_16x16x64_bf16 v[60:63], v[16:19], a[56:63], v2
ds_read_b128 v[24:27], v0 offset:19456
s_waitcnt lgkmcnt(1)
v_cmp_eq_u32 vcc, -1, v20
v_smfmac_f32_16x16x64_bf16 v[64:67], v[16:19], v[96:103], v2
buffer_load_dwordx4 v[36:39], v0, s[8:11], s51 offen offset:2048 sc1
v_smfmac_f32_16x16x64_bf16 v[68:71], v[16:19], v[104:111], v2
s_cbranch_vccnz Lc_retry22
Lc_back22:
v_smfmac_f32_16x16x64_bf16 v[48:51], v[20:23], a[64:71], v2
v_smfmac_f32_16x16x64_bf16 v[52:55], v[20:23], a[72:79], v2
v_smfmac_f32_16x16x64_bf16 v[56:59], v[20:23], a[80:87], v2
buffer_load_dwordx4 v[40:43], v0, s[8:11], s51 offen offset:3072 sc1
v_smfmac_f32_16x16x64_bf16 v[60:63], v[20:23], a[88:95], v2
s_waitcnt lgkmcnt(0)
v_cmp_eq_u32 vcc, -1, v24
v_smfmac_f32_16x16x64_bf16 v[64:67], v[20:23], v[112:119], v2
v_smfmac_f32_16x16x64_bf16 v[68:71], v[20:23], v[120:127], v2
buffer_load_dwordx4 v[44:47], v0, s[8:11], s52 offen sc1
s_cbranch_vccnz Lc_retry32
Lc_back32:
v_smfmac_f32_16x16x64_bf16 v[48:51], v[24:27], a[96:103], v2
s_waitcnt vmcnt(5)
s_barrier
v_smfmac_f32_16x16x64_bf16 v[52:55], v[24:27], a[104:111], v2
s_waitcnt vmcnt(4)
v_cmp_eq_u32 vcc, -1, v28
v_smfmac_f32_16x16x64_bf16 v[56:59], v[24:27], a[112:119], v2
ds_read_b128 v[12:15], v0
v_smfmac_f32_16x16x64_bf16 v[60:63], v[24:27], a[120:127], v2
ds_read_b128 v[16:19], v0 offset:4096
s_cbranch_vccnz Lc_retry42
Lc_back42:
v_smfmac_f32_16x16x64_bf16 v[48:51], v[28:31], a[128:135], v2
ds_read_b128 v[20:23], v0 offset:1024
v_smfmac_f32_16x16x64_bf16 v[52:55], v[28:31], a[136:143], v2
s_waitcnt vmcnt(3)
v_cmp_eq_u32 vcc, -1, v32
v_smfmac_f32_16x16x64_bf16 v[56:59], v[28:31], a[144:151], v2
v_smfmac_f32_16x16x64_bf16 v[60:63], v[28:31], a[152:159], v2
s_cbranch_vccnz Lc_retry52
Lc_back52:
v_smfmac_f32_16x16x64_bf16 v[48:51], v[32:35], a[160:167], v2
v_smfmac_f32_16x16x64_bf16 v[52:55], v[32:35], a[168:175], v2
s_waitcnt vmcnt(2)
v_cmp_eq_u32 vcc, -1, v36
v_smfmac_f32_16x16x64_bf16 v[56:59], v[32:35], a[176:183], v2
v_smfmac_f32_16x16x64_bf16 v[60:63], v[32:35], a[184:191], v2
s_cbranch_vccnz Lc_retry62
Lc_back62:
v_smfmac_f32_16x16x64_bf16 v[48:51], v[36:39], a[192:199], v2
v_smfmac_f32_16x16x64_bf16 v[52:55], v[36:39], a[200:207], v2
s_waitcnt vmcnt(1)
v_cmp_eq_u32 vcc, -1, v40
v_smfmac_f32_16x16x64_bf16 v[56:59], v[36:39], a[208:215], v2
v_smfmac_f32_16x16x64_bf16 v[60:63], v[36:39], a[216:223], v2
s_cbranch_vccnz Lc_retry72
Lc_back72:
v_smfmac_f32_16x16x64_bf16 v[48:51], v[40:43], a[224:231], v2
v_smfmac_f32_16x16x64_bf16 v[52:55], v[40:43], a[232:239], v2
s_waitcnt vmcnt(0)
v_cmp_eq_u32 vcc, -1, v44
v_smfmac_f32_16x16x64_bf16 v[56:59], v[40:43], a[240:247], v2
v_smfmac_f32_16x16x64_bf16 v[60:63], v[40:43], a[248:255], v2
s_cbranch_vccnz Lc_retry82
Lc_back82:
v_smfmac_f32_16x16x64_bf16 v[48:51], v[44:47], v[224:231], v2
v_smfmac_f32_16x16x64_bf16 v[52:55], v[44:47], v[232:239], v2
v_smfmac_f32_16x16x64_bf16 v[56:59], v[44:47], v[240:247], v2
v_add_f32 v48, v48, v50
v_smfmac_f32_16x16x64_bf16 v[60:63], v[44:47], v[248:255], v2
v_add_f32 v49, v49, v51
v_smfmac_f32_16x16x64_bf16 v[64:67], v[24:27], v[128:135], v2
v_add_f32 v52, v52, v54
v_smfmac_f32_16x16x64_bf16 v[68:71], v[24:27], v[136:143], v2
v_add_f32 v53, v53, v55
Lc_post2:
v_add_f32 v56, v56, v58
v_add_f32 v60, v60, v62
v_cvt_pk_bf16_f32 v50, v48, v52
v_cvt_pk_bf16_f32 v51, v56, v60
v_xor_b32 v58, 16, v3
ds_write_b64 v3, v[50:51] offset:16384
v_add_f32 v57, v57, v59
v_add_f32 v61, v61, v63
v_cvt_pk_bf16_f32 v54, v49, v53
v_cvt_pk_bf16_f32 v55, v57, v61
ds_write_b64 v58, v[54:55] offset:16384
v_cmp_u_f32 vcc, v48, v49
v_smfmac_f32_16x16x64_bf16 v[64:67], v[28:31], v[144:151], v2
v_smfmac_f32_16x16x64_bf16 v[68:71], v[28:31], v[152:159], v2
s_cbranch_vccnz Lc_redo2
Lc_redoback2:
v_smfmac_f32_16x16x64_bf16 v[64:67], v[32:35], v[160:167], v2
s_cmp_lt_u32 s96, 3
v_smfmac_f32_16x16x64_bf16 v[68:71], v[32:35], v[168:175], v2
s_cbranch_scc1 Lc_hist2
Lc_histback2:
v_xor_b32 v32, 64, v4
s_waitcnt lgkmcnt(0)
s_barrier
ds_read_b128 v[28:31], v4 offset:16384
ds_read_b128 v[32:35], v32 offset:17408
ds_read_b128 v[56:59], v0 offset:5120
v_smfmac_f32_16x16x64_bf16 v[64:67], v[36:39], v[176:183], v2
v_smfmac_f32_16x16x64_bf16 v[68:71], v[36:39], v[184:191], v2
ds_read_b128 v[36:39], v4 offset:18432
ds_read_b128 v[60:63], v0 offset:2048
ds_read_b128 v[24:27], v0 offset:6144
v_smfmac_f32_16x16x64_bf16 v[64:67], v[40:43], v[192:199], v2
v_smfmac_f32_16x16x64_bf16 v[68:71], v[40:43], v[200:207], v2
v_xor_b32 v40, 64, v4
ds_read_b128 v[40:43], v40 offset:19456
v_smfmac_f32_16x16x64_bf16 v[64:67], v[44:47], v[208:215], v2
v_smfmac_f32_16x16x64_bf16 v[68:71], v[44:47], v[216:223], v2
s_waitcnt lgkmcnt(6)
v_mfma_f32_16x16x32_bf16 v[48:51], v[12:15], v[28:31], 0
ds_read_b128 v[12:15], v0 offset:3072
v_mfma_f32_16x16x32_bf16 v[52:55], v[16:19], v[28:31], 0
ds_read_b128 v[16:19], v0 offset:7168
v_mfma_f32_16x16x32_bf16 v[44:47], v[28:31], v[28:31], 0
s_waitcnt lgkmcnt(6)
v_mfma_f32_16x16x32_bf16 v[48:51], v[20:23], v[32:35], v[48:51]
v_add_f32 v64, v64, v66
v_add_f32 v65, v65, v67
v_mfma_f32_16x16x32_bf16 v[52:55], v[56:59], v[32:35], v[52:55]
v_add_f32 v68, v68, v70
ds_read_b128 v[56:59], v0 offset:12288
v_mfma_f32_16x16x32_bf16 v[44:47], v[32:35], v[32:35], v[44:47]
v_add_f32 v69, v69, v71
v_cvt_pk_bf16_f32 v66, v64, v65
s_waitcnt lgkmcnt(4)
v_mfma_f32_16x16x32_bf16 v[48:51], v[60:63], v[36:39], v[48:51]
v_cvt_pk_bf16_f32 v67, v68, v69
ds_read_b128 v[60:63], v0 offset:13312
v_mfma_f32_16x16x32_bf16 v[52:55], v[24:27], v[36:39], v[52:55]
ds_read_b128 v[28:31], v1
s_cmp_eq_u32 s18, 62
v_mfma_f32_16x16x32_bf16 v[44:47], v[36:39], v[36:39], v[44:47]
ds_read_b128 v[32:35], v1 offset:1024
s_cbranch_scc1 Lc_vm2
Lc_vmb2:
s_waitcnt lgkmcnt(4)
v_mfma_f32_16x16x32_bf16 v[44:47], v[40:43], v[40:43], v[44:47]
s_barrier
v_mfma_f32_16x16x32_bf16 v[48:51], v[12:15], v[40:43], v[48:51]
ds_read_b128 v[20:23], v1 offset:2048
v_mfma_f32_16x16x32_bf16 v[52:55], v[16:19], v[40:43], v[52:55]
ds_read_b128 v[24:27], v1 offset:3072
v_mov_b32 v36, -1
v_mov_b32 v37, -1
v_mov_b32 v38, -1
v_max3_f32 v64, v46, v47, v48
v_max3_f32 v64, v64, v49, v50
v_mov_b32 v39, -1
s_nop 0
v_max3_f32 v65, v51, v52, v53
v_max3_f32 v65, v65, v54, v55
v_max_f32 v44, v64, v65
v_max_f32 v65, v64, v65
ds_read_b128 v[12:15], v1 offset:4096
ds_read_b128 v[16:19], v1 offset:5120
v_permlane32_swap_b32 v44, v65
v_max_f32 v64, v44, v65
v_max_f32 v65, v44, v65
s_mov_b32 s20, s24
s_bitcmp0_b32 s18, 1
v_permlane16_swap_b32 v64, v65
v_max_f32 v64, v64, v65
v_fma_f32 v64, v64, s30, v5
v_pk_fma_f32 v[46:47], v[46:47], s[30:31], v[64:65] op_sel_hi:[1,1,0] neg_lo:[0,0,1] neg_hi:[0,0,1]
v_pk_fma_f32 v[48:49], v[48:49], s[30:31], v[64:65] op_sel_hi:[1,1,0] neg_lo:[0,0,1] neg_hi:[0,0,1]
v_pk_fma_f32 v[50:51], v[50:51], s[30:31], v[64:65] op_sel_hi:[1,1,0] neg_lo:[0,0,1] neg_hi:[0,0,1]
v_pk_fma_f32 v[52:53], v[52:53], s[30:31], v[64:65] op_sel_hi:[1,1,0] neg_lo:[0,0,1] neg_hi:[0,0,1]
v_pk_fma_f32 v[54:55], v[54:55], s[30:31], v[64:65] op_sel_hi:[1,1,0] neg_lo:[0,0,1] neg_hi:[0,0,1]
v_exp_f32 v46, v46
v_exp_f32 v47, v47
v_exp_f32 v48, v48
v_cvt_pk_bf16_f32 v44, v46, v47
v_exp_f32 v49, v49
v_exp_f32 v50, v50
v_mov_b32_dpp v45, v44 quad_perm:[2,3,0,1] row_mask:0xf bank_mask:0xf
v_exp_f32 v51, v51
v_cvt_pk_bf16_f32 v48, v48, v49
v_mfma_f32_16x16x16_bf16 v[40:43], v[66:67], v[44:45], 0
ds_write_b128 v0, v[36:39] offset:18432
v_exp_f32 v52, v52
v_mfma_f32_16x16x16_bf16 v[68:71], v[8:9], v[44:45], 0
v_exp_f32 v53, v53
v_cvt_pk_bf16_f32 v49, v50, v51
v_exp_f32 v54, v54
v_exp_f32 v55, v55
v_cvt_pk_bf16_f32 v50, v52, v53
v_mov_b32_dpp v52, v48 quad_perm:[2,3,0,1] row_mask:0xf bank_mask:0xf
v_cvt_pk_bf16_f32 v51, v54, v55
v_mov_b32_dpp v53, v49 quad_perm:[2,3,0,1] row_mask:0xf bank_mask:0xf
s_cselect_b32 s32, -1, 0
s_waitcnt lgkmcnt(7)
v_mfma_f32_16x16x32_bf16 v[68:71], v[8:11], v[48:51], v[68:71]
v_mov_b32_dpp v54, v50 quad_perm:[2,3,0,1] row_mask:0xf bank_mask:0xf
v_mov_b32_dpp v55, v51 quad_perm:[2,3,0,1] row_mask:0xf bank_mask:0xf
v_mfma_f32_16x16x32_bf16 v[40:43], v[56:59], v[48:51], v[40:43]
s_mov_b32 s53, s25
s_add_u32 s55, s22, s34
v_mfma_f32_16x16x32_bf16 v[40:43], v[60:63], v[52:55], v[40:43]
s_add_u32 s49, s23, s34
s_add_u32 s38, s38, 64
ds_read_b128 v[44:47], v1 offset:6144
ds_read_b128 v[48:51], v1 offset:7168
v_rcp_f32 v56, v68
s_add_u32 s18, s18, 1
s_add_u32 s27, s27, 9216
v_mov_b32_dpp v56, v56 quad_perm:[0,1,0,1] row_mask:0xf bank_mask:0xf
v_pk_mul_f32 v[40:41], v[40:41], v[56:57] op_sel_hi:[1,0]
v_pk_mul_f32 v[42:43], v[42:43], v[56:57] op_sel_hi:[1,0]
v_cvt_pk_bf16_f32 v40, v40, v41
v_cvt_pk_bf16_f32 v41, v42, v43
ds_write_b64 v0, v[40:41] offset:21504
v_or_b32 v36, v7, v5
ds_read_b128 v[64:67], v1 offset:8192
ds_read_b128 v[68:71], v1 offset:9216
s_mov_b32 s22, s23
s_add_u32 s23, s23, 9216
s_waitcnt lgkmcnt(2)
s_barrier
ds_read_b128 v[8:11], v36 offset:20992
ds_read_b128 v[36:39], v36 offset:20480
ds_read_b128 v[40:43], v0 offset:21504
s_cmp_eq_u32 s23, 12610560
s_cselect_b32 s23, 12582912, s23
s_add_u32 s24, s24, s33
s_add_u32 s25, s25, s33
s_sub_u32 s33, 0, s33
s_add_u32 s51, s22, 4096
s_add_u32 s52, s22, 8192
s_waitcnt lgkmcnt(1)
v_mfma_f32_16x16x32_bf16 v[52:55], v[36:39], v[72:75], 0
v_mfma_f32_16x16x32_bf16 v[52:55], v[8:11], v[76:79], v[52:55]
s_waitcnt lgkmcnt(0)
v_smfmac_f32_16x16x64_bf16 v[52:55], v[40:43], v[28:35], v2
ds_read_b128 v[28:31], v1 offset:10240
ds_read_b128 v[32:35], v1 offset:11264
v_mfma_f32_16x16x32_bf16 v[56:59], v[36:39], v[20:23], 0
v_mfma_f32_16x16x32_bf16 v[56:59], v[8:11], v[24:27], v[56:59]
ds_read_b128 v[20:23], v1 offset:12288
v_add_f32 v52, v52, v54
v_smfmac_f32_16x16x64_bf16 v[56:59], v[40:43], v[12:19], v2
ds_read_b128 v[24:27], v1 offset:13312
ds_read_b128 v[12:15], v1 offset:14336
v_add_f32 v53, v53, v55
v_cvt_pk_bf16_f32 v54, v52, v53
v_bfi_b32 v54, -2, v54, s32
s_nop 2
v_add_f32 v56, v56, v58
v_add_f32 v57, v57, v59
v_cvt_pk_bf16_f32 v55, v56, v57
buffer_store_dwordx2 v[54:55], v6, s[8:11], s20 offen
s_add_u32 s20, s20, 49152
v_mfma_f32_16x16x32_bf16 v[60:63], v[36:39], v[44:47], 0
ds_read_b128 v[16:19], v1 offset:15360
v_mfma_f32_16x16x32_bf16 v[60:63], v[8:11], v[48:51], v[60:63]
ds_read_b128 v[44:47], v1 offset:16384
v_smfmac_f32_16x16x64_bf16 v[60:63], v[40:43], v[64:71], v2
ds_read_b128 v[48:51], v1 offset:17408
ds_read_b128 v[64:67], v1 offset:18432
s_waitcnt lgkmcnt(7)
v_mfma_f32_16x16x32_bf16 v[52:55], v[36:39], v[28:31], 0
ds_read_b128 v[68:71], v1 offset:19456
v_mfma_f32_16x16x32_bf16 v[52:55], v[8:11], v[32:35], v[52:55]
ds_read_b128 v[28:31], v1 offset:20480
s_waitcnt lgkmcnt(7)
v_smfmac_f32_16x16x64_bf16 v[52:55], v[40:43], v[20:27], v2
ds_read_b128 v[32:35], v1 offset:21504
ds_read_b128 v[20:23], v1 offset:22528
s_waitcnt lgkmcnt(7)
v_mfma_f32_16x16x32_bf16 v[56:59], v[36:39], v[12:15], 0
ds_read_b128 v[24:27], v1 offset:23552
v_add_f32 v60, v60, v62
v_mfma_f32_16x16x32_bf16 v[56:59], v[8:11], v[16:19], v[56:59]
ds_read_b128 v[12:15], v1 offset:24576
v_add_f32 v61, v61, v63
s_waitcnt lgkmcnt(7)
v_smfmac_f32_16x16x64_bf16 v[56:59], v[40:43], v[44:51], v2
ds_read_b128 v[16:19], v1 offset:25600
ds_read_b128 v[44:47], v1 offset:26624
v_add_f32 v52, v52, v54
v_cvt_pk_bf16_f32 v54, v60, v61
v_add_f32 v53, v53, v55
s_waitcnt lgkmcnt(7)
v_mfma_f32_16x16x32_bf16 v[60:63], v[36:39], v[64:67], 0
ds_read_b128 v[48:51], v1 offset:27648
v_bfi_b32 v54, -2, v54, s32
v_mfma_f32_16x16x32_bf16 v[60:63], v[8:11], v[68:71], v[60:63]
ds_read_b128 v[64:67], v1 offset:28672
v_cvt_pk_bf16_f32 v55, v52, v53
s_waitcnt lgkmcnt(7)
v_smfmac_f32_16x16x64_bf16 v[60:63], v[40:43], v[28:35], v2
ds_read_b128 v[68:71], v1 offset:29696
ds_read_b128 v[28:31], v1 offset:30720
buffer_store_dwordx2 v[54:55], v6, s[8:11], s20 offen
s_add_u32 s20, s20, 49152
s_waitcnt lgkmcnt(7)
v_mfma_f32_16x16x32_bf16 v[52:55], v[36:39], v[20:23], 0
ds_read_b128 v[32:35], v1 offset:31744
v_add_f32 v56, v56, v58
v_mfma_f32_16x16x32_bf16 v[52:55], v[8:11], v[24:27], v[52:55]
ds_read_b128 v[20:23], v1 offset:32768
v_add_f32 v57, v57, v59
s_waitcnt lgkmcnt(7)
v_smfmac_f32_16x16x64_bf16 v[52:55], v[40:43], v[12:19], v2
ds_read_b128 v[24:27], v1 offset:33792
ds_read_b128 v[12:15], v1 offset:34816
v_add_f32 v60, v60, v62
v_cvt_pk_bf16_f32 v62, v56, v57
v_add_f32 v61, v61, v63
s_waitcnt lgkmcnt(7)
v_mfma_f32_16x16x32_bf16 v[56:59], v[36:39], v[44:47], 0
ds_read_b128 v[16:19], v1 offset:35840
v_bfi_b32 v62, -2, v62, s32
v_mfma_f32_16x16x32_bf16 v[56:59], v[8:11], v[48:51], v[56:59]
ds_read_b128 v[44:47], v1 offset:36864
v_cvt_pk_bf16_f32 v63, v60, v61
s_waitcnt lgkmcnt(7)
v_smfmac_f32_16x16x64_bf16 v[56:59], v[40:43], v[64:71], v2
ds_read_b128 v[48:51], v1 offset:37888
ds_read_b128 v[64:67], v1 offset:38912
buffer_store_dwordx2 v[62:63], v6, s[8:11], s20 offen
s_add_u32 s20, s20, 49152
s_waitcnt lgkmcnt(7)
v_mfma_f32_16x16x32_bf16 v[60:63], v[36:39], v[28:31], 0
ds_read_b128 v[68:71], v1 offset:39936
v_add_f32 v52, v52, v54
v_mfma_f32_16x16x32_bf16 v[60:63], v[8:11], v[32:35], v[60:63]
ds_read_b128 v[28:31], v1 offset:40960
v_add_f32 v53, v53, v55
s_waitcnt lgkmcnt(7)
v_smfmac_f32_16x16x64_bf16 v[60:63], v[40:43], v[20:27], v2
ds_read_b128 v[32:35], v1 offset:41984
ds_read_b128 v[20:23], v1 offset:43008
v_add_f32 v56, v56, v58
v_cvt_pk_bf16_f32 v58, v52, v53
v_add_f32 v57, v57, v59
s_waitcnt lgkmcnt(7)
v_mfma_f32_16x16x32_bf16 v[52:55], v[36:39], v[12:15], 0
ds_read_b128 v[24:27], v1 offset:44032
v_bfi_b32 v58, -2, v58, s32
v_mfma_f32_16x16x32_bf16 v[52:55], v[8:11], v[16:19], v[52:55]
ds_read_b128 v[12:15], v1 offset:45056
v_cvt_pk_bf16_f32 v59, v56, v57
s_waitcnt lgkmcnt(7)
v_smfmac_f32_16x16x64_bf16 v[52:55], v[40:43], v[44:51], v2
ds_read_b128 v[16:19], v1 offset:46080
buffer_store_dwordx2 v[58:59], v6, s[8:11], s20 offen
s_add_u32 s20, s20, 49152
s_waitcnt lgkmcnt(6)
v_mfma_f32_16x16x32_bf16 v[56:59], v[36:39], v[64:67], 0
v_add_f32 v60, v60, v62
v_mfma_f32_16x16x32_bf16 v[56:59], v[8:11], v[68:71], v[56:59]
v_add_f32 v61, v61, v63
s_waitcnt lgkmcnt(4)
v_smfmac_f32_16x16x64_bf16 v[56:59], v[40:43], v[28:35], v2
v_add_f32 v52, v52, v54
v_cvt_pk_bf16_f32 v54, v60, v61
v_add_f32 v53, v53, v55
s_waitcnt lgkmcnt(2)
v_mfma_f32_16x16x32_bf16 v[60:63], v[36:39], v[20:23], 0
v_bfi_b32 v54, -2, v54, s32
v_mfma_f32_16x16x32_bf16 v[60:63], v[8:11], v[24:27], v[60:63]
v_cvt_pk_bf16_f32 v55, v52, v53
s_waitcnt lgkmcnt(0)
v_smfmac_f32_16x16x64_bf16 v[60:63], v[40:43], v[12:19], v2
buffer_store_dwordx2 v[54:55], v6, s[8:11], s20 offen
s_add_u32 s20, s20, 49152
s_add_u32 s26, s26, 524288
s_mov_b32 m0, 16384
v_mov_b64 v[48:49], 0
v_mov_b64 v[50:51], 0
v_mov_b64 v[52:53], 0
v_mov_b64 v[54:55], 0
v_mov_b64 v[64:65], 0
v_mov_b64 v[66:67], 0
v_mov_b64 v[68:69], 0
v_mov_b64 v[70:71], 0
v_add_f32 v56, v56, v58
v_add_f32 v57, v57, v59
v_add_f32 v60, v60, v62
v_cvt_pk_bf16_f32 v62, v56, v57
v_add_f32 v61, v61, v63
v_bfi_b32 v62, -2, v62, s32
v_cvt_pk_bf16_f32 v63, v60, v61
buffer_store_dwordx2 v[62:63], v6, s[8:11], s20 offen
v_mov_b32 v8, 0x3f803f80
v_mov_b32 v9, v8
v_mov_b64 v[10:11], v[8:9]
v_mov_b64 v[56:57], 0
v_mov_b64 v[58:59], 0
v_mov_b64 v[60:61], 0
v_mov_b64 v[62:63], 0
s_cmp_eq_u32 s18, 40
s_cbranch_scc1 Lc_pre2
Lc_preb2:
s_mov_b32 s75, 0
s_mov_b32 s19, s74
Lc_dl2:
s_sub_u32 s19, s19, 1
s_cbranch_scc0 Lc_dl2
s_cmp_eq_u32 s18, 63
s_cbranch_scc0 Lc_top2
s_waitcnt vmcnt(0)
s_lshl_b32 s19, s17, 5
s_add_u32 s19, s19, 129040
buffer_store_dword v2, off, s[8:11], s19 sc1
buffer_store_dword v2, off, s[8:11], s19 offset:4 sc1
s_branch Lc_topL2
Lc_hist2:
s_cmp_eq_u32 s96, 0
s_cbranch_scc0 Lc_hist12
buffer_store_dwordx4 v[36:39], v0, s[8:11], s27 offen sc1
s_nop 0
s_branch Lc_histback2
Lc_hist12:
s_cmp_eq_u32 s96, 1
s_cbranch_scc0 Lc_hist22
buffer_store_dwordx4 v[40:43], v0, s[8:11], s27 offen sc1
s_nop 0
s_branch Lc_histback2
Lc_hist22:
buffer_store_dwordx4 v[44:47], v0, s[8:11], s27 offen sc1
s_nop 0
s_branch Lc_histback2
Lc_vm2:
v_lshrrev_b32 v64, 1, v0
s_mul_i32 s19, s17, 4096
s_add_u32 s19, s19, 24906752
buffer_store_dwordx2 v[66:67], v64, s[8:11], s19 offen sc1
s_branch Lc_vmb2
Lc_pre2:
v_mov_b32 v12, 0
global_load_dword v13, v12, s[6:7] offset:104 sc1
s_waitcnt vmcnt(0)
v_cmp_gt_u32 vcc, 28, v13
s_cbranch_vccz Lc_preb2
s_add_u32 s21, s21, 1
s_cmp_ge_u32 s21, 4194304
s_cbranch_scc1 L_abort
s_branch Lc_pre2
Lc_retry22:
buffer_load_dwordx4 v0, s[8:11], s22 offen offset:2048 sc1 lds
ds_read_b128 v[20:23], v0 offset:18432
s_add_u32 s21, s21, 1
s_cmp_ge_u32 s21, 4194304
s_cbranch_scc1 L_abort
s_waitcnt lgkmcnt(0)
v_cmp_eq_u32 vcc, -1, v20
s_cbranch_vccnz Lc_retry22
s_waitcnt vmcnt(0)
s_branch Lc_back22
Lc_retry32:
buffer_load_dwordx4 v0, s[8:11], s22 offen offset:3072 sc1 lds
ds_read_b128 v[24:27], v0 offset:19456
s_add_u32 s21, s21, 1
s_cmp_ge_u32 s21, 4194304
s_cbranch_scc1 L_abort
s_waitcnt lgkmcnt(0)
v_cmp_eq_u32 vcc, -1, v24
s_cbranch_vccnz Lc_retry32
s_waitcnt vmcnt(0)
s_branch Lc_back32
Lc_retry42:
buffer_load_dwordx4 v[28:31], v0, s[8:11], s51 offen sc1
s_waitcnt vmcnt(0)
v_cmp_eq_u32 vcc, -1, v28
s_cbranch_vccz Lc_back42
s_add_u32 s21, s21, 1
s_cmp_ge_u32 s21, 4194304
s_cbranch_scc1 L_abort
s_branch Lc_retry42
Lc_retry52:
buffer_load_dwordx4 v[32:35], v0, s[8:11], s51 offen offset:1024 sc1
s_waitcnt vmcnt(0)
v_cmp_eq_u32 vcc, -1, v32
s_cbranch_vccz Lc_back52
s_add_u32 s21, s21, 1
s_cmp_ge_u32 s21, 4194304
s_cbranch_scc1 L_abort
s_branch Lc_retry52
Lc_retry62:
buffer_load_dwordx4 v[36:39], v0, s[8:11], s51 offen offset:2048 sc1
s_waitcnt vmcnt(0)
v_cmp_eq_u32 vcc, -1, v36
s_cbranch_vccz Lc_back62
s_add_u32 s21, s21, 1
s_cmp_ge_u32 s21, 4194304
s_cbranch_scc1 L_abort
s_branch Lc_retry62
Lc_retry72:
buffer_load_dwordx4 v[40:43], v0, s[8:11], s51 offen offset:3072 sc1
s_waitcnt vmcnt(0)
v_cmp_eq_u32 vcc, -1, v40
s_cbranch_vccz Lc_back72
s_add_u32 s21, s21, 1
s_cmp_ge_u32 s21, 4194304
s_cbranch_scc1 L_abort
s_branch Lc_retry72
Lc_retry82:
buffer_load_dwordx4 v[44:47], v0, s[8:11], s52 offen sc1
s_waitcnt vmcnt(0)
v_cmp_eq_u32 vcc, -1, v44
s_cbranch_vccz Lc_back82
s_add_u32 s21, s21, 1
s_cmp_ge_u32 s21, 4194304
s_cbranch_scc1 L_abort
s_branch Lc_retry82
Lc_redo2:
s_cmp_eq_u32 s48, s18
s_cbranch_scc1 Lc_redoback2
s_mov_b32 s48, s18
s_waitcnt lgkmcnt(0)
s_nop 15
Lc_redo22:
buffer_load_dwordx4 v[12:15], v0, s[8:11], s22 offen sc1
buffer_load_dwordx4 v[16:19], v0, s[8:11], s22 offen offset:1024 sc1
buffer_load_dwordx4 v[20:23], v0, s[8:11], s22 offen offset:2048 sc1
buffer_load_dwordx4 v[24:27], v0, s[8:11], s22 offen offset:3072 sc1
buffer_load_dwordx4 v[28:31], v0, s[8:11], s51 offen sc1
buffer_load_dwordx4 v[32:35], v0, s[8:11], s51 offen offset:1024 sc1
buffer_load_dwordx4 v[36:39], v0, s[8:11], s51 offen offset:2048 sc1
buffer_load_dwordx4 v[40:43], v0, s[8:11], s51 offen offset:3072 sc1
buffer_load_dwordx4 v[44:47], v0, s[8:11], s52 offen sc1
v_mov_b64 v[48:49], 0
v_mov_b64 v[50:51], 0
v_mov_b64 v[52:53], 0
v_mov_b64 v[54:55], 0
v_mov_b64 v[56:57], 0
v_mov_b64 v[58:59], 0
v_mov_b64 v[60:61], 0
v_mov_b64 v[62:63], 0
v_mov_b64 v[64:65], 0
v_mov_b64 v[66:67], 0
v_mov_b64 v[68:69], 0
v_mov_b64 v[70:71], 0
s_waitcnt vmcnt(0)
v_max_u32 v48, v12, v13
v_max3_u32 v48, v48, v14, v15
v_max3_u32 v48, v48, v16, v17
v_max3_u32 v48, v48, v18, v19
v_max3_u32 v48, v48, v20, v21
v_max3_u32 v48, v48, v22, v23
v_max3_u32 v48, v48, v24, v25
v_max3_u32 v48, v48, v26, v27
v_max3_u32 v48, v48, v28, v29
v_max3_u32 v48, v48, v30, v31
v_max3_u32 v48, v48, v32, v33
v_max3_u32 v48, v48, v34, v35
v_max3_u32 v48, v48, v36, v37
v_max3_u32 v48, v48, v38, v39
v_max3_u32 v48, v48, v40, v41
v_max3_u32 v48, v48, v42, v43
v_max3_u32 v48, v48, v44, v45
v_max3_u32 v48, v48, v46, v47
v_cmp_eq_u32 vcc, -1, v48
v_mov_b32 v48, 0
s_cbranch_vccnz Lc_redo32
s_nop 0
v_smfmac_f32_16x16x64_bf16 v[48:51], v[12:15], a[0:7], v2
v_smfmac_f32_16x16x64_bf16 v[52:55], v[12:15], a[8:15], v2
v_smfmac_f32_16x16x64_bf16 v[56:59], v[12:15], a[16:23], v2
v_smfmac_f32_16x16x64_bf16 v[60:63], v[12:15], a[24:31], v2
v_smfmac_f32_16x16x64_bf16 v[64:67], v[12:15], v[80:87], v2
v_smfmac_f32_16x16x64_bf16 v[68:71], v[12:15], v[88:95], v2
v_smfmac_f32_16x16x64_bf16 v[48:51], v[16:19], a[32:39], v2
v_smfmac_f32_16x16x64_bf16 v[52:55], v[16:19], a[40:47], v2
v_smfmac_f32_16x16x64_bf16 v[56:59], v[16:19], a[48:55], v2
v_smfmac_f32_16x16x64_bf16 v[60:63], v[16:19], a[56:63], v2
v_smfmac_f32_16x16x64_bf16 v[64:67], v[16:19], v[96:103], v2
v_smfmac_f32_16x16x64_bf16 v[68:71], v[16:19], v[104:111], v2
v_smfmac_f32_16x16x64_bf16 v[48:51], v[20:23], a[64:71], v2
v_smfmac_f32_16x16x64_bf16 v[52:55], v[20:23], a[72:79], v2
v_smfmac_f32_16x16x64_bf16 v[56:59], v[20:23], a[80:87], v2
v_smfmac_f32_16x16x64_bf16 v[60:63], v[20:23], a[88:95], v2
v_smfmac_f32_16x16x64_bf16 v[64:67], v[20:23], v[112:119], v2
v_smfmac_f32_16x16x64_bf16 v[68:71], v[20:23], v[120:127], v2
v_smfmac_f32_16x16x64_bf16 v[48:51], v[24:27], a[96:103], v2
v_smfmac_f32_16x16x64_bf16 v[52:55], v[24:27], a[104:111], v2
v_smfmac_f32_16x16x64_bf16 v[56:59], v[24:27], a[112:119], v2
v_smfmac_f32_16x16x64_bf16 v[60:63], v[24:27], a[120:127], v2
v_smfmac_f32_16x16x64_bf16 v[64:67], v[24:27], v[128:135], v2
v_smfmac_f32_16x16x64_bf16 v[68:71], v[24:27], v[136:143], v2
v_smfmac_f32_16x16x64_bf16 v[48:51], v[28:31], a[128:135], v2
v_smfmac_f32_16x16x64_bf16 v[52:55], v[28:31], a[136:143], v2
v_smfmac_f32_16x16x64_bf16 v[56:59], v[28:31], a[144:151], v2
v_smfmac_f32_16x16x64_bf16 v[60:63], v[28:31], a[152:159], v2
v_smfmac_f32_16x16x64_bf16 v[48:51], v[32:35], a[160:167], v2
v_smfmac_f32_16x16x64_bf16 v[52:55], v[32:35], a[168:175], v2
v_smfmac_f32_16x16x64_bf16 v[56:59], v[32:35], a[176:183], v2
v_smfmac_f32_16x16x64_bf16 v[60:63], v[32:35], a[184:191], v2
v_smfmac_f32_16x16x64_bf16 v[48:51], v[36:39], a[192:199], v2
v_smfmac_f32_16x16x64_bf16 v[52:55], v[36:39], a[200:207], v2
v_smfmac_f32_16x16x64_bf16 v[56:59], v[36:39], a[208:215], v2
v_smfmac_f32_16x16x64_bf16 v[60:63], v[36:39], a[216:223], v2
v_smfmac_f32_16x16x64_bf16 v[48:51], v[40:43], a[224:231], v2
v_smfmac_f32_16x16x64_bf16 v[52:55], v[40:43], a[232:239], v2
v_smfmac_f32_16x16x64_bf16 v[56:59], v[40:43], a[240:247], v2
v_smfmac_f32_16x16x64_bf16 v[60:63], v[40:43], a[248:255], v2
v_smfmac_f32_16x16x64_bf16 v[48:51], v[44:47], v[224:231], v2
v_smfmac_f32_16x16x64_bf16 v[52:55], v[44:47], v[232:239], v2
v_smfmac_f32_16x16x64_bf16 v[56:59], v[44:47], v[240:247], v2
v_smfmac_f32_16x16x64_bf16 v[60:63], v[44:47], v[248:255], v2
ds_read_b128 v[12:15], v0
ds_read_b128 v[16:19], v0 offset:4096
ds_read_b128 v[20:23], v0 offset:1024
s_nop 7
v_add_f32 v48, v48, v50
v_add_f32 v49, v49, v51
v_add_f32 v52, v52, v54
v_add_f32 v53, v53, v55
s_branch Lc_post2
Lc_redo32:
s_add_u32 s21, s21, 1
s_cmp_ge_u32 s21, 4194304
s_cbranch_scc1 L_abort
s_branch Lc_redo22
.p2align 6
s_nop 0
s_nop 0
Lc_top3b:
ds_read_b128 v[12:15], v0 offset:16384
ds_read_b128 v[16:19], v0 offset:17408
s_add_u32 s21, s21, 1
s_cmp_ge_u32 s21, 4194304
s_cbranch_scc1 L_abort
s_waitcnt lgkmcnt(0)
v_max_u32 v43, v12, v16
v_cmp_eq_u32 vcc, -1, v43
s_cbranch_vccnz Lc_top3b
v_smfmac_f32_16x16x64_bf16 v[48:51], v[12:15], a[0:7], v2
v_smfmac_f32_16x16x64_bf16 v[52:55], v[12:15], a[8:15], v2
v_smfmac_f32_16x16x64_bf16 v[56:59], v[12:15], a[16:23], v2
buffer_load_dwordx4 v[28:31], v0, s[8:11], s51 offen sc1
v_smfmac_f32_16x16x64_bf16 v[60:63], v[12:15], a[24:31], v2
v_smfmac_f32_16x16x64_bf16 v[64:67], v[12:15], v[80:87], v2
ds_read_b128 v[20:23], v0 offset:18432
v_smfmac_f32_16x16x64_bf16 v[68:71], v[12:15], v[88:95], v2
v_smfmac_f32_16x16x64_bf16 v[48:51], v[16:19], a[32:39], v2
buffer_load_dwordx4 v[32:35], v0, s[8:11], s51 offen offset:1024 sc1
v_smfmac_f32_16x16x64_bf16 v[52:55], v[16:19], a[40:47], v2
v_smfmac_f32_16x16x64_bf16 v[56:59], v[16:19], a[48:55], v2
v_smfmac_f32_16x16x64_bf16 v[60:63], v[16:19], a[56:63], v2
ds_read_b128 v[24:27], v0 offset:19456
s_waitcnt lgkmcnt(1)
v_cmp_eq_u32 vcc, -1, v20
v_smfmac_f32_16x16x64_bf16 v[64:67], v[16:19], v[96:103], v2
buffer_load_dwordx4 v[36:39], v0, s[8:11], s51 offen offset:2048 sc1
v_smfmac_f32_16x16x64_bf16 v[68:71], v[16:19], v[104:111], v2
s_cbranch_vccnz Lc_retry23b
Lc_back23b:
v_smfmac_f32_16x16x64_bf16 v[48:51], v[20:23], a[64:71], v2
v_smfmac_f32_16x16x64_bf16 v[52:55], v[20:23], a[72:79], v2
v_smfmac_f32_16x16x64_bf16 v[56:59], v[20:23], a[80:87], v2
buffer_load_dwordx4 v[40:43], v0, s[8:11], s51 offen offset:3072 sc1
v_smfmac_f32_16x16x64_bf16 v[60:63], v[20:23], a[88:95], v2
s_waitcnt lgkmcnt(0)
v_cmp_eq_u32 vcc, -1, v24
v_smfmac_f32_16x16x64_bf16 v[64:67], v[20:23], v[112:119], v2
v_smfmac_f32_16x16x64_bf16 v[68:71], v[20:23], v[120:127], v2
buffer_load_dwordx4 v[44:47], v0, s[8:11], s52 offen sc1
s_cbranch_vccnz Lc_retry33b
Lc_back33b:
v_smfmac_f32_16x16x64_bf16 v[48:51], v[24:27], a[96:103], v2
s_waitcnt vmcnt(5)
s_barrier
v_smfmac_f32_16x16x64_bf16 v[52:55], v[24:27], a[104:111], v2
s_waitcnt vmcnt(4)
v_cmp_eq_u32 vcc, -1, v28
v_smfmac_f32_16x16x64_bf16 v[56:59], v[24:27], a[112:119], v2
ds_read_b128 v[12:15], v0
v_smfmac_f32_16x16x64_bf16 v[60:63], v[24:27], a[120:127], v2
ds_read_b128 v[16:19], v0 offset:4096
s_cbranch_vccnz Lc_retry43b
Lc_back43b:
v_smfmac_f32_16x16x64_bf16 v[48:51], v[28:31], a[128:135], v2
ds_read_b128 v[20:23], v0 offset:1024
v_smfmac_f32_16x16x64_bf16 v[52:55], v[28:31], a[136:143], v2
s_waitcnt vmcnt(3)
v_cmp_eq_u32 vcc, -1, v32
v_smfmac_f32_16x16x64_bf16 v[56:59], v[28:31], a[144:151], v2
v_smfmac_f32_16x16x64_bf16 v[60:63], v[28:31], a[152:159], v2
s_cbranch_vccnz Lc_retry53b
Lc_back53b:
v_smfmac_f32_16x16x64_bf16 v[48:51], v[32:35], a[160:167], v2
s_add_u32 s19, s55, 0
buffer_store_dword v79, v76, s[8:11], s19 offen
v_smfmac_f32_16x16x64_bf16 v[52:55], v[32:35], a[168:175], v2
s_waitcnt vmcnt(3)
v_cmp_eq_u32 vcc, -1, v36
v_smfmac_f32_16x16x64_bf16 v[56:59], v[32:35], a[176:183], v2
v_smfmac_f32_16x16x64_bf16 v[60:63], v[32:35], a[184:191], v2
s_cbranch_vccnz Lc_retry63b
Lc_back63b:
v_smfmac_f32_16x16x64_bf16 v[48:51], v[36:39], a[192:199], v2
s_add_u32 s19, s55, 4096
buffer_store_dword v79, v76, s[8:11], s19 offen
v_smfmac_f32_16x16x64_bf16 v[52:55], v[36:39], a[200:207], v2
s_waitcnt vmcnt(3)
v_cmp_eq_u32 vcc, -1, v40
v_smfmac_f32_16x16x64_bf16 v[56:59], v[36:39], a[208:215], v2
v_smfmac_f32_16x16x64_bf16 v[60:63], v[36:39], a[216:223], v2
s_cbranch_vccnz Lc_retry73b
Lc_back73b:
v_smfmac_f32_16x16x64_bf16 v[48:51], v[40:43], a[224:231], v2
v_smfmac_f32_16x16x64_bf16 v[52:55], v[40:43], a[232:239], v2
s_waitcnt vmcnt(2)
v_cmp_eq_u32 vcc, -1, v44
v_smfmac_f32_16x16x64_bf16 v[56:59], v[40:43], a[240:247], v2
v_smfmac_f32_16x16x64_bf16 v[60:63], v[40:43], a[248:255], v2
s_cbranch_vccnz Lc_retry83b
Lc_back83b:
v_smfmac_f32_16x16x64_bf16 v[48:51], v[44:47], v[224:231], v2
v_smfmac_f32_16x16x64_bf16 v[52:55], v[44:47], v[232:239], v2
v_lshlrev_b32 v78, 3, v0
s_add_u32 s19, s39, 8192
buffer_load_dword v78, v78, s[8:11], s39 offen
buffer_load_dword v78, v78, s[8:11], s19 offen
s_add_u32 s39, s39, s97
s_mov_b32 s97, 524288
v_smfmac_f32_16x16x64_bf16 v[56:59], v[44:47], v[240:247], v2
v_add_f32 v48, v48, v50
v_smfmac_f32_16x16x64_bf16 v[60:63], v[44:47], v[248:255], v2
v_add_f32 v49, v49, v51
v_smfmac_f32_16x16x64_bf16 v[64:67], v[24:27], v[128:135], v2
v_add_f32 v52, v52, v54
v_smfmac_f32_16x16x64_bf16 v[68:71], v[24:27], v[136:143], v2
v_add_f32 v53, v53, v55
Lc_post3b:
v_add_f32 v56, v56, v58
v_add_f32 v60, v60, v62
v_cvt_pk_bf16_f32 v50, v48, v52
v_cvt_pk_bf16_f32 v51, v56, v60
v_xor_b32 v58, 16, v3
ds_write_b64 v3, v[50:51] offset:16384
v_add_f32 v57, v57, v59
v_add_f32 v61, v61, v63
v_cvt_pk_bf16_f32 v54, v49, v53
v_cvt_pk_bf16_f32 v55, v57, v61
ds_write_b64 v58, v[54:55] offset:16384
v_cmp_u_f32 vcc, v48, v49
v_smfmac_f32_16x16x64_bf16 v[64:67], v[28:31], v[144:151], v2
v_smfmac_f32_16x16x64_bf16 v[68:71], v[28:31], v[152:159], v2
s_cbranch_vccnz Lc_redo3b
Lc_redoback3b:
v_smfmac_f32_16x16x64_bf16 v[64:67], v[32:35], v[160:167], v2
v_smfmac_f32_16x16x64_bf16 v[68:71], v[32:35], v[168:175], v2
v_xor_b32 v32, 64, v4
s_waitcnt lgkmcnt(0)
s_barrier
ds_read_b128 v[28:31], v4 offset:16384
ds_read_b128 v[32:35], v32 offset:17408
ds_read_b128 v[56:59], v0 offset:5120
v_smfmac_f32_16x16x64_bf16 v[64:67], v[36:39], v[176:183], v2
v_smfmac_f32_16x16x64_bf16 v[68:71], v[36:39], v[184:191], v2
ds_read_b128 v[36:39], v4 offset:18432
ds_read_b128 v[60:63], v0 offset:2048
ds_read_b128 v[24:27], v0 offset:6144
v_smfmac_f32_16x16x64_bf16 v[64:67], v[40:43], v[192:199], v2
v_smfmac_f32_16x16x64_bf16 v[68:71], v[40:43], v[200:207], v2
v_xor_b32 v40, 64, v4
ds_read_b128 v[40:43], v40 offset:19456
v_smfmac_f32_16x16x64_bf16 v[64:67], v[44:47], v[208:215], v2
v_bfe_u32 v48, v0, 4, 3
v_lshlrev_b32 v48, 2, v48
buffer_load_dword v78, v48, s[8:11], s35 offen sc1
v_smfmac_f32_16x16x64_bf16 v[68:71], v[44:47], v[216:223], v2
s_waitcnt lgkmcnt(6)
v_mfma_f32_16x16x32_bf16 v[48:51], v[12:15], v[28:31], 0
ds_read_b128 v[12:15], v0 offset:3072
v_mfma_f32_16x16x32_bf16 v[52:55], v[16:19], v[28:31], 0
ds_read_b128 v[16:19], v0 offset:7168
v_mfma_f32_16x16x32_bf16 v[44:47], v[28:31], v[28:31], 0
s_waitcnt lgkmcnt(6)
v_mfma_f32_16x16x32_bf16 v[48:51], v[20:23], v[32:35], v[48:51]
v_add_f32 v64, v64, v66
v_add_f32 v65, v65, v67
v_mfma_f32_16x16x32_bf16 v[52:55], v[56:59], v[32:35], v[52:55]
v_add_f32 v68, v68, v70
ds_read_b128 v[56:59], v0 offset:14336
v_mfma_f32_16x16x32_bf16 v[44:47], v[32:35], v[32:35], v[44:47]
v_add_f32 v69, v69, v71
v_cvt_pk_bf16_f32 v66, v64, v65
s_waitcnt lgkmcnt(4)
v_mfma_f32_16x16x32_bf16 v[48:51], v[60:63], v[36:39], v[48:51]
v_cvt_pk_bf16_f32 v67, v68, v69
ds_read_b128 v[60:63], v0 offset:15360
v_mfma_f32_16x16x32_bf16 v[52:55], v[24:27], v[36:39], v[52:55]
s_cmp_eq_u32 s18, 62
v_mfma_f32_16x16x32_bf16 v[44:47], v[36:39], v[36:39], v[44:47]
s_cbranch_scc1 Lc_vm3b
Lc_vmb3b:
s_waitcnt lgkmcnt(2)
v_mfma_f32_16x16x32_bf16 v[44:47], v[40:43], v[40:43], v[44:47]
s_barrier
v_mfma_f32_16x16x32_bf16 v[48:51], v[12:15], v[40:43], v[48:51]
v_mfma_f32_16x16x32_bf16 v[52:55], v[16:19], v[40:43], v[52:55]
v_mov_b32 v36, -1
v_mov_b32 v37, -1
v_mov_b32 v38, -1
s_nop 0
v_max3_f32 v64, v46, v47, v48
v_max3_f32 v64, v64, v49, v50
v_mov_b32 v39, -1
s_nop 0
v_max3_f32 v65, v51, v52, v53
v_max3_f32 v65, v65, v54, v55
v_max_f32 v44, v64, v65
v_max_f32 v65, v64, v65
s_nop 1
v_permlane32_swap_b32 v44, v65
v_max_f32 v64, v44, v65
v_max_f32 v65, v44, v65
s_mov_b32 s20, s24
s_bitcmp0_b32 s18, 1
v_permlane16_swap_b32 v64, v65
v_max_f32 v64, v64, v65
v_fma_f32 v64, v64, s30, v5
v_pk_fma_f32 v[46:47], v[46:47], s[30:31], v[64:65] op_sel_hi:[1,1,0] neg_lo:[0,0,1] neg_hi:[0,0,1]
v_pk_fma_f32 v[48:49], v[48:49], s[30:31], v[64:65] op_sel_hi:[1,1,0] neg_lo:[0,0,1] neg_hi:[0,0,1]
v_pk_fma_f32 v[50:51], v[50:51], s[30:31], v[64:65] op_sel_hi:[1,1,0] neg_lo:[0,0,1] neg_hi:[0,0,1]
v_pk_fma_f32 v[52:53], v[52:53], s[30:31], v[64:65] op_sel_hi:[1,1,0] neg_lo:[0,0,1] neg_hi:[0,0,1]
v_pk_fma_f32 v[54:55], v[54:55], s[30:31], v[64:65] op_sel_hi:[1,1,0] neg_lo:[0,0,1] neg_hi:[0,0,1]
v_exp_f32 v46, v46
v_exp_f32 v47, v47
v_exp_f32 v48, v48
v_cvt_pk_bf16_f32 v44, v46, v47
v_exp_f32 v49, v49
v_exp_f32 v50, v50
v_mov_b32_dpp v45, v44 quad_perm:[2,3,0,1] row_mask:0xf bank_mask:0xf
v_exp_f32 v51, v51
v_cvt_pk_bf16_f32 v48, v48, v49
v_mfma_f32_16x16x16_bf16 v[40:43], v[66:67], v[44:45], 0
ds_write_b128 v0, v[36:39] offset:19456
v_exp_f32 v52, v52
v_mfma_f32_16x16x16_bf16 v[68:71], v[8:9], v[44:45], 0
v_exp_f32 v53, v53
v_cvt_pk_bf16_f32 v49, v50, v51
v_exp_f32 v54, v54
v_exp_f32 v55, v55
v_cvt_pk_bf16_f32 v50, v52, v53
v_mov_b32_dpp v52, v48 quad_perm:[2,3,0,1] row_mask:0xf bank_mask:0xf
v_cvt_pk_bf16_f32 v51, v54, v55
v_mov_b32_dpp v53, v49 quad_perm:[2,3,0,1] row_mask:0xf bank_mask:0xf
s_cselect_b32 s32, -1, 0
s_waitcnt lgkmcnt(1)
v_mfma_f32_16x16x32_bf16 v[68:71], v[8:11], v[48:51], v[68:71]
v_mov_b32_dpp v54, v50 quad_perm:[2,3,0,1] row_mask:0xf bank_mask:0xf
v_mov_b32_dpp v55, v51 quad_perm:[2,3,0,1] row_mask:0xf bank_mask:0xf
v_mfma_f32_16x16x32_bf16 v[40:43], v[56:59], v[48:51], v[40:43]
s_mov_b32 s53, s25
s_add_u32 s55, s22, s34
v_mfma_f32_16x16x32_bf16 v[40:43], v[60:63], v[52:55], v[40:43]
s_add_u32 s49, s23, s34
s_add_u32 s38, s38, 64
v_rcp_f32 v56, v68
s_add_u32 s18, s18, 1
s_add_u32 s27, s27, 9216
v_mov_b32_dpp v56, v56 quad_perm:[0,1,0,1] row_mask:0xf bank_mask:0xf
s_nop 1
v_pk_mul_f32 v[40:41], v[40:41], v[56:57] op_sel_hi:[1,0]
v_pk_mul_f32 v[42:43], v[42:43], v[56:57] op_sel_hi:[1,0]
v_cvt_pk_bf16_f32 v40, v40, v41
v_cvt_pk_bf16_f32 v41, v42, v43
ds_write_b64 v0, v[40:41] offset:21512
s_mov_b32 s22, s23
s_add_u32 s23, s23, 9216
s_waitcnt lgkmcnt(0)
s_barrier
s_cmp_eq_u32 s23, 12610560
s_cselect_b32 s23, 12582912, s23
s_add_u32 s24, s24, s33
s_add_u32 s25, s25, s33
s_sub_u32 s33, 0, s33
s_add_u32 s51, s22, 4096
s_add_u32 s52, s22, 8192
s_mov_b32 m0, 0
s_add_u32 s19, s26, 0
buffer_load_dwordx4 v0, s[8:11], s19 offen lds
buffer_load_dwordx4 v0, s[8:11], s19 offen offset:1024 lds
buffer_load_dwordx4 v0, s[8:11], s19 offen offset:2048 lds
buffer_load_dwordx4 v0, s[8:11], s19 offen offset:3072 lds
s_mov_b32 m0, 4096
s_add_u32 s19, s26, 4096
buffer_load_dwordx4 v0, s[8:11], s19 offen lds
buffer_load_dwordx4 v0, s[8:11], s19 offen offset:1024 lds
buffer_load_dwordx4 v0, s[8:11], s19 offen offset:2048 lds
buffer_load_dwordx4 v0, s[8:11], s19 offen offset:3072 lds
s_mov_b32 m0, 8192
s_add_u32 s19, s26, 8192
buffer_load_dwordx4 v0, s[8:11], s19 offen lds
buffer_load_dwordx4 v0, s[8:11], s19 offen offset:1024 lds
buffer_load_dwordx4 v0, s[8:11], s19 offen offset:2048 lds
buffer_load_dwordx4 v0, s[8:11], s19 offen offset:3072 lds
s_mov_b32 m0, 12288
s_add_u32 s19, s26, 12288
buffer_load_dwordx4 v0, s[8:11], s19 offen lds
buffer_load_dwordx4 v0, s[8:11], s19 offen offset:1024 lds
buffer_load_dwordx4 v0, s[8:11], s19 offen offset:2048 lds
buffer_load_dwordx4 v0, s[8:11], s19 offen offset:3072 lds
s_add_u32 s26, s26, 524288
s_mov_b32 m0, 16384
v_mov_b64 v[48:49], 0
v_mov_b64 v[50:51], 0
v_mov_b64 v[68:69], 0
v_mov_b64 v[70:71], 0
s_add_u32 s72, s53, 131072
s_add_u32 s73, s53, 262144
s_mov_b32 s19, s74
Lc_dl3b:
s_sub_u32 s19, s19, 1
s_cbranch_scc0 Lc_dl3b
s_mov_b32 s75, 0
buffer_load_dwordx4 v[20:23], v7, s[8:11], s53 offen sc1
buffer_load_dwordx4 v[24:27], v7, s[8:11], s53 offen offset:1024 sc1
buffer_load_dwordx4 v[28:31], v7, s[8:11], s53 offen offset:2048 sc1
buffer_load_dwordx4 v[32:35], v7, s[8:11], s53 offen offset:3072 sc1
Lc_rA3b:
s_waitcnt vmcnt(3)
v_mfma_f32_16x16x32_bf16 v[36:39], v[72:75], v[20:23], 0
buffer_load_dwordx4 v[52:55], v7, s[8:11], s72 offen sc1
buffer_load_dwordx4 v[56:59], v7, s[8:11], s72 offen offset:1024 sc1
v_bitop3_b32 v41, v20, v22, s32 bitop3:0x7e
s_waitcnt vmcnt(4)
v_mfma_f32_16x16x32_bf16 v[36:39], v[72:75], v[24:27], v[36:39]
buffer_load_dwordx4 v[60:63], v7, s[8:11], s72 offen offset:2048 sc1
buffer_load_dwordx4 v[64:67], v7, s[8:11], s72 offen offset:3072 sc1
v_bitop3_b32 v42, v24, v26, s32 bitop3:0x7e
s_waitcnt vmcnt(5)
v_mfma_f32_16x16x32_bf16 v[36:39], v[72:75], v[28:31], v[36:39]
v_bitop3_b32 v43, v28, v30, s32 bitop3:0x7e
s_waitcnt vmcnt(4)
v_mfma_f32_16x16x32_bf16 v[36:39], v[72:75], v[32:35], v[36:39]
v_or3_b32 v41, v41, v42, v43
v_bitop3_b32 v42, v32, v34, s32 bitop3:0x7e
v_bitop3_b32 v41, v41, v42, 1 bitop3:0xa8
v_cmp_ne_u32 vcc, 0, v41
s_cbranch_vccnz Lc_rB3b
s_nop 2
v_add_f32_dpp v36, v36, v36 row_ror:8 row_mask:0xf bank_mask:0xf
v_add_f32_dpp v37, v37, v37 row_ror:8 row_mask:0xf bank_mask:0xf
v_cvt_pk_bf16_f32 v40, v36, v37
buffer_store_dword v40, v76, s[8:11], s49 offen
s_add_u32 s49, s49, 4096
s_waitcnt vmcnt(4)
v_mfma_f32_16x16x32_bf16 v[36:39], v[72:75], v[52:55], 0
v_bitop3_b32 v41, v52, v54, s32 bitop3:0x7e
s_waitcnt vmcnt(3)
v_mfma_f32_16x16x32_bf16 v[36:39], v[72:75], v[56:59], v[36:39]
v_bitop3_b32 v42, v56, v58, s32 bitop3:0x7e
s_waitcnt vmcnt(2)
v_mfma_f32_16x16x32_bf16 v[36:39], v[72:75], v[60:63], v[36:39]
v_bitop3_b32 v43, v60, v62, s32 bitop3:0x7e
s_waitcnt vmcnt(1)
v_mfma_f32_16x16x32_bf16 v[36:39], v[72:75], v[64:67], v[36:39]
v_or3_b32 v41, v41, v42, v43
v_bitop3_b32 v42, v64, v66, s32 bitop3:0x7e
v_bitop3_b32 v41, v41, v42, 1 bitop3:0xa8
v_cmp_ne_u32 vcc, 0, v41
s_cbranch_vccnz Lc_rF103b
Lc_rok103b:
s_nop 2
v_add_f32_dpp v36, v36, v36 row_ror:8 row_mask:0xf bank_mask:0xf
v_add_f32_dpp v37, v37, v37 row_ror:8 row_mask:0xf bank_mask:0xf
v_cvt_pk_bf16_f32 v40, v36, v37
buffer_store_dword v40, v76, s[8:11], s49 offen
Lc_rdone3b:
v_mov_b64 v[52:53], 0
v_mov_b64 v[54:55], 0
v_mov_b64 v[56:57], 0
v_mov_b64 v[58:59], 0
v_mov_b64 v[60:61], 0
v_mov_b64 v[62:63], 0
v_mov_b64 v[64:65], 0
v_mov_b64 v[66:67], 0
s_cmp_eq_u32 s18, 40
s_cbranch_scc1 Lc_pre3b
Lc_preb3b:
v_cmp_eq_u32 vcc, 0, v78
s_cbranch_vccnz Lc_kvslow3b
Lc_kvback3b:
s_add_u32 s35, s35, 1024
s_cmp_eq_u32 s18, 63
s_cbranch_scc0 Lc_top3b
s_lshl_b32 s19, s17, 5
s_add_u32 s19, s19, 129048
buffer_store_dword v2, off, s[8:11], s19 sc1
buffer_store_dword v2, off, s[8:11], s19 offset:4 sc1
s_branch Lc_topL3
Lc_rB3b:
buffer_load_dwordx4 v[20:23], v7, s[8:11], s53 offen sc1
buffer_load_dwordx4 v[24:27], v7, s[8:11], s53 offen offset:1024 sc1
buffer_load_dwordx4 v[28:31], v7, s[8:11], s53 offen offset:2048 sc1
buffer_load_dwordx4 v[32:35], v7, s[8:11], s53 offen offset:3072 sc1
s_add_u32 s75, s75, 1
s_add_u32 s21, s21, 1
s_cmp_ge_u32 s21, 4194304
s_cbranch_scc1 L_abort
s_branch Lc_rA3b
Lc_vm3b:
v_lshrrev_b32 v64, 1, v0
s_mul_i32 s19, s17, 4096
s_add_u32 s19, s19, 24907264
buffer_store_dwordx2 v[66:67], v64, s[8:11], s19 offen sc1
s_branch Lc_vmb3b
Lc_rF103b:
buffer_load_dwordx4 v[52:55], v7, s[8:11], s72 offen sc1
buffer_load_dwordx4 v[56:59], v7, s[8:11], s72 offen offset:1024 sc1
buffer_load_dwordx4 v[60:63], v7, s[8:11], s72 offen offset:2048 sc1
buffer_load_dwordx4 v[64:67], v7, s[8:11], s72 offen offset:3072 sc1
s_add_u32 s21, s21, 1
s_cmp_ge_u32 s21, 4194304
s_cbranch_scc1 L_abort
s_waitcnt vmcnt(3)
v_mfma_f32_16x16x32_bf16 v[36:39], v[72:75], v[52:55], 0
v_bitop3_b32 v41, v52, v54, s32 bitop3:0x7e
s_waitcnt vmcnt(2)
v_mfma_f32_16x16x32_bf16 v[36:39], v[72:75], v[56:59], v[36:39]
v_bitop3_b32 v42, v56, v58, s32 bitop3:0x7e
s_waitcnt vmcnt(1)
v_mfma_f32_16x16x32_bf16 v[36:39], v[72:75], v[60:63], v[36:39]
v_bitop3_b32 v43, v60, v62, s32 bitop3:0x7e
s_waitcnt vmcnt(0)
v_mfma_f32_16x16x32_bf16 v[36:39], v[72:75], v[64:67], v[36:39]
v_or3_b32 v41, v41, v42, v43
v_bitop3_b32 v42, v64, v66, s32 bitop3:0x7e
v_bitop3_b32 v41, v41, v42, 1 bitop3:0xa8
v_cmp_ne_u32 vcc, 0, v41
s_cbranch_vccz Lc_rok103b
s_branch Lc_rF103b
Lc_pre3b:
v_mov_b32 v12, 0
global_load_dword v13, v12, s[6:7] offset:104 sc1
s_waitcnt vmcnt(0)
v_cmp_gt_u32 vcc, 28, v13
s_cbranch_vccz Lc_preb3b
s_add_u32 s21, s21, 1
s_cmp_ge_u32 s21, 4194304
s_cbranch_scc1 L_abort
s_branch Lc_pre3b
Lc_retry23b:
buffer_load_dwordx4 v0, s[8:11], s22 offen offset:2048 sc1 lds
ds_read_b128 v[20:23], v0 offset:18432
s_add_u32 s21, s21, 1
s_cmp_ge_u32 s21, 4194304
s_cbranch_scc1 L_abort
s_waitcnt lgkmcnt(0)
v_cmp_eq_u32 vcc, -1, v20
s_cbranch_vccnz Lc_retry23b
s_waitcnt vmcnt(0)
s_branch Lc_back23b
Lc_retry33b:
buffer_load_dwordx4 v0, s[8:11], s22 offen offset:3072 sc1 lds
ds_read_b128 v[24:27], v0 offset:19456
s_add_u32 s21, s21, 1
s_cmp_ge_u32 s21, 4194304
s_cbranch_scc1 L_abort
s_waitcnt lgkmcnt(0)
v_cmp_eq_u32 vcc, -1, v24
s_cbranch_vccnz Lc_retry33b
s_waitcnt vmcnt(0)
s_branch Lc_back33b
Lc_retry43b:
buffer_load_dwordx4 v[28:31], v0, s[8:11], s51 offen sc1
s_waitcnt vmcnt(0)
v_cmp_eq_u32 vcc, -1, v28
s_cbranch_vccz Lc_back43b
s_add_u32 s21, s21, 1
s_cmp_ge_u32 s21, 4194304
s_cbranch_scc1 L_abort
s_branch Lc_retry43b
Lc_retry53b:
buffer_load_dwordx4 v[32:35], v0, s[8:11], s51 offen offset:1024 sc1
s_waitcnt vmcnt(0)
v_cmp_eq_u32 vcc, -1, v32
s_cbranch_vccz Lc_back53b
s_add_u32 s21, s21, 1
s_cmp_ge_u32 s21, 4194304
s_cbranch_scc1 L_abort
s_branch Lc_retry53b
Lc_retry63b:
buffer_load_dwordx4 v[36:39], v0, s[8:11], s51 offen offset:2048 sc1
s_waitcnt vmcnt(0)
v_cmp_eq_u32 vcc, -1, v36
s_cbranch_vccz Lc_back63b
s_add_u32 s21, s21, 1
s_cmp_ge_u32 s21, 4194304
s_cbranch_scc1 L_abort
s_branch Lc_retry63b
Lc_retry73b:
buffer_load_dwordx4 v[40:43], v0, s[8:11], s51 offen offset:3072 sc1
s_waitcnt vmcnt(0)
v_cmp_eq_u32 vcc, -1, v40
s_cbranch_vccz Lc_back73b
s_add_u32 s21, s21, 1
s_cmp_ge_u32 s21, 4194304
s_cbranch_scc1 L_abort
s_branch Lc_retry73b
Lc_retry83b:
buffer_load_dwordx4 v[44:47], v0, s[8:11], s52 offen sc1
s_waitcnt vmcnt(0)
v_cmp_eq_u32 vcc, -1, v44
s_cbranch_vccz Lc_back83b
s_add_u32 s21, s21, 1
s_cmp_ge_u32 s21, 4194304
s_cbranch_scc1 L_abort
s_branch Lc_retry83b
Lc_redo3b:
s_cmp_eq_u32 s48, s18
s_cbranch_scc1 Lc_redoback3b
s_mov_b32 s48, s18
s_waitcnt lgkmcnt(0)
s_nop 15
Lc_redo23b:
buffer_load_dwordx4 v[12:15], v0, s[8:11], s22 offen sc1
buffer_load_dwordx4 v[16:19], v0, s[8:11], s22 offen offset:1024 sc1
buffer_load_dwordx4 v[20:23], v0, s[8:11], s22 offen offset:2048 sc1
buffer_load_dwordx4 v[24:27], v0, s[8:11], s22 offen offset:3072 sc1
buffer_load_dwordx4 v[28:31], v0, s[8:11], s51 offen sc1
buffer_load_dwordx4 v[32:35], v0, s[8:11], s51 offen offset:1024 sc1
buffer_load_dwordx4 v[36:39], v0, s[8:11], s51 offen offset:2048 sc1
buffer_load_dwordx4 v[40:43], v0, s[8:11], s51 offen offset:3072 sc1
buffer_load_dwordx4 v[44:47], v0, s[8:11], s52 offen sc1
v_mov_b64 v[48:49], 0
v_mov_b64 v[50:51], 0
v_mov_b64 v[52:53], 0
v_mov_b64 v[54:55], 0
v_mov_b64 v[56:57], 0
v_mov_b64 v[58:59], 0
v_mov_b64 v[60:61], 0
v_mov_b64 v[62:63], 0
v_mov_b64 v[64:65], 0
v_mov_b64 v[66:67], 0
v_mov_b64 v[68:69], 0
v_mov_b64 v[70:71], 0
s_waitcnt vmcnt(0)
v_max_u32 v48, v12, v13
v_max3_u32 v48, v48, v14, v15
v_max3_u32 v48, v48, v16, v17
v_max3_u32 v48, v48, v18, v19
v_max3_u32 v48, v48, v20, v21
v_max3_u32 v48, v48, v22, v23
v_max3_u32 v48, v48, v24, v25
v_max3_u32 v48, v48, v26, v27
v_max3_u32 v48, v48, v28, v29
v_max3_u32 v48, v48, v30, v31
v_max3_u32 v48, v48, v32, v33
v_max3_u32 v48, v48, v34, v35
v_max3_u32 v48, v48, v36, v37
v_max3_u32 v48, v48, v38, v39
v_max3_u32 v48, v48, v40, v41
v_max3_u32 v48, v48, v42, v43
v_max3_u32 v48, v48, v44, v45
v_max3_u32 v48, v48, v46, v47
v_cmp_eq_u32 vcc, -1, v48
v_mov_b32 v48, 0
s_cbranch_vccnz Lc_redo33b
s_nop 0
v_smfmac_f32_16x16x64_bf16 v[48:51], v[12:15], a[0:7], v2
v_smfmac_f32_16x16x64_bf16 v[52:55], v[12:15], a[8:15], v2
v_smfmac_f32_16x16x64_bf16 v[56:59], v[12:15], a[16:23], v2
v_smfmac_f32_16x16x64_bf16 v[60:63], v[12:15], a[24:31], v2
v_smfmac_f32_16x16x64_bf16 v[64:67], v[12:15], v[80:87], v2
v_smfmac_f32_16x16x64_bf16 v[68:71], v[12:15], v[88:95], v2
v_smfmac_f32_16x16x64_bf16 v[48:51], v[16:19], a[32:39], v2
v_smfmac_f32_16x16x64_bf16 v[52:55], v[16:19], a[40:47], v2
v_smfmac_f32_16x16x64_bf16 v[56:59], v[16:19], a[48:55], v2
v_smfmac_f32_16x16x64_bf16 v[60:63], v[16:19], a[56:63], v2
v_smfmac_f32_16x16x64_bf16 v[64:67], v[16:19], v[96:103], v2
v_smfmac_f32_16x16x64_bf16 v[68:71], v[16:19], v[104:111], v2
v_smfmac_f32_16x16x64_bf16 v[48:51], v[20:23], a[64:71], v2
v_smfmac_f32_16x16x64_bf16 v[52:55], v[20:23], a[72:79], v2
v_smfmac_f32_16x16x64_bf16 v[56:59], v[20:23], a[80:87], v2
v_smfmac_f32_16x16x64_bf16 v[60:63], v[20:23], a[88:95], v2
v_smfmac_f32_16x16x64_bf16 v[64:67], v[20:23], v[112:119], v2
v_smfmac_f32_16x16x64_bf16 v[68:71], v[20:23], v[120:127], v2
v_smfmac_f32_16x16x64_bf16 v[48:51], v[24:27], a[96:103], v2
v_smfmac_f32_16x16x64_bf16 v[52:55], v[24:27], a[104:111], v2
v_smfmac_f32_16x16x64_bf16 v[56:59], v[24:27], a[112:119], v2
v_smfmac_f32_16x16x64_bf16 v[60:63], v[24:27], a[120:127], v2
v_smfmac_f32_16x16x64_bf16 v[64:67], v[24:27], v[128:135], v2
v_smfmac_f32_16x16x64_bf16 v[68:71], v[24:27], v[136:143], v2
v_smfmac_f32_16x16x64_bf16 v[48:51], v[28:31], a[128:135], v2
v_smfmac_f32_16x16x64_bf16 v[52:55], v[28:31], a[136:143], v2
v_smfmac_f32_16x16x64_bf16 v[56:59], v[28:31], a[144:151], v2
v_smfmac_f32_16x16x64_bf16 v[60:63], v[28:31], a[152:159], v2
v_smfmac_f32_16x16x64_bf16 v[48:51], v[32:35], a[160:167], v2
v_smfmac_f32_16x16x64_bf16 v[52:55], v[32:35], a[168:175], v2
v_smfmac_f32_16x16x64_bf16 v[56:59], v[32:35], a[176:183], v2
v_smfmac_f32_16x16x64_bf16 v[60:63], v[32:35], a[184:191], v2
v_smfmac_f32_16x16x64_bf16 v[48:51], v[36:39], a[192:199], v2
v_smfmac_f32_16x16x64_bf16 v[52:55], v[36:39], a[200:207], v2
v_smfmac_f32_16x16x64_bf16 v[56:59], v[36:39], a[208:215], v2
v_smfmac_f32_16x16x64_bf16 v[60:63], v[36:39], a[216:223], v2
v_smfmac_f32_16x16x64_bf16 v[48:51], v[40:43], a[224:231], v2
v_smfmac_f32_16x16x64_bf16 v[52:55], v[40:43], a[232:239], v2
v_smfmac_f32_16x16x64_bf16 v[56:59], v[40:43], a[240:247], v2
v_smfmac_f32_16x16x64_bf16 v[60:63], v[40:43], a[248:255], v2
v_smfmac_f32_16x16x64_bf16 v[48:51], v[44:47], v[224:231], v2
v_smfmac_f32_16x16x64_bf16 v[52:55], v[44:47], v[232:239], v2
v_smfmac_f32_16x16x64_bf16 v[56:59], v[44:47], v[240:247], v2
v_smfmac_f32_16x16x64_bf16 v[60:63], v[44:47], v[248:255], v2
ds_read_b128 v[12:15], v0
ds_read_b128 v[16:19], v0 offset:4096
ds_read_b128 v[20:23], v0 offset:1024
s_nop 7
v_add_f32 v48, v48, v50
v_add_f32 v49, v49, v51
v_add_f32 v52, v52, v54
v_add_f32 v53, v53, v55
s_branch Lc_post3b
Lc_redo33b:
s_add_u32 s21, s21, 1
s_cmp_ge_u32 s21, 4194304
s_cbranch_scc1 L_abort
s_branch Lc_redo23b
Lc_kvslow3b:
s_cmp_ge_u32 s18, 62
s_cbranch_scc1 Lc_kvback3b
v_bfe_u32 v40, v0, 4, 3
v_lshlrev_b32 v40, 2, v40
Lc_wkvx3b:
buffer_load_dword v41, v40, s[8:11], s35 offen sc1
s_waitcnt vmcnt(0)
v_cmp_eq_u32 vcc, 0, v41
s_cbranch_vccz Lc_wkv_okx3b
s_sleep 4
s_add_u32 s21, s21, 1
s_cmp_ge_u32 s21, 4194304
s_cbranch_scc1 L_abort
s_branch Lc_wkvx3b
Lc_wkv_okx3b:
s_branch Lc_kvback3b
.p2align 6
s_nop 0
s_nop 0
Lc_top3c:
ds_read_b128 v[12:15], v0 offset:16384
ds_read_b128 v[16:19], v0 offset:17408
s_add_u32 s21, s21, 1
s_cmp_ge_u32 s21, 4194304
s_cbranch_scc1 L_abort
s_waitcnt lgkmcnt(0)
v_max_u32 v43, v12, v16
v_cmp_eq_u32 vcc, -1, v43
s_cbranch_vccnz Lc_top3c
v_smfmac_f32_16x16x64_bf16 v[48:51], v[12:15], a[0:7], v2
v_smfmac_f32_16x16x64_bf16 v[52:55], v[12:15], a[8:15], v2
v_smfmac_f32_16x16x64_bf16 v[56:59], v[12:15], a[16:23], v2
buffer_load_dwordx4 v[28:31], v0, s[8:11], s51 offen sc1
v_smfmac_f32_16x16x64_bf16 v[60:63], v[12:15], a[24:31], v2
v_smfmac_f32_16x16x64_bf16 v[64:67], v[12:15], v[80:87], v2
ds_read_b128 v[20:23], v0 offset:18432
v_smfmac_f32_16x16x64_bf16 v[68:71], v[12:15], v[88:95], v2
v_smfmac_f32_16x16x64_bf16 v[48:51], v[16:19], a[32:39], v2
buffer_load_dwordx4 v[32:35], v0, s[8:11], s51 offen offset:1024 sc1
v_smfmac_f32_16x16x64_bf16 v[52:55], v[16:19], a[40:47], v2
v_smfmac_f32_16x16x64_bf16 v[56:59], v[16:19], a[48:55], v2
v_smfmac_f32_16x16x64_bf16 v[60:63], v[16:19], a[56:63], v2
ds_read_b128 v[24:27], v0 offset:19456
s_waitcnt lgkmcnt(1)
v_cmp_eq_u32 vcc, -1, v20
v_smfmac_f32_16x16x64_bf16 v[64:67], v[16:19], v[96:103], v2
buffer_load_dwordx4 v[36:39], v0, s[8:11], s51 offen offset:2048 sc1
v_smfmac_f32_16x16x64_bf16 v[68:71], v[16:19], v[104:111], v2
s_cbranch_vccnz Lc_retry23c
Lc_back23c:
v_smfmac_f32_16x16x64_bf16 v[48:51], v[20:23], a[64:71], v2
v_smfmac_f32_16x16x64_bf16 v[52:55], v[20:23], a[72:79], v2
v_smfmac_f32_16x16x64_bf16 v[56:59], v[20:23], a[80:87], v2
buffer_load_dwordx4 v[40:43], v0, s[8:11], s51 offen offset:3072 sc1
v_smfmac_f32_16x16x64_bf16 v[60:63], v[20:23], a[88:95], v2
s_waitcnt lgkmcnt(0)
v_cmp_eq_u32 vcc, -1, v24
v_smfmac_f32_16x16x64_bf16 v[64:67], v[20:23], v[112:119], v2
v_smfmac_f32_16x16x64_bf16 v[68:71], v[20:23], v[120:127], v2
buffer_load_dwordx4 v[44:47], v0, s[8:11], s52 offen sc1
s_cbranch_vccnz Lc_retry33c
Lc_back33c:
v_smfmac_f32_16x16x64_bf16 v[48:51], v[24:27], a[96:103], v2
s_waitcnt vmcnt(5)
s_barrier
v_smfmac_f32_16x16x64_bf16 v[52:55], v[24:27], a[104:111], v2
s_waitcnt vmcnt(4)
v_cmp_eq_u32 vcc, -1, v28
v_smfmac_f32_16x16x64_bf16 v[56:59], v[24:27], a[112:119], v2
ds_read_b128 v[12:15], v0
v_smfmac_f32_16x16x64_bf16 v[60:63], v[24:27], a[120:127], v2
ds_read_b128 v[16:19], v0 offset:4096
s_cbranch_vccnz Lc_retry43c
Lc_back43c:
v_smfmac_f32_16x16x64_bf16 v[48:51], v[28:31], a[128:135], v2
ds_read_b128 v[20:23], v0 offset:1024
v_smfmac_f32_16x16x64_bf16 v[52:55], v[28:31], a[136:143], v2
s_waitcnt vmcnt(3)
v_cmp_eq_u32 vcc, -1, v32
v_smfmac_f32_16x16x64_bf16 v[56:59], v[28:31], a[144:151], v2
v_smfmac_f32_16x16x64_bf16 v[60:63], v[28:31], a[152:159], v2
s_cbranch_vccnz Lc_retry53c
Lc_back53c:
v_smfmac_f32_16x16x64_bf16 v[48:51], v[32:35], a[160:167], v2
s_add_u32 s19, s55, 0
buffer_store_dword v79, v76, s[8:11], s19 offen
v_smfmac_f32_16x16x64_bf16 v[52:55], v[32:35], a[168:175], v2
s_waitcnt vmcnt(3)
v_cmp_eq_u32 vcc, -1, v36
v_smfmac_f32_16x16x64_bf16 v[56:59], v[32:35], a[176:183], v2
v_smfmac_f32_16x16x64_bf16 v[60:63], v[32:35], a[184:191], v2
s_cbranch_vccnz Lc_retry63c
Lc_back63c:
v_smfmac_f32_16x16x64_bf16 v[48:51], v[36:39], a[192:199], v2
s_add_u32 s19, s55, 4096
buffer_store_dword v79, v76, s[8:11], s19 offen
v_smfmac_f32_16x16x64_bf16 v[52:55], v[36:39], a[200:207], v2
s_waitcnt vmcnt(3)
v_cmp_eq_u32 vcc, -1, v40
v_smfmac_f32_16x16x64_bf16 v[56:59], v[36:39], a[208:215], v2
v_smfmac_f32_16x16x64_bf16 v[60:63], v[36:39], a[216:223], v2
s_cbranch_vccnz Lc_retry73c
Lc_back73c:
v_smfmac_f32_16x16x64_bf16 v[48:51], v[40:43], a[224:231], v2
s_add_u32 s19, s55, 8192
buffer_store_dword v79, v76, s[8:11], s19 offen
v_smfmac_f32_16x16x64_bf16 v[52:55], v[40:43], a[232:239], v2
s_waitcnt vmcnt(3)
v_cmp_eq_u32 vcc, -1, v44
v_smfmac_f32_16x16x64_bf16 v[56:59], v[40:43], a[240:247], v2
v_smfmac_f32_16x16x64_bf16 v[60:63], v[40:43], a[248:255], v2
s_cbranch_vccnz Lc_retry83c
Lc_back83c:
v_smfmac_f32_16x16x64_bf16 v[48:51], v[44:47], v[224:231], v2
v_smfmac_f32_16x16x64_bf16 v[52:55], v[44:47], v[232:239], v2
v_lshlrev_b32 v78, 3, v0
s_add_u32 s19, s39, 8192
buffer_load_dword v78, v78, s[8:11], s39 offen
buffer_load_dword v78, v78, s[8:11], s19 offen
s_add_u32 s39, s39, s97
s_mov_b32 s97, 524288
v_smfmac_f32_16x16x64_bf16 v[56:59], v[44:47], v[240:247], v2
v_add_f32 v48, v48, v50
v_smfmac_f32_16x16x64_bf16 v[60:63], v[44:47], v[248:255], v2
v_add_f32 v49, v49, v51
v_smfmac_f32_16x16x64_bf16 v[64:67], v[24:27], v[128:135], v2
v_add_f32 v52, v52, v54
v_smfmac_f32_16x16x64_bf16 v[68:71], v[24:27], v[136:143], v2
v_add_f32 v53, v53, v55
Lc_post3c:
v_add_f32 v56, v56, v58
v_add_f32 v60, v60, v62
v_cvt_pk_bf16_f32 v50, v48, v52
v_cvt_pk_bf16_f32 v51, v56, v60
v_xor_b32 v58, 16, v3
ds_write_b64 v3, v[50:51] offset:16384
v_add_f32 v57, v57, v59
v_add_f32 v61, v61, v63
v_cvt_pk_bf16_f32 v54, v49, v53
v_cvt_pk_bf16_f32 v55, v57, v61
ds_write_b64 v58, v[54:55] offset:16384
v_cmp_u_f32 vcc, v48, v49
v_smfmac_f32_16x16x64_bf16 v[64:67], v[28:31], v[144:151], v2
v_smfmac_f32_16x16x64_bf16 v[68:71], v[28:31], v[152:159], v2
s_cbranch_vccnz Lc_redo3c
Lc_redoback3c:
v_smfmac_f32_16x16x64_bf16 v[64:67], v[32:35], v[160:167], v2
v_smfmac_f32_16x16x64_bf16 v[68:71], v[32:35], v[168:175], v2
v_xor_b32 v32, 64, v4
s_waitcnt lgkmcnt(0)
s_barrier
ds_read_b128 v[28:31], v4 offset:16384
ds_read_b128 v[32:35], v32 offset:17408
ds_read_b128 v[56:59], v0 offset:5120
v_smfmac_f32_16x16x64_bf16 v[64:67], v[36:39], v[176:183], v2
v_smfmac_f32_16x16x64_bf16 v[68:71], v[36:39], v[184:191], v2
ds_read_b128 v[36:39], v4 offset:18432
ds_read_b128 v[60:63], v0 offset:2048
ds_read_b128 v[24:27], v0 offset:6144
v_smfmac_f32_16x16x64_bf16 v[64:67], v[40:43], v[192:199], v2
v_smfmac_f32_16x16x64_bf16 v[68:71], v[40:43], v[200:207], v2
v_xor_b32 v40, 64, v4
ds_read_b128 v[40:43], v40 offset:19456
v_smfmac_f32_16x16x64_bf16 v[64:67], v[44:47], v[208:215], v2
v_bfe_u32 v48, v0, 4, 3
v_lshlrev_b32 v48, 2, v48
buffer_load_dword v78, v48, s[8:11], s35 offen sc1
v_smfmac_f32_16x16x64_bf16 v[68:71], v[44:47], v[216:223], v2
s_waitcnt lgkmcnt(6)
v_mfma_f32_16x16x32_bf16 v[48:51], v[12:15], v[28:31], 0
ds_read_b128 v[12:15], v0 offset:3072
v_mfma_f32_16x16x32_bf16 v[52:55], v[16:19], v[28:31], 0
ds_read_b128 v[16:19], v0 offset:7168
v_mfma_f32_16x16x32_bf16 v[44:47], v[28:31], v[28:31], 0
s_waitcnt lgkmcnt(6)
v_mfma_f32_16x16x32_bf16 v[48:51], v[20:23], v[32:35], v[48:51]
v_add_f32 v64, v64, v66
v_add_f32 v65, v65, v67
v_mfma_f32_16x16x32_bf16 v[52:55], v[56:59], v[32:35], v[52:55]
v_add_f32 v68, v68, v70
ds_read_b128 v[56:59], v0 offset:14336
v_mfma_f32_16x16x32_bf16 v[44:47], v[32:35], v[32:35], v[44:47]
v_add_f32 v69, v69, v71
v_cvt_pk_bf16_f32 v66, v64, v65
s_waitcnt lgkmcnt(4)
v_mfma_f32_16x16x32_bf16 v[48:51], v[60:63], v[36:39], v[48:51]
v_cvt_pk_bf16_f32 v67, v68, v69
ds_read_b128 v[60:63], v0 offset:15360
v_mfma_f32_16x16x32_bf16 v[52:55], v[24:27], v[36:39], v[52:55]
s_cmp_eq_u32 s18, 62
v_mfma_f32_16x16x32_bf16 v[44:47], v[36:39], v[36:39], v[44:47]
s_cbranch_scc1 Lc_vm3c
Lc_vmb3c:
s_waitcnt lgkmcnt(2)
v_mfma_f32_16x16x32_bf16 v[44:47], v[40:43], v[40:43], v[44:47]
s_barrier
v_mfma_f32_16x16x32_bf16 v[48:51], v[12:15], v[40:43], v[48:51]
v_mfma_f32_16x16x32_bf16 v[52:55], v[16:19], v[40:43], v[52:55]
v_mov_b32 v36, -1
v_mov_b32 v37, -1
v_mov_b32 v38, -1
s_nop 0
v_max3_f32 v64, v46, v47, v48
v_max3_f32 v64, v64, v49, v50
v_mov_b32 v39, -1
s_nop 0
v_max3_f32 v65, v51, v52, v53
v_max3_f32 v65, v65, v54, v55
v_max_f32 v44, v64, v65
v_max_f32 v65, v64, v65
s_nop 1
v_permlane32_swap_b32 v44, v65
v_max_f32 v64, v44, v65
v_max_f32 v65, v44, v65
s_mov_b32 s20, s24
s_bitcmp0_b32 s18, 1
v_permlane16_swap_b32 v64, v65
v_max_f32 v64, v64, v65
v_fma_f32 v64, v64, s30, v5
v_pk_fma_f32 v[46:47], v[46:47], s[30:31], v[64:65] op_sel_hi:[1,1,0] neg_lo:[0,0,1] neg_hi:[0,0,1]
v_pk_fma_f32 v[48:49], v[48:49], s[30:31], v[64:65] op_sel_hi:[1,1,0] neg_lo:[0,0,1] neg_hi:[0,0,1]
v_pk_fma_f32 v[50:51], v[50:51], s[30:31], v[64:65] op_sel_hi:[1,1,0] neg_lo:[0,0,1] neg_hi:[0,0,1]
v_pk_fma_f32 v[52:53], v[52:53], s[30:31], v[64:65] op_sel_hi:[1,1,0] neg_lo:[0,0,1] neg_hi:[0,0,1]
v_pk_fma_f32 v[54:55], v[54:55], s[30:31], v[64:65] op_sel_hi:[1,1,0] neg_lo:[0,0,1] neg_hi:[0,0,1]
v_exp_f32 v46, v46
v_exp_f32 v47, v47
v_exp_f32 v48, v48
v_cvt_pk_bf16_f32 v44, v46, v47
v_exp_f32 v49, v49
v_exp_f32 v50, v50
v_mov_b32_dpp v45, v44 quad_perm:[2,3,0,1] row_mask:0xf bank_mask:0xf
v_exp_f32 v51, v51
v_cvt_pk_bf16_f32 v48, v48, v49
v_mfma_f32_16x16x16_bf16 v[40:43], v[66:67], v[44:45], 0
ds_write_b128 v0, v[36:39] offset:19456
v_exp_f32 v52, v52
v_mfma_f32_16x16x16_bf16 v[68:71], v[8:9], v[44:45], 0
v_exp_f32 v53, v53
v_cvt_pk_bf16_f32 v49, v50, v51
v_exp_f32 v54, v54
v_exp_f32 v55, v55
v_cvt_pk_bf16_f32 v50, v52, v53
v_mov_b32_dpp v52, v48 quad_perm:[2,3,0,1] row_mask:0xf bank_mask:0xf
v_cvt_pk_bf16_f32 v51, v54, v55
v_mov_b32_dpp v53, v49 quad_perm:[2,3,0,1] row_mask:0xf bank_mask:0xf
s_cselect_b32 s32, -1, 0
s_waitcnt lgkmcnt(1)
v_mfma_f32_16x16x32_bf16 v[68:71], v[8:11], v[48:51], v[68:71]
v_mov_b32_dpp v54, v50 quad_perm:[2,3,0,1] row_mask:0xf bank_mask:0xf
v_mov_b32_dpp v55, v51 quad_perm:[2,3,0,1] row_mask:0xf bank_mask:0xf
v_mfma_f32_16x16x32_bf16 v[40:43], v[56:59], v[48:51], v[40:43]
s_mov_b32 s53, s25
s_add_u32 s55, s22, s34
v_mfma_f32_16x16x32_bf16 v[40:43], v[60:63], v[52:55], v[40:43]
s_add_u32 s49, s23, s34
s_add_u32 s38, s38, 64
v_rcp_f32 v56, v68
s_add_u32 s18, s18, 1
s_add_u32 s27, s27, 9216
v_mov_b32_dpp v56, v56 quad_perm:[0,1,0,1] row_mask:0xf bank_mask:0xf
s_nop 1
v_pk_mul_f32 v[40:41], v[40:41], v[56:57] op_sel_hi:[1,0]
v_pk_mul_f32 v[42:43], v[42:43], v[56:57] op_sel_hi:[1,0]
v_cvt_pk_bf16_f32 v40, v40, v41
v_cvt_pk_bf16_f32 v41, v42, v43
ds_write_b64 v0, v[40:41] offset:21512
s_mov_b32 s22, s23
s_add_u32 s23, s23, 9216
s_waitcnt lgkmcnt(0)
s_barrier
s_cmp_eq_u32 s23, 12610560
s_cselect_b32 s23, 12582912, s23
s_add_u32 s24, s24, s33
s_add_u32 s25, s25, s33
s_sub_u32 s33, 0, s33
s_add_u32 s51, s22, 4096
s_add_u32 s52, s22, 8192
s_mov_b32 m0, 0
s_add_u32 s19, s26, 0
buffer_load_dwordx4 v0, s[8:11], s19 offen lds
buffer_load_dwordx4 v0, s[8:11], s19 offen offset:1024 lds
buffer_load_dwordx4 v0, s[8:11], s19 offen offset:2048 lds
buffer_load_dwordx4 v0, s[8:11], s19 offen offset:3072 lds
s_mov_b32 m0, 4096
s_add_u32 s19, s26, 4096
buffer_load_dwordx4 v0, s[8:11], s19 offen lds
buffer_load_dwordx4 v0, s[8:11], s19 offen offset:1024 lds
buffer_load_dwordx4 v0, s[8:11], s19 offen offset:2048 lds
buffer_load_dwordx4 v0, s[8:11], s19 offen offset:3072 lds
s_mov_b32 m0, 8192
s_add_u32 s19, s26, 8192
buffer_load_dwordx4 v0, s[8:11], s19 offen lds
buffer_load_dwordx4 v0, s[8:11], s19 offen offset:1024 lds
buffer_load_dwordx4 v0, s[8:11], s19 offen offset:2048 lds
buffer_load_dwordx4 v0, s[8:11], s19 offen offset:3072 lds
s_mov_b32 m0, 12288
s_add_u32 s19, s26, 12288
buffer_load_dwordx4 v0, s[8:11], s19 offen lds
buffer_load_dwordx4 v0, s[8:11], s19 offen offset:1024 lds
buffer_load_dwordx4 v0, s[8:11], s19 offen offset:2048 lds
buffer_load_dwordx4 v0, s[8:11], s19 offen offset:3072 lds
s_add_u32 s26, s26, 524288
s_mov_b32 m0, 16384
v_mov_b64 v[48:49], 0
v_mov_b64 v[50:51], 0
v_mov_b64 v[68:69], 0
v_mov_b64 v[70:71], 0
s_add_u32 s72, s53, 131072
s_add_u32 s73, s53, 262144
s_mov_b32 s19, s74
Lc_dl3c:
s_sub_u32 s19, s19, 1
s_cbranch_scc0 Lc_dl3c
s_mov_b32 s75, 0
buffer_load_dwordx4 v[20:23], v7, s[8:11], s53 offen sc1
buffer_load_dwordx4 v[24:27], v7, s[8:11], s53 offen offset:1024 sc1
buffer_load_dwordx4 v[28:31], v7, s[8:11], s53 offen offset:2048 sc1
buffer_load_dwordx4 v[32:35], v7, s[8:11], s53 offen offset:3072 sc1
Lc_rA3c:
s_waitcnt vmcnt(3)
v_mfma_f32_16x16x32_bf16 v[36:39], v[72:75], v[20:23], 0
buffer_load_dwordx4 v[52:55], v7, s[8:11], s72 offen sc1
buffer_load_dwordx4 v[56:59], v7, s[8:11], s72 offen offset:1024 sc1
v_bitop3_b32 v41, v20, v22, s32 bitop3:0x7e
s_waitcnt vmcnt(4)
v_mfma_f32_16x16x32_bf16 v[36:39], v[72:75], v[24:27], v[36:39]
buffer_load_dwordx4 v[60:63], v7, s[8:11], s72 offen offset:2048 sc1
buffer_load_dwordx4 v[64:67], v7, s[8:11], s72 offen offset:3072 sc1
v_bitop3_b32 v42, v24, v26, s32 bitop3:0x7e
s_waitcnt vmcnt(5)
v_mfma_f32_16x16x32_bf16 v[36:39], v[72:75], v[28:31], v[36:39]
v_bitop3_b32 v43, v28, v30, s32 bitop3:0x7e
s_waitcnt vmcnt(4)
v_mfma_f32_16x16x32_bf16 v[36:39], v[72:75], v[32:35], v[36:39]
v_or3_b32 v41, v41, v42, v43
v_bitop3_b32 v42, v32, v34, s32 bitop3:0x7e
v_bitop3_b32 v41, v41, v42, 1 bitop3:0xa8
v_cmp_ne_u32 vcc, 0, v41
s_cbranch_vccnz Lc_rB3c
s_nop 2
v_add_f32_dpp v36, v36, v36 row_ror:8 row_mask:0xf bank_mask:0xf
v_add_f32_dpp v37, v37, v37 row_ror:8 row_mask:0xf bank_mask:0xf
v_cvt_pk_bf16_f32 v40, v36, v37
buffer_store_dword v40, v76, s[8:11], s49 offen
s_add_u32 s49, s49, 4096
s_waitcnt vmcnt(4)
v_mfma_f32_16x16x32_bf16 v[36:39], v[72:75], v[52:55], 0
buffer_load_dwordx4 v[20:23], v7, s[8:11], s73 offen sc1
buffer_load_dwordx4 v[24:27], v7, s[8:11], s73 offen offset:1024 sc1
v_bitop3_b32 v41, v52, v54, s32 bitop3:0x7e
s_waitcnt vmcnt(5)
v_mfma_f32_16x16x32_bf16 v[36:39], v[72:75], v[56:59], v[36:39]
buffer_load_dwordx4 v[28:31], v7, s[8:11], s73 offen offset:2048 sc1
buffer_load_dwordx4 v[32:35], v7, s[8:11], s73 offen offset:3072 sc1
v_bitop3_b32 v42, v56, v58, s32 bitop3:0x7e
s_waitcnt vmcnt(6)
v_mfma_f32_16x16x32_bf16 v[36:39], v[72:75], v[60:63], v[36:39]
v_bitop3_b32 v43, v60, v62, s32 bitop3:0x7e
s_waitcnt vmcnt(5)
v_mfma_f32_16x16x32_bf16 v[36:39], v[72:75], v[64:67], v[36:39]
v_or3_b32 v41, v41, v42, v43
v_bitop3_b32 v42, v64, v66, s32 bitop3:0x7e
v_bitop3_b32 v41, v41, v42, 1 bitop3:0xa8
v_cmp_ne_u32 vcc, 0, v41
s_cbranch_vccnz Lc_rF103c
Lc_rok103c:
s_nop 2
v_add_f32_dpp v36, v36, v36 row_ror:8 row_mask:0xf bank_mask:0xf
v_add_f32_dpp v37, v37, v37 row_ror:8 row_mask:0xf bank_mask:0xf
v_cvt_pk_bf16_f32 v40, v36, v37
buffer_store_dword v40, v76, s[8:11], s49 offen
s_add_u32 s49, s49, 4096
s_waitcnt vmcnt(4)
v_mfma_f32_16x16x32_bf16 v[36:39], v[72:75], v[20:23], 0
v_bitop3_b32 v41, v20, v22, s32 bitop3:0x7e
s_waitcnt vmcnt(3)
v_mfma_f32_16x16x32_bf16 v[36:39], v[72:75], v[24:27], v[36:39]
v_bitop3_b32 v42, v24, v26, s32 bitop3:0x7e
s_waitcnt vmcnt(2)
v_mfma_f32_16x16x32_bf16 v[36:39], v[72:75], v[28:31], v[36:39]
v_bitop3_b32 v43, v28, v30, s32 bitop3:0x7e
s_waitcnt vmcnt(1)
v_mfma_f32_16x16x32_bf16 v[36:39], v[72:75], v[32:35], v[36:39]
v_or3_b32 v41, v41, v42, v43
v_bitop3_b32 v42, v32, v34, s32 bitop3:0x7e
v_bitop3_b32 v41, v41, v42, 1 bitop3:0xa8
v_cmp_ne_u32 vcc, 0, v41
s_cbranch_vccnz Lc_rF203c
Lc_rok203c:
s_nop 2
v_add_f32_dpp v36, v36, v36 row_ror:8 row_mask:0xf bank_mask:0xf
v_add_f32_dpp v37, v37, v37 row_ror:8 row_mask:0xf bank_mask:0xf
v_cvt_pk_bf16_f32 v40, v36, v37
buffer_store_dword v40, v76, s[8:11], s49 offen
Lc_rdone3c:
v_mov_b64 v[52:53], 0
v_mov_b64 v[54:55], 0
v_mov_b64 v[56:57], 0
v_mov_b64 v[58:59], 0
v_mov_b64 v[60:61], 0
v_mov_b64 v[62:63], 0
v_mov_b64 v[64:65], 0
v_mov_b64 v[66:67], 0
s_cmp_eq_u32 s18, 40
s_cbranch_scc1 Lc_pre3c
Lc_preb3c:
v_cmp_eq_u32 vcc, 0, v78
s_cbranch_vccnz Lc_kvslow3c
Lc_kvback3c:
s_add_u32 s35, s35, 1024
s_cmp_eq_u32 s18, 63
s_cbranch_scc0 Lc_top3c
s_lshl_b32 s19, s17, 5
s_add_u32 s19, s19, 129048
buffer_store_dword v2, off, s[8:11], s19 sc1
buffer_store_dword v2, off, s[8:11], s19 offset:4 sc1
s_branch Lc_topL3
Lc_rB3c:
buffer_load_dwordx4 v[20:23], v7, s[8:11], s53 offen sc1
buffer_load_dwordx4 v[24:27], v7, s[8:11], s53 offen offset:1024 sc1
buffer_load_dwordx4 v[28:31], v7, s[8:11], s53 offen offset:2048 sc1
buffer_load_dwordx4 v[32:35], v7, s[8:11], s53 offen offset:3072 sc1
s_add_u32 s75, s75, 1
s_add_u32 s21, s21, 1
s_cmp_ge_u32 s21, 4194304
s_cbranch_scc1 L_abort
s_branch Lc_rA3c
Lc_vm3c:
v_lshrrev_b32 v64, 1, v0
s_mul_i32 s19, s17, 4096
s_add_u32 s19, s19, 24907264
buffer_store_dwordx2 v[66:67], v64, s[8:11], s19 offen sc1
s_branch Lc_vmb3c
Lc_rF103c:
buffer_load_dwordx4 v[52:55], v7, s[8:11], s72 offen sc1
buffer_load_dwordx4 v[56:59], v7, s[8:11], s72 offen offset:1024 sc1
buffer_load_dwordx4 v[60:63], v7, s[8:11], s72 offen offset:2048 sc1
buffer_load_dwordx4 v[64:67], v7, s[8:11], s72 offen offset:3072 sc1
s_add_u32 s21, s21, 1
s_cmp_ge_u32 s21, 4194304
s_cbranch_scc1 L_abort
s_waitcnt vmcnt(3)
v_mfma_f32_16x16x32_bf16 v[36:39], v[72:75], v[52:55], 0
buffer_load_dwordx4 v[20:23], v7, s[8:11], s73 offen sc1
buffer_load_dwordx4 v[24:27], v7, s[8:11], s73 offen offset:1024 sc1
v_bitop3_b32 v41, v52, v54, s32 bitop3:0x7e
s_waitcnt vmcnt(4)
v_mfma_f32_16x16x32_bf16 v[36:39], v[72:75], v[56:59], v[36:39]
buffer_load_dwordx4 v[28:31], v7, s[8:11], s73 offen offset:2048 sc1
buffer_load_dwordx4 v[32:35], v7, s[8:11], s73 offen offset:3072 sc1
v_bitop3_b32 v42, v56, v58, s32 bitop3:0x7e
s_waitcnt vmcnt(5)
v_mfma_f32_16x16x32_bf16 v[36:39], v[72:75], v[60:63], v[36:39]
v_bitop3_b32 v43, v60, v62, s32 bitop3:0x7e
s_waitcnt vmcnt(4)
v_mfma_f32_16x16x32_bf16 v[36:39], v[72:75], v[64:67], v[36:39]
v_or3_b32 v41, v41, v42, v43
v_bitop3_b32 v42, v64, v66, s32 bitop3:0x7e
v_bitop3_b32 v41, v41, v42, 1 bitop3:0xa8
v_cmp_ne_u32 vcc, 0, v41
s_cbranch_vccz Lc_rok103c
s_branch Lc_rF103c
Lc_rF203c:
buffer_load_dwordx4 v[20:23], v7, s[8:11], s73 offen sc1
buffer_load_dwordx4 v[24:27], v7, s[8:11], s73 offen offset:1024 sc1
buffer_load_dwordx4 v[28:31], v7, s[8:11], s73 offen offset:2048 sc1
buffer_load_dwordx4 v[32:35], v7, s[8:11], s73 offen offset:3072 sc1
s_add_u32 s21, s21, 1
s_cmp_ge_u32 s21, 4194304
s_cbranch_scc1 L_abort
s_waitcnt vmcnt(3)
v_mfma_f32_16x16x32_bf16 v[36:39], v[72:75], v[20:23], 0
v_bitop3_b32 v41, v20, v22, s32 bitop3:0x7e
s_waitcnt vmcnt(2)
v_mfma_f32_16x16x32_bf16 v[36:39], v[72:75], v[24:27], v[36:39]
v_bitop3_b32 v42, v24, v26, s32 bitop3:0x7e
s_waitcnt vmcnt(1)
v_mfma_f32_16x16x32_bf16 v[36:39], v[72:75], v[28:31], v[36:39]
v_bitop3_b32 v43, v28, v30, s32 bitop3:0x7e
s_waitcnt vmcnt(0)
v_mfma_f32_16x16x32_bf16 v[36:39], v[72:75], v[32:35], v[36:39]
v_or3_b32 v41, v41, v42, v43
v_bitop3_b32 v42, v32, v34, s32 bitop3:0x7e
v_bitop3_b32 v41, v41, v42, 1 bitop3:0xa8
v_cmp_ne_u32 vcc, 0, v41
s_cbranch_vccz Lc_rok203c
s_branch Lc_rF203c
Lc_pre3c:
v_mov_b32 v12, 0
global_load_dword v13, v12, s[6:7] offset:104 sc1
s_waitcnt vmcnt(0)
v_cmp_gt_u32 vcc, 28, v13
s_cbranch_vccz Lc_preb3c
s_add_u32 s21, s21, 1
s_cmp_ge_u32 s21, 4194304
s_cbranch_scc1 L_abort
s_branch Lc_pre3c
Lc_retry23c:
buffer_load_dwordx4 v0, s[8:11], s22 offen offset:2048 sc1 lds
ds_read_b128 v[20:23], v0 offset:18432
s_add_u32 s21, s21, 1
s_cmp_ge_u32 s21, 4194304
s_cbranch_scc1 L_abort
s_waitcnt lgkmcnt(0)
v_cmp_eq_u32 vcc, -1, v20
s_cbranch_vccnz Lc_retry23c
s_waitcnt vmcnt(0)
s_branch Lc_back23c
Lc_retry33c:
buffer_load_dwordx4 v0, s[8:11], s22 offen offset:3072 sc1 lds
ds_read_b128 v[24:27], v0 offset:19456
s_add_u32 s21, s21, 1
s_cmp_ge_u32 s21, 4194304
s_cbranch_scc1 L_abort
s_waitcnt lgkmcnt(0)
v_cmp_eq_u32 vcc, -1, v24
s_cbranch_vccnz Lc_retry33c
s_waitcnt vmcnt(0)
s_branch Lc_back33c
Lc_retry43c:
buffer_load_dwordx4 v[28:31], v0, s[8:11], s51 offen sc1
s_waitcnt vmcnt(0)
v_cmp_eq_u32 vcc, -1, v28
s_cbranch_vccz Lc_back43c
s_add_u32 s21, s21, 1
s_cmp_ge_u32 s21, 4194304
s_cbranch_scc1 L_abort
s_branch Lc_retry43c
Lc_retry53c:
buffer_load_dwordx4 v[32:35], v0, s[8:11], s51 offen offset:1024 sc1
s_waitcnt vmcnt(0)
v_cmp_eq_u32 vcc, -1, v32
s_cbranch_vccz Lc_back53c
s_add_u32 s21, s21, 1
s_cmp_ge_u32 s21, 4194304
s_cbranch_scc1 L_abort
s_branch Lc_retry53c
Lc_retry63c:
buffer_load_dwordx4 v[36:39], v0, s[8:11], s51 offen offset:2048 sc1
s_waitcnt vmcnt(0)
v_cmp_eq_u32 vcc, -1, v36
s_cbranch_vccz Lc_back63c
s_add_u32 s21, s21, 1
s_cmp_ge_u32 s21, 4194304
s_cbranch_scc1 L_abort
s_branch Lc_retry63c
Lc_retry73c:
buffer_load_dwordx4 v[40:43], v0, s[8:11], s51 offen offset:3072 sc1
s_waitcnt vmcnt(0)
v_cmp_eq_u32 vcc, -1, v40
s_cbranch_vccz Lc_back73c
s_add_u32 s21, s21, 1
s_cmp_ge_u32 s21, 4194304
s_cbranch_scc1 L_abort
s_branch Lc_retry73c
Lc_retry83c:
buffer_load_dwordx4 v[44:47], v0, s[8:11], s52 offen sc1
s_waitcnt vmcnt(0)
v_cmp_eq_u32 vcc, -1, v44
s_cbranch_vccz Lc_back83c
s_add_u32 s21, s21, 1
s_cmp_ge_u32 s21, 4194304
s_cbranch_scc1 L_abort
s_branch Lc_retry83c
Lc_redo3c:
s_cmp_eq_u32 s48, s18
s_cbranch_scc1 Lc_redoback3c
s_mov_b32 s48, s18
s_waitcnt lgkmcnt(0)
s_nop 15
Lc_redo23c:
buffer_load_dwordx4 v[12:15], v0, s[8:11], s22 offen sc1
buffer_load_dwordx4 v[16:19], v0, s[8:11], s22 offen offset:1024 sc1
buffer_load_dwordx4 v[20:23], v0, s[8:11], s22 offen offset:2048 sc1
buffer_load_dwordx4 v[24:27], v0, s[8:11], s22 offen offset:3072 sc1
buffer_load_dwordx4 v[28:31], v0, s[8:11], s51 offen sc1
buffer_load_dwordx4 v[32:35], v0, s[8:11], s51 offen offset:1024 sc1
buffer_load_dwordx4 v[36:39], v0, s[8:11], s51 offen offset:2048 sc1
buffer_load_dwordx4 v[40:43], v0, s[8:11], s51 offen offset:3072 sc1
buffer_load_dwordx4 v[44:47], v0, s[8:11], s52 offen sc1
v_mov_b64 v[48:49], 0
v_mov_b64 v[50:51], 0
v_mov_b64 v[52:53], 0
v_mov_b64 v[54:55], 0
v_mov_b64 v[56:57], 0
v_mov_b64 v[58:59], 0
v_mov_b64 v[60:61], 0
v_mov_b64 v[62:63], 0
v_mov_b64 v[64:65], 0
v_mov_b64 v[66:67], 0
v_mov_b64 v[68:69], 0
v_mov_b64 v[70:71], 0
s_waitcnt vmcnt(0)
v_max_u32 v48, v12, v13
v_max3_u32 v48, v48, v14, v15
v_max3_u32 v48, v48, v16, v17
v_max3_u32 v48, v48, v18, v19
v_max3_u32 v48, v48, v20, v21
v_max3_u32 v48, v48, v22, v23
v_max3_u32 v48, v48, v24, v25
v_max3_u32 v48, v48, v26, v27
v_max3_u32 v48, v48, v28, v29
v_max3_u32 v48, v48, v30, v31
v_max3_u32 v48, v48, v32, v33
v_max3_u32 v48, v48, v34, v35
v_max3_u32 v48, v48, v36, v37
v_max3_u32 v48, v48, v38, v39
v_max3_u32 v48, v48, v40, v41
v_max3_u32 v48, v48, v42, v43
v_max3_u32 v48, v48, v44, v45
v_max3_u32 v48, v48, v46, v47
v_cmp_eq_u32 vcc, -1, v48
v_mov_b32 v48, 0
s_cbranch_vccnz Lc_redo33c
s_nop 0
v_smfmac_f32_16x16x64_bf16 v[48:51], v[12:15], a[0:7], v2
v_smfmac_f32_16x16x64_bf16 v[52:55], v[12:15], a[8:15], v2
v_smfmac_f32_16x16x64_bf16 v[56:59], v[12:15], a[16:23], v2
v_smfmac_f32_16x16x64_bf16 v[60:63], v[12:15], a[24:31], v2
v_smfmac_f32_16x16x64_bf16 v[64:67], v[12:15], v[80:87], v2
v_smfmac_f32_16x16x64_bf16 v[68:71], v[12:15], v[88:95], v2
v_smfmac_f32_16x16x64_bf16 v[48:51], v[16:19], a[32:39], v2
v_smfmac_f32_16x16x64_bf16 v[52:55], v[16:19], a[40:47], v2
v_smfmac_f32_16x16x64_bf16 v[56:59], v[16:19], a[48:55], v2
v_smfmac_f32_16x16x64_bf16 v[60:63], v[16:19], a[56:63], v2
v_smfmac_f32_16x16x64_bf16 v[64:67], v[16:19], v[96:103], v2
v_smfmac_f32_16x16x64_bf16 v[68:71], v[16:19], v[104:111], v2
v_smfmac_f32_16x16x64_bf16 v[48:51], v[20:23], a[64:71], v2
v_smfmac_f32_16x16x64_bf16 v[52:55], v[20:23], a[72:79], v2
v_smfmac_f32_16x16x64_bf16 v[56:59], v[20:23], a[80:87], v2
v_smfmac_f32_16x16x64_bf16 v[60:63], v[20:23], a[88:95], v2
v_smfmac_f32_16x16x64_bf16 v[64:67], v[20:23], v[112:119], v2
v_smfmac_f32_16x16x64_bf16 v[68:71], v[20:23], v[120:127], v2
v_smfmac_f32_16x16x64_bf16 v[48:51], v[24:27], a[96:103], v2
v_smfmac_f32_16x16x64_bf16 v[52:55], v[24:27], a[104:111], v2
v_smfmac_f32_16x16x64_bf16 v[56:59], v[24:27], a[112:119], v2
v_smfmac_f32_16x16x64_bf16 v[60:63], v[24:27], a[120:127], v2
v_smfmac_f32_16x16x64_bf16 v[64:67], v[24:27], v[128:135], v2
v_smfmac_f32_16x16x64_bf16 v[68:71], v[24:27], v[136:143], v2
v_smfmac_f32_16x16x64_bf16 v[48:51], v[28:31], a[128:135], v2
v_smfmac_f32_16x16x64_bf16 v[52:55], v[28:31], a[136:143], v2
v_smfmac_f32_16x16x64_bf16 v[56:59], v[28:31], a[144:151], v2
v_smfmac_f32_16x16x64_bf16 v[60:63], v[28:31], a[152:159], v2
v_smfmac_f32_16x16x64_bf16 v[48:51], v[32:35], a[160:167], v2
v_smfmac_f32_16x16x64_bf16 v[52:55], v[32:35], a[168:175], v2
v_smfmac_f32_16x16x64_bf16 v[56:59], v[32:35], a[176:183], v2
v_smfmac_f32_16x16x64_bf16 v[60:63], v[32:35], a[184:191], v2
v_smfmac_f32_16x16x64_bf16 v[48:51], v[36:39], a[192:199], v2
v_smfmac_f32_16x16x64_bf16 v[52:55], v[36:39], a[200:207], v2
v_smfmac_f32_16x16x64_bf16 v[56:59], v[36:39], a[208:215], v2
v_smfmac_f32_16x16x64_bf16 v[60:63], v[36:39], a[216:223], v2
v_smfmac_f32_16x16x64_bf16 v[48:51], v[40:43], a[224:231], v2
v_smfmac_f32_16x16x64_bf16 v[52:55], v[40:43], a[232:239], v2
v_smfmac_f32_16x16x64_bf16 v[56:59], v[40:43], a[240:247], v2
v_smfmac_f32_16x16x64_bf16 v[60:63], v[40:43], a[248:255], v2
v_smfmac_f32_16x16x64_bf16 v[48:51], v[44:47], v[224:231], v2
v_smfmac_f32_16x16x64_bf16 v[52:55], v[44:47], v[232:239], v2
v_smfmac_f32_16x16x64_bf16 v[56:59], v[44:47], v[240:247], v2
v_smfmac_f32_16x16x64_bf16 v[60:63], v[44:47], v[248:255], v2
ds_read_b128 v[12:15], v0
ds_read_b128 v[16:19], v0 offset:4096
ds_read_b128 v[20:23], v0 offset:1024
s_nop 7
v_add_f32 v48, v48, v50
v_add_f32 v49, v49, v51
v_add_f32 v52, v52, v54
v_add_f32 v53, v53, v55
s_branch Lc_post3c
Lc_redo33c:
s_add_u32 s21, s21, 1
s_cmp_ge_u32 s21, 4194304
s_cbranch_scc1 L_abort
s_branch Lc_redo23c
Lc_kvslow3c:
s_cmp_ge_u32 s18, 62
s_cbranch_scc1 Lc_kvback3c
v_bfe_u32 v40, v0, 4, 3
v_lshlrev_b32 v40, 2, v40
Lc_wkvx3c:
buffer_load_dword v41, v40, s[8:11], s35 offen sc1
s_waitcnt vmcnt(0)
v_cmp_eq_u32 vcc, 0, v41
s_cbranch_vccz Lc_wkv_okx3c
s_sleep 4
s_add_u32 s21, s21, 1
s_cmp_ge_u32 s21, 4194304
s_cbranch_scc1 L_abort
s_branch Lc_wkvx3c
Lc_wkv_okx3c:
s_branch Lc_kvback3c
.p2align 6
s_nop 0
s_nop 0
Lc_topL0:
buffer_load_dwordx4 v0, s[8:11], s22 offen sc1 lds
ds_read_b128 v[12:15], v0 offset:16384
ds_read_b128 v[16:19], v0 offset:17408
s_add_u32 s21, s21, 1
s_cmp_ge_u32 s21, 4194304
s_cbranch_scc1 L_abort
s_waitcnt lgkmcnt(0)
v_max_u32 v43, v12, v16
v_cmp_eq_u32 vcc, -1, v43
s_cbranch_vccnz Lc_topL0
v_smfmac_f32_16x16x64_bf16 v[48:51], v[12:15], a[0:7], v2
v_smfmac_f32_16x16x64_bf16 v[52:55], v[12:15], a[8:15], v2
v_smfmac_f32_16x16x64_bf16 v[56:59], v[12:15], a[16:23], v2
buffer_load_dwordx4 v[28:31], v0, s[8:11], s51 offen sc1
v_smfmac_f32_16x16x64_bf16 v[60:63], v[12:15], a[24:31], v2
v_smfmac_f32_16x16x64_bf16 v[64:67], v[12:15], v[80:87], v2
ds_read_b128 v[20:23], v0 offset:18432
v_smfmac_f32_16x16x64_bf16 v[68:71], v[12:15], v[88:95], v2
v_smfmac_f32_16x16x64_bf16 v[48:51], v[16:19], a[32:39], v2
buffer_load_dwordx4 v[32:35], v0, s[8:11], s51 offen offset:1024 sc1
v_smfmac_f32_16x16x64_bf16 v[52:55], v[16:19], a[40:47], v2
v_smfmac_f32_16x16x64_bf16 v[56:59], v[16:19], a[48:55], v2
v_smfmac_f32_16x16x64_bf16 v[60:63], v[16:19], a[56:63], v2
ds_read_b128 v[24:27], v0 offset:19456
s_waitcnt lgkmcnt(1)
v_cmp_eq_u32 vcc, -1, v20
v_smfmac_f32_16x16x64_bf16 v[64:67], v[16:19], v[96:103], v2
buffer_load_dwordx4 v[36:39], v0, s[8:11], s51 offen offset:2048 sc1
v_smfmac_f32_16x16x64_bf16 v[68:71], v[16:19], v[104:111], v2
s_cbranch_vccnz Lc_retry2L0
Lc_back2L0:
v_smfmac_f32_16x16x64_bf16 v[48:51], v[20:23], a[64:71], v2
v_smfmac_f32_16x16x64_bf16 v[52:55], v[20:23], a[72:79], v2
v_smfmac_f32_16x16x64_bf16 v[56:59], v[20:23], a[80:87], v2
buffer_load_dwordx4 v[40:43], v0, s[8:11], s51 offen offset:3072 sc1
v_smfmac_f32_16x16x64_bf16 v[60:63], v[20:23], a[88:95], v2
s_waitcnt lgkmcnt(0)
v_cmp_eq_u32 vcc, -1, v24
v_smfmac_f32_16x16x64_bf16 v[64:67], v[20:23], v[112:119], v2
v_smfmac_f32_16x16x64_bf16 v[68:71], v[20:23], v[120:127], v2
buffer_load_dwordx4 v[44:47], v0, s[8:11], s52 offen sc1
s_cbranch_vccnz Lc_retry3L0
Lc_back3L0:
v_smfmac_f32_16x16x64_bf16 v[48:51], v[24:27], a[96:103], v2
s_waitcnt vmcnt(5)
s_barrier
v_smfmac_f32_16x16x64_bf16 v[52:55], v[24:27], a[104:111], v2
s_waitcnt vmcnt(4)
v_cmp_eq_u32 vcc, -1, v28
v_smfmac_f32_16x16x64_bf16 v[56:59], v[24:27], a[112:119], v2
v_smfmac_f32_16x16x64_bf16 v[60:63], v[24:27], a[120:127], v2
s_cbranch_vccnz Lc_retry4L0
Lc_back4L0:
v_smfmac_f32_16x16x64_bf16 v[48:51], v[28:31], a[128:135], v2
v_smfmac_f32_16x16x64_bf16 v[52:55], v[28:31], a[136:143], v2
s_waitcnt vmcnt(3)
v_cmp_eq_u32 vcc, -1, v32
v_smfmac_f32_16x16x64_bf16 v[56:59], v[28:31], a[144:151], v2
v_smfmac_f32_16x16x64_bf16 v[60:63], v[28:31], a[152:159], v2
s_cbranch_vccnz Lc_retry5L0
Lc_back5L0:
v_smfmac_f32_16x16x64_bf16 v[48:51], v[32:35], a[160:167], v2
v_smfmac_f32_16x16x64_bf16 v[52:55], v[32:35], a[168:175], v2
s_waitcnt vmcnt(2)
v_cmp_eq_u32 vcc, -1, v36
v_smfmac_f32_16x16x64_bf16 v[56:59], v[32:35], a[176:183], v2
v_smfmac_f32_16x16x64_bf16 v[60:63], v[32:35], a[184:191], v2
s_cbranch_vccnz Lc_retry6L0
Lc_back6L0:
v_smfmac_f32_16x16x64_bf16 v[48:51], v[36:39], a[192:199], v2
v_smfmac_f32_16x16x64_bf16 v[52:55], v[36:39], a[200:207], v2
s_waitcnt vmcnt(1)
v_cmp_eq_u32 vcc, -1, v40
v_smfmac_f32_16x16x64_bf16 v[56:59], v[36:39], a[208:215], v2
v_smfmac_f32_16x16x64_bf16 v[60:63], v[36:39], a[216:223], v2
s_cbranch_vccnz Lc_retry7L0
Lc_back7L0:
v_smfmac_f32_16x16x64_bf16 v[48:51], v[40:43], a[224:231], v2
v_smfmac_f32_16x16x64_bf16 v[52:55], v[40:43], a[232:239], v2
s_waitcnt vmcnt(0)
v_cmp_eq_u32 vcc, -1, v44
v_smfmac_f32_16x16x64_bf16 v[56:59], v[40:43], a[240:247], v2
v_smfmac_f32_16x16x64_bf16 v[60:63], v[40:43], a[248:255], v2
s_cbranch_vccnz Lc_retry8L0
Lc_back8L0:
v_smfmac_f32_16x16x64_bf16 v[48:51], v[44:47], v[224:231], v2
v_smfmac_f32_16x16x64_bf16 v[52:55], v[44:47], v[232:239], v2
v_smfmac_f32_16x16x64_bf16 v[56:59], v[44:47], v[240:247], v2
v_add_f32 v48, v48, v50
v_smfmac_f32_16x16x64_bf16 v[60:63], v[44:47], v[248:255], v2
v_add_f32 v49, v49, v51
v_smfmac_f32_16x16x64_bf16 v[64:67], v[24:27], v[128:135], v2
v_add_f32 v52, v52, v54
v_smfmac_f32_16x16x64_bf16 v[68:71], v[24:27], v[136:143], v2
v_add_f32 v53, v53, v55
Lc_postL0:
v_add_f32 v56, v56, v58
v_add_f32 v60, v60, v62
v_cvt_pk_bf16_f32 v50, v48, v52
v_cvt_pk_bf16_f32 v51, v56, v60
v_xor_b32 v58, 16, v3
ds_write_b64 v3, v[50:51] offset:16384
v_add_f32 v57, v57, v59
v_add_f32 v61, v61, v63
v_cvt_pk_bf16_f32 v54, v49, v53
v_cvt_pk_bf16_f32 v55, v57, v61
ds_write_b64 v58, v[54:55] offset:16384
v_cmp_u_f32 vcc, v48, v49
v_smfmac_f32_16x16x64_bf16 v[64:67], v[28:31], v[144:151], v2
v_smfmac_f32_16x16x64_bf16 v[68:71], v[28:31], v[152:159], v2
s_cbranch_vccnz Lc_redoL0
Lc_redobackL0:
v_smfmac_f32_16x16x64_bf16 v[64:67], v[32:35], v[160:167], v2
v_smfmac_f32_16x16x64_bf16 v[68:71], v[32:35], v[168:175], v2
v_xor_b32 v32, 64, v4
s_waitcnt lgkmcnt(0)
s_barrier
v_bfe_u32 v48, v0, 7, 1
v_lshlrev_b32 v48, 9, v48
v_bfe_u32 v49, v0, 5, 2
v_lshl_add_u32 v48, v49, 7, v48
v_lshrrev_b32 v49, 8, v0
v_lshl_add_u32 v48, v49, 5, v48
v_bfe_u32 v49, v0, 4, 1
v_lshl_add_u32 v48, v49, 3, v48
s_mul_i32 s19, s17, 4096
s_add_u32 s19, s19, 25034752
buffer_store_dwordx2 v[50:51], v48, s[8:11], s19 offen sc1
buffer_store_dwordx2 v[54:55], v48, s[8:11], s19 offen offset:16 sc1
v_smfmac_f32_16x16x64_bf16 v[64:67], v[36:39], v[176:183], v2
v_smfmac_f32_16x16x64_bf16 v[68:71], v[36:39], v[184:191], v2
v_smfmac_f32_16x16x64_bf16 v[64:67], v[40:43], v[192:199], v2
v_smfmac_f32_16x16x64_bf16 v[68:71], v[40:43], v[200:207], v2
v_smfmac_f32_16x16x64_bf16 v[64:67], v[44:47], v[208:215], v2
v_smfmac_f32_16x16x64_bf16 v[68:71], v[44:47], v[216:223], v2
s_nop 3
v_pk_add_f32 v[64:65], v[64:65], v[66:67]
s_nop 2
v_pk_add_f32 v[68:69], v[68:69], v[70:71]
v_cvt_pk_bf16_f32 v66, v64, v65
v_cvt_pk_bf16_f32 v67, v68, v69
v_lshrrev_b32 v64, 1, v0
s_mul_i32 s19, s17, 4096
s_add_u32 s19, s19, 25036800
buffer_store_dwordx2 v[66:67], v64, s[8:11], s19 offen sc1
s_waitcnt vmcnt(0)
s_lshl_b32 s19, s17, 5
s_add_u32 s19, s19, 130048
buffer_store_dword v2, off, s[8:11], s19 sc1
buffer_store_dword v2, off, s[8:11], s19 offset:4 sc1
s_waitcnt vmcnt(0)
s_endpgm
Lc_retry2L0:
buffer_load_dwordx4 v0, s[8:11], s22 offen offset:2048 sc1 lds
ds_read_b128 v[20:23], v0 offset:18432
s_add_u32 s21, s21, 1
s_cmp_ge_u32 s21, 4194304
s_cbranch_scc1 L_abort
s_waitcnt lgkmcnt(0)
v_cmp_eq_u32 vcc, -1, v20
s_cbranch_vccnz Lc_retry2L0
s_waitcnt vmcnt(0)
s_branch Lc_back2L0
Lc_retry3L0:
buffer_load_dwordx4 v0, s[8:11], s22 offen offset:3072 sc1 lds
ds_read_b128 v[24:27], v0 offset:19456
s_add_u32 s21, s21, 1
s_cmp_ge_u32 s21, 4194304
s_cbranch_scc1 L_abort
s_waitcnt lgkmcnt(0)
v_cmp_eq_u32 vcc, -1, v24
s_cbranch_vccnz Lc_retry3L0
s_waitcnt vmcnt(0)
s_branch Lc_back3L0
Lc_retry4L0:
buffer_load_dwordx4 v[28:31], v0, s[8:11], s51 offen sc1
s_waitcnt vmcnt(0)
v_cmp_eq_u32 vcc, -1, v28
s_cbranch_vccz Lc_back4L0
s_add_u32 s21, s21, 1
s_cmp_ge_u32 s21, 4194304
s_cbranch_scc1 L_abort
s_branch Lc_retry4L0
Lc_retry5L0:
buffer_load_dwordx4 v[32:35], v0, s[8:11], s51 offen offset:1024 sc1
s_waitcnt vmcnt(0)
v_cmp_eq_u32 vcc, -1, v32
s_cbranch_vccz Lc_back5L0
s_add_u32 s21, s21, 1
s_cmp_ge_u32 s21, 4194304
s_cbranch_scc1 L_abort
s_branch Lc_retry5L0
Lc_retry6L0:
buffer_load_dwordx4 v[36:39], v0, s[8:11], s51 offen offset:2048 sc1
s_waitcnt vmcnt(0)
v_cmp_eq_u32 vcc, -1, v36
s_cbranch_vccz Lc_back6L0
s_add_u32 s21, s21, 1
s_cmp_ge_u32 s21, 4194304
s_cbranch_scc1 L_abort
s_branch Lc_retry6L0
Lc_retry7L0:
buffer_load_dwordx4 v[40:43], v0, s[8:11], s51 offen offset:3072 sc1
s_waitcnt vmcnt(0)
v_cmp_eq_u32 vcc, -1, v40
s_cbranch_vccz Lc_back7L0
s_add_u32 s21, s21, 1
s_cmp_ge_u32 s21, 4194304
s_cbranch_scc1 L_abort
s_branch Lc_retry7L0
Lc_retry8L0:
buffer_load_dwordx4 v[44:47], v0, s[8:11], s52 offen sc1
s_waitcnt vmcnt(0)
v_cmp_eq_u32 vcc, -1, v44
s_cbranch_vccz Lc_back8L0
s_add_u32 s21, s21, 1
s_cmp_ge_u32 s21, 4194304
s_cbranch_scc1 L_abort
s_branch Lc_retry8L0
Lc_redoL0:
s_cmp_eq_u32 s48, s18
s_cbranch_scc1 Lc_redobackL0
s_mov_b32 s48, s18
s_waitcnt lgkmcnt(0)
s_nop 15
Lc_redo2L0:
buffer_load_dwordx4 v[12:15], v0, s[8:11], s22 offen sc1
buffer_load_dwordx4 v[16:19], v0, s[8:11], s22 offen offset:1024 sc1
buffer_load_dwordx4 v[20:23], v0, s[8:11], s22 offen offset:2048 sc1
buffer_load_dwordx4 v[24:27], v0, s[8:11], s22 offen offset:3072 sc1
buffer_load_dwordx4 v[28:31], v0, s[8:11], s51 offen sc1
buffer_load_dwordx4 v[32:35], v0, s[8:11], s51 offen offset:1024 sc1
buffer_load_dwordx4 v[36:39], v0, s[8:11], s51 offen offset:2048 sc1
buffer_load_dwordx4 v[40:43], v0, s[8:11], s51 offen offset:3072 sc1
buffer_load_dwordx4 v[44:47], v0, s[8:11], s52 offen sc1
v_mov_b64 v[48:49], 0
v_mov_b64 v[50:51], 0
v_mov_b64 v[52:53], 0
v_mov_b64 v[54:55], 0
v_mov_b64 v[56:57], 0
v_mov_b64 v[58:59], 0
v_mov_b64 v[60:61], 0
v_mov_b64 v[62:63], 0
v_mov_b64 v[64:65], 0
v_mov_b64 v[66:67], 0
v_mov_b64 v[68:69], 0
v_mov_b64 v[70:71], 0
s_waitcnt vmcnt(0)
v_max_u32 v48, v12, v13
v_max3_u32 v48, v48, v14, v15
v_max3_u32 v48, v48, v16, v17
v_max3_u32 v48, v48, v18, v19
v_max3_u32 v48, v48, v20, v21
v_max3_u32 v48, v48, v22, v23
v_max3_u32 v48, v48, v24, v25
v_max3_u32 v48, v48, v26, v27
v_max3_u32 v48, v48, v28, v29
v_max3_u32 v48, v48, v30, v31
v_max3_u32 v48, v48, v32, v33
v_max3_u32 v48, v48, v34, v35
v_max3_u32 v48, v48, v36, v37
v_max3_u32 v48, v48, v38, v39
v_max3_u32 v48, v48, v40, v41
v_max3_u32 v48, v48, v42, v43
v_max3_u32 v48, v48, v44, v45
v_max3_u32 v48, v48, v46, v47
v_cmp_eq_u32 vcc, -1, v48
v_mov_b32 v48, 0
s_cbranch_vccnz Lc_redo3L0
s_nop 0
v_smfmac_f32_16x16x64_bf16 v[48:51], v[12:15], a[0:7], v2
v_smfmac_f32_16x16x64_bf16 v[52:55], v[12:15], a[8:15], v2
v_smfmac_f32_16x16x64_bf16 v[56:59], v[12:15], a[16:23], v2
v_smfmac_f32_16x16x64_bf16 v[60:63], v[12:15], a[24:31], v2
v_smfmac_f32_16x16x64_bf16 v[64:67], v[12:15], v[80:87], v2
v_smfmac_f32_16x16x64_bf16 v[68:71], v[12:15], v[88:95], v2
v_smfmac_f32_16x16x64_bf16 v[48:51], v[16:19], a[32:39], v2
v_smfmac_f32_16x16x64_bf16 v[52:55], v[16:19], a[40:47], v2
v_smfmac_f32_16x16x64_bf16 v[56:59], v[16:19], a[48:55], v2
v_smfmac_f32_16x16x64_bf16 v[60:63], v[16:19], a[56:63], v2
v_smfmac_f32_16x16x64_bf16 v[64:67], v[16:19], v[96:103], v2
v_smfmac_f32_16x16x64_bf16 v[68:71], v[16:19], v[104:111], v2
v_smfmac_f32_16x16x64_bf16 v[48:51], v[20:23], a[64:71], v2
v_smfmac_f32_16x16x64_bf16 v[52:55], v[20:23], a[72:79], v2
v_smfmac_f32_16x16x64_bf16 v[56:59], v[20:23], a[80:87], v2
v_smfmac_f32_16x16x64_bf16 v[60:63], v[20:23], a[88:95], v2
v_smfmac_f32_16x16x64_bf16 v[64:67], v[20:23], v[112:119], v2
v_smfmac_f32_16x16x64_bf16 v[68:71], v[20:23], v[120:127], v2
v_smfmac_f32_16x16x64_bf16 v[48:51], v[24:27], a[96:103], v2
v_smfmac_f32_16x16x64_bf16 v[52:55], v[24:27], a[104:111], v2
v_smfmac_f32_16x16x64_bf16 v[56:59], v[24:27], a[112:119], v2
v_smfmac_f32_16x16x64_bf16 v[60:63], v[24:27], a[120:127], v2
v_smfmac_f32_16x16x64_bf16 v[64:67], v[24:27], v[128:135], v2
v_smfmac_f32_16x16x64_bf16 v[68:71], v[24:27], v[136:143], v2
v_smfmac_f32_16x16x64_bf16 v[48:51], v[28:31], a[128:135], v2
v_smfmac_f32_16x16x64_bf16 v[52:55], v[28:31], a[136:143], v2
v_smfmac_f32_16x16x64_bf16 v[56:59], v[28:31], a[144:151], v2
v_smfmac_f32_16x16x64_bf16 v[60:63], v[28:31], a[152:159], v2
v_smfmac_f32_16x16x64_bf16 v[48:51], v[32:35], a[160:167], v2
v_smfmac_f32_16x16x64_bf16 v[52:55], v[32:35], a[168:175], v2
v_smfmac_f32_16x16x64_bf16 v[56:59], v[32:35], a[176:183], v2
v_smfmac_f32_16x16x64_bf16 v[60:63], v[32:35], a[184:191], v2
v_smfmac_f32_16x16x64_bf16 v[48:51], v[36:39], a[192:199], v2
v_smfmac_f32_16x16x64_bf16 v[52:55], v[36:39], a[200:207], v2
v_smfmac_f32_16x16x64_bf16 v[56:59], v[36:39], a[208:215], v2
v_smfmac_f32_16x16x64_bf16 v[60:63], v[36:39], a[216:223], v2
v_smfmac_f32_16x16x64_bf16 v[48:51], v[40:43], a[224:231], v2
v_smfmac_f32_16x16x64_bf16 v[52:55], v[40:43], a[232:239], v2
v_smfmac_f32_16x16x64_bf16 v[56:59], v[40:43], a[240:247], v2
v_smfmac_f32_16x16x64_bf16 v[60:63], v[40:43], a[248:255], v2
v_smfmac_f32_16x16x64_bf16 v[48:51], v[44:47], v[224:231], v2
v_smfmac_f32_16x16x64_bf16 v[52:55], v[44:47], v[232:239], v2
v_smfmac_f32_16x16x64_bf16 v[56:59], v[44:47], v[240:247], v2
v_smfmac_f32_16x16x64_bf16 v[60:63], v[44:47], v[248:255], v2
s_nop 7
v_add_f32 v48, v48, v50
v_add_f32 v49, v49, v51
v_add_f32 v52, v52, v54
v_add_f32 v53, v53, v55
s_branch Lc_postL0
Lc_redo3L0:
s_add_u32 s21, s21, 1
s_cmp_ge_u32 s21, 4194304
s_cbranch_scc1 L_abort
s_branch Lc_redo2L0
.p2align 6
s_nop 0
s_nop 0
Lc_topL1:
buffer_load_dwordx4 v0, s[8:11], s22 offen offset:1024 sc1 lds
ds_read_b128 v[12:15], v0 offset:16384
ds_read_b128 v[16:19], v0 offset:17408
s_add_u32 s21, s21, 1
s_cmp_ge_u32 s21, 4194304
s_cbranch_scc1 L_abort
s_waitcnt lgkmcnt(0)
v_max_u32 v43, v12, v16
v_cmp_eq_u32 vcc, -1, v43
s_cbranch_vccnz Lc_topL1
v_smfmac_f32_16x16x64_bf16 v[48:51], v[12:15], a[0:7], v2
v_smfmac_f32_16x16x64_bf16 v[52:55], v[12:15], a[8:15], v2
v_smfmac_f32_16x16x64_bf16 v[56:59], v[12:15], a[16:23], v2
buffer_load_dwordx4 v[28:31], v0, s[8:11], s51 offen sc1
v_smfmac_f32_16x16x64_bf16 v[60:63], v[12:15], a[24:31], v2
v_smfmac_f32_16x16x64_bf16 v[64:67], v[12:15], v[80:87], v2
ds_read_b128 v[20:23], v0 offset:18432
v_smfmac_f32_16x16x64_bf16 v[68:71], v[12:15], v[88:95], v2
v_smfmac_f32_16x16x64_bf16 v[48:51], v[16:19], a[32:39], v2
buffer_load_dwordx4 v[32:35], v0, s[8:11], s51 offen offset:1024 sc1
v_smfmac_f32_16x16x64_bf16 v[52:55], v[16:19], a[40:47], v2
v_smfmac_f32_16x16x64_bf16 v[56:59], v[16:19], a[48:55], v2
v_smfmac_f32_16x16x64_bf16 v[60:63], v[16:19], a[56:63], v2
ds_read_b128 v[24:27], v0 offset:19456
s_waitcnt lgkmcnt(1)
v_cmp_eq_u32 vcc, -1, v20
v_smfmac_f32_16x16x64_bf16 v[64:67], v[16:19], v[96:103], v2
buffer_load_dwordx4 v[36:39], v0, s[8:11], s51 offen offset:2048 sc1
v_smfmac_f32_16x16x64_bf16 v[68:71], v[16:19], v[104:111], v2
s_cbranch_vccnz Lc_retry2L1
Lc_back2L1:
v_smfmac_f32_16x16x64_bf16 v[48:51], v[20:23], a[64:71], v2
v_smfmac_f32_16x16x64_bf16 v[52:55], v[20:23], a[72:79], v2
v_smfmac_f32_16x16x64_bf16 v[56:59], v[20:23], a[80:87], v2
buffer_load_dwordx4 v[40:43], v0, s[8:11], s51 offen offset:3072 sc1
v_smfmac_f32_16x16x64_bf16 v[60:63], v[20:23], a[88:95], v2
s_waitcnt lgkmcnt(0)
v_cmp_eq_u32 vcc, -1, v24
v_smfmac_f32_16x16x64_bf16 v[64:67], v[20:23], v[112:119], v2
v_smfmac_f32_16x16x64_bf16 v[68:71], v[20:23], v[120:127], v2
buffer_load_dwordx4 v[44:47], v0, s[8:11], s52 offen sc1
s_cbranch_vccnz Lc_retry3L1
Lc_back3L1:
v_smfmac_f32_16x16x64_bf16 v[48:51], v[24:27], a[96:103], v2
s_waitcnt vmcnt(5)
s_barrier
v_smfmac_f32_16x16x64_bf16 v[52:55], v[24:27], a[104:111], v2
s_waitcnt vmcnt(4)
v_cmp_eq_u32 vcc, -1, v28
v_smfmac_f32_16x16x64_bf16 v[56:59], v[24:27], a[112:119], v2
v_smfmac_f32_16x16x64_bf16 v[60:63], v[24:27], a[120:127], v2
s_cbranch_vccnz Lc_retry4L1
Lc_back4L1:
v_smfmac_f32_16x16x64_bf16 v[48:51], v[28:31], a[128:135], v2
v_smfmac_f32_16x16x64_bf16 v[52:55], v[28:31], a[136:143], v2
s_waitcnt vmcnt(3)
v_cmp_eq_u32 vcc, -1, v32
v_smfmac_f32_16x16x64_bf16 v[56:59], v[28:31], a[144:151], v2
v_smfmac_f32_16x16x64_bf16 v[60:63], v[28:31], a[152:159], v2
s_cbranch_vccnz Lc_retry5L1
Lc_back5L1:
v_smfmac_f32_16x16x64_bf16 v[48:51], v[32:35], a[160:167], v2
v_smfmac_f32_16x16x64_bf16 v[52:55], v[32:35], a[168:175], v2
s_waitcnt vmcnt(2)
v_cmp_eq_u32 vcc, -1, v36
v_smfmac_f32_16x16x64_bf16 v[56:59], v[32:35], a[176:183], v2
v_smfmac_f32_16x16x64_bf16 v[60:63], v[32:35], a[184:191], v2
s_cbranch_vccnz Lc_retry6L1
Lc_back6L1:
v_smfmac_f32_16x16x64_bf16 v[48:51], v[36:39], a[192:199], v2
v_smfmac_f32_16x16x64_bf16 v[52:55], v[36:39], a[200:207], v2
s_waitcnt vmcnt(1)
v_cmp_eq_u32 vcc, -1, v40
v_smfmac_f32_16x16x64_bf16 v[56:59], v[36:39], a[208:215], v2
v_smfmac_f32_16x16x64_bf16 v[60:63], v[36:39], a[216:223], v2
s_cbranch_vccnz Lc_retry7L1
Lc_back7L1:
v_smfmac_f32_16x16x64_bf16 v[48:51], v[40:43], a[224:231], v2
v_smfmac_f32_16x16x64_bf16 v[52:55], v[40:43], a[232:239], v2
s_waitcnt vmcnt(0)
v_cmp_eq_u32 vcc, -1, v44
v_smfmac_f32_16x16x64_bf16 v[56:59], v[40:43], a[240:247], v2
v_smfmac_f32_16x16x64_bf16 v[60:63], v[40:43], a[248:255], v2
s_cbranch_vccnz Lc_retry8L1
Lc_back8L1:
v_smfmac_f32_16x16x64_bf16 v[48:51], v[44:47], v[224:231], v2
v_smfmac_f32_16x16x64_bf16 v[52:55], v[44:47], v[232:239], v2
v_smfmac_f32_16x16x64_bf16 v[56:59], v[44:47], v[240:247], v2
v_add_f32 v48, v48, v50
v_smfmac_f32_16x16x64_bf16 v[60:63], v[44:47], v[248:255], v2
v_add_f32 v49, v49, v51
v_smfmac_f32_16x16x64_bf16 v[64:67], v[24:27], v[128:135], v2
v_add_f32 v52, v52, v54
v_smfmac_f32_16x16x64_bf16 v[68:71], v[24:27], v[136:143], v2
v_add_f32 v53, v53, v55
Lc_postL1:
v_add_f32 v56, v56, v58
v_add_f32 v60, v60, v62
v_cvt_pk_bf16_f32 v50, v48, v52
v_cvt_pk_bf16_f32 v51, v56, v60
v_xor_b32 v58, 16, v3
ds_write_b64 v3, v[50:51] offset:16384
v_add_f32 v57, v57, v59
v_add_f32 v61, v61, v63
v_cvt_pk_bf16_f32 v54, v49, v53
v_cvt_pk_bf16_f32 v55, v57, v61
ds_write_b64 v58, v[54:55] offset:16384
v_cmp_u_f32 vcc, v48, v49
v_smfmac_f32_16x16x64_bf16 v[64:67], v[28:31], v[144:151], v2
v_smfmac_f32_16x16x64_bf16 v[68:71], v[28:31], v[152:159], v2
s_cbranch_vccnz Lc_redoL1
Lc_redobackL1:
v_smfmac_f32_16x16x64_bf16 v[64:67], v[32:35], v[160:167], v2
v_smfmac_f32_16x16x64_bf16 v[68:71], v[32:35], v[168:175], v2
v_xor_b32 v32, 64, v4
s_waitcnt lgkmcnt(0)
s_barrier
v_bfe_u32 v48, v0, 7, 1
v_lshlrev_b32 v48, 9, v48
v_bfe_u32 v49, v0, 5, 2
v_lshl_add_u32 v48, v49, 7, v48
v_lshrrev_b32 v49, 8, v0
v_lshl_add_u32 v48, v49, 5, v48
v_bfe_u32 v49, v0, 4, 1
v_lshl_add_u32 v48, v49, 3, v48
s_mul_i32 s19, s17, 4096
s_add_u32 s19, s19, 25035776
buffer_store_dwordx2 v[50:51], v48, s[8:11], s19 offen sc1
buffer_store_dwordx2 v[54:55], v48, s[8:11], s19 offen offset:16 sc1
v_smfmac_f32_16x16x64_bf16 v[64:67], v[36:39], v[176:183], v2
v_smfmac_f32_16x16x64_bf16 v[68:71], v[36:39], v[184:191], v2
v_smfmac_f32_16x16x64_bf16 v[64:67], v[40:43], v[192:199], v2
v_smfmac_f32_16x16x64_bf16 v[68:71], v[40:43], v[200:207], v2
v_smfmac_f32_16x16x64_bf16 v[64:67], v[44:47], v[208:215], v2
v_smfmac_f32_16x16x64_bf16 v[68:71], v[44:47], v[216:223], v2
s_nop 3
v_pk_add_f32 v[64:65], v[64:65], v[66:67]
s_nop 2
v_pk_add_f32 v[68:69], v[68:69], v[70:71]
v_cvt_pk_bf16_f32 v66, v64, v65
v_cvt_pk_bf16_f32 v67, v68, v69
v_lshrrev_b32 v64, 1, v0
s_mul_i32 s19, s17, 4096
s_add_u32 s19, s19, 25037312
buffer_store_dwordx2 v[66:67], v64, s[8:11], s19 offen sc1
s_waitcnt vmcnt(0)
s_lshl_b32 s19, s17, 5
s_add_u32 s19, s19, 130056
buffer_store_dword v2, off, s[8:11], s19 sc1
buffer_store_dword v2, off, s[8:11], s19 offset:4 sc1
s_waitcnt vmcnt(0)
s_endpgm
Lc_retry2L1:
buffer_load_dwordx4 v0, s[8:11], s22 offen offset:2048 sc1 lds
ds_read_b128 v[20:23], v0 offset:18432
s_add_u32 s21, s21, 1
s_cmp_ge_u32 s21, 4194304
s_cbranch_scc1 L_abort
s_waitcnt lgkmcnt(0)
v_cmp_eq_u32 vcc, -1, v20
s_cbranch_vccnz Lc_retry2L1
s_waitcnt vmcnt(0)
s_branch Lc_back2L1
Lc_retry3L1:
buffer_load_dwordx4 v0, s[8:11], s22 offen offset:3072 sc1 lds
ds_read_b128 v[24:27], v0 offset:19456
s_add_u32 s21, s21, 1
s_cmp_ge_u32 s21, 4194304
s_cbranch_scc1 L_abort
s_waitcnt lgkmcnt(0)
v_cmp_eq_u32 vcc, -1, v24
s_cbranch_vccnz Lc_retry3L1
s_waitcnt vmcnt(0)
s_branch Lc_back3L1
Lc_retry4L1:
buffer_load_dwordx4 v[28:31], v0, s[8:11], s51 offen sc1
s_waitcnt vmcnt(0)
v_cmp_eq_u32 vcc, -1, v28
s_cbranch_vccz Lc_back4L1
s_add_u32 s21, s21, 1
s_cmp_ge_u32 s21, 4194304
s_cbranch_scc1 L_abort
s_branch Lc_retry4L1
Lc_retry5L1:
buffer_load_dwordx4 v[32:35], v0, s[8:11], s51 offen offset:1024 sc1
s_waitcnt vmcnt(0)
v_cmp_eq_u32 vcc, -1, v32
s_cbranch_vccz Lc_back5L1
s_add_u32 s21, s21, 1
s_cmp_ge_u32 s21, 4194304
s_cbranch_scc1 L_abort
s_branch Lc_retry5L1
Lc_retry6L1:
buffer_load_dwordx4 v[36:39], v0, s[8:11], s51 offen offset:2048 sc1
s_waitcnt vmcnt(0)
v_cmp_eq_u32 vcc, -1, v36
s_cbranch_vccz Lc_back6L1
s_add_u32 s21, s21, 1
s_cmp_ge_u32 s21, 4194304
s_cbranch_scc1 L_abort
s_branch Lc_retry6L1
Lc_retry7L1:
buffer_load_dwordx4 v[40:43], v0, s[8:11], s51 offen offset:3072 sc1
s_waitcnt vmcnt(0)
v_cmp_eq_u32 vcc, -1, v40
s_cbranch_vccz Lc_back7L1
s_add_u32 s21, s21, 1
s_cmp_ge_u32 s21, 4194304
s_cbranch_scc1 L_abort
s_branch Lc_retry7L1
Lc_retry8L1:
buffer_load_dwordx4 v[44:47], v0, s[8:11], s52 offen sc1
s_waitcnt vmcnt(0)
v_cmp_eq_u32 vcc, -1, v44
s_cbranch_vccz Lc_back8L1
s_add_u32 s21, s21, 1
s_cmp_ge_u32 s21, 4194304
s_cbranch_scc1 L_abort
s_branch Lc_retry8L1
Lc_redoL1:
s_cmp_eq_u32 s48, s18
s_cbranch_scc1 Lc_redobackL1
s_mov_b32 s48, s18
s_waitcnt lgkmcnt(0)
s_nop 15
Lc_redo2L1:
buffer_load_dwordx4 v[12:15], v0, s[8:11], s22 offen sc1
buffer_load_dwordx4 v[16:19], v0, s[8:11], s22 offen offset:1024 sc1
buffer_load_dwordx4 v[20:23], v0, s[8:11], s22 offen offset:2048 sc1
buffer_load_dwordx4 v[24:27], v0, s[8:11], s22 offen offset:3072 sc1
buffer_load_dwordx4 v[28:31], v0, s[8:11], s51 offen sc1
buffer_load_dwordx4 v[32:35], v0, s[8:11], s51 offen offset:1024 sc1
buffer_load_dwordx4 v[36:39], v0, s[8:11], s51 offen offset:2048 sc1
buffer_load_dwordx4 v[40:43], v0, s[8:11], s51 offen offset:3072 sc1
buffer_load_dwordx4 v[44:47], v0, s[8:11], s52 offen sc1
v_mov_b64 v[48:49], 0
v_mov_b64 v[50:51], 0
v_mov_b64 v[52:53], 0
v_mov_b64 v[54:55], 0
v_mov_b64 v[56:57], 0
v_mov_b64 v[58:59], 0
v_mov_b64 v[60:61], 0
v_mov_b64 v[62:63], 0
v_mov_b64 v[64:65], 0
v_mov_b64 v[66:67], 0
v_mov_b64 v[68:69], 0
v_mov_b64 v[70:71], 0
s_waitcnt vmcnt(0)
v_max_u32 v48, v12, v13
v_max3_u32 v48, v48, v14, v15
v_max3_u32 v48, v48, v16, v17
v_max3_u32 v48, v48, v18, v19
v_max3_u32 v48, v48, v20, v21
v_max3_u32 v48, v48, v22, v23
v_max3_u32 v48, v48, v24, v25
v_max3_u32 v48, v48, v26, v27
v_max3_u32 v48, v48, v28, v29
v_max3_u32 v48, v48, v30, v31
v_max3_u32 v48, v48, v32, v33
v_max3_u32 v48, v48, v34, v35
v_max3_u32 v48, v48, v36, v37
v_max3_u32 v48, v48, v38, v39
v_max3_u32 v48, v48, v40, v41
v_max3_u32 v48, v48, v42, v43
v_max3_u32 v48, v48, v44, v45
v_max3_u32 v48, v48, v46, v47
v_cmp_eq_u32 vcc, -1, v48
v_mov_b32 v48, 0
s_cbranch_vccnz Lc_redo3L1
s_nop 0
v_smfmac_f32_16x16x64_bf16 v[48:51], v[12:15], a[0:7], v2
v_smfmac_f32_16x16x64_bf16 v[52:55], v[12:15], a[8:15], v2
v_smfmac_f32_16x16x64_bf16 v[56:59], v[12:15], a[16:23], v2
v_smfmac_f32_16x16x64_bf16 v[60:63], v[12:15], a[24:31], v2
v_smfmac_f32_16x16x64_bf16 v[64:67], v[12:15], v[80:87], v2
v_smfmac_f32_16x16x64_bf16 v[68:71], v[12:15], v[88:95], v2
v_smfmac_f32_16x16x64_bf16 v[48:51], v[16:19], a[32:39], v2
v_smfmac_f32_16x16x64_bf16 v[52:55], v[16:19], a[40:47], v2
v_smfmac_f32_16x16x64_bf16 v[56:59], v[16:19], a[48:55], v2
v_smfmac_f32_16x16x64_bf16 v[60:63], v[16:19], a[56:63], v2
v_smfmac_f32_16x16x64_bf16 v[64:67], v[16:19], v[96:103], v2
v_smfmac_f32_16x16x64_bf16 v[68:71], v[16:19], v[104:111], v2
v_smfmac_f32_16x16x64_bf16 v[48:51], v[20:23], a[64:71], v2
v_smfmac_f32_16x16x64_bf16 v[52:55], v[20:23], a[72:79], v2
v_smfmac_f32_16x16x64_bf16 v[56:59], v[20:23], a[80:87], v2
v_smfmac_f32_16x16x64_bf16 v[60:63], v[20:23], a[88:95], v2
v_smfmac_f32_16x16x64_bf16 v[64:67], v[20:23], v[112:119], v2
v_smfmac_f32_16x16x64_bf16 v[68:71], v[20:23], v[120:127], v2
v_smfmac_f32_16x16x64_bf16 v[48:51], v[24:27], a[96:103], v2
v_smfmac_f32_16x16x64_bf16 v[52:55], v[24:27], a[104:111], v2
v_smfmac_f32_16x16x64_bf16 v[56:59], v[24:27], a[112:119], v2
v_smfmac_f32_16x16x64_bf16 v[60:63], v[24:27], a[120:127], v2
v_smfmac_f32_16x16x64_bf16 v[64:67], v[24:27], v[128:135], v2
v_smfmac_f32_16x16x64_bf16 v[68:71], v[24:27], v[136:143], v2
v_smfmac_f32_16x16x64_bf16 v[48:51], v[28:31], a[128:135], v2
v_smfmac_f32_16x16x64_bf16 v[52:55], v[28:31], a[136:143], v2
v_smfmac_f32_16x16x64_bf16 v[56:59], v[28:31], a[144:151], v2
v_smfmac_f32_16x16x64_bf16 v[60:63], v[28:31], a[152:159], v2
v_smfmac_f32_16x16x64_bf16 v[48:51], v[32:35], a[160:167], v2
v_smfmac_f32_16x16x64_bf16 v[52:55], v[32:35], a[168:175], v2
v_smfmac_f32_16x16x64_bf16 v[56:59], v[32:35], a[176:183], v2
v_smfmac_f32_16x16x64_bf16 v[60:63], v[32:35], a[184:191], v2
v_smfmac_f32_16x16x64_bf16 v[48:51], v[36:39], a[192:199], v2
v_smfmac_f32_16x16x64_bf16 v[52:55], v[36:39], a[200:207], v2
v_smfmac_f32_16x16x64_bf16 v[56:59], v[36:39], a[208:215], v2
v_smfmac_f32_16x16x64_bf16 v[60:63], v[36:39], a[216:223], v2
v_smfmac_f32_16x16x64_bf16 v[48:51], v[40:43], a[224:231], v2
v_smfmac_f32_16x16x64_bf16 v[52:55], v[40:43], a[232:239], v2
v_smfmac_f32_16x16x64_bf16 v[56:59], v[40:43], a[240:247], v2
v_smfmac_f32_16x16x64_bf16 v[60:63], v[40:43], a[248:255], v2
v_smfmac_f32_16x16x64_bf16 v[48:51], v[44:47], v[224:231], v2
v_smfmac_f32_16x16x64_bf16 v[52:55], v[44:47], v[232:239], v2
v_smfmac_f32_16x16x64_bf16 v[56:59], v[44:47], v[240:247], v2
v_smfmac_f32_16x16x64_bf16 v[60:63], v[44:47], v[248:255], v2
s_nop 7
v_add_f32 v48, v48, v50
v_add_f32 v49, v49, v51
v_add_f32 v52, v52, v54
v_add_f32 v53, v53, v55
s_branch Lc_postL1
Lc_redo3L1:
s_add_u32 s21, s21, 1
s_cmp_ge_u32 s21, 4194304
s_cbranch_scc1 L_abort
s_branch Lc_redo2L1
.p2align 6
s_nop 0
s_nop 0
Lc_topL2:
buffer_load_dwordx4 v0, s[8:11], s22 offen offset:2048 sc1 lds
buffer_load_dwordx4 v0, s[8:11], s22 offen offset:3072 sc1 lds
ds_read_b128 v[12:15], v0 offset:16384
ds_read_b128 v[16:19], v0 offset:17408
s_add_u32 s21, s21, 1
s_cmp_ge_u32 s21, 4194304
s_cbranch_scc1 L_abort
s_waitcnt lgkmcnt(0)
v_max_u32 v43, v12, v16
v_cmp_eq_u32 vcc, -1, v43
s_cbranch_vccnz Lc_topL2
v_smfmac_f32_16x16x64_bf16 v[48:51], v[12:15], a[0:7], v2
buffer_load_dwordx4 v0, s[8:11], s22 offen offset:2048 sc1 lds
buffer_load_dwordx4 v0, s[8:11], s22 offen offset:3072 sc1 lds
v_smfmac_f32_16x16x64_bf16 v[52:55], v[12:15], a[8:15], v2
v_smfmac_f32_16x16x64_bf16 v[56:59], v[12:15], a[16:23], v2
buffer_load_dwordx4 v[28:31], v0, s[8:11], s51 offen sc1
v_smfmac_f32_16x16x64_bf16 v[60:63], v[12:15], a[24:31], v2
v_smfmac_f32_16x16x64_bf16 v[64:67], v[12:15], v[80:87], v2
ds_read_b128 v[20:23], v0 offset:18432
v_smfmac_f32_16x16x64_bf16 v[68:71], v[12:15], v[88:95], v2
v_smfmac_f32_16x16x64_bf16 v[48:51], v[16:19], a[32:39], v2
buffer_load_dwordx4 v[32:35], v0, s[8:11], s51 offen offset:1024 sc1
v_smfmac_f32_16x16x64_bf16 v[52:55], v[16:19], a[40:47], v2
v_smfmac_f32_16x16x64_bf16 v[56:59], v[16:19], a[48:55], v2
v_smfmac_f32_16x16x64_bf16 v[60:63], v[16:19], a[56:63], v2
ds_read_b128 v[24:27], v0 offset:19456
s_waitcnt lgkmcnt(1)
v_cmp_eq_u32 vcc, -1, v20
v_smfmac_f32_16x16x64_bf16 v[64:67], v[16:19], v[96:103], v2
buffer_load_dwordx4 v[36:39], v0, s[8:11], s51 offen offset:2048 sc1
v_smfmac_f32_16x16x64_bf16 v[68:71], v[16:19], v[104:111], v2
s_cbranch_vccnz Lc_retry2L2
Lc_back2L2:
v_smfmac_f32_16x16x64_bf16 v[48:51], v[20:23], a[64:71], v2
v_smfmac_f32_16x16x64_bf16 v[52:55], v[20:23], a[72:79], v2
v_smfmac_f32_16x16x64_bf16 v[56:59], v[20:23], a[80:87], v2
buffer_load_dwordx4 v[40:43], v0, s[8:11], s51 offen offset:3072 sc1
v_smfmac_f32_16x16x64_bf16 v[60:63], v[20:23], a[88:95], v2
s_waitcnt lgkmcnt(0)
v_cmp_eq_u32 vcc, -1, v24
v_smfmac_f32_16x16x64_bf16 v[64:67], v[20:23], v[112:119], v2
v_smfmac_f32_16x16x64_bf16 v[68:71], v[20:23], v[120:127], v2
buffer_load_dwordx4 v[44:47], v0, s[8:11], s52 offen sc1
s_cbranch_vccnz Lc_retry3L2
Lc_back3L2:
v_smfmac_f32_16x16x64_bf16 v[48:51], v[24:27], a[96:103], v2
s_waitcnt vmcnt(5)
s_barrier
v_smfmac_f32_16x16x64_bf16 v[52:55], v[24:27], a[104:111], v2
s_waitcnt vmcnt(4)
v_cmp_eq_u32 vcc, -1, v28
v_smfmac_f32_16x16x64_bf16 v[56:59], v[24:27], a[112:119], v2
v_smfmac_f32_16x16x64_bf16 v[60:63], v[24:27], a[120:127], v2
s_cbranch_vccnz Lc_retry4L2
Lc_back4L2:
v_smfmac_f32_16x16x64_bf16 v[48:51], v[28:31], a[128:135], v2
v_smfmac_f32_16x16x64_bf16 v[52:55], v[28:31], a[136:143], v2
s_waitcnt vmcnt(3)
v_cmp_eq_u32 vcc, -1, v32
v_smfmac_f32_16x16x64_bf16 v[56:59], v[28:31], a[144:151], v2
v_smfmac_f32_16x16x64_bf16 v[60:63], v[28:31], a[152:159], v2
s_cbranch_vccnz Lc_retry5L2
Lc_back5L2:
v_smfmac_f32_16x16x64_bf16 v[48:51], v[32:35], a[160:167], v2
v_smfmac_f32_16x16x64_bf16 v[52:55], v[32:35], a[168:175], v2
s_waitcnt vmcnt(2)
v_cmp_eq_u32 vcc, -1, v36
v_smfmac_f32_16x16x64_bf16 v[56:59], v[32:35], a[176:183], v2
v_smfmac_f32_16x16x64_bf16 v[60:63], v[32:35], a[184:191], v2
s_cbranch_vccnz Lc_retry6L2
Lc_back6L2:
v_smfmac_f32_16x16x64_bf16 v[48:51], v[36:39], a[192:199], v2
v_smfmac_f32_16x16x64_bf16 v[52:55], v[36:39], a[200:207], v2
s_waitcnt vmcnt(1)
v_cmp_eq_u32 vcc, -1, v40
v_smfmac_f32_16x16x64_bf16 v[56:59], v[36:39], a[208:215], v2
v_smfmac_f32_16x16x64_bf16 v[60:63], v[36:39], a[216:223], v2
s_cbranch_vccnz Lc_retry7L2
Lc_back7L2:
v_smfmac_f32_16x16x64_bf16 v[48:51], v[40:43], a[224:231], v2
v_smfmac_f32_16x16x64_bf16 v[52:55], v[40:43], a[232:239], v2
s_waitcnt vmcnt(0)
v_cmp_eq_u32 vcc, -1, v44
v_smfmac_f32_16x16x64_bf16 v[56:59], v[40:43], a[240:247], v2
v_smfmac_f32_16x16x64_bf16 v[60:63], v[40:43], a[248:255], v2
s_cbranch_vccnz Lc_retry8L2
Lc_back8L2:
v_smfmac_f32_16x16x64_bf16 v[48:51], v[44:47], v[224:231], v2
v_smfmac_f32_16x16x64_bf16 v[52:55], v[44:47], v[232:239], v2
v_smfmac_f32_16x16x64_bf16 v[56:59], v[44:47], v[240:247], v2
v_add_f32 v48, v48, v50
v_smfmac_f32_16x16x64_bf16 v[60:63], v[44:47], v[248:255], v2
v_add_f32 v49, v49, v51
v_smfmac_f32_16x16x64_bf16 v[64:67], v[24:27], v[128:135], v2
v_add_f32 v52, v52, v54
v_smfmac_f32_16x16x64_bf16 v[68:71], v[24:27], v[136:143], v2
v_add_f32 v53, v53, v55
Lc_postL2:
v_add_f32 v56, v56, v58
v_add_f32 v60, v60, v62
v_cvt_pk_bf16_f32 v50, v48, v52
v_cvt_pk_bf16_f32 v51, v56, v60
v_xor_b32 v58, 16, v3
ds_write_b64 v3, v[50:51] offset:16384
v_add_f32 v57, v57, v59
v_add_f32 v61, v61, v63
v_cvt_pk_bf16_f32 v54, v49, v53
v_cvt_pk_bf16_f32 v55, v57, v61
ds_write_b64 v58, v[54:55] offset:16384
v_cmp_u_f32 vcc, v48, v49
v_smfmac_f32_16x16x64_bf16 v[64:67], v[28:31], v[144:151], v2
v_smfmac_f32_16x16x64_bf16 v[68:71], v[28:31], v[152:159], v2
s_cbranch_vccnz Lc_redoL2
Lc_redobackL2:
v_smfmac_f32_16x16x64_bf16 v[64:67], v[32:35], v[160:167], v2
v_smfmac_f32_16x16x64_bf16 v[68:71], v[32:35], v[168:175], v2
v_xor_b32 v32, 64, v4
s_waitcnt lgkmcnt(0)
s_barrier
v_smfmac_f32_16x16x64_bf16 v[64:67], v[36:39], v[176:183], v2
v_smfmac_f32_16x16x64_bf16 v[68:71], v[36:39], v[184:191], v2
v_smfmac_f32_16x16x64_bf16 v[64:67], v[40:43], v[192:199], v2
v_smfmac_f32_16x16x64_bf16 v[68:71], v[40:43], v[200:207], v2
v_smfmac_f32_16x16x64_bf16 v[64:67], v[44:47], v[208:215], v2
v_smfmac_f32_16x16x64_bf16 v[68:71], v[44:47], v[216:223], v2
s_nop 3
v_pk_add_f32 v[64:65], v[64:65], v[66:67]
s_nop 2
v_pk_add_f32 v[68:69], v[68:69], v[70:71]
v_cvt_pk_bf16_f32 v66, v64, v65
v_cvt_pk_bf16_f32 v67, v68, v69
v_lshrrev_b32 v64, 1, v0
s_mul_i32 s19, s17, 4096
s_add_u32 s19, s19, 25037824
buffer_store_dwordx2 v[66:67], v64, s[8:11], s19 offen sc1
s_waitcnt vmcnt(0)
s_lshl_b32 s19, s17, 5
s_add_u32 s19, s19, 130064
buffer_store_dword v2, off, s[8:11], s19 sc1
buffer_store_dword v2, off, s[8:11], s19 offset:4 sc1
s_waitcnt vmcnt(0)
s_endpgm
Lc_retry2L2:
buffer_load_dwordx4 v0, s[8:11], s22 offen offset:2048 sc1 lds
ds_read_b128 v[20:23], v0 offset:18432
s_add_u32 s21, s21, 1
s_cmp_ge_u32 s21, 4194304
s_cbranch_scc1 L_abort
s_waitcnt lgkmcnt(0)
v_cmp_eq_u32 vcc, -1, v20
s_cbranch_vccnz Lc_retry2L2
s_waitcnt vmcnt(0)
s_branch Lc_back2L2
Lc_retry3L2:
buffer_load_dwordx4 v0, s[8:11], s22 offen offset:3072 sc1 lds
ds_read_b128 v[24:27], v0 offset:19456
s_add_u32 s21, s21, 1
s_cmp_ge_u32 s21, 4194304
s_cbranch_scc1 L_abort
s_waitcnt lgkmcnt(0)
v_cmp_eq_u32 vcc, -1, v24
s_cbranch_vccnz Lc_retry3L2
s_waitcnt vmcnt(0)
s_branch Lc_back3L2
Lc_retry4L2:
buffer_load_dwordx4 v[28:31], v0, s[8:11], s51 offen sc1
s_waitcnt vmcnt(0)
v_cmp_eq_u32 vcc, -1, v28
s_cbranch_vccz Lc_back4L2
s_add_u32 s21, s21, 1
s_cmp_ge_u32 s21, 4194304
s_cbranch_scc1 L_abort
s_branch Lc_retry4L2
Lc_retry5L2:
buffer_load_dwordx4 v[32:35], v0, s[8:11], s51 offen offset:1024 sc1
s_waitcnt vmcnt(0)
v_cmp_eq_u32 vcc, -1, v32
s_cbranch_vccz Lc_back5L2
s_add_u32 s21, s21, 1
s_cmp_ge_u32 s21, 4194304
s_cbranch_scc1 L_abort
s_branch Lc_retry5L2
Lc_retry6L2:
buffer_load_dwordx4 v[36:39], v0, s[8:11], s51 offen offset:2048 sc1
s_waitcnt vmcnt(0)
v_cmp_eq_u32 vcc, -1, v36
s_cbranch_vccz Lc_back6L2
s_add_u32 s21, s21, 1
s_cmp_ge_u32 s21, 4194304
s_cbranch_scc1 L_abort
s_branch Lc_retry6L2
Lc_retry7L2:
buffer_load_dwordx4 v[40:43], v0, s[8:11], s51 offen offset:3072 sc1
s_waitcnt vmcnt(0)
v_cmp_eq_u32 vcc, -1, v40
s_cbranch_vccz Lc_back7L2
s_add_u32 s21, s21, 1
s_cmp_ge_u32 s21, 4194304
s_cbranch_scc1 L_abort
s_branch Lc_retry7L2
Lc_retry8L2:
buffer_load_dwordx4 v[44:47], v0, s[8:11], s52 offen sc1
s_waitcnt vmcnt(0)
v_cmp_eq_u32 vcc, -1, v44
s_cbranch_vccz Lc_back8L2
s_add_u32 s21, s21, 1
s_cmp_ge_u32 s21, 4194304
s_cbranch_scc1 L_abort
s_branch Lc_retry8L2
Lc_redoL2:
s_cmp_eq_u32 s48, s18
s_cbranch_scc1 Lc_redobackL2
s_mov_b32 s48, s18
s_waitcnt lgkmcnt(0)
s_nop 15
Lc_redo2L2:
buffer_load_dwordx4 v[12:15], v0, s[8:11], s22 offen sc1
buffer_load_dwordx4 v[16:19], v0, s[8:11], s22 offen offset:1024 sc1
buffer_load_dwordx4 v[20:23], v0, s[8:11], s22 offen offset:2048 sc1
buffer_load_dwordx4 v[24:27], v0, s[8:11], s22 offen offset:3072 sc1
buffer_load_dwordx4 v[28:31], v0, s[8:11], s51 offen sc1
buffer_load_dwordx4 v[32:35], v0, s[8:11], s51 offen offset:1024 sc1
buffer_load_dwordx4 v[36:39], v0, s[8:11], s51 offen offset:2048 sc1
buffer_load_dwordx4 v[40:43], v0, s[8:11], s51 offen offset:3072 sc1
buffer_load_dwordx4 v[44:47], v0, s[8:11], s52 offen sc1
v_mov_b64 v[48:49], 0
v_mov_b64 v[50:51], 0
v_mov_b64 v[52:53], 0
v_mov_b64 v[54:55], 0
v_mov_b64 v[56:57], 0
v_mov_b64 v[58:59], 0
v_mov_b64 v[60:61], 0
v_mov_b64 v[62:63], 0
v_mov_b64 v[64:65], 0
v_mov_b64 v[66:67], 0
v_mov_b64 v[68:69], 0
v_mov_b64 v[70:71], 0
s_waitcnt vmcnt(0)
v_max_u32 v48, v12, v13
v_max3_u32 v48, v48, v14, v15
v_max3_u32 v48, v48, v16, v17
v_max3_u32 v48, v48, v18, v19
v_max3_u32 v48, v48, v20, v21
v_max3_u32 v48, v48, v22, v23
v_max3_u32 v48, v48, v24, v25
v_max3_u32 v48, v48, v26, v27
v_max3_u32 v48, v48, v28, v29
v_max3_u32 v48, v48, v30, v31
v_max3_u32 v48, v48, v32, v33
v_max3_u32 v48, v48, v34, v35
v_max3_u32 v48, v48, v36, v37
v_max3_u32 v48, v48, v38, v39
v_max3_u32 v48, v48, v40, v41
v_max3_u32 v48, v48, v42, v43
v_max3_u32 v48, v48, v44, v45
v_max3_u32 v48, v48, v46, v47
v_cmp_eq_u32 vcc, -1, v48
v_mov_b32 v48, 0
s_cbranch_vccnz Lc_redo3L2
s_nop 0
v_smfmac_f32_16x16x64_bf16 v[48:51], v[12:15], a[0:7], v2
v_smfmac_f32_16x16x64_bf16 v[52:55], v[12:15], a[8:15], v2
v_smfmac_f32_16x16x64_bf16 v[56:59], v[12:15], a[16:23], v2
v_smfmac_f32_16x16x64_bf16 v[60:63], v[12:15], a[24:31], v2
v_smfmac_f32_16x16x64_bf16 v[64:67], v[12:15], v[80:87], v2
v_smfmac_f32_16x16x64_bf16 v[68:71], v[12:15], v[88:95], v2
v_smfmac_f32_16x16x64_bf16 v[48:51], v[16:19], a[32:39], v2
v_smfmac_f32_16x16x64_bf16 v[52:55], v[16:19], a[40:47], v2
v_smfmac_f32_16x16x64_bf16 v[56:59], v[16:19], a[48:55], v2
v_smfmac_f32_16x16x64_bf16 v[60:63], v[16:19], a[56:63], v2
v_smfmac_f32_16x16x64_bf16 v[64:67], v[16:19], v[96:103], v2
v_smfmac_f32_16x16x64_bf16 v[68:71], v[16:19], v[104:111], v2
v_smfmac_f32_16x16x64_bf16 v[48:51], v[20:23], a[64:71], v2
v_smfmac_f32_16x16x64_bf16 v[52:55], v[20:23], a[72:79], v2
v_smfmac_f32_16x16x64_bf16 v[56:59], v[20:23], a[80:87], v2
v_smfmac_f32_16x16x64_bf16 v[60:63], v[20:23], a[88:95], v2
v_smfmac_f32_16x16x64_bf16 v[64:67], v[20:23], v[112:119], v2
v_smfmac_f32_16x16x64_bf16 v[68:71], v[20:23], v[120:127], v2
v_smfmac_f32_16x16x64_bf16 v[48:51], v[24:27], a[96:103], v2
v_smfmac_f32_16x16x64_bf16 v[52:55], v[24:27], a[104:111], v2
v_smfmac_f32_16x16x64_bf16 v[56:59], v[24:27], a[112:119], v2
v_smfmac_f32_16x16x64_bf16 v[60:63], v[24:27], a[120:127], v2
v_smfmac_f32_16x16x64_bf16 v[64:67], v[24:27], v[128:135], v2
v_smfmac_f32_16x16x64_bf16 v[68:71], v[24:27], v[136:143], v2
v_smfmac_f32_16x16x64_bf16 v[48:51], v[28:31], a[128:135], v2
v_smfmac_f32_16x16x64_bf16 v[52:55], v[28:31], a[136:143], v2
v_smfmac_f32_16x16x64_bf16 v[56:59], v[28:31], a[144:151], v2
v_smfmac_f32_16x16x64_bf16 v[60:63], v[28:31], a[152:159], v2
v_smfmac_f32_16x16x64_bf16 v[48:51], v[32:35], a[160:167], v2
v_smfmac_f32_16x16x64_bf16 v[52:55], v[32:35], a[168:175], v2
v_smfmac_f32_16x16x64_bf16 v[56:59], v[32:35], a[176:183], v2
v_smfmac_f32_16x16x64_bf16 v[60:63], v[32:35], a[184:191], v2
v_smfmac_f32_16x16x64_bf16 v[48:51], v[36:39], a[192:199], v2
v_smfmac_f32_16x16x64_bf16 v[52:55], v[36:39], a[200:207], v2
v_smfmac_f32_16x16x64_bf16 v[56:59], v[36:39], a[208:215], v2
v_smfmac_f32_16x16x64_bf16 v[60:63], v[36:39], a[216:223], v2
v_smfmac_f32_16x16x64_bf16 v[48:51], v[40:43], a[224:231], v2
v_smfmac_f32_16x16x64_bf16 v[52:55], v[40:43], a[232:239], v2
v_smfmac_f32_16x16x64_bf16 v[56:59], v[40:43], a[240:247], v2
v_smfmac_f32_16x16x64_bf16 v[60:63], v[40:43], a[248:255], v2
v_smfmac_f32_16x16x64_bf16 v[48:51], v[44:47], v[224:231], v2
v_smfmac_f32_16x16x64_bf16 v[52:55], v[44:47], v[232:239], v2
v_smfmac_f32_16x16x64_bf16 v[56:59], v[44:47], v[240:247], v2
v_smfmac_f32_16x16x64_bf16 v[60:63], v[44:47], v[248:255], v2
s_nop 7
v_add_f32 v48, v48, v50
v_add_f32 v49, v49, v51
v_add_f32 v52, v52, v54
v_add_f32 v53, v53, v55
s_branch Lc_postL2
Lc_redo3L2:
s_add_u32 s21, s21, 1
s_cmp_ge_u32 s21, 4194304
s_cbranch_scc1 L_abort
s_branch Lc_redo2L2
.p2align 6
s_nop 0
s_nop 0
Lc_topL3:
ds_read_b128 v[12:15], v0 offset:16384
ds_read_b128 v[16:19], v0 offset:17408
s_add_u32 s21, s21, 1
s_cmp_ge_u32 s21, 4194304
s_cbranch_scc1 L_abort
s_waitcnt lgkmcnt(0)
v_max_u32 v43, v12, v16
v_cmp_eq_u32 vcc, -1, v43
s_cbranch_vccnz Lc_topL3
v_smfmac_f32_16x16x64_bf16 v[48:51], v[12:15], a[0:7], v2
v_smfmac_f32_16x16x64_bf16 v[52:55], v[12:15], a[8:15], v2
v_smfmac_f32_16x16x64_bf16 v[56:59], v[12:15], a[16:23], v2
buffer_load_dwordx4 v[28:31], v0, s[8:11], s51 offen sc1
v_smfmac_f32_16x16x64_bf16 v[60:63], v[12:15], a[24:31], v2
v_smfmac_f32_16x16x64_bf16 v[64:67], v[12:15], v[80:87], v2
ds_read_b128 v[20:23], v0 offset:18432
v_smfmac_f32_16x16x64_bf16 v[68:71], v[12:15], v[88:95], v2
v_smfmac_f32_16x16x64_bf16 v[48:51], v[16:19], a[32:39], v2
buffer_load_dwordx4 v[32:35], v0, s[8:11], s51 offen offset:1024 sc1
v_smfmac_f32_16x16x64_bf16 v[52:55], v[16:19], a[40:47], v2
v_smfmac_f32_16x16x64_bf16 v[56:59], v[16:19], a[48:55], v2
v_smfmac_f32_16x16x64_bf16 v[60:63], v[16:19], a[56:63], v2
ds_read_b128 v[24:27], v0 offset:19456
s_waitcnt lgkmcnt(1)
v_cmp_eq_u32 vcc, -1, v20
v_smfmac_f32_16x16x64_bf16 v[64:67], v[16:19], v[96:103], v2
buffer_load_dwordx4 v[36:39], v0, s[8:11], s51 offen offset:2048 sc1
v_smfmac_f32_16x16x64_bf16 v[68:71], v[16:19], v[104:111], v2
s_cbranch_vccnz Lc_retry2L3
Lc_back2L3:
v_smfmac_f32_16x16x64_bf16 v[48:51], v[20:23], a[64:71], v2
v_smfmac_f32_16x16x64_bf16 v[52:55], v[20:23], a[72:79], v2
v_smfmac_f32_16x16x64_bf16 v[56:59], v[20:23], a[80:87], v2
buffer_load_dwordx4 v[40:43], v0, s[8:11], s51 offen offset:3072 sc1
v_smfmac_f32_16x16x64_bf16 v[60:63], v[20:23], a[88:95], v2
s_waitcnt lgkmcnt(0)
v_cmp_eq_u32 vcc, -1, v24
v_smfmac_f32_16x16x64_bf16 v[64:67], v[20:23], v[112:119], v2
v_smfmac_f32_16x16x64_bf16 v[68:71], v[20:23], v[120:127], v2
buffer_load_dwordx4 v[44:47], v0, s[8:11], s52 offen sc1
s_cbranch_vccnz Lc_retry3L3
Lc_back3L3:
v_smfmac_f32_16x16x64_bf16 v[48:51], v[24:27], a[96:103], v2
s_waitcnt vmcnt(5)
s_barrier
v_smfmac_f32_16x16x64_bf16 v[52:55], v[24:27], a[104:111], v2
s_waitcnt vmcnt(4)
v_cmp_eq_u32 vcc, -1, v28
v_smfmac_f32_16x16x64_bf16 v[56:59], v[24:27], a[112:119], v2
v_smfmac_f32_16x16x64_bf16 v[60:63], v[24:27], a[120:127], v2
s_cbranch_vccnz Lc_retry4L3
Lc_back4L3:
v_smfmac_f32_16x16x64_bf16 v[48:51], v[28:31], a[128:135], v2
v_smfmac_f32_16x16x64_bf16 v[52:55], v[28:31], a[136:143], v2
s_waitcnt vmcnt(3)
v_cmp_eq_u32 vcc, -1, v32
v_smfmac_f32_16x16x64_bf16 v[56:59], v[28:31], a[144:151], v2
v_smfmac_f32_16x16x64_bf16 v[60:63], v[28:31], a[152:159], v2
s_cbranch_vccnz Lc_retry5L3
Lc_back5L3:
v_smfmac_f32_16x16x64_bf16 v[48:51], v[32:35], a[160:167], v2
v_smfmac_f32_16x16x64_bf16 v[52:55], v[32:35], a[168:175], v2
s_waitcnt vmcnt(2)
v_cmp_eq_u32 vcc, -1, v36
v_smfmac_f32_16x16x64_bf16 v[56:59], v[32:35], a[176:183], v2
v_smfmac_f32_16x16x64_bf16 v[60:63], v[32:35], a[184:191], v2
s_cbranch_vccnz Lc_retry6L3
Lc_back6L3:
v_smfmac_f32_16x16x64_bf16 v[48:51], v[36:39], a[192:199], v2
v_smfmac_f32_16x16x64_bf16 v[52:55], v[36:39], a[200:207], v2
s_waitcnt vmcnt(1)
v_cmp_eq_u32 vcc, -1, v40
v_smfmac_f32_16x16x64_bf16 v[56:59], v[36:39], a[208:215], v2
v_smfmac_f32_16x16x64_bf16 v[60:63], v[36:39], a[216:223], v2
s_cbranch_vccnz Lc_retry7L3
Lc_back7L3:
v_smfmac_f32_16x16x64_bf16 v[48:51], v[40:43], a[224:231], v2
v_smfmac_f32_16x16x64_bf16 v[52:55], v[40:43], a[232:239], v2
s_waitcnt vmcnt(0)
v_cmp_eq_u32 vcc, -1, v44
v_smfmac_f32_16x16x64_bf16 v[56:59], v[40:43], a[240:247], v2
v_smfmac_f32_16x16x64_bf16 v[60:63], v[40:43], a[248:255], v2
s_cbranch_vccnz Lc_retry8L3
Lc_back8L3:
v_smfmac_f32_16x16x64_bf16 v[48:51], v[44:47], v[224:231], v2
v_smfmac_f32_16x16x64_bf16 v[52:55], v[44:47], v[232:239], v2
v_smfmac_f32_16x16x64_bf16 v[56:59], v[44:47], v[240:247], v2
v_add_f32 v48, v48, v50
v_smfmac_f32_16x16x64_bf16 v[60:63], v[44:47], v[248:255], v2
v_add_f32 v49, v49, v51
v_smfmac_f32_16x16x64_bf16 v[64:67], v[24:27], v[128:135], v2
v_add_f32 v52, v52, v54
v_smfmac_f32_16x16x64_bf16 v[68:71], v[24:27], v[136:143], v2
v_add_f32 v53, v53, v55
Lc_postL3:
v_add_f32 v56, v56, v58
v_add_f32 v60, v60, v62
v_cvt_pk_bf16_f32 v50, v48, v52
v_cvt_pk_bf16_f32 v51, v56, v60
v_xor_b32 v58, 16, v3
ds_write_b64 v3, v[50:51] offset:16384
v_add_f32 v57, v57, v59
v_add_f32 v61, v61, v63
v_cvt_pk_bf16_f32 v54, v49, v53
v_cvt_pk_bf16_f32 v55, v57, v61
ds_write_b64 v58, v[54:55] offset:16384
v_cmp_u_f32 vcc, v48, v49
v_smfmac_f32_16x16x64_bf16 v[64:67], v[28:31], v[144:151], v2
v_smfmac_f32_16x16x64_bf16 v[68:71], v[28:31], v[152:159], v2
s_cbranch_vccnz Lc_redoL3
Lc_redobackL3:
v_smfmac_f32_16x16x64_bf16 v[64:67], v[32:35], v[160:167], v2
v_smfmac_f32_16x16x64_bf16 v[68:71], v[32:35], v[168:175], v2
v_xor_b32 v32, 64, v4
s_waitcnt lgkmcnt(0)
s_barrier
v_smfmac_f32_16x16x64_bf16 v[64:67], v[36:39], v[176:183], v2
v_smfmac_f32_16x16x64_bf16 v[68:71], v[36:39], v[184:191], v2
v_smfmac_f32_16x16x64_bf16 v[64:67], v[40:43], v[192:199], v2
v_smfmac_f32_16x16x64_bf16 v[68:71], v[40:43], v[200:207], v2
v_smfmac_f32_16x16x64_bf16 v[64:67], v[44:47], v[208:215], v2
v_smfmac_f32_16x16x64_bf16 v[68:71], v[44:47], v[216:223], v2
s_nop 3
v_pk_add_f32 v[64:65], v[64:65], v[66:67]
s_nop 2
v_pk_add_f32 v[68:69], v[68:69], v[70:71]
v_cvt_pk_bf16_f32 v66, v64, v65
v_cvt_pk_bf16_f32 v67, v68, v69
v_lshrrev_b32 v64, 1, v0
s_mul_i32 s19, s17, 4096
s_add_u32 s19, s19, 25038336
buffer_store_dwordx2 v[66:67], v64, s[8:11], s19 offen sc1
s_waitcnt vmcnt(0)
s_lshl_b32 s19, s17, 5
s_add_u32 s19, s19, 130072
buffer_store_dword v2, off, s[8:11], s19 sc1
buffer_store_dword v2, off, s[8:11], s19 offset:4 sc1
s_waitcnt vmcnt(0)
s_endpgm
Lc_retry2L3:
buffer_load_dwordx4 v0, s[8:11], s22 offen offset:2048 sc1 lds
ds_read_b128 v[20:23], v0 offset:18432
s_add_u32 s21, s21, 1
s_cmp_ge_u32 s21, 4194304
s_cbranch_scc1 L_abort
s_waitcnt lgkmcnt(0)
v_cmp_eq_u32 vcc, -1, v20
s_cbranch_vccnz Lc_retry2L3
s_waitcnt vmcnt(0)
s_branch Lc_back2L3
Lc_retry3L3:
buffer_load_dwordx4 v0, s[8:11], s22 offen offset:3072 sc1 lds
ds_read_b128 v[24:27], v0 offset:19456
s_add_u32 s21, s21, 1
s_cmp_ge_u32 s21, 4194304
s_cbranch_scc1 L_abort
s_waitcnt lgkmcnt(0)
v_cmp_eq_u32 vcc, -1, v24
s_cbranch_vccnz Lc_retry3L3
s_waitcnt vmcnt(0)
s_branch Lc_back3L3
Lc_retry4L3:
buffer_load_dwordx4 v[28:31], v0, s[8:11], s51 offen sc1
s_waitcnt vmcnt(0)
v_cmp_eq_u32 vcc, -1, v28
s_cbranch_vccz Lc_back4L3
s_add_u32 s21, s21, 1
s_cmp_ge_u32 s21, 4194304
s_cbranch_scc1 L_abort
s_branch Lc_retry4L3
Lc_retry5L3:
buffer_load_dwordx4 v[32:35], v0, s[8:11], s51 offen offset:1024 sc1
s_waitcnt vmcnt(0)
v_cmp_eq_u32 vcc, -1, v32
s_cbranch_vccz Lc_back5L3
s_add_u32 s21, s21, 1
s_cmp_ge_u32 s21, 4194304
s_cbranch_scc1 L_abort
s_branch Lc_retry5L3
Lc_retry6L3:
buffer_load_dwordx4 v[36:39], v0, s[8:11], s51 offen offset:2048 sc1
s_waitcnt vmcnt(0)
v_cmp_eq_u32 vcc, -1, v36
s_cbranch_vccz Lc_back6L3
s_add_u32 s21, s21, 1
s_cmp_ge_u32 s21, 4194304
s_cbranch_scc1 L_abort
s_branch Lc_retry6L3
Lc_retry7L3:
buffer_load_dwordx4 v[40:43], v0, s[8:11], s51 offen offset:3072 sc1
s_waitcnt vmcnt(0)
v_cmp_eq_u32 vcc, -1, v40
s_cbranch_vccz Lc_back7L3
s_add_u32 s21, s21, 1
s_cmp_ge_u32 s21, 4194304
s_cbranch_scc1 L_abort
s_branch Lc_retry7L3
Lc_retry8L3:
buffer_load_dwordx4 v[44:47], v0, s[8:11], s52 offen sc1
s_waitcnt vmcnt(0)
v_cmp_eq_u32 vcc, -1, v44
s_cbranch_vccz Lc_back8L3
s_add_u32 s21, s21, 1
s_cmp_ge_u32 s21, 4194304
s_cbranch_scc1 L_abort
s_branch Lc_retry8L3
Lc_redoL3:
s_cmp_eq_u32 s48, s18
s_cbranch_scc1 Lc_redobackL3
s_mov_b32 s48, s18
s_waitcnt lgkmcnt(0)
s_nop 15
Lc_redo2L3:
buffer_load_dwordx4 v[12:15], v0, s[8:11], s22 offen sc1
buffer_load_dwordx4 v[16:19], v0, s[8:11], s22 offen offset:1024 sc1
buffer_load_dwordx4 v[20:23], v0, s[8:11], s22 offen offset:2048 sc1
buffer_load_dwordx4 v[24:27], v0, s[8:11], s22 offen offset:3072 sc1
buffer_load_dwordx4 v[28:31], v0, s[8:11], s51 offen sc1
buffer_load_dwordx4 v[32:35], v0, s[8:11], s51 offen offset:1024 sc1
buffer_load_dwordx4 v[36:39], v0, s[8:11], s51 offen offset:2048 sc1
buffer_load_dwordx4 v[40:43], v0, s[8:11], s51 offen offset:3072 sc1
buffer_load_dwordx4 v[44:47], v0, s[8:11], s52 offen sc1
v_mov_b64 v[48:49], 0
v_mov_b64 v[50:51], 0
v_mov_b64 v[52:53], 0
v_mov_b64 v[54:55], 0
v_mov_b64 v[56:57], 0
v_mov_b64 v[58:59], 0
v_mov_b64 v[60:61], 0
v_mov_b64 v[62:63], 0
v_mov_b64 v[64:65], 0
v_mov_b64 v[66:67], 0
v_mov_b64 v[68:69], 0
v_mov_b64 v[70:71], 0
s_waitcnt vmcnt(0)
v_max_u32 v48, v12, v13
v_max3_u32 v48, v48, v14, v15
v_max3_u32 v48, v48, v16, v17
v_max3_u32 v48, v48, v18, v19
v_max3_u32 v48, v48, v20, v21
v_max3_u32 v48, v48, v22, v23
v_max3_u32 v48, v48, v24, v25
v_max3_u32 v48, v48, v26, v27
v_max3_u32 v48, v48, v28, v29
v_max3_u32 v48, v48, v30, v31
v_max3_u32 v48, v48, v32, v33
v_max3_u32 v48, v48, v34, v35
v_max3_u32 v48, v48, v36, v37
v_max3_u32 v48, v48, v38, v39
v_max3_u32 v48, v48, v40, v41
v_max3_u32 v48, v48, v42, v43
v_max3_u32 v48, v48, v44, v45
v_max3_u32 v48, v48, v46, v47
v_cmp_eq_u32 vcc, -1, v48
v_mov_b32 v48, 0
s_cbranch_vccnz Lc_redo3L3
s_nop 0
v_smfmac_f32_16x16x64_bf16 v[48:51], v[12:15], a[0:7], v2
v_smfmac_f32_16x16x64_bf16 v[52:55], v[12:15], a[8:15], v2
v_smfmac_f32_16x16x64_bf16 v[56:59], v[12:15], a[16:23], v2
v_smfmac_f32_16x16x64_bf16 v[60:63], v[12:15], a[24:31], v2
v_smfmac_f32_16x16x64_bf16 v[64:67], v[12:15], v[80:87], v2
v_smfmac_f32_16x16x64_bf16 v[68:71], v[12:15], v[88:95], v2
v_smfmac_f32_16x16x64_bf16 v[48:51], v[16:19], a[32:39], v2
v_smfmac_f32_16x16x64_bf16 v[52:55], v[16:19], a[40:47], v2
v_smfmac_f32_16x16x64_bf16 v[56:59], v[16:19], a[48:55], v2
v_smfmac_f32_16x16x64_bf16 v[60:63], v[16:19], a[56:63], v2
v_smfmac_f32_16x16x64_bf16 v[64:67], v[16:19], v[96:103], v2
v_smfmac_f32_16x16x64_bf16 v[68:71], v[16:19], v[104:111], v2
v_smfmac_f32_16x16x64_bf16 v[48:51], v[20:23], a[64:71], v2
v_smfmac_f32_16x16x64_bf16 v[52:55], v[20:23], a[72:79], v2
v_smfmac_f32_16x16x64_bf16 v[56:59], v[20:23], a[80:87], v2
v_smfmac_f32_16x16x64_bf16 v[60:63], v[20:23], a[88:95], v2
v_smfmac_f32_16x16x64_bf16 v[64:67], v[20:23], v[112:119], v2
v_smfmac_f32_16x16x64_bf16 v[68:71], v[20:23], v[120:127], v2
v_smfmac_f32_16x16x64_bf16 v[48:51], v[24:27], a[96:103], v2
v_smfmac_f32_16x16x64_bf16 v[52:55], v[24:27], a[104:111], v2
v_smfmac_f32_16x16x64_bf16 v[56:59], v[24:27], a[112:119], v2
v_smfmac_f32_16x16x64_bf16 v[60:63], v[24:27], a[120:127], v2
v_smfmac_f32_16x16x64_bf16 v[64:67], v[24:27], v[128:135], v2
v_smfmac_f32_16x16x64_bf16 v[68:71], v[24:27], v[136:143], v2
v_smfmac_f32_16x16x64_bf16 v[48:51], v[28:31], a[128:135], v2
v_smfmac_f32_16x16x64_bf16 v[52:55], v[28:31], a[136:143], v2
v_smfmac_f32_16x16x64_bf16 v[56:59], v[28:31], a[144:151], v2
v_smfmac_f32_16x16x64_bf16 v[60:63], v[28:31], a[152:159], v2
v_smfmac_f32_16x16x64_bf16 v[48:51], v[32:35], a[160:167], v2
v_smfmac_f32_16x16x64_bf16 v[52:55], v[32:35], a[168:175], v2
v_smfmac_f32_16x16x64_bf16 v[56:59], v[32:35], a[176:183], v2
v_smfmac_f32_16x16x64_bf16 v[60:63], v[32:35], a[184:191], v2
v_smfmac_f32_16x16x64_bf16 v[48:51], v[36:39], a[192:199], v2
v_smfmac_f32_16x16x64_bf16 v[52:55], v[36:39], a[200:207], v2
v_smfmac_f32_16x16x64_bf16 v[56:59], v[36:39], a[208:215], v2
v_smfmac_f32_16x16x64_bf16 v[60:63], v[36:39], a[216:223], v2
v_smfmac_f32_16x16x64_bf16 v[48:51], v[40:43], a[224:231], v2
v_smfmac_f32_16x16x64_bf16 v[52:55], v[40:43], a[232:239], v2
v_smfmac_f32_16x16x64_bf16 v[56:59], v[40:43], a[240:247], v2
v_smfmac_f32_16x16x64_bf16 v[60:63], v[40:43], a[248:255], v2
v_smfmac_f32_16x16x64_bf16 v[48:51], v[44:47], v[224:231], v2
v_smfmac_f32_16x16x64_bf16 v[52:55], v[44:47], v[232:239], v2
v_smfmac_f32_16x16x64_bf16 v[56:59], v[44:47], v[240:247], v2
v_smfmac_f32_16x16x64_bf16 v[60:63], v[44:47], v[248:255], v2
s_nop 7
v_add_f32 v48, v48, v50
v_add_f32 v49, v49, v51
v_add_f32 v52, v52, v54
v_add_f32 v53, v53, v55
s_branch Lc_postL3
Lc_redo3L3:
s_add_u32 s21, s21, 1
s_cmp_ge_u32 s21, 4194304
s_cbranch_scc1 L_abort
s_branch Lc_redo2L3
Lc_gosc1:
s_cmp_eq_u32 s16, 0
s_cbranch_scc1 Lc_top0sc1
s_cmp_eq_u32 s16, 1
s_cbranch_scc1 Lc_top1sc1
s_cmp_eq_u32 s16, 2
s_cbranch_scc1 Lc_top2sc1
s_cmp_lt_u32 s17, 8
s_cbranch_scc1 Lc_top3csc1
s_branch Lc_top3bsc1
.p2align 6
s_nop 0
s_nop 0
Lc_top0sc1:
buffer_load_dwordx4 v0, s[8:11], s22 offen sc1 lds
ds_read_b128 v[12:15], v0 offset:16384
ds_read_b128 v[16:19], v0 offset:17408
s_add_u32 s21, s21, 1
s_cmp_ge_u32 s21, 4194304
s_cbranch_scc1 L_abort
s_waitcnt lgkmcnt(0)
v_max_u32 v43, v12, v16
v_cmp_eq_u32 vcc, -1, v43
s_cbranch_vccnz Lc_top0sc1
v_smfmac_f32_16x16x64_bf16 v[48:51], v[12:15], a[0:7], v2
v_smfmac_f32_16x16x64_bf16 v[52:55], v[12:15], a[8:15], v2
v_smfmac_f32_16x16x64_bf16 v[56:59], v[12:15], a[16:23], v2
buffer_load_dwordx4 v[28:31], v0, s[8:11], s51 offen sc1
v_smfmac_f32_16x16x64_bf16 v[60:63], v[12:15], a[24:31], v2
v_smfmac_f32_16x16x64_bf16 v[64:67], v[12:15], v[80:87], v2
ds_read_b128 v[20:23], v0 offset:18432
v_smfmac_f32_16x16x64_bf16 v[68:71], v[12:15], v[88:95], v2
v_smfmac_f32_16x16x64_bf16 v[48:51], v[16:19], a[32:39], v2
buffer_load_dwordx4 v[32:35], v0, s[8:11], s51 offen offset:1024 sc1
v_smfmac_f32_16x16x64_bf16 v[52:55], v[16:19], a[40:47], v2
v_smfmac_f32_16x16x64_bf16 v[56:59], v[16:19], a[48:55], v2
v_smfmac_f32_16x16x64_bf16 v[60:63], v[16:19], a[56:63], v2
ds_read_b128 v[24:27], v0 offset:19456
s_waitcnt lgkmcnt(1)
v_cmp_eq_u32 vcc, -1, v20
v_smfmac_f32_16x16x64_bf16 v[64:67], v[16:19], v[96:103], v2
buffer_load_dwordx4 v[36:39], v0, s[8:11], s51 offen offset:2048 sc1
v_smfmac_f32_16x16x64_bf16 v[68:71], v[16:19], v[104:111], v2
s_cbranch_vccnz Lc_retry20sc1
Lc_back20sc1:
v_smfmac_f32_16x16x64_bf16 v[48:51], v[20:23], a[64:71], v2
v_smfmac_f32_16x16x64_bf16 v[52:55], v[20:23], a[72:79], v2
v_smfmac_f32_16x16x64_bf16 v[56:59], v[20:23], a[80:87], v2
buffer_load_dwordx4 v[40:43], v0, s[8:11], s51 offen offset:3072 sc1
v_smfmac_f32_16x16x64_bf16 v[60:63], v[20:23], a[88:95], v2
s_waitcnt lgkmcnt(0)
v_cmp_eq_u32 vcc, -1, v24
v_smfmac_f32_16x16x64_bf16 v[64:67], v[20:23], v[112:119], v2
v_smfmac_f32_16x16x64_bf16 v[68:71], v[20:23], v[120:127], v2
buffer_load_dwordx4 v[44:47], v0, s[8:11], s52 offen sc1
s_cbranch_vccnz Lc_retry30sc1
Lc_back30sc1:
v_smfmac_f32_16x16x64_bf16 v[48:51], v[24:27], a[96:103], v2
s_waitcnt vmcnt(5)
s_barrier
v_smfmac_f32_16x16x64_bf16 v[52:55], v[24:27], a[104:111], v2
s_waitcnt vmcnt(4)
v_cmp_eq_u32 vcc, -1, v28
v_smfmac_f32_16x16x64_bf16 v[56:59], v[24:27], a[112:119], v2
v_smfmac_f32_16x16x64_bf16 v[60:63], v[24:27], a[120:127], v2
s_cbranch_vccnz Lc_retry40sc1
Lc_back40sc1:
v_smfmac_f32_16x16x64_bf16 v[48:51], v[28:31], a[128:135], v2
v_smfmac_f32_16x16x64_bf16 v[52:55], v[28:31], a[136:143], v2
s_waitcnt vmcnt(3)
v_cmp_eq_u32 vcc, -1, v32
v_smfmac_f32_16x16x64_bf16 v[56:59], v[28:31], a[144:151], v2
v_smfmac_f32_16x16x64_bf16 v[60:63], v[28:31], a[152:159], v2
s_cbranch_vccnz Lc_retry50sc1
Lc_back50sc1:
v_smfmac_f32_16x16x64_bf16 v[48:51], v[32:35], a[160:167], v2
v_smfmac_f32_16x16x64_bf16 v[52:55], v[32:35], a[168:175], v2
s_waitcnt vmcnt(2)
v_cmp_eq_u32 vcc, -1, v36
v_smfmac_f32_16x16x64_bf16 v[56:59], v[32:35], a[176:183], v2
v_smfmac_f32_16x16x64_bf16 v[60:63], v[32:35], a[184:191], v2
s_cbranch_vccnz Lc_retry60sc1
Lc_back60sc1:
v_smfmac_f32_16x16x64_bf16 v[48:51], v[36:39], a[192:199], v2
v_smfmac_f32_16x16x64_bf16 v[52:55], v[36:39], a[200:207], v2
s_waitcnt vmcnt(1)
v_cmp_eq_u32 vcc, -1, v40
v_smfmac_f32_16x16x64_bf16 v[56:59], v[36:39], a[208:215], v2
v_smfmac_f32_16x16x64_bf16 v[60:63], v[36:39], a[216:223], v2
s_cbranch_vccnz Lc_retry70sc1
Lc_back70sc1:
v_smfmac_f32_16x16x64_bf16 v[48:51], v[40:43], a[224:231], v2
v_smfmac_f32_16x16x64_bf16 v[52:55], v[40:43], a[232:239], v2
s_waitcnt vmcnt(0)
v_cmp_eq_u32 vcc, -1, v44
v_smfmac_f32_16x16x64_bf16 v[56:59], v[40:43], a[240:247], v2
v_smfmac_f32_16x16x64_bf16 v[60:63], v[40:43], a[248:255], v2
s_cbranch_vccnz Lc_retry80sc1
Lc_back80sc1:
v_smfmac_f32_16x16x64_bf16 v[48:51], v[44:47], v[224:231], v2
v_smfmac_f32_16x16x64_bf16 v[52:55], v[44:47], v[232:239], v2
v_smfmac_f32_16x16x64_bf16 v[56:59], v[44:47], v[240:247], v2
v_add_f32 v48, v48, v50
v_smfmac_f32_16x16x64_bf16 v[60:63], v[44:47], v[248:255], v2
v_add_f32 v49, v49, v51
v_smfmac_f32_16x16x64_bf16 v[64:67], v[24:27], v[128:135], v2
v_add_f32 v52, v52, v54
v_smfmac_f32_16x16x64_bf16 v[68:71], v[24:27], v[136:143], v2
v_add_f32 v53, v53, v55
Lc_post0sc1:
v_add_f32 v56, v56, v58
v_add_f32 v60, v60, v62
v_cvt_pk_bf16_f32 v50, v48, v52
v_cvt_pk_bf16_f32 v51, v56, v60
v_xor_b32 v58, 16, v3
ds_write_b64 v3, v[50:51] offset:16384
v_add_f32 v57, v57, v59
v_add_f32 v61, v61, v63
v_cvt_pk_bf16_f32 v54, v49, v53
v_cvt_pk_bf16_f32 v55, v57, v61
ds_write_b64 v58, v[54:55] offset:16384
v_cmp_u_f32 vcc, v48, v49
v_smfmac_f32_16x16x64_bf16 v[64:67], v[28:31], v[144:151], v2
v_smfmac_f32_16x16x64_bf16 v[68:71], v[28:31], v[152:159], v2
s_cbranch_vccnz Lc_redo0sc1
Lc_redoback0sc1:
v_smfmac_f32_16x16x64_bf16 v[64:67], v[32:35], v[160:167], v2
s_cmp_lt_u32 s96, 3
v_smfmac_f32_16x16x64_bf16 v[68:71], v[32:35], v[168:175], v2
s_cbranch_scc1 Lc_hist0sc1
Lc_histback0sc1:
ds_read_b128 v[12:15], v0
ds_read_b128 v[16:19], v0 offset:4096
ds_read_b128 v[20:23], v0 offset:1024
v_xor_b32 v32, 64, v4
s_waitcnt lgkmcnt(3)
s_barrier
ds_read_b128 v[28:31], v4 offset:16384
ds_read_b128 v[32:35], v32 offset:17408
ds_read_b128 v[56:59], v0 offset:5120
v_smfmac_f32_16x16x64_bf16 v[64:67], v[36:39], v[176:183], v2
s_cmp_eq_u32 s18, 62
v_smfmac_f32_16x16x64_bf16 v[68:71], v[36:39], v[184:191], v2
s_cbranch_scc1 Lc_km0sc1
Lc_kmb0sc1:
ds_read_b128 v[36:39], v4 offset:18432
ds_read_b128 v[60:63], v0 offset:2048
ds_read_b128 v[24:27], v0 offset:6144
v_smfmac_f32_16x16x64_bf16 v[64:67], v[40:43], v[192:199], v2
v_smfmac_f32_16x16x64_bf16 v[68:71], v[40:43], v[200:207], v2
v_xor_b32 v40, 64, v4
ds_read_b128 v[40:43], v40 offset:19456
v_smfmac_f32_16x16x64_bf16 v[64:67], v[44:47], v[208:215], v2
v_smfmac_f32_16x16x64_bf16 v[68:71], v[44:47], v[216:223], v2
s_waitcnt lgkmcnt(6)
v_mfma_f32_16x16x32_bf16 v[48:51], v[12:15], v[28:31], 0
ds_read_b128 v[12:15], v0 offset:3072
v_mfma_f32_16x16x32_bf16 v[52:55], v[16:19], v[28:31], 0
ds_read_b128 v[16:19], v0 offset:7168
v_mfma_f32_16x16x32_bf16 v[44:47], v[28:31], v[28:31], 0
s_waitcnt lgkmcnt(6)
v_mfma_f32_16x16x32_bf16 v[48:51], v[20:23], v[32:35], v[48:51]
v_add_f32 v64, v64, v66
v_add_f32 v65, v65, v67
v_mfma_f32_16x16x32_bf16 v[52:55], v[56:59], v[32:35], v[52:55]
v_add_f32 v68, v68, v70
ds_read_b128 v[56:59], v0 offset:8192
v_mfma_f32_16x16x32_bf16 v[44:47], v[32:35], v[32:35], v[44:47]
v_add_f32 v69, v69, v71
v_cvt_pk_bf16_f32 v66, v64, v65
s_waitcnt lgkmcnt(4)
v_mfma_f32_16x16x32_bf16 v[48:51], v[60:63], v[36:39], v[48:51]
v_cvt_pk_bf16_f32 v67, v68, v69
ds_read_b128 v[60:63], v0 offset:9216
v_mfma_f32_16x16x32_bf16 v[52:55], v[24:27], v[36:39], v[52:55]
ds_read_b128 v[28:31], v1
s_cmp_eq_u32 s18, 62
v_mfma_f32_16x16x32_bf16 v[44:47], v[36:39], v[36:39], v[44:47]
ds_read_b128 v[32:35], v1 offset:1024
s_cbranch_scc1 Lc_vm0sc1
Lc_vmb0sc1:
s_waitcnt lgkmcnt(4)
v_mfma_f32_16x16x32_bf16 v[44:47], v[40:43], v[40:43], v[44:47]
s_barrier
v_mfma_f32_16x16x32_bf16 v[48:51], v[12:15], v[40:43], v[48:51]
ds_read_b128 v[20:23], v1 offset:2048
v_mfma_f32_16x16x32_bf16 v[52:55], v[16:19], v[40:43], v[52:55]
ds_read_b128 v[24:27], v1 offset:3072
v_mov_b32 v36, -1
v_mov_b32 v37, -1
v_mov_b32 v38, -1
v_max3_f32 v64, v46, v47, v48
v_max3_f32 v64, v64, v49, v50
v_mov_b32 v39, -1
s_nop 0
v_max3_f32 v65, v51, v52, v53
v_max3_f32 v65, v65, v54, v55
v_max_f32 v44, v64, v65
v_max_f32 v65, v64, v65
ds_read_b128 v[12:15], v1 offset:4096
ds_read_b128 v[16:19], v1 offset:5120
v_permlane32_swap_b32 v44, v65
v_max_f32 v64, v44, v65
v_max_f32 v65, v44, v65
s_mov_b32 s20, s24
s_bitcmp0_b32 s18, 1
v_permlane16_swap_b32 v64, v65
v_max_f32 v64, v64, v65
v_fma_f32 v64, v64, s30, v5
v_pk_fma_f32 v[46:47], v[46:47], s[30:31], v[64:65] op_sel_hi:[1,1,0] neg_lo:[0,0,1] neg_hi:[0,0,1]
v_pk_fma_f32 v[48:49], v[48:49], s[30:31], v[64:65] op_sel_hi:[1,1,0] neg_lo:[0,0,1] neg_hi:[0,0,1]
v_pk_fma_f32 v[50:51], v[50:51], s[30:31], v[64:65] op_sel_hi:[1,1,0] neg_lo:[0,0,1] neg_hi:[0,0,1]
v_pk_fma_f32 v[52:53], v[52:53], s[30:31], v[64:65] op_sel_hi:[1,1,0] neg_lo:[0,0,1] neg_hi:[0,0,1]
v_pk_fma_f32 v[54:55], v[54:55], s[30:31], v[64:65] op_sel_hi:[1,1,0] neg_lo:[0,0,1] neg_hi:[0,0,1]
v_exp_f32 v46, v46
v_exp_f32 v47, v47
v_exp_f32 v48, v48
v_cvt_pk_bf16_f32 v44, v46, v47
v_exp_f32 v49, v49
v_exp_f32 v50, v50
v_mov_b32_dpp v45, v44 quad_perm:[2,3,0,1] row_mask:0xf bank_mask:0xf
v_exp_f32 v51, v51
v_cvt_pk_bf16_f32 v48, v48, v49
v_mfma_f32_16x16x16_bf16 v[40:43], v[66:67], v[44:45], 0
ds_write_b128 v0, v[36:39] offset:16384
v_exp_f32 v52, v52
v_mfma_f32_16x16x16_bf16 v[68:71], v[8:9], v[44:45], 0
v_exp_f32 v53, v53
v_cvt_pk_bf16_f32 v49, v50, v51
v_exp_f32 v54, v54
v_exp_f32 v55, v55
v_cvt_pk_bf16_f32 v50, v52, v53
v_mov_b32_dpp v52, v48 quad_perm:[2,3,0,1] row_mask:0xf bank_mask:0xf
v_cvt_pk_bf16_f32 v51, v54, v55
v_mov_b32_dpp v53, v49 quad_perm:[2,3,0,1] row_mask:0xf bank_mask:0xf
s_cselect_b32 s32, -1, 0
s_waitcnt lgkmcnt(7)
v_mfma_f32_16x16x32_bf16 v[68:71], v[8:11], v[48:51], v[68:71]
v_mov_b32_dpp v54, v50 quad_perm:[2,3,0,1] row_mask:0xf bank_mask:0xf
v_mov_b32_dpp v55, v51 quad_perm:[2,3,0,1] row_mask:0xf bank_mask:0xf
v_mfma_f32_16x16x32_bf16 v[40:43], v[56:59], v[48:51], v[40:43]
s_mov_b32 s53, s25
s_add_u32 s55, s22, s34
v_mfma_f32_16x16x32_bf16 v[40:43], v[60:63], v[52:55], v[40:43]
s_add_u32 s49, s23, s34
s_add_u32 s38, s38, 64
ds_read_b128 v[44:47], v1 offset:6144
ds_read_b128 v[48:51], v1 offset:7168
v_rcp_f32 v56, v68
s_add_u32 s18, s18, 1
s_add_u32 s27, s27, 9216
v_mov_b32_dpp v56, v56 quad_perm:[0,1,0,1] row_mask:0xf bank_mask:0xf
v_pk_mul_f32 v[40:41], v[40:41], v[56:57] op_sel_hi:[1,0]
v_pk_mul_f32 v[42:43], v[42:43], v[56:57] op_sel_hi:[1,0]
v_cvt_pk_bf16_f32 v40, v40, v41
v_cvt_pk_bf16_f32 v41, v42, v43
ds_write_b64 v7, v[40:41] offset:20480
v_or_b32 v36, v7, v5
ds_read_b128 v[64:67], v1 offset:8192
ds_read_b128 v[68:71], v1 offset:9216
s_mov_b32 s22, s23
s_add_u32 s23, s23, 9216
s_waitcnt lgkmcnt(2)
s_barrier
ds_read_b128 v[8:11], v36 offset:20992
ds_read_b128 v[36:39], v36 offset:20480
ds_read_b128 v[40:43], v0 offset:21504
s_cmp_eq_u32 s23, 12610560
s_cselect_b32 s23, 12582912, s23
s_add_u32 s24, s24, s33
s_add_u32 s25, s25, s33
s_sub_u32 s33, 0, s33
s_add_u32 s51, s22, 4096
s_add_u32 s52, s22, 8192
s_waitcnt lgkmcnt(1)
v_mfma_f32_16x16x32_bf16 v[52:55], v[36:39], v[72:75], 0
v_mfma_f32_16x16x32_bf16 v[52:55], v[8:11], v[76:79], v[52:55]
s_waitcnt lgkmcnt(0)
v_smfmac_f32_16x16x64_bf16 v[52:55], v[40:43], v[28:35], v2
ds_read_b128 v[28:31], v1 offset:10240
ds_read_b128 v[32:35], v1 offset:11264
v_mfma_f32_16x16x32_bf16 v[56:59], v[36:39], v[20:23], 0
v_mfma_f32_16x16x32_bf16 v[56:59], v[8:11], v[24:27], v[56:59]
ds_read_b128 v[20:23], v1 offset:12288
v_add_f32 v52, v52, v54
v_smfmac_f32_16x16x64_bf16 v[56:59], v[40:43], v[12:19], v2
ds_read_b128 v[24:27], v1 offset:13312
ds_read_b128 v[12:15], v1 offset:14336
v_add_f32 v53, v53, v55
v_cvt_pk_bf16_f32 v54, v52, v53
v_bfi_b32 v54, -2, v54, s32
s_nop 2
v_add_f32 v56, v56, v58
v_add_f32 v57, v57, v59
v_cvt_pk_bf16_f32 v55, v56, v57
buffer_store_dwordx2 v[54:55], v6, s[8:11], s20 offen sc1
s_add_u32 s20, s20, 49152
v_mfma_f32_16x16x32_bf16 v[60:63], v[36:39], v[44:47], 0
ds_read_b128 v[16:19], v1 offset:15360
v_mfma_f32_16x16x32_bf16 v[60:63], v[8:11], v[48:51], v[60:63]
ds_read_b128 v[44:47], v1 offset:16384
v_smfmac_f32_16x16x64_bf16 v[60:63], v[40:43], v[64:71], v2
ds_read_b128 v[48:51], v1 offset:17408
ds_read_b128 v[64:67], v1 offset:18432
s_waitcnt lgkmcnt(7)
v_mfma_f32_16x16x32_bf16 v[52:55], v[36:39], v[28:31], 0
ds_read_b128 v[68:71], v1 offset:19456
v_mfma_f32_16x16x32_bf16 v[52:55], v[8:11], v[32:35], v[52:55]
ds_read_b128 v[28:31], v1 offset:20480
s_waitcnt lgkmcnt(7)
v_smfmac_f32_16x16x64_bf16 v[52:55], v[40:43], v[20:27], v2
ds_read_b128 v[32:35], v1 offset:21504
ds_read_b128 v[20:23], v1 offset:22528
s_waitcnt lgkmcnt(7)
v_mfma_f32_16x16x32_bf16 v[56:59], v[36:39], v[12:15], 0
ds_read_b128 v[24:27], v1 offset:23552
v_add_f32 v60, v60, v62
v_mfma_f32_16x16x32_bf16 v[56:59], v[8:11], v[16:19], v[56:59]
ds_read_b128 v[12:15], v1 offset:24576
v_add_f32 v61, v61, v63
s_waitcnt lgkmcnt(7)
v_smfmac_f32_16x16x64_bf16 v[56:59], v[40:43], v[44:51], v2
ds_read_b128 v[16:19], v1 offset:25600
ds_read_b128 v[44:47], v1 offset:26624
v_add_f32 v52, v52, v54
v_cvt_pk_bf16_f32 v54, v60, v61
v_add_f32 v53, v53, v55
s_waitcnt lgkmcnt(7)
v_mfma_f32_16x16x32_bf16 v[60:63], v[36:39], v[64:67], 0
ds_read_b128 v[48:51], v1 offset:27648
v_bfi_b32 v54, -2, v54, s32
v_mfma_f32_16x16x32_bf16 v[60:63], v[8:11], v[68:71], v[60:63]
ds_read_b128 v[64:67], v1 offset:28672
v_cvt_pk_bf16_f32 v55, v52, v53
s_waitcnt lgkmcnt(7)
v_smfmac_f32_16x16x64_bf16 v[60:63], v[40:43], v[28:35], v2
ds_read_b128 v[68:71], v1 offset:29696
ds_read_b128 v[28:31], v1 offset:30720
buffer_store_dwordx2 v[54:55], v6, s[8:11], s20 offen sc1
s_add_u32 s20, s20, 49152
s_waitcnt lgkmcnt(7)
v_mfma_f32_16x16x32_bf16 v[52:55], v[36:39], v[20:23], 0
ds_read_b128 v[32:35], v1 offset:31744
v_add_f32 v56, v56, v58
v_mfma_f32_16x16x32_bf16 v[52:55], v[8:11], v[24:27], v[52:55]
ds_read_b128 v[20:23], v1 offset:32768
v_add_f32 v57, v57, v59
s_waitcnt lgkmcnt(7)
v_smfmac_f32_16x16x64_bf16 v[52:55], v[40:43], v[12:19], v2
ds_read_b128 v[24:27], v1 offset:33792
ds_read_b128 v[12:15], v1 offset:34816
v_add_f32 v60, v60, v62
v_cvt_pk_bf16_f32 v62, v56, v57
v_add_f32 v61, v61, v63
s_waitcnt lgkmcnt(7)
v_mfma_f32_16x16x32_bf16 v[56:59], v[36:39], v[44:47], 0
ds_read_b128 v[16:19], v1 offset:35840
v_bfi_b32 v62, -2, v62, s32
v_mfma_f32_16x16x32_bf16 v[56:59], v[8:11], v[48:51], v[56:59]
ds_read_b128 v[44:47], v1 offset:36864
v_cvt_pk_bf16_f32 v63, v60, v61
s_waitcnt lgkmcnt(7)
v_smfmac_f32_16x16x64_bf16 v[56:59], v[40:43], v[64:71], v2
ds_read_b128 v[48:51], v1 offset:37888
ds_read_b128 v[64:67], v1 offset:38912
buffer_store_dwordx2 v[62:63], v6, s[8:11], s20 offen sc1
s_add_u32 s20, s20, 49152
s_waitcnt lgkmcnt(7)
v_mfma_f32_16x16x32_bf16 v[60:63], v[36:39], v[28:31], 0
ds_read_b128 v[68:71], v1 offset:39936
v_add_f32 v52, v52, v54
v_mfma_f32_16x16x32_bf16 v[60:63], v[8:11], v[32:35], v[60:63]
ds_read_b128 v[28:31], v1 offset:40960
v_add_f32 v53, v53, v55
s_waitcnt lgkmcnt(7)
v_smfmac_f32_16x16x64_bf16 v[60:63], v[40:43], v[20:27], v2
ds_read_b128 v[32:35], v1 offset:41984
ds_read_b128 v[20:23], v1 offset:43008
v_add_f32 v56, v56, v58
v_cvt_pk_bf16_f32 v58, v52, v53
v_add_f32 v57, v57, v59
s_waitcnt lgkmcnt(7)
v_mfma_f32_16x16x32_bf16 v[52:55], v[36:39], v[12:15], 0
ds_read_b128 v[24:27], v1 offset:44032
v_bfi_b32 v58, -2, v58, s32
v_mfma_f32_16x16x32_bf16 v[52:55], v[8:11], v[16:19], v[52:55]
ds_read_b128 v[12:15], v1 offset:45056
v_cvt_pk_bf16_f32 v59, v56, v57
s_waitcnt lgkmcnt(7)
v_smfmac_f32_16x16x64_bf16 v[52:55], v[40:43], v[44:51], v2
ds_read_b128 v[16:19], v1 offset:46080
buffer_store_dwordx2 v[58:59], v6, s[8:11], s20 offen sc1
s_add_u32 s20, s20, 49152
s_waitcnt lgkmcnt(6)
v_mfma_f32_16x16x32_bf16 v[56:59], v[36:39], v[64:67], 0
v_add_f32 v60, v60, v62
v_mfma_f32_16x16x32_bf16 v[56:59], v[8:11], v[68:71], v[56:59]
v_add_f32 v61, v61, v63
s_waitcnt lgkmcnt(4)
v_smfmac_f32_16x16x64_bf16 v[56:59], v[40:43], v[28:35], v2
v_add_f32 v52, v52, v54
v_cvt_pk_bf16_f32 v54, v60, v61
v_add_f32 v53, v53, v55
s_waitcnt lgkmcnt(2)
v_mfma_f32_16x16x32_bf16 v[60:63], v[36:39], v[20:23], 0
v_bfi_b32 v54, -2, v54, s32
v_mfma_f32_16x16x32_bf16 v[60:63], v[8:11], v[24:27], v[60:63]
v_cvt_pk_bf16_f32 v55, v52, v53
s_waitcnt lgkmcnt(0)
v_smfmac_f32_16x16x64_bf16 v[60:63], v[40:43], v[12:19], v2
buffer_store_dwordx2 v[54:55], v6, s[8:11], s20 offen sc1
s_add_u32 s20, s20, 49152
s_add_u32 s26, s26, 524288
s_mov_b32 m0, 16384
v_mov_b64 v[48:49], 0
v_mov_b64 v[50:51], 0
v_mov_b64 v[52:53], 0
v_mov_b64 v[54:55], 0
v_mov_b64 v[64:65], 0
v_mov_b64 v[66:67], 0
v_mov_b64 v[68:69], 0
v_mov_b64 v[70:71], 0
v_add_f32 v56, v56, v58
v_add_f32 v57, v57, v59
v_add_f32 v60, v60, v62
v_cvt_pk_bf16_f32 v62, v56, v57
v_add_f32 v61, v61, v63
v_bfi_b32 v62, -2, v62, s32
v_cvt_pk_bf16_f32 v63, v60, v61
buffer_store_dwordx2 v[62:63], v6, s[8:11], s20 offen sc1
v_mov_b32 v8, 0x3f803f80
v_mov_b32 v9, v8
v_mov_b64 v[10:11], v[8:9]
v_mov_b64 v[56:57], 0
v_mov_b64 v[58:59], 0
v_mov_b64 v[60:61], 0
v_mov_b64 v[62:63], 0
s_cmp_eq_u32 s18, 40
s_cbranch_scc1 Lc_pre0sc1
Lc_preb0sc1:
s_mov_b32 s75, 0
s_mov_b32 s19, s74
Lc_dl0sc1:
s_sub_u32 s19, s19, 1
s_cbranch_scc0 Lc_dl0sc1
s_cmp_eq_u32 s18, 63
s_cbranch_scc0 Lc_top0sc1
s_waitcnt vmcnt(0)
s_lshl_b32 s19, s17, 5
s_add_u32 s19, s19, 129024
buffer_store_dword v2, off, s[8:11], s19 sc1
buffer_store_dword v2, off, s[8:11], s19 offset:4 sc1
s_branch Lc_topL0
Lc_hist0sc1:
s_cmp_eq_u32 s96, 0
s_cbranch_scc0 Lc_hist10sc1
buffer_store_dwordx4 v[12:15], v0, s[8:11], s27 offen sc1
s_nop 0
s_branch Lc_histback0sc1
Lc_hist10sc1:
s_cmp_eq_u32 s96, 1
s_cbranch_scc0 Lc_hist20sc1
buffer_store_dwordx4 v[16:19], v0, s[8:11], s27 offen sc1
s_nop 0
s_branch Lc_histback0sc1
Lc_hist20sc1:
buffer_store_dwordx4 v[20:23], v0, s[8:11], s27 offen sc1
s_nop 0
s_branch Lc_histback0sc1
Lc_km0sc1:
v_bfe_u32 v48, v0, 7, 1
v_lshlrev_b32 v48, 9, v48
v_bfe_u32 v49, v0, 5, 2
v_lshl_add_u32 v48, v49, 7, v48
v_lshrrev_b32 v49, 8, v0
v_lshl_add_u32 v48, v49, 5, v48
v_bfe_u32 v49, v0, 4, 1
v_lshl_add_u32 v48, v49, 3, v48
s_mul_i32 s19, s17, 4096
s_add_u32 s19, s19, 24903680
buffer_store_dwordx2 v[50:51], v48, s[8:11], s19 offen sc1
buffer_store_dwordx2 v[54:55], v48, s[8:11], s19 offen offset:16 sc1
s_branch Lc_kmb0sc1
Lc_vm0sc1:
v_lshrrev_b32 v64, 1, v0
s_mul_i32 s19, s17, 4096
s_add_u32 s19, s19, 24905728
buffer_store_dwordx2 v[66:67], v64, s[8:11], s19 offen sc1
s_branch Lc_vmb0sc1
Lc_pre0sc1:
v_mov_b32 v12, 0
global_load_dword v13, v12, s[6:7] offset:104 sc1
s_waitcnt vmcnt(0)
v_cmp_gt_u32 vcc, 28, v13
s_cbranch_vccz Lc_preb0sc1
s_add_u32 s21, s21, 1
s_cmp_ge_u32 s21, 4194304
s_cbranch_scc1 L_abort
s_branch Lc_pre0sc1
Lc_retry20sc1:
buffer_load_dwordx4 v0, s[8:11], s22 offen offset:2048 sc1 lds
ds_read_b128 v[20:23], v0 offset:18432
s_add_u32 s21, s21, 1
s_cmp_ge_u32 s21, 4194304
s_cbranch_scc1 L_abort
s_waitcnt lgkmcnt(0)
v_cmp_eq_u32 vcc, -1, v20
s_cbranch_vccnz Lc_retry20sc1
s_waitcnt vmcnt(0)
s_branch Lc_back20sc1
Lc_retry30sc1:
buffer_load_dwordx4 v0, s[8:11], s22 offen offset:3072 sc1 lds
ds_read_b128 v[24:27], v0 offset:19456
s_add_u32 s21, s21, 1
s_cmp_ge_u32 s21, 4194304
s_cbranch_scc1 L_abort
s_waitcnt lgkmcnt(0)
v_cmp_eq_u32 vcc, -1, v24
s_cbranch_vccnz Lc_retry30sc1
s_waitcnt vmcnt(0)
s_branch Lc_back30sc1
Lc_retry40sc1:
buffer_load_dwordx4 v[28:31], v0, s[8:11], s51 offen sc1
s_waitcnt vmcnt(0)
v_cmp_eq_u32 vcc, -1, v28
s_cbranch_vccz Lc_back40sc1
s_add_u32 s21, s21, 1
s_cmp_ge_u32 s21, 4194304
s_cbranch_scc1 L_abort
s_branch Lc_retry40sc1
Lc_retry50sc1:
buffer_load_dwordx4 v[32:35], v0, s[8:11], s51 offen offset:1024 sc1
s_waitcnt vmcnt(0)
v_cmp_eq_u32 vcc, -1, v32
s_cbranch_vccz Lc_back50sc1
s_add_u32 s21, s21, 1
s_cmp_ge_u32 s21, 4194304
s_cbranch_scc1 L_abort
s_branch Lc_retry50sc1
Lc_retry60sc1:
buffer_load_dwordx4 v[36:39], v0, s[8:11], s51 offen offset:2048 sc1
s_waitcnt vmcnt(0)
v_cmp_eq_u32 vcc, -1, v36
s_cbranch_vccz Lc_back60sc1
s_add_u32 s21, s21, 1
s_cmp_ge_u32 s21, 4194304
s_cbranch_scc1 L_abort
s_branch Lc_retry60sc1
Lc_retry70sc1:
buffer_load_dwordx4 v[40:43], v0, s[8:11], s51 offen offset:3072 sc1
s_waitcnt vmcnt(0)
v_cmp_eq_u32 vcc, -1, v40
s_cbranch_vccz Lc_back70sc1
s_add_u32 s21, s21, 1
s_cmp_ge_u32 s21, 4194304
s_cbranch_scc1 L_abort
s_branch Lc_retry70sc1
Lc_retry80sc1:
buffer_load_dwordx4 v[44:47], v0, s[8:11], s52 offen sc1
s_waitcnt vmcnt(0)
v_cmp_eq_u32 vcc, -1, v44
s_cbranch_vccz Lc_back80sc1
s_add_u32 s21, s21, 1
s_cmp_ge_u32 s21, 4194304
s_cbranch_scc1 L_abort
s_branch Lc_retry80sc1
Lc_redo0sc1:
s_cmp_eq_u32 s48, s18
s_cbranch_scc1 Lc_redoback0sc1
s_mov_b32 s48, s18
s_waitcnt lgkmcnt(0)
s_nop 15
Lc_redo20sc1:
buffer_load_dwordx4 v[12:15], v0, s[8:11], s22 offen sc1
buffer_load_dwordx4 v[16:19], v0, s[8:11], s22 offen offset:1024 sc1
buffer_load_dwordx4 v[20:23], v0, s[8:11], s22 offen offset:2048 sc1
buffer_load_dwordx4 v[24:27], v0, s[8:11], s22 offen offset:3072 sc1
buffer_load_dwordx4 v[28:31], v0, s[8:11], s51 offen sc1
buffer_load_dwordx4 v[32:35], v0, s[8:11], s51 offen offset:1024 sc1
buffer_load_dwordx4 v[36:39], v0, s[8:11], s51 offen offset:2048 sc1
buffer_load_dwordx4 v[40:43], v0, s[8:11], s51 offen offset:3072 sc1
buffer_load_dwordx4 v[44:47], v0, s[8:11], s52 offen sc1
v_mov_b64 v[48:49], 0
v_mov_b64 v[50:51], 0
v_mov_b64 v[52:53], 0
v_mov_b64 v[54:55], 0
v_mov_b64 v[56:57], 0
v_mov_b64 v[58:59], 0
v_mov_b64 v[60:61], 0
v_mov_b64 v[62:63], 0
v_mov_b64 v[64:65], 0
v_mov_b64 v[66:67], 0
v_mov_b64 v[68:69], 0
v_mov_b64 v[70:71], 0
s_waitcnt vmcnt(0)
v_max_u32 v48, v12, v13
v_max3_u32 v48, v48, v14, v15
v_max3_u32 v48, v48, v16, v17
v_max3_u32 v48, v48, v18, v19
v_max3_u32 v48, v48, v20, v21
v_max3_u32 v48, v48, v22, v23
v_max3_u32 v48, v48, v24, v25
v_max3_u32 v48, v48, v26, v27
v_max3_u32 v48, v48, v28, v29
v_max3_u32 v48, v48, v30, v31
v_max3_u32 v48, v48, v32, v33
v_max3_u32 v48, v48, v34, v35
v_max3_u32 v48, v48, v36, v37
v_max3_u32 v48, v48, v38, v39
v_max3_u32 v48, v48, v40, v41
v_max3_u32 v48, v48, v42, v43
v_max3_u32 v48, v48, v44, v45
v_max3_u32 v48, v48, v46, v47
v_cmp_eq_u32 vcc, -1, v48
v_mov_b32 v48, 0
s_cbranch_vccnz Lc_redo30sc1
s_nop 0
v_smfmac_f32_16x16x64_bf16 v[48:51], v[12:15], a[0:7], v2
v_smfmac_f32_16x16x64_bf16 v[52:55], v[12:15], a[8:15], v2
v_smfmac_f32_16x16x64_bf16 v[56:59], v[12:15], a[16:23], v2
v_smfmac_f32_16x16x64_bf16 v[60:63], v[12:15], a[24:31], v2
v_smfmac_f32_16x16x64_bf16 v[64:67], v[12:15], v[80:87], v2
v_smfmac_f32_16x16x64_bf16 v[68:71], v[12:15], v[88:95], v2
v_smfmac_f32_16x16x64_bf16 v[48:51], v[16:19], a[32:39], v2
v_smfmac_f32_16x16x64_bf16 v[52:55], v[16:19], a[40:47], v2
v_smfmac_f32_16x16x64_bf16 v[56:59], v[16:19], a[48:55], v2
v_smfmac_f32_16x16x64_bf16 v[60:63], v[16:19], a[56:63], v2
v_smfmac_f32_16x16x64_bf16 v[64:67], v[16:19], v[96:103], v2
v_smfmac_f32_16x16x64_bf16 v[68:71], v[16:19], v[104:111], v2
v_smfmac_f32_16x16x64_bf16 v[48:51], v[20:23], a[64:71], v2
v_smfmac_f32_16x16x64_bf16 v[52:55], v[20:23], a[72:79], v2
v_smfmac_f32_16x16x64_bf16 v[56:59], v[20:23], a[80:87], v2
v_smfmac_f32_16x16x64_bf16 v[60:63], v[20:23], a[88:95], v2
v_smfmac_f32_16x16x64_bf16 v[64:67], v[20:23], v[112:119], v2
v_smfmac_f32_16x16x64_bf16 v[68:71], v[20:23], v[120:127], v2
v_smfmac_f32_16x16x64_bf16 v[48:51], v[24:27], a[96:103], v2
v_smfmac_f32_16x16x64_bf16 v[52:55], v[24:27], a[104:111], v2
v_smfmac_f32_16x16x64_bf16 v[56:59], v[24:27], a[112:119], v2
v_smfmac_f32_16x16x64_bf16 v[60:63], v[24:27], a[120:127], v2
v_smfmac_f32_16x16x64_bf16 v[64:67], v[24:27], v[128:135], v2
v_smfmac_f32_16x16x64_bf16 v[68:71], v[24:27], v[136:143], v2
v_smfmac_f32_16x16x64_bf16 v[48:51], v[28:31], a[128:135], v2
v_smfmac_f32_16x16x64_bf16 v[52:55], v[28:31], a[136:143], v2
v_smfmac_f32_16x16x64_bf16 v[56:59], v[28:31], a[144:151], v2
v_smfmac_f32_16x16x64_bf16 v[60:63], v[28:31], a[152:159], v2
v_smfmac_f32_16x16x64_bf16 v[48:51], v[32:35], a[160:167], v2
v_smfmac_f32_16x16x64_bf16 v[52:55], v[32:35], a[168:175], v2
v_smfmac_f32_16x16x64_bf16 v[56:59], v[32:35], a[176:183], v2
v_smfmac_f32_16x16x64_bf16 v[60:63], v[32:35], a[184:191], v2
v_smfmac_f32_16x16x64_bf16 v[48:51], v[36:39], a[192:199], v2
v_smfmac_f32_16x16x64_bf16 v[52:55], v[36:39], a[200:207], v2
v_smfmac_f32_16x16x64_bf16 v[56:59], v[36:39], a[208:215], v2
v_smfmac_f32_16x16x64_bf16 v[60:63], v[36:39], a[216:223], v2
v_smfmac_f32_16x16x64_bf16 v[48:51], v[40:43], a[224:231], v2
v_smfmac_f32_16x16x64_bf16 v[52:55], v[40:43], a[232:239], v2
v_smfmac_f32_16x16x64_bf16 v[56:59], v[40:43], a[240:247], v2
v_smfmac_f32_16x16x64_bf16 v[60:63], v[40:43], a[248:255], v2
v_smfmac_f32_16x16x64_bf16 v[48:51], v[44:47], v[224:231], v2
v_smfmac_f32_16x16x64_bf16 v[52:55], v[44:47], v[232:239], v2
v_smfmac_f32_16x16x64_bf16 v[56:59], v[44:47], v[240:247], v2
v_smfmac_f32_16x16x64_bf16 v[60:63], v[44:47], v[248:255], v2
s_nop 7
v_add_f32 v48, v48, v50
v_add_f32 v49, v49, v51
v_add_f32 v52, v52, v54
v_add_f32 v53, v53, v55
s_branch Lc_post0sc1
Lc_redo30sc1:
s_add_u32 s21, s21, 1
s_cmp_ge_u32 s21, 4194304
s_cbranch_scc1 L_abort
s_branch Lc_redo20sc1
.p2align 6
s_nop 0
s_nop 0
Lc_top1sc1:
buffer_load_dwordx4 v0, s[8:11], s22 offen offset:1024 sc1 lds
ds_read_b128 v[12:15], v0 offset:16384
ds_read_b128 v[16:19], v0 offset:17408
s_add_u32 s21, s21, 1
s_cmp_ge_u32 s21, 4194304
s_cbranch_scc1 L_abort
s_waitcnt lgkmcnt(0)
v_max_u32 v43, v12, v16
v_cmp_eq_u32 vcc, -1, v43
s_cbranch_vccnz Lc_top1sc1
v_smfmac_f32_16x16x64_bf16 v[48:51], v[12:15], a[0:7], v2
v_smfmac_f32_16x16x64_bf16 v[52:55], v[12:15], a[8:15], v2
v_smfmac_f32_16x16x64_bf16 v[56:59], v[12:15], a[16:23], v2
buffer_load_dwordx4 v[28:31], v0, s[8:11], s51 offen sc1
v_smfmac_f32_16x16x64_bf16 v[60:63], v[12:15], a[24:31], v2
v_smfmac_f32_16x16x64_bf16 v[64:67], v[12:15], v[80:87], v2
ds_read_b128 v[20:23], v0 offset:18432
v_smfmac_f32_16x16x64_bf16 v[68:71], v[12:15], v[88:95], v2
v_smfmac_f32_16x16x64_bf16 v[48:51], v[16:19], a[32:39], v2
buffer_load_dwordx4 v[32:35], v0, s[8:11], s51 offen offset:1024 sc1
v_smfmac_f32_16x16x64_bf16 v[52:55], v[16:19], a[40:47], v2
v_smfmac_f32_16x16x64_bf16 v[56:59], v[16:19], a[48:55], v2
v_smfmac_f32_16x16x64_bf16 v[60:63], v[16:19], a[56:63], v2
ds_read_b128 v[24:27], v0 offset:19456
s_waitcnt lgkmcnt(1)
v_cmp_eq_u32 vcc, -1, v20
v_smfmac_f32_16x16x64_bf16 v[64:67], v[16:19], v[96:103], v2
buffer_load_dwordx4 v[36:39], v0, s[8:11], s51 offen offset:2048 sc1
v_smfmac_f32_16x16x64_bf16 v[68:71], v[16:19], v[104:111], v2
s_cbranch_vccnz Lc_retry21sc1
Lc_back21sc1:
v_smfmac_f32_16x16x64_bf16 v[48:51], v[20:23], a[64:71], v2
v_smfmac_f32_16x16x64_bf16 v[52:55], v[20:23], a[72:79], v2
v_smfmac_f32_16x16x64_bf16 v[56:59], v[20:23], a[80:87], v2
buffer_load_dwordx4 v[40:43], v0, s[8:11], s51 offen offset:3072 sc1
v_smfmac_f32_16x16x64_bf16 v[60:63], v[20:23], a[88:95], v2
s_waitcnt lgkmcnt(0)
v_cmp_eq_u32 vcc, -1, v24
v_smfmac_f32_16x16x64_bf16 v[64:67], v[20:23], v[112:119], v2
v_smfmac_f32_16x16x64_bf16 v[68:71], v[20:23], v[120:127], v2
buffer_load_dwordx4 v[44:47], v0, s[8:11], s52 offen sc1
s_cbranch_vccnz Lc_retry31sc1
Lc_back31sc1:
v_smfmac_f32_16x16x64_bf16 v[48:51], v[24:27], a[96:103], v2
s_waitcnt vmcnt(5)
s_barrier
v_smfmac_f32_16x16x64_bf16 v[52:55], v[24:27], a[104:111], v2
s_waitcnt vmcnt(4)
v_cmp_eq_u32 vcc, -1, v28
v_smfmac_f32_16x16x64_bf16 v[56:59], v[24:27], a[112:119], v2
ds_read_b128 v[12:15], v0
v_smfmac_f32_16x16x64_bf16 v[60:63], v[24:27], a[120:127], v2
ds_read_b128 v[16:19], v0 offset:4096
s_cbranch_vccnz Lc_retry41sc1
Lc_back41sc1:
v_smfmac_f32_16x16x64_bf16 v[48:51], v[28:31], a[128:135], v2
ds_read_b128 v[20:23], v0 offset:1024
v_smfmac_f32_16x16x64_bf16 v[52:55], v[28:31], a[136:143], v2
s_waitcnt vmcnt(3)
v_cmp_eq_u32 vcc, -1, v32
v_smfmac_f32_16x16x64_bf16 v[56:59], v[28:31], a[144:151], v2
v_smfmac_f32_16x16x64_bf16 v[60:63], v[28:31], a[152:159], v2
s_cbranch_vccnz Lc_retry51sc1
Lc_back51sc1:
v_smfmac_f32_16x16x64_bf16 v[48:51], v[32:35], a[160:167], v2
v_smfmac_f32_16x16x64_bf16 v[52:55], v[32:35], a[168:175], v2
s_waitcnt vmcnt(2)
v_cmp_eq_u32 vcc, -1, v36
v_smfmac_f32_16x16x64_bf16 v[56:59], v[32:35], a[176:183], v2
v_smfmac_f32_16x16x64_bf16 v[60:63], v[32:35], a[184:191], v2
s_cbranch_vccnz Lc_retry61sc1
Lc_back61sc1:
v_smfmac_f32_16x16x64_bf16 v[48:51], v[36:39], a[192:199], v2
v_smfmac_f32_16x16x64_bf16 v[52:55], v[36:39], a[200:207], v2
s_waitcnt vmcnt(1)
v_cmp_eq_u32 vcc, -1, v40
v_smfmac_f32_16x16x64_bf16 v[56:59], v[36:39], a[208:215], v2
v_smfmac_f32_16x16x64_bf16 v[60:63], v[36:39], a[216:223], v2
s_cbranch_vccnz Lc_retry71sc1
Lc_back71sc1:
v_smfmac_f32_16x16x64_bf16 v[48:51], v[40:43], a[224:231], v2
v_smfmac_f32_16x16x64_bf16 v[52:55], v[40:43], a[232:239], v2
s_waitcnt vmcnt(0)
v_cmp_eq_u32 vcc, -1, v44
v_smfmac_f32_16x16x64_bf16 v[56:59], v[40:43], a[240:247], v2
v_smfmac_f32_16x16x64_bf16 v[60:63], v[40:43], a[248:255], v2
s_cbranch_vccnz Lc_retry81sc1
Lc_back81sc1:
v_smfmac_f32_16x16x64_bf16 v[48:51], v[44:47], v[224:231], v2
v_smfmac_f32_16x16x64_bf16 v[52:55], v[44:47], v[232:239], v2
v_smfmac_f32_16x16x64_bf16 v[56:59], v[44:47], v[240:247], v2
v_add_f32 v48, v48, v50
v_smfmac_f32_16x16x64_bf16 v[60:63], v[44:47], v[248:255], v2
v_add_f32 v49, v49, v51
v_smfmac_f32_16x16x64_bf16 v[64:67], v[24:27], v[128:135], v2
v_add_f32 v52, v52, v54
v_smfmac_f32_16x16x64_bf16 v[68:71], v[24:27], v[136:143], v2
v_add_f32 v53, v53, v55
Lc_post1sc1:
v_add_f32 v56, v56, v58
v_add_f32 v60, v60, v62
v_cvt_pk_bf16_f32 v50, v48, v52
v_cvt_pk_bf16_f32 v51, v56, v60
v_xor_b32 v58, 16, v3
ds_write_b64 v3, v[50:51] offset:16384
v_add_f32 v57, v57, v59
v_add_f32 v61, v61, v63
v_cvt_pk_bf16_f32 v54, v49, v53
v_cvt_pk_bf16_f32 v55, v57, v61
ds_write_b64 v58, v[54:55] offset:16384
v_cmp_u_f32 vcc, v48, v49
v_smfmac_f32_16x16x64_bf16 v[64:67], v[28:31], v[144:151], v2
v_smfmac_f32_16x16x64_bf16 v[68:71], v[28:31], v[152:159], v2
s_cbranch_vccnz Lc_redo1sc1
Lc_redoback1sc1:
v_smfmac_f32_16x16x64_bf16 v[64:67], v[32:35], v[160:167], v2
s_cmp_lt_u32 s96, 3
v_smfmac_f32_16x16x64_bf16 v[68:71], v[32:35], v[168:175], v2
s_cbranch_scc1 Lc_hist1sc1
Lc_histback1sc1:
v_xor_b32 v32, 64, v4
s_waitcnt lgkmcnt(0)
s_barrier
ds_read_b128 v[28:31], v4 offset:16384
ds_read_b128 v[32:35], v32 offset:17408
ds_read_b128 v[56:59], v0 offset:5120
v_smfmac_f32_16x16x64_bf16 v[64:67], v[36:39], v[176:183], v2
s_cmp_eq_u32 s18, 62
v_smfmac_f32_16x16x64_bf16 v[68:71], v[36:39], v[184:191], v2
s_cbranch_scc1 Lc_km1sc1
Lc_kmb1sc1:
ds_read_b128 v[36:39], v4 offset:18432
ds_read_b128 v[60:63], v0 offset:2048
ds_read_b128 v[24:27], v0 offset:6144
v_smfmac_f32_16x16x64_bf16 v[64:67], v[40:43], v[192:199], v2
v_smfmac_f32_16x16x64_bf16 v[68:71], v[40:43], v[200:207], v2
v_xor_b32 v40, 64, v4
ds_read_b128 v[40:43], v40 offset:19456
v_smfmac_f32_16x16x64_bf16 v[64:67], v[44:47], v[208:215], v2
v_smfmac_f32_16x16x64_bf16 v[68:71], v[44:47], v[216:223], v2
s_waitcnt lgkmcnt(6)
v_mfma_f32_16x16x32_bf16 v[48:51], v[12:15], v[28:31], 0
ds_read_b128 v[12:15], v0 offset:3072
v_mfma_f32_16x16x32_bf16 v[52:55], v[16:19], v[28:31], 0
ds_read_b128 v[16:19], v0 offset:7168
v_mfma_f32_16x16x32_bf16 v[44:47], v[28:31], v[28:31], 0
s_waitcnt lgkmcnt(6)
v_mfma_f32_16x16x32_bf16 v[48:51], v[20:23], v[32:35], v[48:51]
v_add_f32 v64, v64, v66
v_add_f32 v65, v65, v67
v_mfma_f32_16x16x32_bf16 v[52:55], v[56:59], v[32:35], v[52:55]
v_add_f32 v68, v68, v70
ds_read_b128 v[56:59], v0 offset:10240
v_mfma_f32_16x16x32_bf16 v[44:47], v[32:35], v[32:35], v[44:47]
v_add_f32 v69, v69, v71
v_cvt_pk_bf16_f32 v66, v64, v65
s_waitcnt lgkmcnt(4)
v_mfma_f32_16x16x32_bf16 v[48:51], v[60:63], v[36:39], v[48:51]
v_cvt_pk_bf16_f32 v67, v68, v69
ds_read_b128 v[60:63], v0 offset:11264
v_mfma_f32_16x16x32_bf16 v[52:55], v[24:27], v[36:39], v[52:55]
ds_read_b128 v[28:31], v1
s_cmp_eq_u32 s18, 62
v_mfma_f32_16x16x32_bf16 v[44:47], v[36:39], v[36:39], v[44:47]
ds_read_b128 v[32:35], v1 offset:1024
s_cbranch_scc1 Lc_vm1sc1
Lc_vmb1sc1:
s_waitcnt lgkmcnt(4)
v_mfma_f32_16x16x32_bf16 v[44:47], v[40:43], v[40:43], v[44:47]
s_barrier
v_mfma_f32_16x16x32_bf16 v[48:51], v[12:15], v[40:43], v[48:51]
ds_read_b128 v[20:23], v1 offset:2048
v_mfma_f32_16x16x32_bf16 v[52:55], v[16:19], v[40:43], v[52:55]
ds_read_b128 v[24:27], v1 offset:3072
v_mov_b32 v36, -1
v_mov_b32 v37, -1
v_mov_b32 v38, -1
v_max3_f32 v64, v46, v47, v48
v_max3_f32 v64, v64, v49, v50
v_mov_b32 v39, -1
s_nop 0
v_max3_f32 v65, v51, v52, v53
v_max3_f32 v65, v65, v54, v55
v_max_f32 v44, v64, v65
v_max_f32 v65, v64, v65
ds_read_b128 v[12:15], v1 offset:4096
ds_read_b128 v[16:19], v1 offset:5120
v_permlane32_swap_b32 v44, v65
v_max_f32 v64, v44, v65
v_max_f32 v65, v44, v65
s_mov_b32 s20, s24
s_bitcmp0_b32 s18, 1
v_permlane16_swap_b32 v64, v65
v_max_f32 v64, v64, v65
v_fma_f32 v64, v64, s30, v5
v_pk_fma_f32 v[46:47], v[46:47], s[30:31], v[64:65] op_sel_hi:[1,1,0] neg_lo:[0,0,1] neg_hi:[0,0,1]
v_pk_fma_f32 v[48:49], v[48:49], s[30:31], v[64:65] op_sel_hi:[1,1,0] neg_lo:[0,0,1] neg_hi:[0,0,1]
v_pk_fma_f32 v[50:51], v[50:51], s[30:31], v[64:65] op_sel_hi:[1,1,0] neg_lo:[0,0,1] neg_hi:[0,0,1]
v_pk_fma_f32 v[52:53], v[52:53], s[30:31], v[64:65] op_sel_hi:[1,1,0] neg_lo:[0,0,1] neg_hi:[0,0,1]
v_pk_fma_f32 v[54:55], v[54:55], s[30:31], v[64:65] op_sel_hi:[1,1,0] neg_lo:[0,0,1] neg_hi:[0,0,1]
v_exp_f32 v46, v46
v_exp_f32 v47, v47
v_exp_f32 v48, v48
v_cvt_pk_bf16_f32 v44, v46, v47
v_exp_f32 v49, v49
v_exp_f32 v50, v50
v_mov_b32_dpp v45, v44 quad_perm:[2,3,0,1] row_mask:0xf bank_mask:0xf
v_exp_f32 v51, v51
v_cvt_pk_bf16_f32 v48, v48, v49
v_mfma_f32_16x16x16_bf16 v[40:43], v[66:67], v[44:45], 0
ds_write_b128 v0, v[36:39] offset:17408
v_exp_f32 v52, v52
v_mfma_f32_16x16x16_bf16 v[68:71], v[8:9], v[44:45], 0
v_exp_f32 v53, v53
v_cvt_pk_bf16_f32 v49, v50, v51
v_exp_f32 v54, v54
v_exp_f32 v55, v55
v_cvt_pk_bf16_f32 v50, v52, v53
v_mov_b32_dpp v52, v48 quad_perm:[2,3,0,1] row_mask:0xf bank_mask:0xf
v_cvt_pk_bf16_f32 v51, v54, v55
v_mov_b32_dpp v53, v49 quad_perm:[2,3,0,1] row_mask:0xf bank_mask:0xf
s_cselect_b32 s32, -1, 0
s_waitcnt lgkmcnt(7)
v_mfma_f32_16x16x32_bf16 v[68:71], v[8:11], v[48:51], v[68:71]
v_mov_b32_dpp v54, v50 quad_perm:[2,3,0,1] row_mask:0xf bank_mask:0xf
v_mov_b32_dpp v55, v51 quad_perm:[2,3,0,1] row_mask:0xf bank_mask:0xf
v_mfma_f32_16x16x32_bf16 v[40:43], v[56:59], v[48:51], v[40:43]
s_mov_b32 s53, s25
s_add_u32 s55, s22, s34
v_mfma_f32_16x16x32_bf16 v[40:43], v[60:63], v[52:55], v[40:43]
s_add_u32 s49, s23, s34
s_add_u32 s38, s38, 64
ds_read_b128 v[44:47], v1 offset:6144
ds_read_b128 v[48:51], v1 offset:7168
v_rcp_f32 v56, v68
s_add_u32 s18, s18, 1
s_add_u32 s27, s27, 9216
v_mov_b32_dpp v56, v56 quad_perm:[0,1,0,1] row_mask:0xf bank_mask:0xf
v_pk_mul_f32 v[40:41], v[40:41], v[56:57] op_sel_hi:[1,0]
v_pk_mul_f32 v[42:43], v[42:43], v[56:57] op_sel_hi:[1,0]
v_cvt_pk_bf16_f32 v40, v40, v41
v_cvt_pk_bf16_f32 v41, v42, v43
ds_write_b64 v7, v[40:41] offset:20992
v_or_b32 v36, v7, v5
ds_read_b128 v[64:67], v1 offset:8192
ds_read_b128 v[68:71], v1 offset:9216
s_mov_b32 s22, s23
s_add_u32 s23, s23, 9216
s_waitcnt lgkmcnt(2)
s_barrier
ds_read_b128 v[8:11], v36 offset:20992
ds_read_b128 v[36:39], v36 offset:20480
ds_read_b128 v[40:43], v0 offset:21504
s_cmp_eq_u32 s23, 12610560
s_cselect_b32 s23, 12582912, s23
s_add_u32 s24, s24, s33
s_add_u32 s25, s25, s33
s_sub_u32 s33, 0, s33
s_add_u32 s51, s22, 4096
s_add_u32 s52, s22, 8192
s_waitcnt lgkmcnt(1)
v_mfma_f32_16x16x32_bf16 v[52:55], v[36:39], v[72:75], 0
v_mfma_f32_16x16x32_bf16 v[52:55], v[8:11], v[76:79], v[52:55]
s_waitcnt lgkmcnt(0)
v_smfmac_f32_16x16x64_bf16 v[52:55], v[40:43], v[28:35], v2
ds_read_b128 v[28:31], v1 offset:10240
ds_read_b128 v[32:35], v1 offset:11264
v_mfma_f32_16x16x32_bf16 v[56:59], v[36:39], v[20:23], 0
v_mfma_f32_16x16x32_bf16 v[56:59], v[8:11], v[24:27], v[56:59]
ds_read_b128 v[20:23], v1 offset:12288
v_add_f32 v52, v52, v54
v_smfmac_f32_16x16x64_bf16 v[56:59], v[40:43], v[12:19], v2
ds_read_b128 v[24:27], v1 offset:13312
ds_read_b128 v[12:15], v1 offset:14336
v_add_f32 v53, v53, v55
v_cvt_pk_bf16_f32 v54, v52, v53
v_bfi_b32 v54, -2, v54, s32
s_nop 2
v_add_f32 v56, v56, v58
v_add_f32 v57, v57, v59
v_cvt_pk_bf16_f32 v55, v56, v57
buffer_store_dwordx2 v[54:55], v6, s[8:11], s20 offen sc1
s_add_u32 s20, s20, 49152
v_mfma_f32_16x16x32_bf16 v[60:63], v[36:39], v[44:47], 0
ds_read_b128 v[16:19], v1 offset:15360
v_mfma_f32_16x16x32_bf16 v[60:63], v[8:11], v[48:51], v[60:63]
ds_read_b128 v[44:47], v1 offset:16384
v_smfmac_f32_16x16x64_bf16 v[60:63], v[40:43], v[64:71], v2
ds_read_b128 v[48:51], v1 offset:17408
ds_read_b128 v[64:67], v1 offset:18432
s_waitcnt lgkmcnt(7)
v_mfma_f32_16x16x32_bf16 v[52:55], v[36:39], v[28:31], 0
ds_read_b128 v[68:71], v1 offset:19456
v_mfma_f32_16x16x32_bf16 v[52:55], v[8:11], v[32:35], v[52:55]
ds_read_b128 v[28:31], v1 offset:20480
s_waitcnt lgkmcnt(7)
v_smfmac_f32_16x16x64_bf16 v[52:55], v[40:43], v[20:27], v2
ds_read_b128 v[32:35], v1 offset:21504
ds_read_b128 v[20:23], v1 offset:22528
s_waitcnt lgkmcnt(7)
v_mfma_f32_16x16x32_bf16 v[56:59], v[36:39], v[12:15], 0
ds_read_b128 v[24:27], v1 offset:23552
v_add_f32 v60, v60, v62
v_mfma_f32_16x16x32_bf16 v[56:59], v[8:11], v[16:19], v[56:59]
ds_read_b128 v[12:15], v1 offset:24576
v_add_f32 v61, v61, v63
s_waitcnt lgkmcnt(7)
v_smfmac_f32_16x16x64_bf16 v[56:59], v[40:43], v[44:51], v2
ds_read_b128 v[16:19], v1 offset:25600
ds_read_b128 v[44:47], v1 offset:26624
v_add_f32 v52, v52, v54
v_cvt_pk_bf16_f32 v54, v60, v61
v_add_f32 v53, v53, v55
s_waitcnt lgkmcnt(7)
v_mfma_f32_16x16x32_bf16 v[60:63], v[36:39], v[64:67], 0
ds_read_b128 v[48:51], v1 offset:27648
v_bfi_b32 v54, -2, v54, s32
v_mfma_f32_16x16x32_bf16 v[60:63], v[8:11], v[68:71], v[60:63]
ds_read_b128 v[64:67], v1 offset:28672
v_cvt_pk_bf16_f32 v55, v52, v53
s_waitcnt lgkmcnt(7)
v_smfmac_f32_16x16x64_bf16 v[60:63], v[40:43], v[28:35], v2
ds_read_b128 v[68:71], v1 offset:29696
ds_read_b128 v[28:31], v1 offset:30720
buffer_store_dwordx2 v[54:55], v6, s[8:11], s20 offen sc1
s_add_u32 s20, s20, 49152
s_waitcnt lgkmcnt(7)
v_mfma_f32_16x16x32_bf16 v[52:55], v[36:39], v[20:23], 0
ds_read_b128 v[32:35], v1 offset:31744
v_add_f32 v56, v56, v58
v_mfma_f32_16x16x32_bf16 v[52:55], v[8:11], v[24:27], v[52:55]
ds_read_b128 v[20:23], v1 offset:32768
v_add_f32 v57, v57, v59
s_waitcnt lgkmcnt(7)
v_smfmac_f32_16x16x64_bf16 v[52:55], v[40:43], v[12:19], v2
ds_read_b128 v[24:27], v1 offset:33792
ds_read_b128 v[12:15], v1 offset:34816
v_add_f32 v60, v60, v62
v_cvt_pk_bf16_f32 v62, v56, v57
v_add_f32 v61, v61, v63
s_waitcnt lgkmcnt(7)
v_mfma_f32_16x16x32_bf16 v[56:59], v[36:39], v[44:47], 0
ds_read_b128 v[16:19], v1 offset:35840
v_bfi_b32 v62, -2, v62, s32
v_mfma_f32_16x16x32_bf16 v[56:59], v[8:11], v[48:51], v[56:59]
ds_read_b128 v[44:47], v1 offset:36864
v_cvt_pk_bf16_f32 v63, v60, v61
s_waitcnt lgkmcnt(7)
v_smfmac_f32_16x16x64_bf16 v[56:59], v[40:43], v[64:71], v2
ds_read_b128 v[48:51], v1 offset:37888
ds_read_b128 v[64:67], v1 offset:38912
buffer_store_dwordx2 v[62:63], v6, s[8:11], s20 offen sc1
s_add_u32 s20, s20, 49152
s_waitcnt lgkmcnt(7)
v_mfma_f32_16x16x32_bf16 v[60:63], v[36:39], v[28:31], 0
ds_read_b128 v[68:71], v1 offset:39936
v_add_f32 v52, v52, v54
v_mfma_f32_16x16x32_bf16 v[60:63], v[8:11], v[32:35], v[60:63]
ds_read_b128 v[28:31], v1 offset:40960
v_add_f32 v53, v53, v55
s_waitcnt lgkmcnt(7)
v_smfmac_f32_16x16x64_bf16 v[60:63], v[40:43], v[20:27], v2
ds_read_b128 v[32:35], v1 offset:41984
ds_read_b128 v[20:23], v1 offset:43008
v_add_f32 v56, v56, v58
v_cvt_pk_bf16_f32 v58, v52, v53
v_add_f32 v57, v57, v59
s_waitcnt lgkmcnt(7)
v_mfma_f32_16x16x32_bf16 v[52:55], v[36:39], v[12:15], 0
ds_read_b128 v[24:27], v1 offset:44032
v_bfi_b32 v58, -2, v58, s32
v_mfma_f32_16x16x32_bf16 v[52:55], v[8:11], v[16:19], v[52:55]
ds_read_b128 v[12:15], v1 offset:45056
v_cvt_pk_bf16_f32 v59, v56, v57
s_waitcnt lgkmcnt(7)
v_smfmac_f32_16x16x64_bf16 v[52:55], v[40:43], v[44:51], v2
ds_read_b128 v[16:19], v1 offset:46080
buffer_store_dwordx2 v[58:59], v6, s[8:11], s20 offen sc1
s_add_u32 s20, s20, 49152
s_waitcnt lgkmcnt(6)
v_mfma_f32_16x16x32_bf16 v[56:59], v[36:39], v[64:67], 0
v_add_f32 v60, v60, v62
v_mfma_f32_16x16x32_bf16 v[56:59], v[8:11], v[68:71], v[56:59]
v_add_f32 v61, v61, v63
s_waitcnt lgkmcnt(4)
v_smfmac_f32_16x16x64_bf16 v[56:59], v[40:43], v[28:35], v2
v_add_f32 v52, v52, v54
v_cvt_pk_bf16_f32 v54, v60, v61
v_add_f32 v53, v53, v55
s_waitcnt lgkmcnt(2)
v_mfma_f32_16x16x32_bf16 v[60:63], v[36:39], v[20:23], 0
v_bfi_b32 v54, -2, v54, s32
v_mfma_f32_16x16x32_bf16 v[60:63], v[8:11], v[24:27], v[60:63]
v_cvt_pk_bf16_f32 v55, v52, v53
s_waitcnt lgkmcnt(0)
v_smfmac_f32_16x16x64_bf16 v[60:63], v[40:43], v[12:19], v2
buffer_store_dwordx2 v[54:55], v6, s[8:11], s20 offen sc1
s_add_u32 s20, s20, 49152
s_add_u32 s26, s26, 524288
s_mov_b32 m0, 16384
v_mov_b64 v[48:49], 0
v_mov_b64 v[50:51], 0
v_mov_b64 v[52:53], 0
v_mov_b64 v[54:55], 0
v_mov_b64 v[64:65], 0
v_mov_b64 v[66:67], 0
v_mov_b64 v[68:69], 0
v_mov_b64 v[70:71], 0
v_add_f32 v56, v56, v58
v_add_f32 v57, v57, v59
v_add_f32 v60, v60, v62
v_cvt_pk_bf16_f32 v62, v56, v57
v_add_f32 v61, v61, v63
v_bfi_b32 v62, -2, v62, s32
v_cvt_pk_bf16_f32 v63, v60, v61
buffer_store_dwordx2 v[62:63], v6, s[8:11], s20 offen sc1
v_mov_b32 v8, 0x3f803f80
v_mov_b32 v9, v8
v_mov_b64 v[10:11], v[8:9]
v_mov_b64 v[56:57], 0
v_mov_b64 v[58:59], 0
v_mov_b64 v[60:61], 0
v_mov_b64 v[62:63], 0
s_cmp_eq_u32 s18, 40
s_cbranch_scc1 Lc_pre1sc1
Lc_preb1sc1:
s_mov_b32 s75, 0
s_mov_b32 s19, s74
Lc_dl1sc1:
s_sub_u32 s19, s19, 1
s_cbranch_scc0 Lc_dl1sc1
s_cmp_eq_u32 s18, 63
s_cbranch_scc0 Lc_top1sc1
s_waitcnt vmcnt(0)
s_lshl_b32 s19, s17, 5
s_add_u32 s19, s19, 129032
buffer_store_dword v2, off, s[8:11], s19 sc1
buffer_store_dword v2, off, s[8:11], s19 offset:4 sc1
s_branch Lc_topL1
Lc_hist1sc1:
s_cmp_eq_u32 s96, 0
s_cbranch_scc0 Lc_hist11sc1
buffer_store_dwordx4 v[24:27], v0, s[8:11], s27 offen sc1
s_nop 0
s_branch Lc_histback1sc1
Lc_hist11sc1:
s_cmp_eq_u32 s96, 1
s_cbranch_scc0 Lc_hist21sc1
buffer_store_dwordx4 v[28:31], v0, s[8:11], s27 offen sc1
s_nop 0
s_branch Lc_histback1sc1
Lc_hist21sc1:
buffer_store_dwordx4 v[32:35], v0, s[8:11], s27 offen sc1
s_nop 0
s_branch Lc_histback1sc1
Lc_km1sc1:
v_bfe_u32 v48, v0, 7, 1
v_lshlrev_b32 v48, 9, v48
v_bfe_u32 v49, v0, 5, 2
v_lshl_add_u32 v48, v49, 7, v48
v_lshrrev_b32 v49, 8, v0
v_lshl_add_u32 v48, v49, 5, v48
v_bfe_u32 v49, v0, 4, 1
v_lshl_add_u32 v48, v49, 3, v48
s_mul_i32 s19, s17, 4096
s_add_u32 s19, s19, 24904704
buffer_store_dwordx2 v[50:51], v48, s[8:11], s19 offen sc1
buffer_store_dwordx2 v[54:55], v48, s[8:11], s19 offen offset:16 sc1
s_branch Lc_kmb1sc1
Lc_vm1sc1:
v_lshrrev_b32 v64, 1, v0
s_mul_i32 s19, s17, 4096
s_add_u32 s19, s19, 24906240
buffer_store_dwordx2 v[66:67], v64, s[8:11], s19 offen sc1
s_branch Lc_vmb1sc1
Lc_pre1sc1:
v_mov_b32 v12, 0
global_load_dword v13, v12, s[6:7] offset:104 sc1
s_waitcnt vmcnt(0)
v_cmp_gt_u32 vcc, 28, v13
s_cbranch_vccz Lc_preb1sc1
s_add_u32 s21, s21, 1
s_cmp_ge_u32 s21, 4194304
s_cbranch_scc1 L_abort
s_branch Lc_pre1sc1
Lc_retry21sc1:
buffer_load_dwordx4 v0, s[8:11], s22 offen offset:2048 sc1 lds
ds_read_b128 v[20:23], v0 offset:18432
s_add_u32 s21, s21, 1
s_cmp_ge_u32 s21, 4194304
s_cbranch_scc1 L_abort
s_waitcnt lgkmcnt(0)
v_cmp_eq_u32 vcc, -1, v20
s_cbranch_vccnz Lc_retry21sc1
s_waitcnt vmcnt(0)
s_branch Lc_back21sc1
Lc_retry31sc1:
buffer_load_dwordx4 v0, s[8:11], s22 offen offset:3072 sc1 lds
ds_read_b128 v[24:27], v0 offset:19456
s_add_u32 s21, s21, 1
s_cmp_ge_u32 s21, 4194304
s_cbranch_scc1 L_abort
s_waitcnt lgkmcnt(0)
v_cmp_eq_u32 vcc, -1, v24
s_cbranch_vccnz Lc_retry31sc1
s_waitcnt vmcnt(0)
s_branch Lc_back31sc1
Lc_retry41sc1:
buffer_load_dwordx4 v[28:31], v0, s[8:11], s51 offen sc1
s_waitcnt vmcnt(0)
v_cmp_eq_u32 vcc, -1, v28
s_cbranch_vccz Lc_back41sc1
s_add_u32 s21, s21, 1
s_cmp_ge_u32 s21, 4194304
s_cbranch_scc1 L_abort
s_branch Lc_retry41sc1
Lc_retry51sc1:
buffer_load_dwordx4 v[32:35], v0, s[8:11], s51 offen offset:1024 sc1
s_waitcnt vmcnt(0)
v_cmp_eq_u32 vcc, -1, v32
s_cbranch_vccz Lc_back51sc1
s_add_u32 s21, s21, 1
s_cmp_ge_u32 s21, 4194304
s_cbranch_scc1 L_abort
s_branch Lc_retry51sc1
Lc_retry61sc1:
buffer_load_dwordx4 v[36:39], v0, s[8:11], s51 offen offset:2048 sc1
s_waitcnt vmcnt(0)
v_cmp_eq_u32 vcc, -1, v36
s_cbranch_vccz Lc_back61sc1
s_add_u32 s21, s21, 1
s_cmp_ge_u32 s21, 4194304
s_cbranch_scc1 L_abort
s_branch Lc_retry61sc1
Lc_retry71sc1:
buffer_load_dwordx4 v[40:43], v0, s[8:11], s51 offen offset:3072 sc1
s_waitcnt vmcnt(0)
v_cmp_eq_u32 vcc, -1, v40
s_cbranch_vccz Lc_back71sc1
s_add_u32 s21, s21, 1
s_cmp_ge_u32 s21, 4194304
s_cbranch_scc1 L_abort
s_branch Lc_retry71sc1
Lc_retry81sc1:
buffer_load_dwordx4 v[44:47], v0, s[8:11], s52 offen sc1
s_waitcnt vmcnt(0)
v_cmp_eq_u32 vcc, -1, v44
s_cbranch_vccz Lc_back81sc1
s_add_u32 s21, s21, 1
s_cmp_ge_u32 s21, 4194304
s_cbranch_scc1 L_abort
s_branch Lc_retry81sc1
Lc_redo1sc1:
s_cmp_eq_u32 s48, s18
s_cbranch_scc1 Lc_redoback1sc1
s_mov_b32 s48, s18
s_waitcnt lgkmcnt(0)
s_nop 15
Lc_redo21sc1:
buffer_load_dwordx4 v[12:15], v0, s[8:11], s22 offen sc1
buffer_load_dwordx4 v[16:19], v0, s[8:11], s22 offen offset:1024 sc1
buffer_load_dwordx4 v[20:23], v0, s[8:11], s22 offen offset:2048 sc1
buffer_load_dwordx4 v[24:27], v0, s[8:11], s22 offen offset:3072 sc1
buffer_load_dwordx4 v[28:31], v0, s[8:11], s51 offen sc1
buffer_load_dwordx4 v[32:35], v0, s[8:11], s51 offen offset:1024 sc1
buffer_load_dwordx4 v[36:39], v0, s[8:11], s51 offen offset:2048 sc1
buffer_load_dwordx4 v[40:43], v0, s[8:11], s51 offen offset:3072 sc1
buffer_load_dwordx4 v[44:47], v0, s[8:11], s52 offen sc1
v_mov_b64 v[48:49], 0
v_mov_b64 v[50:51], 0
v_mov_b64 v[52:53], 0
v_mov_b64 v[54:55], 0
v_mov_b64 v[56:57], 0
v_mov_b64 v[58:59], 0
v_mov_b64 v[60:61], 0
v_mov_b64 v[62:63], 0
v_mov_b64 v[64:65], 0
v_mov_b64 v[66:67], 0
v_mov_b64 v[68:69], 0
v_mov_b64 v[70:71], 0
s_waitcnt vmcnt(0)
v_max_u32 v48, v12, v13
v_max3_u32 v48, v48, v14, v15
v_max3_u32 v48, v48, v16, v17
v_max3_u32 v48, v48, v18, v19
v_max3_u32 v48, v48, v20, v21
v_max3_u32 v48, v48, v22, v23
v_max3_u32 v48, v48, v24, v25
v_max3_u32 v48, v48, v26, v27
v_max3_u32 v48, v48, v28, v29
v_max3_u32 v48, v48, v30, v31
v_max3_u32 v48, v48, v32, v33
v_max3_u32 v48, v48, v34, v35
v_max3_u32 v48, v48, v36, v37
v_max3_u32 v48, v48, v38, v39
v_max3_u32 v48, v48, v40, v41
v_max3_u32 v48, v48, v42, v43
v_max3_u32 v48, v48, v44, v45
v_max3_u32 v48, v48, v46, v47
v_cmp_eq_u32 vcc, -1, v48
v_mov_b32 v48, 0
s_cbranch_vccnz Lc_redo31sc1
s_nop 0
v_smfmac_f32_16x16x64_bf16 v[48:51], v[12:15], a[0:7], v2
v_smfmac_f32_16x16x64_bf16 v[52:55], v[12:15], a[8:15], v2
v_smfmac_f32_16x16x64_bf16 v[56:59], v[12:15], a[16:23], v2
v_smfmac_f32_16x16x64_bf16 v[60:63], v[12:15], a[24:31], v2
v_smfmac_f32_16x16x64_bf16 v[64:67], v[12:15], v[80:87], v2
v_smfmac_f32_16x16x64_bf16 v[68:71], v[12:15], v[88:95], v2
v_smfmac_f32_16x16x64_bf16 v[48:51], v[16:19], a[32:39], v2
v_smfmac_f32_16x16x64_bf16 v[52:55], v[16:19], a[40:47], v2
v_smfmac_f32_16x16x64_bf16 v[56:59], v[16:19], a[48:55], v2
v_smfmac_f32_16x16x64_bf16 v[60:63], v[16:19], a[56:63], v2
v_smfmac_f32_16x16x64_bf16 v[64:67], v[16:19], v[96:103], v2
v_smfmac_f32_16x16x64_bf16 v[68:71], v[16:19], v[104:111], v2
v_smfmac_f32_16x16x64_bf16 v[48:51], v[20:23], a[64:71], v2
v_smfmac_f32_16x16x64_bf16 v[52:55], v[20:23], a[72:79], v2
v_smfmac_f32_16x16x64_bf16 v[56:59], v[20:23], a[80:87], v2
v_smfmac_f32_16x16x64_bf16 v[60:63], v[20:23], a[88:95], v2
v_smfmac_f32_16x16x64_bf16 v[64:67], v[20:23], v[112:119], v2
v_smfmac_f32_16x16x64_bf16 v[68:71], v[20:23], v[120:127], v2
v_smfmac_f32_16x16x64_bf16 v[48:51], v[24:27], a[96:103], v2
v_smfmac_f32_16x16x64_bf16 v[52:55], v[24:27], a[104:111], v2
v_smfmac_f32_16x16x64_bf16 v[56:59], v[24:27], a[112:119], v2
v_smfmac_f32_16x16x64_bf16 v[60:63], v[24:27], a[120:127], v2
v_smfmac_f32_16x16x64_bf16 v[64:67], v[24:27], v[128:135], v2
v_smfmac_f32_16x16x64_bf16 v[68:71], v[24:27], v[136:143], v2
v_smfmac_f32_16x16x64_bf16 v[48:51], v[28:31], a[128:135], v2
v_smfmac_f32_16x16x64_bf16 v[52:55], v[28:31], a[136:143], v2
v_smfmac_f32_16x16x64_bf16 v[56:59], v[28:31], a[144:151], v2
v_smfmac_f32_16x16x64_bf16 v[60:63], v[28:31], a[152:159], v2
v_smfmac_f32_16x16x64_bf16 v[48:51], v[32:35], a[160:167], v2
v_smfmac_f32_16x16x64_bf16 v[52:55], v[32:35], a[168:175], v2
v_smfmac_f32_16x16x64_bf16 v[56:59], v[32:35], a[176:183], v2
v_smfmac_f32_16x16x64_bf16 v[60:63], v[32:35], a[184:191], v2
v_smfmac_f32_16x16x64_bf16 v[48:51], v[36:39], a[192:199], v2
v_smfmac_f32_16x16x64_bf16 v[52:55], v[36:39], a[200:207], v2
v_smfmac_f32_16x16x64_bf16 v[56:59], v[36:39], a[208:215], v2
v_smfmac_f32_16x16x64_bf16 v[60:63], v[36:39], a[216:223], v2
v_smfmac_f32_16x16x64_bf16 v[48:51], v[40:43], a[224:231], v2
v_smfmac_f32_16x16x64_bf16 v[52:55], v[40:43], a[232:239], v2
v_smfmac_f32_16x16x64_bf16 v[56:59], v[40:43], a[240:247], v2
v_smfmac_f32_16x16x64_bf16 v[60:63], v[40:43], a[248:255], v2
v_smfmac_f32_16x16x64_bf16 v[48:51], v[44:47], v[224:231], v2
v_smfmac_f32_16x16x64_bf16 v[52:55], v[44:47], v[232:239], v2
v_smfmac_f32_16x16x64_bf16 v[56:59], v[44:47], v[240:247], v2
v_smfmac_f32_16x16x64_bf16 v[60:63], v[44:47], v[248:255], v2
ds_read_b128 v[12:15], v0
ds_read_b128 v[16:19], v0 offset:4096
ds_read_b128 v[20:23], v0 offset:1024
s_nop 7
v_add_f32 v48, v48, v50
v_add_f32 v49, v49, v51
v_add_f32 v52, v52, v54
v_add_f32 v53, v53, v55
s_branch Lc_post1sc1
Lc_redo31sc1:
s_add_u32 s21, s21, 1
s_cmp_ge_u32 s21, 4194304
s_cbranch_scc1 L_abort
s_branch Lc_redo21sc1
.p2align 6
s_nop 0
s_nop 0
Lc_top2sc1:
buffer_load_dwordx4 v0, s[8:11], s22 offen offset:2048 sc1 lds
buffer_load_dwordx4 v0, s[8:11], s22 offen offset:3072 sc1 lds
ds_read_b128 v[12:15], v0 offset:16384
ds_read_b128 v[16:19], v0 offset:17408
s_add_u32 s21, s21, 1
s_cmp_ge_u32 s21, 4194304
s_cbranch_scc1 L_abort
s_waitcnt lgkmcnt(0)
v_max_u32 v43, v12, v16
v_cmp_eq_u32 vcc, -1, v43
s_cbranch_vccnz Lc_top2sc1
v_smfmac_f32_16x16x64_bf16 v[48:51], v[12:15], a[0:7], v2
buffer_load_dwordx4 v0, s[8:11], s22 offen offset:2048 sc1 lds
buffer_load_dwordx4 v0, s[8:11], s22 offen offset:3072 sc1 lds
v_smfmac_f32_16x16x64_bf16 v[52:55], v[12:15], a[8:15], v2
v_smfmac_f32_16x16x64_bf16 v[56:59], v[12:15], a[16:23], v2
buffer_load_dwordx4 v[28:31], v0, s[8:11], s51 offen sc1
v_smfmac_f32_16x16x64_bf16 v[60:63], v[12:15], a[24:31], v2
v_smfmac_f32_16x16x64_bf16 v[64:67], v[12:15], v[80:87], v2
ds_read_b128 v[20:23], v0 offset:18432
v_smfmac_f32_16x16x64_bf16 v[68:71], v[12:15], v[88:95], v2
v_smfmac_f32_16x16x64_bf16 v[48:51], v[16:19], a[32:39], v2
buffer_load_dwordx4 v[32:35], v0, s[8:11], s51 offen offset:1024 sc1
v_smfmac_f32_16x16x64_bf16 v[52:55], v[16:19], a[40:47], v2
v_smfmac_f32_16x16x64_bf16 v[56:59], v[16:19], a[48:55], v2
v_smfmac_f32_16x16x64_bf16 v[60:63], v[16:19], a[56:63], v2
ds_read_b128 v[24:27], v0 offset:19456
s_waitcnt lgkmcnt(1)
v_cmp_eq_u32 vcc, -1, v20
v_smfmac_f32_16x16x64_bf16 v[64:67], v[16:19], v[96:103], v2
buffer_load_dwordx4 v[36:39], v0, s[8:11], s51 offen offset:2048 sc1
v_smfmac_f32_16x16x64_bf16 v[68:71], v[16:19], v[104:111], v2
s_cbranch_vccnz Lc_retry22sc1
Lc_back22sc1:
v_smfmac_f32_16x16x64_bf16 v[48:51], v[20:23], a[64:71], v2
v_smfmac_f32_16x16x64_bf16 v[52:55], v[20:23], a[72:79], v2
v_smfmac_f32_16x16x64_bf16 v[56:59], v[20:23], a[80:87], v2
buffer_load_dwordx4 v[40:43], v0, s[8:11], s51 offen offset:3072 sc1
v_smfmac_f32_16x16x64_bf16 v[60:63], v[20:23], a[88:95], v2
s_waitcnt lgkmcnt(0)
v_cmp_eq_u32 vcc, -1, v24
v_smfmac_f32_16x16x64_bf16 v[64:67], v[20:23], v[112:119], v2
v_smfmac_f32_16x16x64_bf16 v[68:71], v[20:23], v[120:127], v2
buffer_load_dwordx4 v[44:47], v0, s[8:11], s52 offen sc1
s_cbranch_vccnz Lc_retry32sc1
Lc_back32sc1:
v_smfmac_f32_16x16x64_bf16 v[48:51], v[24:27], a[96:103], v2
s_waitcnt vmcnt(5)
s_barrier
v_smfmac_f32_16x16x64_bf16 v[52:55], v[24:27], a[104:111], v2
s_waitcnt vmcnt(4)
v_cmp_eq_u32 vcc, -1, v28
v_smfmac_f32_16x16x64_bf16 v[56:59], v[24:27], a[112:119], v2
ds_read_b128 v[12:15], v0
v_smfmac_f32_16x16x64_bf16 v[60:63], v[24:27], a[120:127], v2
ds_read_b128 v[16:19], v0 offset:4096
s_cbranch_vccnz Lc_retry42sc1
Lc_back42sc1:
v_smfmac_f32_16x16x64_bf16 v[48:51], v[28:31], a[128:135], v2
ds_read_b128 v[20:23], v0 offset:1024
v_smfmac_f32_16x16x64_bf16 v[52:55], v[28:31], a[136:143], v2
s_waitcnt vmcnt(3)
v_cmp_eq_u32 vcc, -1, v32
v_smfmac_f32_16x16x64_bf16 v[56:59], v[28:31], a[144:151], v2
v_smfmac_f32_16x16x64_bf16 v[60:63], v[28:31], a[152:159], v2
s_cbranch_vccnz Lc_retry52sc1
Lc_back52sc1:
v_smfmac_f32_16x16x64_bf16 v[48:51], v[32:35], a[160:167], v2
v_smfmac_f32_16x16x64_bf16 v[52:55], v[32:35], a[168:175], v2
s_waitcnt vmcnt(2)
v_cmp_eq_u32 vcc, -1, v36
v_smfmac_f32_16x16x64_bf16 v[56:59], v[32:35], a[176:183], v2
v_smfmac_f32_16x16x64_bf16 v[60:63], v[32:35], a[184:191], v2
s_cbranch_vccnz Lc_retry62sc1
Lc_back62sc1:
v_smfmac_f32_16x16x64_bf16 v[48:51], v[36:39], a[192:199], v2
v_smfmac_f32_16x16x64_bf16 v[52:55], v[36:39], a[200:207], v2
s_waitcnt vmcnt(1)
v_cmp_eq_u32 vcc, -1, v40
v_smfmac_f32_16x16x64_bf16 v[56:59], v[36:39], a[208:215], v2
v_smfmac_f32_16x16x64_bf16 v[60:63], v[36:39], a[216:223], v2
s_cbranch_vccnz Lc_retry72sc1
Lc_back72sc1:
v_smfmac_f32_16x16x64_bf16 v[48:51], v[40:43], a[224:231], v2
v_smfmac_f32_16x16x64_bf16 v[52:55], v[40:43], a[232:239], v2
s_waitcnt vmcnt(0)
v_cmp_eq_u32 vcc, -1, v44
v_smfmac_f32_16x16x64_bf16 v[56:59], v[40:43], a[240:247], v2
v_smfmac_f32_16x16x64_bf16 v[60:63], v[40:43], a[248:255], v2
s_cbranch_vccnz Lc_retry82sc1
Lc_back82sc1:
v_smfmac_f32_16x16x64_bf16 v[48:51], v[44:47], v[224:231], v2
v_smfmac_f32_16x16x64_bf16 v[52:55], v[44:47], v[232:239], v2
v_smfmac_f32_16x16x64_bf16 v[56:59], v[44:47], v[240:247], v2
v_add_f32 v48, v48, v50
v_smfmac_f32_16x16x64_bf16 v[60:63], v[44:47], v[248:255], v2
v_add_f32 v49, v49, v51
v_smfmac_f32_16x16x64_bf16 v[64:67], v[24:27], v[128:135], v2
v_add_f32 v52, v52, v54
v_smfmac_f32_16x16x64_bf16 v[68:71], v[24:27], v[136:143], v2
v_add_f32 v53, v53, v55
Lc_post2sc1:
v_add_f32 v56, v56, v58
v_add_f32 v60, v60, v62
v_cvt_pk_bf16_f32 v50, v48, v52
v_cvt_pk_bf16_f32 v51, v56, v60
v_xor_b32 v58, 16, v3
ds_write_b64 v3, v[50:51] offset:16384
v_add_f32 v57, v57, v59
v_add_f32 v61, v61, v63
v_cvt_pk_bf16_f32 v54, v49, v53
v_cvt_pk_bf16_f32 v55, v57, v61
ds_write_b64 v58, v[54:55] offset:16384
v_cmp_u_f32 vcc, v48, v49
v_smfmac_f32_16x16x64_bf16 v[64:67], v[28:31], v[144:151], v2
v_smfmac_f32_16x16x64_bf16 v[68:71], v[28:31], v[152:159], v2
s_cbranch_vccnz Lc_redo2sc1
Lc_redoback2sc1:
v_smfmac_f32_16x16x64_bf16 v[64:67], v[32:35], v[160:167], v2
s_cmp_lt_u32 s96, 3
v_smfmac_f32_16x16x64_bf16 v[68:71], v[32:35], v[168:175], v2
s_cbranch_scc1 Lc_hist2sc1
Lc_histback2sc1:
v_xor_b32 v32, 64, v4
s_waitcnt lgkmcnt(0)
s_barrier
ds_read_b128 v[28:31], v4 offset:16384
ds_read_b128 v[32:35], v32 offset:17408
ds_read_b128 v[56:59], v0 offset:5120
v_smfmac_f32_16x16x64_bf16 v[64:67], v[36:39], v[176:183], v2
v_smfmac_f32_16x16x64_bf16 v[68:71], v[36:39], v[184:191], v2
ds_read_b128 v[36:39], v4 offset:18432
ds_read_b128 v[60:63], v0 offset:2048
ds_read_b128 v[24:27], v0 offset:6144
v_smfmac_f32_16x16x64_bf16 v[64:67], v[40:43], v[192:199], v2
v_smfmac_f32_16x16x64_bf16 v[68:71], v[40:43], v[200:207], v2
v_xor_b32 v40, 64, v4
ds_read_b128 v[40:43], v40 offset:19456
v_smfmac_f32_16x16x64_bf16 v[64:67], v[44:47], v[208:215], v2
v_smfmac_f32_16x16x64_bf16 v[68:71], v[44:47], v[216:223], v2
s_waitcnt lgkmcnt(6)
v_mfma_f32_16x16x32_bf16 v[48:51], v[12:15], v[28:31], 0
ds_read_b128 v[12:15], v0 offset:3072
v_mfma_f32_16x16x32_bf16 v[52:55], v[16:19], v[28:31], 0
ds_read_b128 v[16:19], v0 offset:7168
v_mfma_f32_16x16x32_bf16 v[44:47], v[28:31], v[28:31], 0
s_waitcnt lgkmcnt(6)
v_mfma_f32_16x16x32_bf16 v[48:51], v[20:23], v[32:35], v[48:51]
v_add_f32 v64, v64, v66
v_add_f32 v65, v65, v67
v_mfma_f32_16x16x32_bf16 v[52:55], v[56:59], v[32:35], v[52:55]
v_add_f32 v68, v68, v70
ds_read_b128 v[56:59], v0 offset:12288
v_mfma_f32_16x16x32_bf16 v[44:47], v[32:35], v[32:35], v[44:47]
v_add_f32 v69, v69, v71
v_cvt_pk_bf16_f32 v66, v64, v65
s_waitcnt lgkmcnt(4)
v_mfma_f32_16x16x32_bf16 v[48:51], v[60:63], v[36:39], v[48:51]
v_cvt_pk_bf16_f32 v67, v68, v69
ds_read_b128 v[60:63], v0 offset:13312
v_mfma_f32_16x16x32_bf16 v[52:55], v[24:27], v[36:39], v[52:55]
ds_read_b128 v[28:31], v1
s_cmp_eq_u32 s18, 62
v_mfma_f32_16x16x32_bf16 v[44:47], v[36:39], v[36:39], v[44:47]
ds_read_b128 v[32:35], v1 offset:1024
s_cbranch_scc1 Lc_vm2sc1
Lc_vmb2sc1:
s_waitcnt lgkmcnt(4)
v_mfma_f32_16x16x32_bf16 v[44:47], v[40:43], v[40:43], v[44:47]
s_barrier
v_mfma_f32_16x16x32_bf16 v[48:51], v[12:15], v[40:43], v[48:51]
ds_read_b128 v[20:23], v1 offset:2048
v_mfma_f32_16x16x32_bf16 v[52:55], v[16:19], v[40:43], v[52:55]
ds_read_b128 v[24:27], v1 offset:3072
v_mov_b32 v36, -1
v_mov_b32 v37, -1
v_mov_b32 v38, -1
v_max3_f32 v64, v46, v47, v48
v_max3_f32 v64, v64, v49, v50
v_mov_b32 v39, -1
s_nop 0
v_max3_f32 v65, v51, v52, v53
v_max3_f32 v65, v65, v54, v55
v_max_f32 v44, v64, v65
v_max_f32 v65, v64, v65
ds_read_b128 v[12:15], v1 offset:4096
ds_read_b128 v[16:19], v1 offset:5120
v_permlane32_swap_b32 v44, v65
v_max_f32 v64, v44, v65
v_max_f32 v65, v44, v65
s_mov_b32 s20, s24
s_bitcmp0_b32 s18, 1
v_permlane16_swap_b32 v64, v65
v_max_f32 v64, v64, v65
v_fma_f32 v64, v64, s30, v5
v_pk_fma_f32 v[46:47], v[46:47], s[30:31], v[64:65] op_sel_hi:[1,1,0] neg_lo:[0,0,1] neg_hi:[0,0,1]
v_pk_fma_f32 v[48:49], v[48:49], s[30:31], v[64:65] op_sel_hi:[1,1,0] neg_lo:[0,0,1] neg_hi:[0,0,1]
v_pk_fma_f32 v[50:51], v[50:51], s[30:31], v[64:65] op_sel_hi:[1,1,0] neg_lo:[0,0,1] neg_hi:[0,0,1]
v_pk_fma_f32 v[52:53], v[52:53], s[30:31], v[64:65] op_sel_hi:[1,1,0] neg_lo:[0,0,1] neg_hi:[0,0,1]
v_pk_fma_f32 v[54:55], v[54:55], s[30:31], v[64:65] op_sel_hi:[1,1,0] neg_lo:[0,0,1] neg_hi:[0,0,1]
v_exp_f32 v46, v46
v_exp_f32 v47, v47
v_exp_f32 v48, v48
v_cvt_pk_bf16_f32 v44, v46, v47
v_exp_f32 v49, v49
v_exp_f32 v50, v50
v_mov_b32_dpp v45, v44 quad_perm:[2,3,0,1] row_mask:0xf bank_mask:0xf
v_exp_f32 v51, v51
v_cvt_pk_bf16_f32 v48, v48, v49
v_mfma_f32_16x16x16_bf16 v[40:43], v[66:67], v[44:45], 0
ds_write_b128 v0, v[36:39] offset:18432
v_exp_f32 v52, v52
v_mfma_f32_16x16x16_bf16 v[68:71], v[8:9], v[44:45], 0
v_exp_f32 v53, v53
v_cvt_pk_bf16_f32 v49, v50, v51
v_exp_f32 v54, v54
v_exp_f32 v55, v55
v_cvt_pk_bf16_f32 v50, v52, v53
v_mov_b32_dpp v52, v48 quad_perm:[2,3,0,1] row_mask:0xf bank_mask:0xf
v_cvt_pk_bf16_f32 v51, v54, v55
v_mov_b32_dpp v53, v49 quad_perm:[2,3,0,1] row_mask:0xf bank_mask:0xf
s_cselect_b32 s32, -1, 0
s_waitcnt lgkmcnt(7)
v_mfma_f32_16x16x32_bf16 v[68:71], v[8:11], v[48:51], v[68:71]
v_mov_b32_dpp v54, v50 quad_perm:[2,3,0,1] row_mask:0xf bank_mask:0xf
v_mov_b32_dpp v55, v51 quad_perm:[2,3,0,1] row_mask:0xf bank_mask:0xf
v_mfma_f32_16x16x32_bf16 v[40:43], v[56:59], v[48:51], v[40:43]
s_mov_b32 s53, s25
s_add_u32 s55, s22, s34
v_mfma_f32_16x16x32_bf16 v[40:43], v[60:63], v[52:55], v[40:43]
s_add_u32 s49, s23, s34
s_add_u32 s38, s38, 64
ds_read_b128 v[44:47], v1 offset:6144
ds_read_b128 v[48:51], v1 offset:7168
v_rcp_f32 v56, v68
s_add_u32 s18, s18, 1
s_add_u32 s27, s27, 9216
v_mov_b32_dpp v56, v56 quad_perm:[0,1,0,1] row_mask:0xf bank_mask:0xf
v_pk_mul_f32 v[40:41], v[40:41], v[56:57] op_sel_hi:[1,0]
v_pk_mul_f32 v[42:43], v[42:43], v[56:57] op_sel_hi:[1,0]
v_cvt_pk_bf16_f32 v40, v40, v41
v_cvt_pk_bf16_f32 v41, v42, v43
ds_write_b64 v0, v[40:41] offset:21504
v_or_b32 v36, v7, v5
ds_read_b128 v[64:67], v1 offset:8192
ds_read_b128 v[68:71], v1 offset:9216
s_mov_b32 s22, s23
s_add_u32 s23, s23, 9216
s_waitcnt lgkmcnt(2)
s_barrier
ds_read_b128 v[8:11], v36 offset:20992
ds_read_b128 v[36:39], v36 offset:20480
ds_read_b128 v[40:43], v0 offset:21504
s_cmp_eq_u32 s23, 12610560
s_cselect_b32 s23, 12582912, s23
s_add_u32 s24, s24, s33
s_add_u32 s25, s25, s33
s_sub_u32 s33, 0, s33
s_add_u32 s51, s22, 4096
s_add_u32 s52, s22, 8192
s_waitcnt lgkmcnt(1)
v_mfma_f32_16x16x32_bf16 v[52:55], v[36:39], v[72:75], 0
v_mfma_f32_16x16x32_bf16 v[52:55], v[8:11], v[76:79], v[52:55]
s_waitcnt lgkmcnt(0)
v_smfmac_f32_16x16x64_bf16 v[52:55], v[40:43], v[28:35], v2
ds_read_b128 v[28:31], v1 offset:10240
ds_read_b128 v[32:35], v1 offset:11264
v_mfma_f32_16x16x32_bf16 v[56:59], v[36:39], v[20:23], 0
v_mfma_f32_16x16x32_bf16 v[56:59], v[8:11], v[24:27], v[56:59]
ds_read_b128 v[20:23], v1 offset:12288
v_add_f32 v52, v52, v54
v_smfmac_f32_16x16x64_bf16 v[56:59], v[40:43], v[12:19], v2
ds_read_b128 v[24:27], v1 offset:13312
ds_read_b128 v[12:15], v1 offset:14336
v_add_f32 v53, v53, v55
v_cvt_pk_bf16_f32 v54, v52, v53
v_bfi_b32 v54, -2, v54, s32
s_nop 2
v_add_f32 v56, v56, v58
v_add_f32 v57, v57, v59
v_cvt_pk_bf16_f32 v55, v56, v57
buffer_store_dwordx2 v[54:55], v6, s[8:11], s20 offen sc1
s_add_u32 s20, s20, 49152
v_mfma_f32_16x16x32_bf16 v[60:63], v[36:39], v[44:47], 0
ds_read_b128 v[16:19], v1 offset:15360
v_mfma_f32_16x16x32_bf16 v[60:63], v[8:11], v[48:51], v[60:63]
ds_read_b128 v[44:47], v1 offset:16384
v_smfmac_f32_16x16x64_bf16 v[60:63], v[40:43], v[64:71], v2
ds_read_b128 v[48:51], v1 offset:17408
ds_read_b128 v[64:67], v1 offset:18432
s_waitcnt lgkmcnt(7)
v_mfma_f32_16x16x32_bf16 v[52:55], v[36:39], v[28:31], 0
ds_read_b128 v[68:71], v1 offset:19456
v_mfma_f32_16x16x32_bf16 v[52:55], v[8:11], v[32:35], v[52:55]
ds_read_b128 v[28:31], v1 offset:20480
s_waitcnt lgkmcnt(7)
v_smfmac_f32_16x16x64_bf16 v[52:55], v[40:43], v[20:27], v2
ds_read_b128 v[32:35], v1 offset:21504
ds_read_b128 v[20:23], v1 offset:22528
s_waitcnt lgkmcnt(7)
v_mfma_f32_16x16x32_bf16 v[56:59], v[36:39], v[12:15], 0
ds_read_b128 v[24:27], v1 offset:23552
v_add_f32 v60, v60, v62
v_mfma_f32_16x16x32_bf16 v[56:59], v[8:11], v[16:19], v[56:59]
ds_read_b128 v[12:15], v1 offset:24576
v_add_f32 v61, v61, v63
s_waitcnt lgkmcnt(7)
v_smfmac_f32_16x16x64_bf16 v[56:59], v[40:43], v[44:51], v2
ds_read_b128 v[16:19], v1 offset:25600
ds_read_b128 v[44:47], v1 offset:26624
v_add_f32 v52, v52, v54
v_cvt_pk_bf16_f32 v54, v60, v61
v_add_f32 v53, v53, v55
s_waitcnt lgkmcnt(7)
v_mfma_f32_16x16x32_bf16 v[60:63], v[36:39], v[64:67], 0
ds_read_b128 v[48:51], v1 offset:27648
v_bfi_b32 v54, -2, v54, s32
v_mfma_f32_16x16x32_bf16 v[60:63], v[8:11], v[68:71], v[60:63]
ds_read_b128 v[64:67], v1 offset:28672
v_cvt_pk_bf16_f32 v55, v52, v53
s_waitcnt lgkmcnt(7)
v_smfmac_f32_16x16x64_bf16 v[60:63], v[40:43], v[28:35], v2
ds_read_b128 v[68:71], v1 offset:29696
ds_read_b128 v[28:31], v1 offset:30720
buffer_store_dwordx2 v[54:55], v6, s[8:11], s20 offen sc1
s_add_u32 s20, s20, 49152
s_waitcnt lgkmcnt(7)
v_mfma_f32_16x16x32_bf16 v[52:55], v[36:39], v[20:23], 0
ds_read_b128 v[32:35], v1 offset:31744
v_add_f32 v56, v56, v58
v_mfma_f32_16x16x32_bf16 v[52:55], v[8:11], v[24:27], v[52:55]
ds_read_b128 v[20:23], v1 offset:32768
v_add_f32 v57, v57, v59
s_waitcnt lgkmcnt(7)
v_smfmac_f32_16x16x64_bf16 v[52:55], v[40:43], v[12:19], v2
ds_read_b128 v[24:27], v1 offset:33792
ds_read_b128 v[12:15], v1 offset:34816
v_add_f32 v60, v60, v62
v_cvt_pk_bf16_f32 v62, v56, v57
v_add_f32 v61, v61, v63
s_waitcnt lgkmcnt(7)
v_mfma_f32_16x16x32_bf16 v[56:59], v[36:39], v[44:47], 0
ds_read_b128 v[16:19], v1 offset:35840
v_bfi_b32 v62, -2, v62, s32
v_mfma_f32_16x16x32_bf16 v[56:59], v[8:11], v[48:51], v[56:59]
ds_read_b128 v[44:47], v1 offset:36864
v_cvt_pk_bf16_f32 v63, v60, v61
s_waitcnt lgkmcnt(7)
v_smfmac_f32_16x16x64_bf16 v[56:59], v[40:43], v[64:71], v2
ds_read_b128 v[48:51], v1 offset:37888
ds_read_b128 v[64:67], v1 offset:38912
buffer_store_dwordx2 v[62:63], v6, s[8:11], s20 offen sc1
s_add_u32 s20, s20, 49152
s_waitcnt lgkmcnt(7)
v_mfma_f32_16x16x32_bf16 v[60:63], v[36:39], v[28:31], 0
ds_read_b128 v[68:71], v1 offset:39936
v_add_f32 v52, v52, v54
v_mfma_f32_16x16x32_bf16 v[60:63], v[8:11], v[32:35], v[60:63]
ds_read_b128 v[28:31], v1 offset:40960
v_add_f32 v53, v53, v55
s_waitcnt lgkmcnt(7)
v_smfmac_f32_16x16x64_bf16 v[60:63], v[40:43], v[20:27], v2
ds_read_b128 v[32:35], v1 offset:41984
ds_read_b128 v[20:23], v1 offset:43008
v_add_f32 v56, v56, v58
v_cvt_pk_bf16_f32 v58, v52, v53
v_add_f32 v57, v57, v59
s_waitcnt lgkmcnt(7)
v_mfma_f32_16x16x32_bf16 v[52:55], v[36:39], v[12:15], 0
ds_read_b128 v[24:27], v1 offset:44032
v_bfi_b32 v58, -2, v58, s32
v_mfma_f32_16x16x32_bf16 v[52:55], v[8:11], v[16:19], v[52:55]
ds_read_b128 v[12:15], v1 offset:45056
v_cvt_pk_bf16_f32 v59, v56, v57
s_waitcnt lgkmcnt(7)
v_smfmac_f32_16x16x64_bf16 v[52:55], v[40:43], v[44:51], v2
ds_read_b128 v[16:19], v1 offset:46080
buffer_store_dwordx2 v[58:59], v6, s[8:11], s20 offen sc1
s_add_u32 s20, s20, 49152
s_waitcnt lgkmcnt(6)
v_mfma_f32_16x16x32_bf16 v[56:59], v[36:39], v[64:67], 0
v_add_f32 v60, v60, v62
v_mfma_f32_16x16x32_bf16 v[56:59], v[8:11], v[68:71], v[56:59]
v_add_f32 v61, v61, v63
s_waitcnt lgkmcnt(4)
v_smfmac_f32_16x16x64_bf16 v[56:59], v[40:43], v[28:35], v2
v_add_f32 v52, v52, v54
v_cvt_pk_bf16_f32 v54, v60, v61
v_add_f32 v53, v53, v55
s_waitcnt lgkmcnt(2)
v_mfma_f32_16x16x32_bf16 v[60:63], v[36:39], v[20:23], 0
v_bfi_b32 v54, -2, v54, s32
v_mfma_f32_16x16x32_bf16 v[60:63], v[8:11], v[24:27], v[60:63]
v_cvt_pk_bf16_f32 v55, v52, v53
s_waitcnt lgkmcnt(0)
v_smfmac_f32_16x16x64_bf16 v[60:63], v[40:43], v[12:19], v2
buffer_store_dwordx2 v[54:55], v6, s[8:11], s20 offen sc1
s_add_u32 s20, s20, 49152
s_add_u32 s26, s26, 524288
s_mov_b32 m0, 16384
v_mov_b64 v[48:49], 0
v_mov_b64 v[50:51], 0
v_mov_b64 v[52:53], 0
v_mov_b64 v[54:55], 0
v_mov_b64 v[64:65], 0
v_mov_b64 v[66:67], 0
v_mov_b64 v[68:69], 0
v_mov_b64 v[70:71], 0
v_add_f32 v56, v56, v58
v_add_f32 v57, v57, v59
v_add_f32 v60, v60, v62
v_cvt_pk_bf16_f32 v62, v56, v57
v_add_f32 v61, v61, v63
v_bfi_b32 v62, -2, v62, s32
v_cvt_pk_bf16_f32 v63, v60, v61
buffer_store_dwordx2 v[62:63], v6, s[8:11], s20 offen sc1
v_mov_b32 v8, 0x3f803f80
v_mov_b32 v9, v8
v_mov_b64 v[10:11], v[8:9]
v_mov_b64 v[56:57], 0
v_mov_b64 v[58:59], 0
v_mov_b64 v[60:61], 0
v_mov_b64 v[62:63], 0
s_cmp_eq_u32 s18, 40
s_cbranch_scc1 Lc_pre2sc1
Lc_preb2sc1:
s_mov_b32 s75, 0
s_mov_b32 s19, s74
Lc_dl2sc1:
s_sub_u32 s19, s19, 1
s_cbranch_scc0 Lc_dl2sc1
s_cmp_eq_u32 s18, 63
s_cbranch_scc0 Lc_top2sc1
s_waitcnt vmcnt(0)
s_lshl_b32 s19, s17, 5
s_add_u32 s19, s19, 129040
buffer_store_dword v2, off, s[8:11], s19 sc1
buffer_store_dword v2, off, s[8:11], s19 offset:4 sc1
s_branch Lc_topL2
Lc_hist2sc1:
s_cmp_eq_u32 s96, 0
s_cbranch_scc0 Lc_hist12sc1
buffer_store_dwordx4 v[36:39], v0, s[8:11], s27 offen sc1
s_nop 0
s_branch Lc_histback2sc1
Lc_hist12sc1:
s_cmp_eq_u32 s96, 1
s_cbranch_scc0 Lc_hist22sc1
buffer_store_dwordx4 v[40:43], v0, s[8:11], s27 offen sc1
s_nop 0
s_branch Lc_histback2sc1
Lc_hist22sc1:
buffer_store_dwordx4 v[44:47], v0, s[8:11], s27 offen sc1
s_nop 0
s_branch Lc_histback2sc1
Lc_vm2sc1:
v_lshrrev_b32 v64, 1, v0
s_mul_i32 s19, s17, 4096
s_add_u32 s19, s19, 24906752
buffer_store_dwordx2 v[66:67], v64, s[8:11], s19 offen sc1
s_branch Lc_vmb2sc1
Lc_pre2sc1:
v_mov_b32 v12, 0
global_load_dword v13, v12, s[6:7] offset:104 sc1
s_waitcnt vmcnt(0)
v_cmp_gt_u32 vcc, 28, v13
s_cbranch_vccz Lc_preb2sc1
s_add_u32 s21, s21, 1
s_cmp_ge_u32 s21, 4194304
s_cbranch_scc1 L_abort
s_branch Lc_pre2sc1
Lc_retry22sc1:
buffer_load_dwordx4 v0, s[8:11], s22 offen offset:2048 sc1 lds
ds_read_b128 v[20:23], v0 offset:18432
s_add_u32 s21, s21, 1
s_cmp_ge_u32 s21, 4194304
s_cbranch_scc1 L_abort
s_waitcnt lgkmcnt(0)
v_cmp_eq_u32 vcc, -1, v20
s_cbranch_vccnz Lc_retry22sc1
s_waitcnt vmcnt(0)
s_branch Lc_back22sc1
Lc_retry32sc1:
buffer_load_dwordx4 v0, s[8:11], s22 offen offset:3072 sc1 lds
ds_read_b128 v[24:27], v0 offset:19456
s_add_u32 s21, s21, 1
s_cmp_ge_u32 s21, 4194304
s_cbranch_scc1 L_abort
s_waitcnt lgkmcnt(0)
v_cmp_eq_u32 vcc, -1, v24
s_cbranch_vccnz Lc_retry32sc1
s_waitcnt vmcnt(0)
s_branch Lc_back32sc1
Lc_retry42sc1:
buffer_load_dwordx4 v[28:31], v0, s[8:11], s51 offen sc1
s_waitcnt vmcnt(0)
v_cmp_eq_u32 vcc, -1, v28
s_cbranch_vccz Lc_back42sc1
s_add_u32 s21, s21, 1
s_cmp_ge_u32 s21, 4194304
s_cbranch_scc1 L_abort
s_branch Lc_retry42sc1
Lc_retry52sc1:
buffer_load_dwordx4 v[32:35], v0, s[8:11], s51 offen offset:1024 sc1
s_waitcnt vmcnt(0)
v_cmp_eq_u32 vcc, -1, v32
s_cbranch_vccz Lc_back52sc1
s_add_u32 s21, s21, 1
s_cmp_ge_u32 s21, 4194304
s_cbranch_scc1 L_abort
s_branch Lc_retry52sc1
Lc_retry62sc1:
buffer_load_dwordx4 v[36:39], v0, s[8:11], s51 offen offset:2048 sc1
s_waitcnt vmcnt(0)
v_cmp_eq_u32 vcc, -1, v36
s_cbranch_vccz Lc_back62sc1
s_add_u32 s21, s21, 1
s_cmp_ge_u32 s21, 4194304
s_cbranch_scc1 L_abort
s_branch Lc_retry62sc1
Lc_retry72sc1:
buffer_load_dwordx4 v[40:43], v0, s[8:11], s51 offen offset:3072 sc1
s_waitcnt vmcnt(0)
v_cmp_eq_u32 vcc, -1, v40
s_cbranch_vccz Lc_back72sc1
s_add_u32 s21, s21, 1
s_cmp_ge_u32 s21, 4194304
s_cbranch_scc1 L_abort
s_branch Lc_retry72sc1
Lc_retry82sc1:
buffer_load_dwordx4 v[44:47], v0, s[8:11], s52 offen sc1
s_waitcnt vmcnt(0)
v_cmp_eq_u32 vcc, -1, v44
s_cbranch_vccz Lc_back82sc1
s_add_u32 s21, s21, 1
s_cmp_ge_u32 s21, 4194304
s_cbranch_scc1 L_abort
s_branch Lc_retry82sc1
Lc_redo2sc1:
s_cmp_eq_u32 s48, s18
s_cbranch_scc1 Lc_redoback2sc1
s_mov_b32 s48, s18
s_waitcnt lgkmcnt(0)
s_nop 15
Lc_redo22sc1:
buffer_load_dwordx4 v[12:15], v0, s[8:11], s22 offen sc1
buffer_load_dwordx4 v[16:19], v0, s[8:11], s22 offen offset:1024 sc1
buffer_load_dwordx4 v[20:23], v0, s[8:11], s22 offen offset:2048 sc1
buffer_load_dwordx4 v[24:27], v0, s[8:11], s22 offen offset:3072 sc1
buffer_load_dwordx4 v[28:31], v0, s[8:11], s51 offen sc1
buffer_load_dwordx4 v[32:35], v0, s[8:11], s51 offen offset:1024 sc1
buffer_load_dwordx4 v[36:39], v0, s[8:11], s51 offen offset:2048 sc1
buffer_load_dwordx4 v[40:43], v0, s[8:11], s51 offen offset:3072 sc1
buffer_load_dwordx4 v[44:47], v0, s[8:11], s52 offen sc1
v_mov_b64 v[48:49], 0
v_mov_b64 v[50:51], 0
v_mov_b64 v[52:53], 0
v_mov_b64 v[54:55], 0
v_mov_b64 v[56:57], 0
v_mov_b64 v[58:59], 0
v_mov_b64 v[60:61], 0
v_mov_b64 v[62:63], 0
v_mov_b64 v[64:65], 0
v_mov_b64 v[66:67], 0
v_mov_b64 v[68:69], 0
v_mov_b64 v[70:71], 0
s_waitcnt vmcnt(0)
v_max_u32 v48, v12, v13
v_max3_u32 v48, v48, v14, v15
v_max3_u32 v48, v48, v16, v17
v_max3_u32 v48, v48, v18, v19
v_max3_u32 v48, v48, v20, v21
v_max3_u32 v48, v48, v22, v23
v_max3_u32 v48, v48, v24, v25
v_max3_u32 v48, v48, v26, v27
v_max3_u32 v48, v48, v28, v29
v_max3_u32 v48, v48, v30, v31
v_max3_u32 v48, v48, v32, v33
v_max3_u32 v48, v48, v34, v35
v_max3_u32 v48, v48, v36, v37
v_max3_u32 v48, v48, v38, v39
v_max3_u32 v48, v48, v40, v41
v_max3_u32 v48, v48, v42, v43
v_max3_u32 v48, v48, v44, v45
v_max3_u32 v48, v48, v46, v47
v_cmp_eq_u32 vcc, -1, v48
v_mov_b32 v48, 0
s_cbranch_vccnz Lc_redo32sc1
s_nop 0
v_smfmac_f32_16x16x64_bf16 v[48:51], v[12:15], a[0:7], v2
v_smfmac_f32_16x16x64_bf16 v[52:55], v[12:15], a[8:15], v2
v_smfmac_f32_16x16x64_bf16 v[56:59], v[12:15], a[16:23], v2
v_smfmac_f32_16x16x64_bf16 v[60:63], v[12:15], a[24:31], v2
v_smfmac_f32_16x16x64_bf16 v[64:67], v[12:15], v[80:87], v2
v_smfmac_f32_16x16x64_bf16 v[68:71], v[12:15], v[88:95], v2
v_smfmac_f32_16x16x64_bf16 v[48:51], v[16:19], a[32:39], v2
v_smfmac_f32_16x16x64_bf16 v[52:55], v[16:19], a[40:47], v2
v_smfmac_f32_16x16x64_bf16 v[56:59], v[16:19], a[48:55], v2
v_smfmac_f32_16x16x64_bf16 v[60:63], v[16:19], a[56:63], v2
v_smfmac_f32_16x16x64_bf16 v[64:67], v[16:19], v[96:103], v2
v_smfmac_f32_16x16x64_bf16 v[68:71], v[16:19], v[104:111], v2
v_smfmac_f32_16x16x64_bf16 v[48:51], v[20:23], a[64:71], v2
v_smfmac_f32_16x16x64_bf16 v[52:55], v[20:23], a[72:79], v2
v_smfmac_f32_16x16x64_bf16 v[56:59], v[20:23], a[80:87], v2
v_smfmac_f32_16x16x64_bf16 v[60:63], v[20:23], a[88:95], v2
v_smfmac_f32_16x16x64_bf16 v[64:67], v[20:23], v[112:119], v2
v_smfmac_f32_16x16x64_bf16 v[68:71], v[20:23], v[120:127], v2
v_smfmac_f32_16x16x64_bf16 v[48:51], v[24:27], a[96:103], v2
v_smfmac_f32_16x16x64_bf16 v[52:55], v[24:27], a[104:111], v2
v_smfmac_f32_16x16x64_bf16 v[56:59], v[24:27], a[112:119], v2
v_smfmac_f32_16x16x64_bf16 v[60:63], v[24:27], a[120:127], v2
v_smfmac_f32_16x16x64_bf16 v[64:67], v[24:27], v[128:135], v2
v_smfmac_f32_16x16x64_bf16 v[68:71], v[24:27], v[136:143], v2
v_smfmac_f32_16x16x64_bf16 v[48:51], v[28:31], a[128:135], v2
v_smfmac_f32_16x16x64_bf16 v[52:55], v[28:31], a[136:143], v2
v_smfmac_f32_16x16x64_bf16 v[56:59], v[28:31], a[144:151], v2
v_smfmac_f32_16x16x64_bf16 v[60:63], v[28:31], a[152:159], v2
v_smfmac_f32_16x16x64_bf16 v[48:51], v[32:35], a[160:167], v2
v_smfmac_f32_16x16x64_bf16 v[52:55], v[32:35], a[168:175], v2
v_smfmac_f32_16x16x64_bf16 v[56:59], v[32:35], a[176:183], v2
v_smfmac_f32_16x16x64_bf16 v[60:63], v[32:35], a[184:191], v2
v_smfmac_f32_16x16x64_bf16 v[48:51], v[36:39], a[192:199], v2
v_smfmac_f32_16x16x64_bf16 v[52:55], v[36:39], a[200:207], v2
v_smfmac_f32_16x16x64_bf16 v[56:59], v[36:39], a[208:215], v2
v_smfmac_f32_16x16x64_bf16 v[60:63], v[36:39], a[216:223], v2
v_smfmac_f32_16x16x64_bf16 v[48:51], v[40:43], a[224:231], v2
v_smfmac_f32_16x16x64_bf16 v[52:55], v[40:43], a[232:239], v2
v_smfmac_f32_16x16x64_bf16 v[56:59], v[40:43], a[240:247], v2
v_smfmac_f32_16x16x64_bf16 v[60:63], v[40:43], a[248:255], v2
v_smfmac_f32_16x16x64_bf16 v[48:51], v[44:47], v[224:231], v2
v_smfmac_f32_16x16x64_bf16 v[52:55], v[44:47], v[232:239], v2
v_smfmac_f32_16x16x64_bf16 v[56:59], v[44:47], v[240:247], v2
v_smfmac_f32_16x16x64_bf16 v[60:63], v[44:47], v[248:255], v2
ds_read_b128 v[12:15], v0
ds_read_b128 v[16:19], v0 offset:4096
ds_read_b128 v[20:23], v0 offset:1024
s_nop 7
v_add_f32 v48, v48, v50
v_add_f32 v49, v49, v51
v_add_f32 v52, v52, v54
v_add_f32 v53, v53, v55
s_branch Lc_post2sc1
Lc_redo32sc1:
s_add_u32 s21, s21, 1
s_cmp_ge_u32 s21, 4194304
s_cbranch_scc1 L_abort
s_branch Lc_redo22sc1
.p2align 6
s_nop 0
s_nop 0
Lc_top3bsc1:
ds_read_b128 v[12:15], v0 offset:16384
ds_read_b128 v[16:19], v0 offset:17408
s_add_u32 s21, s21, 1
s_cmp_ge_u32 s21, 4194304
s_cbranch_scc1 L_abort
s_waitcnt lgkmcnt(0)
v_max_u32 v43, v12, v16
v_cmp_eq_u32 vcc, -1, v43
s_cbranch_vccnz Lc_top3bsc1
v_smfmac_f32_16x16x64_bf16 v[48:51], v[12:15], a[0:7], v2
v_smfmac_f32_16x16x64_bf16 v[52:55], v[12:15], a[8:15], v2
v_smfmac_f32_16x16x64_bf16 v[56:59], v[12:15], a[16:23], v2
buffer_load_dwordx4 v[28:31], v0, s[8:11], s51 offen sc1
v_smfmac_f32_16x16x64_bf16 v[60:63], v[12:15], a[24:31], v2
v_smfmac_f32_16x16x64_bf16 v[64:67], v[12:15], v[80:87], v2
ds_read_b128 v[20:23], v0 offset:18432
v_smfmac_f32_16x16x64_bf16 v[68:71], v[12:15], v[88:95], v2
v_smfmac_f32_16x16x64_bf16 v[48:51], v[16:19], a[32:39], v2
buffer_load_dwordx4 v[32:35], v0, s[8:11], s51 offen offset:1024 sc1
v_smfmac_f32_16x16x64_bf16 v[52:55], v[16:19], a[40:47], v2
v_smfmac_f32_16x16x64_bf16 v[56:59], v[16:19], a[48:55], v2
v_smfmac_f32_16x16x64_bf16 v[60:63], v[16:19], a[56:63], v2
ds_read_b128 v[24:27], v0 offset:19456
s_waitcnt lgkmcnt(1)
v_cmp_eq_u32 vcc, -1, v20
v_smfmac_f32_16x16x64_bf16 v[64:67], v[16:19], v[96:103], v2
buffer_load_dwordx4 v[36:39], v0, s[8:11], s51 offen offset:2048 sc1
v_smfmac_f32_16x16x64_bf16 v[68:71], v[16:19], v[104:111], v2
s_cbranch_vccnz Lc_retry23bsc1
Lc_back23bsc1:
v_smfmac_f32_16x16x64_bf16 v[48:51], v[20:23], a[64:71], v2
v_smfmac_f32_16x16x64_bf16 v[52:55], v[20:23], a[72:79], v2
v_smfmac_f32_16x16x64_bf16 v[56:59], v[20:23], a[80:87], v2
buffer_load_dwordx4 v[40:43], v0, s[8:11], s51 offen offset:3072 sc1
v_smfmac_f32_16x16x64_bf16 v[60:63], v[20:23], a[88:95], v2
s_waitcnt lgkmcnt(0)
v_cmp_eq_u32 vcc, -1, v24
v_smfmac_f32_16x16x64_bf16 v[64:67], v[20:23], v[112:119], v2
v_smfmac_f32_16x16x64_bf16 v[68:71], v[20:23], v[120:127], v2
buffer_load_dwordx4 v[44:47], v0, s[8:11], s52 offen sc1
s_cbranch_vccnz Lc_retry33bsc1
Lc_back33bsc1:
v_smfmac_f32_16x16x64_bf16 v[48:51], v[24:27], a[96:103], v2
s_waitcnt vmcnt(5)
s_barrier
v_smfmac_f32_16x16x64_bf16 v[52:55], v[24:27], a[104:111], v2
s_waitcnt vmcnt(4)
v_cmp_eq_u32 vcc, -1, v28
v_smfmac_f32_16x16x64_bf16 v[56:59], v[24:27], a[112:119], v2
ds_read_b128 v[12:15], v0
v_smfmac_f32_16x16x64_bf16 v[60:63], v[24:27], a[120:127], v2
ds_read_b128 v[16:19], v0 offset:4096
s_cbranch_vccnz Lc_retry43bsc1
Lc_back43bsc1:
v_smfmac_f32_16x16x64_bf16 v[48:51], v[28:31], a[128:135], v2
ds_read_b128 v[20:23], v0 offset:1024
v_smfmac_f32_16x16x64_bf16 v[52:55], v[28:31], a[136:143], v2
s_waitcnt vmcnt(3)
v_cmp_eq_u32 vcc, -1, v32
v_smfmac_f32_16x16x64_bf16 v[56:59], v[28:31], a[144:151], v2
v_smfmac_f32_16x16x64_bf16 v[60:63], v[28:31], a[152:159], v2
s_cbranch_vccnz Lc_retry53bsc1
Lc_back53bsc1:
v_smfmac_f32_16x16x64_bf16 v[48:51], v[32:35], a[160:167], v2
s_add_u32 s19, s55, 0
buffer_store_dword v79, v76, s[8:11], s19 offen sc1
v_smfmac_f32_16x16x64_bf16 v[52:55], v[32:35], a[168:175], v2
s_waitcnt vmcnt(3)
v_cmp_eq_u32 vcc, -1, v36
v_smfmac_f32_16x16x64_bf16 v[56:59], v[32:35], a[176:183], v2
v_smfmac_f32_16x16x64_bf16 v[60:63], v[32:35], a[184:191], v2
s_cbranch_vccnz Lc_retry63bsc1
Lc_back63bsc1:
v_smfmac_f32_16x16x64_bf16 v[48:51], v[36:39], a[192:199], v2
s_add_u32 s19, s55, 4096
buffer_store_dword v79, v76, s[8:11], s19 offen sc1
v_smfmac_f32_16x16x64_bf16 v[52:55], v[36:39], a[200:207], v2
s_waitcnt vmcnt(3)
v_cmp_eq_u32 vcc, -1, v40
v_smfmac_f32_16x16x64_bf16 v[56:59], v[36:39], a[208:215], v2
v_smfmac_f32_16x16x64_bf16 v[60:63], v[36:39], a[216:223], v2
s_cbranch_vccnz Lc_retry73bsc1
Lc_back73bsc1:
v_smfmac_f32_16x16x64_bf16 v[48:51], v[40:43], a[224:231], v2
v_smfmac_f32_16x16x64_bf16 v[52:55], v[40:43], a[232:239], v2
s_waitcnt vmcnt(2)
v_cmp_eq_u32 vcc, -1, v44
v_smfmac_f32_16x16x64_bf16 v[56:59], v[40:43], a[240:247], v2
v_smfmac_f32_16x16x64_bf16 v[60:63], v[40:43], a[248:255], v2
s_cbranch_vccnz Lc_retry83bsc1
Lc_back83bsc1:
v_smfmac_f32_16x16x64_bf16 v[48:51], v[44:47], v[224:231], v2
v_smfmac_f32_16x16x64_bf16 v[52:55], v[44:47], v[232:239], v2
v_lshlrev_b32 v78, 3, v0
s_add_u32 s19, s39, 8192
buffer_load_dword v78, v78, s[8:11], s39 offen
buffer_load_dword v78, v78, s[8:11], s19 offen
s_add_u32 s39, s39, s97
s_mov_b32 s97, 524288
v_smfmac_f32_16x16x64_bf16 v[56:59], v[44:47], v[240:247], v2
v_add_f32 v48, v48, v50
v_smfmac_f32_16x16x64_bf16 v[60:63], v[44:47], v[248:255], v2
v_add_f32 v49, v49, v51
v_smfmac_f32_16x16x64_bf16 v[64:67], v[24:27], v[128:135], v2
v_add_f32 v52, v52, v54
v_smfmac_f32_16x16x64_bf16 v[68:71], v[24:27], v[136:143], v2
v_add_f32 v53, v53, v55
Lc_post3bsc1:
v_add_f32 v56, v56, v58
v_add_f32 v60, v60, v62
v_cvt_pk_bf16_f32 v50, v48, v52
v_cvt_pk_bf16_f32 v51, v56, v60
v_xor_b32 v58, 16, v3
ds_write_b64 v3, v[50:51] offset:16384
v_add_f32 v57, v57, v59
v_add_f32 v61, v61, v63
v_cvt_pk_bf16_f32 v54, v49, v53
v_cvt_pk_bf16_f32 v55, v57, v61
ds_write_b64 v58, v[54:55] offset:16384
v_cmp_u_f32 vcc, v48, v49
v_smfmac_f32_16x16x64_bf16 v[64:67], v[28:31], v[144:151], v2
v_smfmac_f32_16x16x64_bf16 v[68:71], v[28:31], v[152:159], v2
s_cbranch_vccnz Lc_redo3bsc1
Lc_redoback3bsc1:
v_smfmac_f32_16x16x64_bf16 v[64:67], v[32:35], v[160:167], v2
v_smfmac_f32_16x16x64_bf16 v[68:71], v[32:35], v[168:175], v2
v_xor_b32 v32, 64, v4
s_waitcnt lgkmcnt(0)
s_barrier
ds_read_b128 v[28:31], v4 offset:16384
ds_read_b128 v[32:35], v32 offset:17408
ds_read_b128 v[56:59], v0 offset:5120
v_smfmac_f32_16x16x64_bf16 v[64:67], v[36:39], v[176:183], v2
v_smfmac_f32_16x16x64_bf16 v[68:71], v[36:39], v[184:191], v2
ds_read_b128 v[36:39], v4 offset:18432
ds_read_b128 v[60:63], v0 offset:2048
ds_read_b128 v[24:27], v0 offset:6144
v_smfmac_f32_16x16x64_bf16 v[64:67], v[40:43], v[192:199], v2
v_smfmac_f32_16x16x64_bf16 v[68:71], v[40:43], v[200:207], v2
v_xor_b32 v40, 64, v4
ds_read_b128 v[40:43], v40 offset:19456
v_smfmac_f32_16x16x64_bf16 v[64:67], v[44:47], v[208:215], v2
v_bfe_u32 v48, v0, 4, 3
v_lshlrev_b32 v48, 2, v48
buffer_load_dword v78, v48, s[8:11], s35 offen sc1
v_smfmac_f32_16x16x64_bf16 v[68:71], v[44:47], v[216:223], v2
s_waitcnt lgkmcnt(6)
v_mfma_f32_16x16x32_bf16 v[48:51], v[12:15], v[28:31], 0
ds_read_b128 v[12:15], v0 offset:3072
v_mfma_f32_16x16x32_bf16 v[52:55], v[16:19], v[28:31], 0
ds_read_b128 v[16:19], v0 offset:7168
v_mfma_f32_16x16x32_bf16 v[44:47], v[28:31], v[28:31], 0
s_waitcnt lgkmcnt(6)
v_mfma_f32_16x16x32_bf16 v[48:51], v[20:23], v[32:35], v[48:51]
v_add_f32 v64, v64, v66
v_add_f32 v65, v65, v67
v_mfma_f32_16x16x32_bf16 v[52:55], v[56:59], v[32:35], v[52:55]
v_add_f32 v68, v68, v70
ds_read_b128 v[56:59], v0 offset:14336
v_mfma_f32_16x16x32_bf16 v[44:47], v[32:35], v[32:35], v[44:47]
v_add_f32 v69, v69, v71
v_cvt_pk_bf16_f32 v66, v64, v65
s_waitcnt lgkmcnt(4)
v_mfma_f32_16x16x32_bf16 v[48:51], v[60:63], v[36:39], v[48:51]
v_cvt_pk_bf16_f32 v67, v68, v69
ds_read_b128 v[60:63], v0 offset:15360
v_mfma_f32_16x16x32_bf16 v[52:55], v[24:27], v[36:39], v[52:55]
s_cmp_eq_u32 s18, 62
v_mfma_f32_16x16x32_bf16 v[44:47], v[36:39], v[36:39], v[44:47]
s_cbranch_scc1 Lc_vm3bsc1
Lc_vmb3bsc1:
s_waitcnt lgkmcnt(2)
v_mfma_f32_16x16x32_bf16 v[44:47], v[40:43], v[40:43], v[44:47]
s_barrier
v_mfma_f32_16x16x32_bf16 v[48:51], v[12:15], v[40:43], v[48:51]
v_mfma_f32_16x16x32_bf16 v[52:55], v[16:19], v[40:43], v[52:55]
v_mov_b32 v36, -1
v_mov_b32 v37, -1
v_mov_b32 v38, -1
s_nop 0
v_max3_f32 v64, v46, v47, v48
v_max3_f32 v64, v64, v49, v50
v_mov_b32 v39, -1
s_nop 0
v_max3_f32 v65, v51, v52, v53
v_max3_f32 v65, v65, v54, v55
v_max_f32 v44, v64, v65
v_max_f32 v65, v64, v65
s_nop 1
v_permlane32_swap_b32 v44, v65
v_max_f32 v64, v44, v65
v_max_f32 v65, v44, v65
s_mov_b32 s20, s24
s_bitcmp0_b32 s18, 1
v_permlane16_swap_b32 v64, v65
v_max_f32 v64, v64, v65
v_fma_f32 v64, v64, s30, v5
v_pk_fma_f32 v[46:47], v[46:47], s[30:31], v[64:65] op_sel_hi:[1,1,0] neg_lo:[0,0,1] neg_hi:[0,0,1]
v_pk_fma_f32 v[48:49], v[48:49], s[30:31], v[64:65] op_sel_hi:[1,1,0] neg_lo:[0,0,1] neg_hi:[0,0,1]
v_pk_fma_f32 v[50:51], v[50:51], s[30:31], v[64:65] op_sel_hi:[1,1,0] neg_lo:[0,0,1] neg_hi:[0,0,1]
v_pk_fma_f32 v[52:53], v[52:53], s[30:31], v[64:65] op_sel_hi:[1,1,0] neg_lo:[0,0,1] neg_hi:[0,0,1]
v_pk_fma_f32 v[54:55], v[54:55], s[30:31], v[64:65] op_sel_hi:[1,1,0] neg_lo:[0,0,1] neg_hi:[0,0,1]
v_exp_f32 v46, v46
v_exp_f32 v47, v47
v_exp_f32 v48, v48
v_cvt_pk_bf16_f32 v44, v46, v47
v_exp_f32 v49, v49
v_exp_f32 v50, v50
v_mov_b32_dpp v45, v44 quad_perm:[2,3,0,1] row_mask:0xf bank_mask:0xf
v_exp_f32 v51, v51
v_cvt_pk_bf16_f32 v48, v48, v49
v_mfma_f32_16x16x16_bf16 v[40:43], v[66:67], v[44:45], 0
ds_write_b128 v0, v[36:39] offset:19456
v_exp_f32 v52, v52
v_mfma_f32_16x16x16_bf16 v[68:71], v[8:9], v[44:45], 0
v_exp_f32 v53, v53
v_cvt_pk_bf16_f32 v49, v50, v51
v_exp_f32 v54, v54
v_exp_f32 v55, v55
v_cvt_pk_bf16_f32 v50, v52, v53
v_mov_b32_dpp v52, v48 quad_perm:[2,3,0,1] row_mask:0xf bank_mask:0xf
v_cvt_pk_bf16_f32 v51, v54, v55
v_mov_b32_dpp v53, v49 quad_perm:[2,3,0,1] row_mask:0xf bank_mask:0xf
s_cselect_b32 s32, -1, 0
s_waitcnt lgkmcnt(1)
v_mfma_f32_16x16x32_bf16 v[68:71], v[8:11], v[48:51], v[68:71]
v_mov_b32_dpp v54, v50 quad_perm:[2,3,0,1] row_mask:0xf bank_mask:0xf
v_mov_b32_dpp v55, v51 quad_perm:[2,3,0,1] row_mask:0xf bank_mask:0xf
v_mfma_f32_16x16x32_bf16 v[40:43], v[56:59], v[48:51], v[40:43]
s_mov_b32 s53, s25
s_add_u32 s55, s22, s34
v_mfma_f32_16x16x32_bf16 v[40:43], v[60:63], v[52:55], v[40:43]
s_add_u32 s49, s23, s34
s_add_u32 s38, s38, 64
v_rcp_f32 v56, v68
s_add_u32 s18, s18, 1
s_add_u32 s27, s27, 9216
v_mov_b32_dpp v56, v56 quad_perm:[0,1,0,1] row_mask:0xf bank_mask:0xf
s_nop 1
v_pk_mul_f32 v[40:41], v[40:41], v[56:57] op_sel_hi:[1,0]
v_pk_mul_f32 v[42:43], v[42:43], v[56:57] op_sel_hi:[1,0]
v_cvt_pk_bf16_f32 v40, v40, v41
v_cvt_pk_bf16_f32 v41, v42, v43
ds_write_b64 v0, v[40:41] offset:21512
s_mov_b32 s22, s23
s_add_u32 s23, s23, 9216
s_waitcnt lgkmcnt(0)
s_barrier
s_cmp_eq_u32 s23, 12610560
s_cselect_b32 s23, 12582912, s23
s_add_u32 s24, s24, s33
s_add_u32 s25, s25, s33
s_sub_u32 s33, 0, s33
s_add_u32 s51, s22, 4096
s_add_u32 s52, s22, 8192
s_mov_b32 m0, 0
s_add_u32 s19, s26, 0
buffer_load_dwordx4 v0, s[8:11], s19 offen lds
buffer_load_dwordx4 v0, s[8:11], s19 offen offset:1024 lds
buffer_load_dwordx4 v0, s[8:11], s19 offen offset:2048 lds
buffer_load_dwordx4 v0, s[8:11], s19 offen offset:3072 lds
s_mov_b32 m0, 4096
s_add_u32 s19, s26, 4096
buffer_load_dwordx4 v0, s[8:11], s19 offen lds
buffer_load_dwordx4 v0, s[8:11], s19 offen offset:1024 lds
buffer_load_dwordx4 v0, s[8:11], s19 offen offset:2048 lds
buffer_load_dwordx4 v0, s[8:11], s19 offen offset:3072 lds
s_mov_b32 m0, 8192
s_add_u32 s19, s26, 8192
buffer_load_dwordx4 v0, s[8:11], s19 offen lds
buffer_load_dwordx4 v0, s[8:11], s19 offen offset:1024 lds
buffer_load_dwordx4 v0, s[8:11], s19 offen offset:2048 lds
buffer_load_dwordx4 v0, s[8:11], s19 offen offset:3072 lds
s_mov_b32 m0, 12288
s_add_u32 s19, s26, 12288
buffer_load_dwordx4 v0, s[8:11], s19 offen lds
buffer_load_dwordx4 v0, s[8:11], s19 offen offset:1024 lds
buffer_load_dwordx4 v0, s[8:11], s19 offen offset:2048 lds
buffer_load_dwordx4 v0, s[8:11], s19 offen offset:3072 lds
s_add_u32 s26, s26, 524288
s_mov_b32 m0, 16384
v_mov_b64 v[48:49], 0
v_mov_b64 v[50:51], 0
v_mov_b64 v[68:69], 0
v_mov_b64 v[70:71], 0
s_add_u32 s72, s53, 131072
s_add_u32 s73, s53, 262144
s_mov_b32 s19, s74
Lc_dl3bsc1:
s_sub_u32 s19, s19, 1
s_cbranch_scc0 Lc_dl3bsc1
s_mov_b32 s75, 0
buffer_load_dwordx4 v[20:23], v7, s[8:11], s53 offen sc1
buffer_load_dwordx4 v[24:27], v7, s[8:11], s53 offen offset:1024 sc1
buffer_load_dwordx4 v[28:31], v7, s[8:11], s53 offen offset:2048 sc1
buffer_load_dwordx4 v[32:35], v7, s[8:11], s53 offen offset:3072 sc1
Lc_rA3bsc1:
s_waitcnt vmcnt(3)
v_mfma_f32_16x16x32_bf16 v[36:39], v[72:75], v[20:23], 0
buffer_load_dwordx4 v[52:55], v7, s[8:11], s72 offen sc1
buffer_load_dwordx4 v[56:59], v7, s[8:11], s72 offen offset:1024 sc1
v_bitop3_b32 v41, v20, v22, s32 bitop3:0x7e
s_waitcnt vmcnt(4)
v_mfma_f32_16x16x32_bf16 v[36:39], v[72:75], v[24:27], v[36:39]
buffer_load_dwordx4 v[60:63], v7, s[8:11], s72 offen offset:2048 sc1
buffer_load_dwordx4 v[64:67], v7, s[8:11], s72 offen offset:3072 sc1
v_bitop3_b32 v42, v24, v26, s32 bitop3:0x7e
s_waitcnt vmcnt(5)
v_mfma_f32_16x16x32_bf16 v[36:39], v[72:75], v[28:31], v[36:39]
v_bitop3_b32 v43, v28, v30, s32 bitop3:0x7e
s_waitcnt vmcnt(4)
v_mfma_f32_16x16x32_bf16 v[36:39], v[72:75], v[32:35], v[36:39]
v_or3_b32 v41, v41, v42, v43
v_bitop3_b32 v42, v32, v34, s32 bitop3:0x7e
v_bitop3_b32 v41, v41, v42, 1 bitop3:0xa8
v_cmp_ne_u32 vcc, 0, v41
s_cbranch_vccnz Lc_rB3bsc1
s_nop 2
v_add_f32_dpp v36, v36, v36 row_ror:8 row_mask:0xf bank_mask:0xf
v_add_f32_dpp v37, v37, v37 row_ror:8 row_mask:0xf bank_mask:0xf
v_cvt_pk_bf16_f32 v40, v36, v37
buffer_store_dword v40, v76, s[8:11], s49 offen sc1
s_add_u32 s49, s49, 4096
s_waitcnt vmcnt(4)
v_mfma_f32_16x16x32_bf16 v[36:39], v[72:75], v[52:55], 0
v_bitop3_b32 v41, v52, v54, s32 bitop3:0x7e
s_waitcnt vmcnt(3)
v_mfma_f32_16x16x32_bf16 v[36:39], v[72:75], v[56:59], v[36:39]
v_bitop3_b32 v42, v56, v58, s32 bitop3:0x7e
s_waitcnt vmcnt(2)
v_mfma_f32_16x16x32_bf16 v[36:39], v[72:75], v[60:63], v[36:39]
v_bitop3_b32 v43, v60, v62, s32 bitop3:0x7e
s_waitcnt vmcnt(1)
v_mfma_f32_16x16x32_bf16 v[36:39], v[72:75], v[64:67], v[36:39]
v_or3_b32 v41, v41, v42, v43
v_bitop3_b32 v42, v64, v66, s32 bitop3:0x7e
v_bitop3_b32 v41, v41, v42, 1 bitop3:0xa8
v_cmp_ne_u32 vcc, 0, v41
s_cbranch_vccnz Lc_rF103bsc1
Lc_rok103bsc1:
s_nop 2
v_add_f32_dpp v36, v36, v36 row_ror:8 row_mask:0xf bank_mask:0xf
v_add_f32_dpp v37, v37, v37 row_ror:8 row_mask:0xf bank_mask:0xf
v_cvt_pk_bf16_f32 v40, v36, v37
buffer_store_dword v40, v76, s[8:11], s49 offen sc1
Lc_rdone3bsc1:
v_mov_b64 v[52:53], 0
v_mov_b64 v[54:55], 0
v_mov_b64 v[56:57], 0
v_mov_b64 v[58:59], 0
v_mov_b64 v[60:61], 0
v_mov_b64 v[62:63], 0
v_mov_b64 v[64:65], 0
v_mov_b64 v[66:67], 0
s_cmp_eq_u32 s18, 40
s_cbranch_scc1 Lc_pre3bsc1
Lc_preb3bsc1:
v_cmp_eq_u32 vcc, 0, v78
s_cbranch_vccnz Lc_kvslow3bsc1
Lc_kvback3bsc1:
s_add_u32 s35, s35, 1024
s_cmp_eq_u32 s18, 63
s_cbranch_scc0 Lc_top3bsc1
s_lshl_b32 s19, s17, 5
s_add_u32 s19, s19, 129048
buffer_store_dword v2, off, s[8:11], s19 sc1
buffer_store_dword v2, off, s[8:11], s19 offset:4 sc1
s_branch Lc_topL3
Lc_rB3bsc1:
buffer_load_dwordx4 v[20:23], v7, s[8:11], s53 offen sc1
buffer_load_dwordx4 v[24:27], v7, s[8:11], s53 offen offset:1024 sc1
buffer_load_dwordx4 v[28:31], v7, s[8:11], s53 offen offset:2048 sc1
buffer_load_dwordx4 v[32:35], v7, s[8:11], s53 offen offset:3072 sc1
s_add_u32 s75, s75, 1
s_add_u32 s21, s21, 1
s_cmp_ge_u32 s21, 4194304
s_cbranch_scc1 L_abort
s_branch Lc_rA3bsc1
Lc_vm3bsc1:
v_lshrrev_b32 v64, 1, v0
s_mul_i32 s19, s17, 4096
s_add_u32 s19, s19, 24907264
buffer_store_dwordx2 v[66:67], v64, s[8:11], s19 offen sc1
s_branch Lc_vmb3bsc1
Lc_rF103bsc1:
buffer_load_dwordx4 v[52:55], v7, s[8:11], s72 offen sc1
buffer_load_dwordx4 v[56:59], v7, s[8:11], s72 offen offset:1024 sc1
buffer_load_dwordx4 v[60:63], v7, s[8:11], s72 offen offset:2048 sc1
buffer_load_dwordx4 v[64:67], v7, s[8:11], s72 offen offset:3072 sc1
s_add_u32 s21, s21, 1
s_cmp_ge_u32 s21, 4194304
s_cbranch_scc1 L_abort
s_waitcnt vmcnt(3)
v_mfma_f32_16x16x32_bf16 v[36:39], v[72:75], v[52:55], 0
v_bitop3_b32 v41, v52, v54, s32 bitop3:0x7e
s_waitcnt vmcnt(2)
v_mfma_f32_16x16x32_bf16 v[36:39], v[72:75], v[56:59], v[36:39]
v_bitop3_b32 v42, v56, v58, s32 bitop3:0x7e
s_waitcnt vmcnt(1)
v_mfma_f32_16x16x32_bf16 v[36:39], v[72:75], v[60:63], v[36:39]
v_bitop3_b32 v43, v60, v62, s32 bitop3:0x7e
s_waitcnt vmcnt(0)
v_mfma_f32_16x16x32_bf16 v[36:39], v[72:75], v[64:67], v[36:39]
v_or3_b32 v41, v41, v42, v43
v_bitop3_b32 v42, v64, v66, s32 bitop3:0x7e
v_bitop3_b32 v41, v41, v42, 1 bitop3:0xa8
v_cmp_ne_u32 vcc, 0, v41
s_cbranch_vccz Lc_rok103bsc1
s_branch Lc_rF103bsc1
Lc_pre3bsc1:
v_mov_b32 v12, 0
global_load_dword v13, v12, s[6:7] offset:104 sc1
s_waitcnt vmcnt(0)
v_cmp_gt_u32 vcc, 28, v13
s_cbranch_vccz Lc_preb3bsc1
s_add_u32 s21, s21, 1
s_cmp_ge_u32 s21, 4194304
s_cbranch_scc1 L_abort
s_branch Lc_pre3bsc1
Lc_retry23bsc1:
buffer_load_dwordx4 v0, s[8:11], s22 offen offset:2048 sc1 lds
ds_read_b128 v[20:23], v0 offset:18432
s_add_u32 s21, s21, 1
s_cmp_ge_u32 s21, 4194304
s_cbranch_scc1 L_abort
s_waitcnt lgkmcnt(0)
v_cmp_eq_u32 vcc, -1, v20
s_cbranch_vccnz Lc_retry23bsc1
s_waitcnt vmcnt(0)
s_branch Lc_back23bsc1
Lc_retry33bsc1:
buffer_load_dwordx4 v0, s[8:11], s22 offen offset:3072 sc1 lds
ds_read_b128 v[24:27], v0 offset:19456
s_add_u32 s21, s21, 1
s_cmp_ge_u32 s21, 4194304
s_cbranch_scc1 L_abort
s_waitcnt lgkmcnt(0)
v_cmp_eq_u32 vcc, -1, v24
s_cbranch_vccnz Lc_retry33bsc1
s_waitcnt vmcnt(0)
s_branch Lc_back33bsc1
Lc_retry43bsc1:
buffer_load_dwordx4 v[28:31], v0, s[8:11], s51 offen sc1
s_waitcnt vmcnt(0)
v_cmp_eq_u32 vcc, -1, v28
s_cbranch_vccz Lc_back43bsc1
s_add_u32 s21, s21, 1
s_cmp_ge_u32 s21, 4194304
s_cbranch_scc1 L_abort
s_branch Lc_retry43bsc1
Lc_retry53bsc1:
buffer_load_dwordx4 v[32:35], v0, s[8:11], s51 offen offset:1024 sc1
s_waitcnt vmcnt(0)
v_cmp_eq_u32 vcc, -1, v32
s_cbranch_vccz Lc_back53bsc1
s_add_u32 s21, s21, 1
s_cmp_ge_u32 s21, 4194304
s_cbranch_scc1 L_abort
s_branch Lc_retry53bsc1
Lc_retry63bsc1:
buffer_load_dwordx4 v[36:39], v0, s[8:11], s51 offen offset:2048 sc1
s_waitcnt vmcnt(0)
v_cmp_eq_u32 vcc, -1, v36
s_cbranch_vccz Lc_back63bsc1
s_add_u32 s21, s21, 1
s_cmp_ge_u32 s21, 4194304
s_cbranch_scc1 L_abort
s_branch Lc_retry63bsc1
Lc_retry73bsc1:
buffer_load_dwordx4 v[40:43], v0, s[8:11], s51 offen offset:3072 sc1
s_waitcnt vmcnt(0)
v_cmp_eq_u32 vcc, -1, v40
s_cbranch_vccz Lc_back73bsc1
s_add_u32 s21, s21, 1
s_cmp_ge_u32 s21, 4194304
s_cbranch_scc1 L_abort
s_branch Lc_retry73bsc1
Lc_retry83bsc1:
buffer_load_dwordx4 v[44:47], v0, s[8:11], s52 offen sc1
s_waitcnt vmcnt(0)
v_cmp_eq_u32 vcc, -1, v44
s_cbranch_vccz Lc_back83bsc1
s_add_u32 s21, s21, 1
s_cmp_ge_u32 s21, 4194304
s_cbranch_scc1 L_abort
s_branch Lc_retry83bsc1
Lc_redo3bsc1:
s_cmp_eq_u32 s48, s18
s_cbranch_scc1 Lc_redoback3bsc1
s_mov_b32 s48, s18
s_waitcnt lgkmcnt(0)
s_nop 15
Lc_redo23bsc1:
buffer_load_dwordx4 v[12:15], v0, s[8:11], s22 offen sc1
buffer_load_dwordx4 v[16:19], v0, s[8:11], s22 offen offset:1024 sc1
buffer_load_dwordx4 v[20:23], v0, s[8:11], s22 offen offset:2048 sc1
buffer_load_dwordx4 v[24:27], v0, s[8:11], s22 offen offset:3072 sc1
buffer_load_dwordx4 v[28:31], v0, s[8:11], s51 offen sc1
buffer_load_dwordx4 v[32:35], v0, s[8:11], s51 offen offset:1024 sc1
buffer_load_dwordx4 v[36:39], v0, s[8:11], s51 offen offset:2048 sc1
buffer_load_dwordx4 v[40:43], v0, s[8:11], s51 offen offset:3072 sc1
buffer_load_dwordx4 v[44:47], v0, s[8:11], s52 offen sc1
v_mov_b64 v[48:49], 0
v_mov_b64 v[50:51], 0
v_mov_b64 v[52:53], 0
v_mov_b64 v[54:55], 0
v_mov_b64 v[56:57], 0
v_mov_b64 v[58:59], 0
v_mov_b64 v[60:61], 0
v_mov_b64 v[62:63], 0
v_mov_b64 v[64:65], 0
v_mov_b64 v[66:67], 0
v_mov_b64 v[68:69], 0
v_mov_b64 v[70:71], 0
s_waitcnt vmcnt(0)
v_max_u32 v48, v12, v13
v_max3_u32 v48, v48, v14, v15
v_max3_u32 v48, v48, v16, v17
v_max3_u32 v48, v48, v18, v19
v_max3_u32 v48, v48, v20, v21
v_max3_u32 v48, v48, v22, v23
v_max3_u32 v48, v48, v24, v25
v_max3_u32 v48, v48, v26, v27
v_max3_u32 v48, v48, v28, v29
v_max3_u32 v48, v48, v30, v31
v_max3_u32 v48, v48, v32, v33
v_max3_u32 v48, v48, v34, v35
v_max3_u32 v48, v48, v36, v37
v_max3_u32 v48, v48, v38, v39
v_max3_u32 v48, v48, v40, v41
v_max3_u32 v48, v48, v42, v43
v_max3_u32 v48, v48, v44, v45
v_max3_u32 v48, v48, v46, v47
v_cmp_eq_u32 vcc, -1, v48
v_mov_b32 v48, 0
s_cbranch_vccnz Lc_redo33bsc1
s_nop 0
v_smfmac_f32_16x16x64_bf16 v[48:51], v[12:15], a[0:7], v2
v_smfmac_f32_16x16x64_bf16 v[52:55], v[12:15], a[8:15], v2
v_smfmac_f32_16x16x64_bf16 v[56:59], v[12:15], a[16:23], v2
v_smfmac_f32_16x16x64_bf16 v[60:63], v[12:15], a[24:31], v2
v_smfmac_f32_16x16x64_bf16 v[64:67], v[12:15], v[80:87], v2
v_smfmac_f32_16x16x64_bf16 v[68:71], v[12:15], v[88:95], v2
v_smfmac_f32_16x16x64_bf16 v[48:51], v[16:19], a[32:39], v2
v_smfmac_f32_16x16x64_bf16 v[52:55], v[16:19], a[40:47], v2
v_smfmac_f32_16x16x64_bf16 v[56:59], v[16:19], a[48:55], v2
v_smfmac_f32_16x16x64_bf16 v[60:63], v[16:19], a[56:63], v2
v_smfmac_f32_16x16x64_bf16 v[64:67], v[16:19], v[96:103], v2
v_smfmac_f32_16x16x64_bf16 v[68:71], v[16:19], v[104:111], v2
v_smfmac_f32_16x16x64_bf16 v[48:51], v[20:23], a[64:71], v2
v_smfmac_f32_16x16x64_bf16 v[52:55], v[20:23], a[72:79], v2
v_smfmac_f32_16x16x64_bf16 v[56:59], v[20:23], a[80:87], v2
v_smfmac_f32_16x16x64_bf16 v[60:63], v[20:23], a[88:95], v2
v_smfmac_f32_16x16x64_bf16 v[64:67], v[20:23], v[112:119], v2
v_smfmac_f32_16x16x64_bf16 v[68:71], v[20:23], v[120:127], v2
v_smfmac_f32_16x16x64_bf16 v[48:51], v[24:27], a[96:103], v2
v_smfmac_f32_16x16x64_bf16 v[52:55], v[24:27], a[104:111], v2
v_smfmac_f32_16x16x64_bf16 v[56:59], v[24:27], a[112:119], v2
v_smfmac_f32_16x16x64_bf16 v[60:63], v[24:27], a[120:127], v2
v_smfmac_f32_16x16x64_bf16 v[64:67], v[24:27], v[128:135], v2
v_smfmac_f32_16x16x64_bf16 v[68:71], v[24:27], v[136:143], v2
v_smfmac_f32_16x16x64_bf16 v[48:51], v[28:31], a[128:135], v2
v_smfmac_f32_16x16x64_bf16 v[52:55], v[28:31], a[136:143], v2
v_smfmac_f32_16x16x64_bf16 v[56:59], v[28:31], a[144:151], v2
v_smfmac_f32_16x16x64_bf16 v[60:63], v[28:31], a[152:159], v2
v_smfmac_f32_16x16x64_bf16 v[48:51], v[32:35], a[160:167], v2
v_smfmac_f32_16x16x64_bf16 v[52:55], v[32:35], a[168:175], v2
v_smfmac_f32_16x16x64_bf16 v[56:59], v[32:35], a[176:183], v2
v_smfmac_f32_16x16x64_bf16 v[60:63], v[32:35], a[184:191], v2
v_smfmac_f32_16x16x64_bf16 v[48:51], v[36:39], a[192:199], v2
v_smfmac_f32_16x16x64_bf16 v[52:55], v[36:39], a[200:207], v2
v_smfmac_f32_16x16x64_bf16 v[56:59], v[36:39], a[208:215], v2
v_smfmac_f32_16x16x64_bf16 v[60:63], v[36:39], a[216:223], v2
v_smfmac_f32_16x16x64_bf16 v[48:51], v[40:43], a[224:231], v2
v_smfmac_f32_16x16x64_bf16 v[52:55], v[40:43], a[232:239], v2
v_smfmac_f32_16x16x64_bf16 v[56:59], v[40:43], a[240:247], v2
v_smfmac_f32_16x16x64_bf16 v[60:63], v[40:43], a[248:255], v2
v_smfmac_f32_16x16x64_bf16 v[48:51], v[44:47], v[224:231], v2
v_smfmac_f32_16x16x64_bf16 v[52:55], v[44:47], v[232:239], v2
v_smfmac_f32_16x16x64_bf16 v[56:59], v[44:47], v[240:247], v2
v_smfmac_f32_16x16x64_bf16 v[60:63], v[44:47], v[248:255], v2
ds_read_b128 v[12:15], v0
ds_read_b128 v[16:19], v0 offset:4096
ds_read_b128 v[20:23], v0 offset:1024
s_nop 7
v_add_f32 v48, v48, v50
v_add_f32 v49, v49, v51
v_add_f32 v52, v52, v54
v_add_f32 v53, v53, v55
s_branch Lc_post3bsc1
Lc_redo33bsc1:
s_add_u32 s21, s21, 1
s_cmp_ge_u32 s21, 4194304
s_cbranch_scc1 L_abort
s_branch Lc_redo23bsc1
Lc_kvslow3bsc1:
s_cmp_ge_u32 s18, 62
s_cbranch_scc1 Lc_kvback3bsc1
v_bfe_u32 v40, v0, 4, 3
v_lshlrev_b32 v40, 2, v40
Lc_wkvx3bsc1:
buffer_load_dword v41, v40, s[8:11], s35 offen sc1
s_waitcnt vmcnt(0)
v_cmp_eq_u32 vcc, 0, v41
s_cbranch_vccz Lc_wkv_okx3bsc1
s_sleep 4
s_add_u32 s21, s21, 1
s_cmp_ge_u32 s21, 4194304
s_cbranch_scc1 L_abort
s_branch Lc_wkvx3bsc1
Lc_wkv_okx3bsc1:
s_branch Lc_kvback3bsc1
.p2align 6
s_nop 0
s_nop 0
Lc_top3csc1:
ds_read_b128 v[12:15], v0 offset:16384
ds_read_b128 v[16:19], v0 offset:17408
s_add_u32 s21, s21, 1
s_cmp_ge_u32 s21, 4194304
s_cbranch_scc1 L_abort
s_waitcnt lgkmcnt(0)
v_max_u32 v43, v12, v16
v_cmp_eq_u32 vcc, -1, v43
s_cbranch_vccnz Lc_top3csc1
v_smfmac_f32_16x16x64_bf16 v[48:51], v[12:15], a[0:7], v2
v_smfmac_f32_16x16x64_bf16 v[52:55], v[12:15], a[8:15], v2
v_smfmac_f32_16x16x64_bf16 v[56:59], v[12:15], a[16:23], v2
buffer_load_dwordx4 v[28:31], v0, s[8:11], s51 offen sc1
v_smfmac_f32_16x16x64_bf16 v[60:63], v[12:15], a[24:31], v2
v_smfmac_f32_16x16x64_bf16 v[64:67], v[12:15], v[80:87], v2
ds_read_b128 v[20:23], v0 offset:18432
v_smfmac_f32_16x16x64_bf16 v[68:71], v[12:15], v[88:95], v2
v_smfmac_f32_16x16x64_bf16 v[48:51], v[16:19], a[32:39], v2
buffer_load_dwordx4 v[32:35], v0, s[8:11], s51 offen offset:1024 sc1
v_smfmac_f32_16x16x64_bf16 v[52:55], v[16:19], a[40:47], v2
v_smfmac_f32_16x16x64_bf16 v[56:59], v[16:19], a[48:55], v2
v_smfmac_f32_16x16x64_bf16 v[60:63], v[16:19], a[56:63], v2
ds_read_b128 v[24:27], v0 offset:19456
s_waitcnt lgkmcnt(1)
v_cmp_eq_u32 vcc, -1, v20
v_smfmac_f32_16x16x64_bf16 v[64:67], v[16:19], v[96:103], v2
buffer_load_dwordx4 v[36:39], v0, s[8:11], s51 offen offset:2048 sc1
v_smfmac_f32_16x16x64_bf16 v[68:71], v[16:19], v[104:111], v2
s_cbranch_vccnz Lc_retry23csc1
Lc_back23csc1:
v_smfmac_f32_16x16x64_bf16 v[48:51], v[20:23], a[64:71], v2
v_smfmac_f32_16x16x64_bf16 v[52:55], v[20:23], a[72:79], v2
v_smfmac_f32_16x16x64_bf16 v[56:59], v[20:23], a[80:87], v2
buffer_load_dwordx4 v[40:43], v0, s[8:11], s51 offen offset:3072 sc1
v_smfmac_f32_16x16x64_bf16 v[60:63], v[20:23], a[88:95], v2
s_waitcnt lgkmcnt(0)
v_cmp_eq_u32 vcc, -1, v24
v_smfmac_f32_16x16x64_bf16 v[64:67], v[20:23], v[112:119], v2
v_smfmac_f32_16x16x64_bf16 v[68:71], v[20:23], v[120:127], v2
buffer_load_dwordx4 v[44:47], v0, s[8:11], s52 offen sc1
s_cbranch_vccnz Lc_retry33csc1
Lc_back33csc1:
v_smfmac_f32_16x16x64_bf16 v[48:51], v[24:27], a[96:103], v2
s_waitcnt vmcnt(5)
s_barrier
v_smfmac_f32_16x16x64_bf16 v[52:55], v[24:27], a[104:111], v2
s_waitcnt vmcnt(4)
v_cmp_eq_u32 vcc, -1, v28
v_smfmac_f32_16x16x64_bf16 v[56:59], v[24:27], a[112:119], v2
ds_read_b128 v[12:15], v0
v_smfmac_f32_16x16x64_bf16 v[60:63], v[24:27], a[120:127], v2
ds_read_b128 v[16:19], v0 offset:4096
s_cbranch_vccnz Lc_retry43csc1
Lc_back43csc1:
v_smfmac_f32_16x16x64_bf16 v[48:51], v[28:31], a[128:135], v2
ds_read_b128 v[20:23], v0 offset:1024
v_smfmac_f32_16x16x64_bf16 v[52:55], v[28:31], a[136:143], v2
s_waitcnt vmcnt(3)
v_cmp_eq_u32 vcc, -1, v32
v_smfmac_f32_16x16x64_bf16 v[56:59], v[28:31], a[144:151], v2
v_smfmac_f32_16x16x64_bf16 v[60:63], v[28:31], a[152:159], v2
s_cbranch_vccnz Lc_retry53csc1
Lc_back53csc1:
v_smfmac_f32_16x16x64_bf16 v[48:51], v[32:35], a[160:167], v2
s_add_u32 s19, s55, 0
buffer_store_dword v79, v76, s[8:11], s19 offen sc1
v_smfmac_f32_16x16x64_bf16 v[52:55], v[32:35], a[168:175], v2
s_waitcnt vmcnt(3)
v_cmp_eq_u32 vcc, -1, v36
v_smfmac_f32_16x16x64_bf16 v[56:59], v[32:35], a[176:183], v2
v_smfmac_f32_16x16x64_bf16 v[60:63], v[32:35], a[184:191], v2
s_cbranch_vccnz Lc_retry63csc1
Lc_back63csc1:
v_smfmac_f32_16x16x64_bf16 v[48:51], v[36:39], a[192:199], v2
s_add_u32 s19, s55, 4096
buffer_store_dword v79, v76, s[8:11], s19 offen sc1
v_smfmac_f32_16x16x64_bf16 v[52:55], v[36:39], a[200:207], v2
s_waitcnt vmcnt(3)
v_cmp_eq_u32 vcc, -1, v40
v_smfmac_f32_16x16x64_bf16 v[56:59], v[36:39], a[208:215], v2
v_smfmac_f32_16x16x64_bf16 v[60:63], v[36:39], a[216:223], v2
s_cbranch_vccnz Lc_retry73csc1
Lc_back73csc1:
v_smfmac_f32_16x16x64_bf16 v[48:51], v[40:43], a[224:231], v2
s_add_u32 s19, s55, 8192
buffer_store_dword v79, v76, s[8:11], s19 offen sc1
v_smfmac_f32_16x16x64_bf16 v[52:55], v[40:43], a[232:239], v2
s_waitcnt vmcnt(3)
v_cmp_eq_u32 vcc, -1, v44
v_smfmac_f32_16x16x64_bf16 v[56:59], v[40:43], a[240:247], v2
v_smfmac_f32_16x16x64_bf16 v[60:63], v[40:43], a[248:255], v2
s_cbranch_vccnz Lc_retry83csc1
Lc_back83csc1:
v_smfmac_f32_16x16x64_bf16 v[48:51], v[44:47], v[224:231], v2
v_smfmac_f32_16x16x64_bf16 v[52:55], v[44:47], v[232:239], v2
v_lshlrev_b32 v78, 3, v0
s_add_u32 s19, s39, 8192
buffer_load_dword v78, v78, s[8:11], s39 offen
buffer_load_dword v78, v78, s[8:11], s19 offen
s_add_u32 s39, s39, s97
s_mov_b32 s97, 524288
v_smfmac_f32_16x16x64_bf16 v[56:59], v[44:47], v[240:247], v2
v_add_f32 v48, v48, v50
v_smfmac_f32_16x16x64_bf16 v[60:63], v[44:47], v[248:255], v2
v_add_f32 v49, v49, v51
v_smfmac_f32_16x16x64_bf16 v[64:67], v[24:27], v[128:135], v2
v_add_f32 v52, v52, v54
v_smfmac_f32_16x16x64_bf16 v[68:71], v[24:27], v[136:143], v2
v_add_f32 v53, v53, v55
Lc_post3csc1:
v_add_f32 v56, v56, v58
v_add_f32 v60, v60, v62
v_cvt_pk_bf16_f32 v50, v48, v52
v_cvt_pk_bf16_f32 v51, v56, v60
v_xor_b32 v58, 16, v3
ds_write_b64 v3, v[50:51] offset:16384
v_add_f32 v57, v57, v59
v_add_f32 v61, v61, v63
v_cvt_pk_bf16_f32 v54, v49, v53
v_cvt_pk_bf16_f32 v55, v57, v61
ds_write_b64 v58, v[54:55] offset:16384
v_cmp_u_f32 vcc, v48, v49
v_smfmac_f32_16x16x64_bf16 v[64:67], v[28:31], v[144:151], v2
v_smfmac_f32_16x16x64_bf16 v[68:71], v[28:31], v[152:159], v2
s_cbranch_vccnz Lc_redo3csc1
Lc_redoback3csc1:
v_smfmac_f32_16x16x64_bf16 v[64:67], v[32:35], v[160:167], v2
v_smfmac_f32_16x16x64_bf16 v[68:71], v[32:35], v[168:175], v2
v_xor_b32 v32, 64, v4
s_waitcnt lgkmcnt(0)
s_barrier
ds_read_b128 v[28:31], v4 offset:16384
ds_read_b128 v[32:35], v32 offset:17408
ds_read_b128 v[56:59], v0 offset:5120
v_smfmac_f32_16x16x64_bf16 v[64:67], v[36:39], v[176:183], v2
v_smfmac_f32_16x16x64_bf16 v[68:71], v[36:39], v[184:191], v2
ds_read_b128 v[36:39], v4 offset:18432
ds_read_b128 v[60:63], v0 offset:2048
ds_read_b128 v[24:27], v0 offset:6144
v_smfmac_f32_16x16x64_bf16 v[64:67], v[40:43], v[192:199], v2
v_smfmac_f32_16x16x64_bf16 v[68:71], v[40:43], v[200:207], v2
v_xor_b32 v40, 64, v4
ds_read_b128 v[40:43], v40 offset:19456
v_smfmac_f32_16x16x64_bf16 v[64:67], v[44:47], v[208:215], v2
v_bfe_u32 v48, v0, 4, 3
v_lshlrev_b32 v48, 2, v48
buffer_load_dword v78, v48, s[8:11], s35 offen sc1
v_smfmac_f32_16x16x64_bf16 v[68:71], v[44:47], v[216:223], v2
s_waitcnt lgkmcnt(6)
v_mfma_f32_16x16x32_bf16 v[48:51], v[12:15], v[28:31], 0
ds_read_b128 v[12:15], v0 offset:3072
v_mfma_f32_16x16x32_bf16 v[52:55], v[16:19], v[28:31], 0
ds_read_b128 v[16:19], v0 offset:7168
v_mfma_f32_16x16x32_bf16 v[44:47], v[28:31], v[28:31], 0
s_waitcnt lgkmcnt(6)
v_mfma_f32_16x16x32_bf16 v[48:51], v[20:23], v[32:35], v[48:51]
v_add_f32 v64, v64, v66
v_add_f32 v65, v65, v67
v_mfma_f32_16x16x32_bf16 v[52:55], v[56:59], v[32:35], v[52:55]
v_add_f32 v68, v68, v70
ds_read_b128 v[56:59], v0 offset:14336
v_mfma_f32_16x16x32_bf16 v[44:47], v[32:35], v[32:35], v[44:47]
v_add_f32 v69, v69, v71
v_cvt_pk_bf16_f32 v66, v64, v65
s_waitcnt lgkmcnt(4)
v_mfma_f32_16x16x32_bf16 v[48:51], v[60:63], v[36:39], v[48:51]
v_cvt_pk_bf16_f32 v67, v68, v69
ds_read_b128 v[60:63], v0 offset:15360
v_mfma_f32_16x16x32_bf16 v[52:55], v[24:27], v[36:39], v[52:55]
s_cmp_eq_u32 s18, 62
v_mfma_f32_16x16x32_bf16 v[44:47], v[36:39], v[36:39], v[44:47]
s_cbranch_scc1 Lc_vm3csc1
Lc_vmb3csc1:
s_waitcnt lgkmcnt(2)
v_mfma_f32_16x16x32_bf16 v[44:47], v[40:43], v[40:43], v[44:47]
s_barrier
v_mfma_f32_16x16x32_bf16 v[48:51], v[12:15], v[40:43], v[48:51]
v_mfma_f32_16x16x32_bf16 v[52:55], v[16:19], v[40:43], v[52:55]
v_mov_b32 v36, -1
v_mov_b32 v37, -1
v_mov_b32 v38, -1
s_nop 0
v_max3_f32 v64, v46, v47, v48
v_max3_f32 v64, v64, v49, v50
v_mov_b32 v39, -1
s_nop 0
v_max3_f32 v65, v51, v52, v53
v_max3_f32 v65, v65, v54, v55
v_max_f32 v44, v64, v65
v_max_f32 v65, v64, v65
s_nop 1
v_permlane32_swap_b32 v44, v65
v_max_f32 v64, v44, v65
v_max_f32 v65, v44, v65
s_mov_b32 s20, s24
s_bitcmp0_b32 s18, 1
v_permlane16_swap_b32 v64, v65
v_max_f32 v64, v64, v65
v_fma_f32 v64, v64, s30, v5
v_pk_fma_f32 v[46:47], v[46:47], s[30:31], v[64:65] op_sel_hi:[1,1,0] neg_lo:[0,0,1] neg_hi:[0,0,1]
v_pk_fma_f32 v[48:49], v[48:49], s[30:31], v[64:65] op_sel_hi:[1,1,0] neg_lo:[0,0,1] neg_hi:[0,0,1]
v_pk_fma_f32 v[50:51], v[50:51], s[30:31], v[64:65] op_sel_hi:[1,1,0] neg_lo:[0,0,1] neg_hi:[0,0,1]
v_pk_fma_f32 v[52:53], v[52:53], s[30:31], v[64:65] op_sel_hi:[1,1,0] neg_lo:[0,0,1] neg_hi:[0,0,1]
v_pk_fma_f32 v[54:55], v[54:55], s[30:31], v[64:65] op_sel_hi:[1,1,0] neg_lo:[0,0,1] neg_hi:[0,0,1]
v_exp_f32 v46, v46
v_exp_f32 v47, v47
v_exp_f32 v48, v48
v_cvt_pk_bf16_f32 v44, v46, v47
v_exp_f32 v49, v49
v_exp_f32 v50, v50
v_mov_b32_dpp v45, v44 quad_perm:[2,3,0,1] row_mask:0xf bank_mask:0xf
v_exp_f32 v51, v51
v_cvt_pk_bf16_f32 v48, v48, v49
v_mfma_f32_16x16x16_bf16 v[40:43], v[66:67], v[44:45], 0
ds_write_b128 v0, v[36:39] offset:19456
v_exp_f32 v52, v52
v_mfma_f32_16x16x16_bf16 v[68:71], v[8:9], v[44:45], 0
v_exp_f32 v53, v53
v_cvt_pk_bf16_f32 v49, v50, v51
v_exp_f32 v54, v54
v_exp_f32 v55, v55
v_cvt_pk_bf16_f32 v50, v52, v53
v_mov_b32_dpp v52, v48 quad_perm:[2,3,0,1] row_mask:0xf bank_mask:0xf
v_cvt_pk_bf16_f32 v51, v54, v55
v_mov_b32_dpp v53, v49 quad_perm:[2,3,0,1] row_mask:0xf bank_mask:0xf
s_cselect_b32 s32, -1, 0
s_waitcnt lgkmcnt(1)
v_mfma_f32_16x16x32_bf16 v[68:71], v[8:11], v[48:51], v[68:71]
v_mov_b32_dpp v54, v50 quad_perm:[2,3,0,1] row_mask:0xf bank_mask:0xf
v_mov_b32_dpp v55, v51 quad_perm:[2,3,0,1] row_mask:0xf bank_mask:0xf
v_mfma_f32_16x16x32_bf16 v[40:43], v[56:59], v[48:51], v[40:43]
s_mov_b32 s53, s25
s_add_u32 s55, s22, s34
v_mfma_f32_16x16x32_bf16 v[40:43], v[60:63], v[52:55], v[40:43]
s_add_u32 s49, s23, s34
s_add_u32 s38, s38, 64
v_rcp_f32 v56, v68
s_add_u32 s18, s18, 1
s_add_u32 s27, s27, 9216
v_mov_b32_dpp v56, v56 quad_perm:[0,1,0,1] row_mask:0xf bank_mask:0xf
s_nop 1
v_pk_mul_f32 v[40:41], v[40:41], v[56:57] op_sel_hi:[1,0]
v_pk_mul_f32 v[42:43], v[42:43], v[56:57] op_sel_hi:[1,0]
v_cvt_pk_bf16_f32 v40, v40, v41
v_cvt_pk_bf16_f32 v41, v42, v43
ds_write_b64 v0, v[40:41] offset:21512
s_mov_b32 s22, s23
s_add_u32 s23, s23, 9216
s_waitcnt lgkmcnt(0)
s_barrier
s_cmp_eq_u32 s23, 12610560
s_cselect_b32 s23, 12582912, s23
s_add_u32 s24, s24, s33
s_add_u32 s25, s25, s33
s_sub_u32 s33, 0, s33
s_add_u32 s51, s22, 4096
s_add_u32 s52, s22, 8192
s_mov_b32 m0, 0
s_add_u32 s19, s26, 0
buffer_load_dwordx4 v0, s[8:11], s19 offen lds
buffer_load_dwordx4 v0, s[8:11], s19 offen offset:1024 lds
buffer_load_dwordx4 v0, s[8:11], s19 offen offset:2048 lds
buffer_load_dwordx4 v0, s[8:11], s19 offen offset:3072 lds
s_mov_b32 m0, 4096
s_add_u32 s19, s26, 4096
buffer_load_dwordx4 v0, s[8:11], s19 offen lds
buffer_load_dwordx4 v0, s[8:11], s19 offen offset:1024 lds
buffer_load_dwordx4 v0, s[8:11], s19 offen offset:2048 lds
buffer_load_dwordx4 v0, s[8:11], s19 offen offset:3072 lds
s_mov_b32 m0, 8192
s_add_u32 s19, s26, 8192
buffer_load_dwordx4 v0, s[8:11], s19 offen lds
buffer_load_dwordx4 v0, s[8:11], s19 offen offset:1024 lds
buffer_load_dwordx4 v0, s[8:11], s19 offen offset:2048 lds
buffer_load_dwordx4 v0, s[8:11], s19 offen offset:3072 lds
s_mov_b32 m0, 12288
s_add_u32 s19, s26, 12288
buffer_load_dwordx4 v0, s[8:11], s19 offen lds
buffer_load_dwordx4 v0, s[8:11], s19 offen offset:1024 lds
buffer_load_dwordx4 v0, s[8:11], s19 offen offset:2048 lds
buffer_load_dwordx4 v0, s[8:11], s19 offen offset:3072 lds
s_add_u32 s26, s26, 524288
s_mov_b32 m0, 16384
v_mov_b64 v[48:49], 0
v_mov_b64 v[50:51], 0
v_mov_b64 v[68:69], 0
v_mov_b64 v[70:71], 0
s_add_u32 s72, s53, 131072
s_add_u32 s73, s53, 262144
s_mov_b32 s19, s74
Lc_dl3csc1:
s_sub_u32 s19, s19, 1
s_cbranch_scc0 Lc_dl3csc1
s_mov_b32 s75, 0
buffer_load_dwordx4 v[20:23], v7, s[8:11], s53 offen sc1
buffer_load_dwordx4 v[24:27], v7, s[8:11], s53 offen offset:1024 sc1
buffer_load_dwordx4 v[28:31], v7, s[8:11], s53 offen offset:2048 sc1
buffer_load_dwordx4 v[32:35], v7, s[8:11], s53 offen offset:3072 sc1
Lc_rA3csc1:
s_waitcnt vmcnt(3)
v_mfma_f32_16x16x32_bf16 v[36:39], v[72:75], v[20:23], 0
buffer_load_dwordx4 v[52:55], v7, s[8:11], s72 offen sc1
buffer_load_dwordx4 v[56:59], v7, s[8:11], s72 offen offset:1024 sc1
v_bitop3_b32 v41, v20, v22, s32 bitop3:0x7e
s_waitcnt vmcnt(4)
v_mfma_f32_16x16x32_bf16 v[36:39], v[72:75], v[24:27], v[36:39]
buffer_load_dwordx4 v[60:63], v7, s[8:11], s72 offen offset:2048 sc1
buffer_load_dwordx4 v[64:67], v7, s[8:11], s72 offen offset:3072 sc1
v_bitop3_b32 v42, v24, v26, s32 bitop3:0x7e
s_waitcnt vmcnt(5)
v_mfma_f32_16x16x32_bf16 v[36:39], v[72:75], v[28:31], v[36:39]
v_bitop3_b32 v43, v28, v30, s32 bitop3:0x7e
s_waitcnt vmcnt(4)
v_mfma_f32_16x16x32_bf16 v[36:39], v[72:75], v[32:35], v[36:39]
v_or3_b32 v41, v41, v42, v43
v_bitop3_b32 v42, v32, v34, s32 bitop3:0x7e
v_bitop3_b32 v41, v41, v42, 1 bitop3:0xa8
v_cmp_ne_u32 vcc, 0, v41
s_cbranch_vccnz Lc_rB3csc1
s_nop 2
v_add_f32_dpp v36, v36, v36 row_ror:8 row_mask:0xf bank_mask:0xf
v_add_f32_dpp v37, v37, v37 row_ror:8 row_mask:0xf bank_mask:0xf
v_cvt_pk_bf16_f32 v40, v36, v37
buffer_store_dword v40, v76, s[8:11], s49 offen sc1
s_add_u32 s49, s49, 4096
s_waitcnt vmcnt(4)
v_mfma_f32_16x16x32_bf16 v[36:39], v[72:75], v[52:55], 0
buffer_load_dwordx4 v[20:23], v7, s[8:11], s73 offen sc1
buffer_load_dwordx4 v[24:27], v7, s[8:11], s73 offen offset:1024 sc1
v_bitop3_b32 v41, v52, v54, s32 bitop3:0x7e
s_waitcnt vmcnt(5)
v_mfma_f32_16x16x32_bf16 v[36:39], v[72:75], v[56:59], v[36:39]
buffer_load_dwordx4 v[28:31], v7, s[8:11], s73 offen offset:2048 sc1
buffer_load_dwordx4 v[32:35], v7, s[8:11], s73 offen offset:3072 sc1
v_bitop3_b32 v42, v56, v58, s32 bitop3:0x7e
s_waitcnt vmcnt(6)
v_mfma_f32_16x16x32_bf16 v[36:39], v[72:75], v[60:63], v[36:39]
v_bitop3_b32 v43, v60, v62, s32 bitop3:0x7e
s_waitcnt vmcnt(5)
v_mfma_f32_16x16x32_bf16 v[36:39], v[72:75], v[64:67], v[36:39]
v_or3_b32 v41, v41, v42, v43
v_bitop3_b32 v42, v64, v66, s32 bitop3:0x7e
v_bitop3_b32 v41, v41, v42, 1 bitop3:0xa8
v_cmp_ne_u32 vcc, 0, v41
s_cbranch_vccnz Lc_rF103csc1
Lc_rok103csc1:
s_nop 2
v_add_f32_dpp v36, v36, v36 row_ror:8 row_mask:0xf bank_mask:0xf
v_add_f32_dpp v37, v37, v37 row_ror:8 row_mask:0xf bank_mask:0xf
v_cvt_pk_bf16_f32 v40, v36, v37
buffer_store_dword v40, v76, s[8:11], s49 offen sc1
s_add_u32 s49, s49, 4096
s_waitcnt vmcnt(4)
v_mfma_f32_16x16x32_bf16 v[36:39], v[72:75], v[20:23], 0
v_bitop3_b32 v41, v20, v22, s32 bitop3:0x7e
s_waitcnt vmcnt(3)
v_mfma_f32_16x16x32_bf16 v[36:39], v[72:75], v[24:27], v[36:39]
v_bitop3_b32 v42, v24, v26, s32 bitop3:0x7e
s_waitcnt vmcnt(2)
v_mfma_f32_16x16x32_bf16 v[36:39], v[72:75], v[28:31], v[36:39]
v_bitop3_b32 v43, v28, v30, s32 bitop3:0x7e
s_waitcnt vmcnt(1)
v_mfma_f32_16x16x32_bf16 v[36:39], v[72:75], v[32:35], v[36:39]
v_or3_b32 v41, v41, v42, v43
v_bitop3_b32 v42, v32, v34, s32 bitop3:0x7e
v_bitop3_b32 v41, v41, v42, 1 bitop3:0xa8
v_cmp_ne_u32 vcc, 0, v41
s_cbranch_vccnz Lc_rF203csc1
Lc_rok203csc1:
s_nop 2
v_add_f32_dpp v36, v36, v36 row_ror:8 row_mask:0xf bank_mask:0xf
v_add_f32_dpp v37, v37, v37 row_ror:8 row_mask:0xf bank_mask:0xf
v_cvt_pk_bf16_f32 v40, v36, v37
buffer_store_dword v40, v76, s[8:11], s49 offen sc1
Lc_rdone3csc1:
v_mov_b64 v[52:53], 0
v_mov_b64 v[54:55], 0
v_mov_b64 v[56:57], 0
v_mov_b64 v[58:59], 0
v_mov_b64 v[60:61], 0
v_mov_b64 v[62:63], 0
v_mov_b64 v[64:65], 0
v_mov_b64 v[66:67], 0
s_cmp_eq_u32 s18, 40
s_cbranch_scc1 Lc_pre3csc1
Lc_preb3csc1:
v_cmp_eq_u32 vcc, 0, v78
s_cbranch_vccnz Lc_kvslow3csc1
Lc_kvback3csc1:
s_add_u32 s35, s35, 1024
s_cmp_eq_u32 s18, 63
s_cbranch_scc0 Lc_top3csc1
s_lshl_b32 s19, s17, 5
s_add_u32 s19, s19, 129048
buffer_store_dword v2, off, s[8:11], s19 sc1
buffer_store_dword v2, off, s[8:11], s19 offset:4 sc1
s_branch Lc_topL3
Lc_rB3csc1:
buffer_load_dwordx4 v[20:23], v7, s[8:11], s53 offen sc1
buffer_load_dwordx4 v[24:27], v7, s[8:11], s53 offen offset:1024 sc1
buffer_load_dwordx4 v[28:31], v7, s[8:11], s53 offen offset:2048 sc1
buffer_load_dwordx4 v[32:35], v7, s[8:11], s53 offen offset:3072 sc1
s_add_u32 s75, s75, 1
s_add_u32 s21, s21, 1
s_cmp_ge_u32 s21, 4194304
s_cbranch_scc1 L_abort
s_branch Lc_rA3csc1
Lc_vm3csc1:
v_lshrrev_b32 v64, 1, v0
s_mul_i32 s19, s17, 4096
s_add_u32 s19, s19, 24907264
buffer_store_dwordx2 v[66:67], v64, s[8:11], s19 offen sc1
s_branch Lc_vmb3csc1
Lc_rF103csc1:
buffer_load_dwordx4 v[52:55], v7, s[8:11], s72 offen sc1
buffer_load_dwordx4 v[56:59], v7, s[8:11], s72 offen offset:1024 sc1
buffer_load_dwordx4 v[60:63], v7, s[8:11], s72 offen offset:2048 sc1
buffer_load_dwordx4 v[64:67], v7, s[8:11], s72 offen offset:3072 sc1
s_add_u32 s21, s21, 1
s_cmp_ge_u32 s21, 4194304
s_cbranch_scc1 L_abort
s_waitcnt vmcnt(3)
v_mfma_f32_16x16x32_bf16 v[36:39], v[72:75], v[52:55], 0
buffer_load_dwordx4 v[20:23], v7, s[8:11], s73 offen sc1
buffer_load_dwordx4 v[24:27], v7, s[8:11], s73 offen offset:1024 sc1
v_bitop3_b32 v41, v52, v54, s32 bitop3:0x7e
s_waitcnt vmcnt(4)
v_mfma_f32_16x16x32_bf16 v[36:39], v[72:75], v[56:59], v[36:39]
buffer_load_dwordx4 v[28:31], v7, s[8:11], s73 offen offset:2048 sc1
buffer_load_dwordx4 v[32:35], v7, s[8:11], s73 offen offset:3072 sc1
v_bitop3_b32 v42, v56, v58, s32 bitop3:0x7e
s_waitcnt vmcnt(5)
v_mfma_f32_16x16x32_bf16 v[36:39], v[72:75], v[60:63], v[36:39]
v_bitop3_b32 v43, v60, v62, s32 bitop3:0x7e
s_waitcnt vmcnt(4)
v_mfma_f32_16x16x32_bf16 v[36:39], v[72:75], v[64:67], v[36:39]
v_or3_b32 v41, v41, v42, v43
v_bitop3_b32 v42, v64, v66, s32 bitop3:0x7e
v_bitop3_b32 v41, v41, v42, 1 bitop3:0xa8
v_cmp_ne_u32 vcc, 0, v41
s_cbranch_vccz Lc_rok103csc1
s_branch Lc_rF103csc1
Lc_rF203csc1:
buffer_load_dwordx4 v[20:23], v7, s[8:11], s73 offen sc1
buffer_load_dwordx4 v[24:27], v7, s[8:11], s73 offen offset:1024 sc1
buffer_load_dwordx4 v[28:31], v7, s[8:11], s73 offen offset:2048 sc1
buffer_load_dwordx4 v[32:35], v7, s[8:11], s73 offen offset:3072 sc1
s_add_u32 s21, s21, 1
s_cmp_ge_u32 s21, 4194304
s_cbranch_scc1 L_abort
s_waitcnt vmcnt(3)
v_mfma_f32_16x16x32_bf16 v[36:39], v[72:75], v[20:23], 0
v_bitop3_b32 v41, v20, v22, s32 bitop3:0x7e
s_waitcnt vmcnt(2)
v_mfma_f32_16x16x32_bf16 v[36:39], v[72:75], v[24:27], v[36:39]
v_bitop3_b32 v42, v24, v26, s32 bitop3:0x7e
s_waitcnt vmcnt(1)
v_mfma_f32_16x16x32_bf16 v[36:39], v[72:75], v[28:31], v[36:39]
v_bitop3_b32 v43, v28, v30, s32 bitop3:0x7e
s_waitcnt vmcnt(0)
v_mfma_f32_16x16x32_bf16 v[36:39], v[72:75], v[32:35], v[36:39]
v_or3_b32 v41, v41, v42, v43
v_bitop3_b32 v42, v32, v34, s32 bitop3:0x7e
v_bitop3_b32 v41, v41, v42, 1 bitop3:0xa8
v_cmp_ne_u32 vcc, 0, v41
s_cbranch_vccz Lc_rok203csc1
s_branch Lc_rF203csc1
Lc_pre3csc1:
v_mov_b32 v12, 0
global_load_dword v13, v12, s[6:7] offset:104 sc1
s_waitcnt vmcnt(0)
v_cmp_gt_u32 vcc, 28, v13
s_cbranch_vccz Lc_preb3csc1
s_add_u32 s21, s21, 1
s_cmp_ge_u32 s21, 4194304
s_cbranch_scc1 L_abort
s_branch Lc_pre3csc1
Lc_retry23csc1:
buffer_load_dwordx4 v0, s[8:11], s22 offen offset:2048 sc1 lds
ds_read_b128 v[20:23], v0 offset:18432
s_add_u32 s21, s21, 1
s_cmp_ge_u32 s21, 4194304
s_cbranch_scc1 L_abort
s_waitcnt lgkmcnt(0)
v_cmp_eq_u32 vcc, -1, v20
s_cbranch_vccnz Lc_retry23csc1
s_waitcnt vmcnt(0)
s_branch Lc_back23csc1
Lc_retry33csc1:
buffer_load_dwordx4 v0, s[8:11], s22 offen offset:3072 sc1 lds
ds_read_b128 v[24:27], v0 offset:19456
s_add_u32 s21, s21, 1
s_cmp_ge_u32 s21, 4194304
s_cbranch_scc1 L_abort
s_waitcnt lgkmcnt(0)
v_cmp_eq_u32 vcc, -1, v24
s_cbranch_vccnz Lc_retry33csc1
s_waitcnt vmcnt(0)
s_branch Lc_back33csc1
Lc_retry43csc1:
buffer_load_dwordx4 v[28:31], v0, s[8:11], s51 offen sc1
s_waitcnt vmcnt(0)
v_cmp_eq_u32 vcc, -1, v28
s_cbranch_vccz Lc_back43csc1
s_add_u32 s21, s21, 1
s_cmp_ge_u32 s21, 4194304
s_cbranch_scc1 L_abort
s_branch Lc_retry43csc1
Lc_retry53csc1:
buffer_load_dwordx4 v[32:35], v0, s[8:11], s51 offen offset:1024 sc1
s_waitcnt vmcnt(0)
v_cmp_eq_u32 vcc, -1, v32
s_cbranch_vccz Lc_back53csc1
s_add_u32 s21, s21, 1
s_cmp_ge_u32 s21, 4194304
s_cbranch_scc1 L_abort
s_branch Lc_retry53csc1
Lc_retry63csc1:
buffer_load_dwordx4 v[36:39], v0, s[8:11], s51 offen offset:2048 sc1
s_waitcnt vmcnt(0)
v_cmp_eq_u32 vcc, -1, v36
s_cbranch_vccz Lc_back63csc1
s_add_u32 s21, s21, 1
s_cmp_ge_u32 s21, 4194304
s_cbranch_scc1 L_abort
s_branch Lc_retry63csc1
Lc_retry73csc1:
buffer_load_dwordx4 v[40:43], v0, s[8:11], s51 offen offset:3072 sc1
s_waitcnt vmcnt(0)
v_cmp_eq_u32 vcc, -1, v40
s_cbranch_vccz Lc_back73csc1
s_add_u32 s21, s21, 1
s_cmp_ge_u32 s21, 4194304
s_cbranch_scc1 L_abort
s_branch Lc_retry73csc1
Lc_retry83csc1:
buffer_load_dwordx4 v[44:47], v0, s[8:11], s52 offen sc1
s_waitcnt vmcnt(0)
v_cmp_eq_u32 vcc, -1, v44
s_cbranch_vccz Lc_back83csc1
s_add_u32 s21, s21, 1
s_cmp_ge_u32 s21, 4194304
s_cbranch_scc1 L_abort
s_branch Lc_retry83csc1
Lc_redo3csc1:
s_cmp_eq_u32 s48, s18
s_cbranch_scc1 Lc_redoback3csc1
s_mov_b32 s48, s18
s_waitcnt lgkmcnt(0)
s_nop 15
Lc_redo23csc1:
buffer_load_dwordx4 v[12:15], v0, s[8:11], s22 offen sc1
buffer_load_dwordx4 v[16:19], v0, s[8:11], s22 offen offset:1024 sc1
buffer_load_dwordx4 v[20:23], v0, s[8:11], s22 offen offset:2048 sc1
buffer_load_dwordx4 v[24:27], v0, s[8:11], s22 offen offset:3072 sc1
buffer_load_dwordx4 v[28:31], v0, s[8:11], s51 offen sc1
buffer_load_dwordx4 v[32:35], v0, s[8:11], s51 offen offset:1024 sc1
buffer_load_dwordx4 v[36:39], v0, s[8:11], s51 offen offset:2048 sc1
buffer_load_dwordx4 v[40:43], v0, s[8:11], s51 offen offset:3072 sc1
buffer_load_dwordx4 v[44:47], v0, s[8:11], s52 offen sc1
v_mov_b64 v[48:49], 0
v_mov_b64 v[50:51], 0
v_mov_b64 v[52:53], 0
v_mov_b64 v[54:55], 0
v_mov_b64 v[56:57], 0
v_mov_b64 v[58:59], 0
v_mov_b64 v[60:61], 0
v_mov_b64 v[62:63], 0
v_mov_b64 v[64:65], 0
v_mov_b64 v[66:67], 0
v_mov_b64 v[68:69], 0
v_mov_b64 v[70:71], 0
s_waitcnt vmcnt(0)
v_max_u32 v48, v12, v13
v_max3_u32 v48, v48, v14, v15
v_max3_u32 v48, v48, v16, v17
v_max3_u32 v48, v48, v18, v19
v_max3_u32 v48, v48, v20, v21
v_max3_u32 v48, v48, v22, v23
v_max3_u32 v48, v48, v24, v25
v_max3_u32 v48, v48, v26, v27
v_max3_u32 v48, v48, v28, v29
v_max3_u32 v48, v48, v30, v31
v_max3_u32 v48, v48, v32, v33
v_max3_u32 v48, v48, v34, v35
v_max3_u32 v48, v48, v36, v37
v_max3_u32 v48, v48, v38, v39
v_max3_u32 v48, v48, v40, v41
v_max3_u32 v48, v48, v42, v43
v_max3_u32 v48, v48, v44, v45
v_max3_u32 v48, v48, v46, v47
v_cmp_eq_u32 vcc, -1, v48
v_mov_b32 v48, 0
s_cbranch_vccnz Lc_redo33csc1
s_nop 0
v_smfmac_f32_16x16x64_bf16 v[48:51], v[12:15], a[0:7], v2
v_smfmac_f32_16x16x64_bf16 v[52:55], v[12:15], a[8:15], v2
v_smfmac_f32_16x16x64_bf16 v[56:59], v[12:15], a[16:23], v2
v_smfmac_f32_16x16x64_bf16 v[60:63], v[12:15], a[24:31], v2
v_smfmac_f32_16x16x64_bf16 v[64:67], v[12:15], v[80:87], v2
v_smfmac_f32_16x16x64_bf16 v[68:71], v[12:15], v[88:95], v2
v_smfmac_f32_16x16x64_bf16 v[48:51], v[16:19], a[32:39], v2
v_smfmac_f32_16x16x64_bf16 v[52:55], v[16:19], a[40:47], v2
v_smfmac_f32_16x16x64_bf16 v[56:59], v[16:19], a[48:55], v2
v_smfmac_f32_16x16x64_bf16 v[60:63], v[16:19], a[56:63], v2
v_smfmac_f32_16x16x64_bf16 v[64:67], v[16:19], v[96:103], v2
v_smfmac_f32_16x16x64_bf16 v[68:71], v[16:19], v[104:111], v2
v_smfmac_f32_16x16x64_bf16 v[48:51], v[20:23], a[64:71], v2
v_smfmac_f32_16x16x64_bf16 v[52:55], v[20:23], a[72:79], v2
v_smfmac_f32_16x16x64_bf16 v[56:59], v[20:23], a[80:87], v2
v_smfmac_f32_16x16x64_bf16 v[60:63], v[20:23], a[88:95], v2
v_smfmac_f32_16x16x64_bf16 v[64:67], v[20:23], v[112:119], v2
v_smfmac_f32_16x16x64_bf16 v[68:71], v[20:23], v[120:127], v2
v_smfmac_f32_16x16x64_bf16 v[48:51], v[24:27], a[96:103], v2
v_smfmac_f32_16x16x64_bf16 v[52:55], v[24:27], a[104:111], v2
v_smfmac_f32_16x16x64_bf16 v[56:59], v[24:27], a[112:119], v2
v_smfmac_f32_16x16x64_bf16 v[60:63], v[24:27], a[120:127], v2
v_smfmac_f32_16x16x64_bf16 v[64:67], v[24:27], v[128:135], v2
v_smfmac_f32_16x16x64_bf16 v[68:71], v[24:27], v[136:143], v2
v_smfmac_f32_16x16x64_bf16 v[48:51], v[28:31], a[128:135], v2
v_smfmac_f32_16x16x64_bf16 v[52:55], v[28:31], a[136:143], v2
v_smfmac_f32_16x16x64_bf16 v[56:59], v[28:31], a[144:151], v2
v_smfmac_f32_16x16x64_bf16 v[60:63], v[28:31], a[152:159], v2
v_smfmac_f32_16x16x64_bf16 v[48:51], v[32:35], a[160:167], v2
v_smfmac_f32_16x16x64_bf16 v[52:55], v[32:35], a[168:175], v2
v_smfmac_f32_16x16x64_bf16 v[56:59], v[32:35], a[176:183], v2
v_smfmac_f32_16x16x64_bf16 v[60:63], v[32:35], a[184:191], v2
v_smfmac_f32_16x16x64_bf16 v[48:51], v[36:39], a[192:199], v2
v_smfmac_f32_16x16x64_bf16 v[52:55], v[36:39], a[200:207], v2
v_smfmac_f32_16x16x64_bf16 v[56:59], v[36:39], a[208:215], v2
v_smfmac_f32_16x16x64_bf16 v[60:63], v[36:39], a[216:223], v2
v_smfmac_f32_16x16x64_bf16 v[48:51], v[40:43], a[224:231], v2
v_smfmac_f32_16x16x64_bf16 v[52:55], v[40:43], a[232:239], v2
v_smfmac_f32_16x16x64_bf16 v[56:59], v[40:43], a[240:247], v2
v_smfmac_f32_16x16x64_bf16 v[60:63], v[40:43], a[248:255], v2
v_smfmac_f32_16x16x64_bf16 v[48:51], v[44:47], v[224:231], v2
v_smfmac_f32_16x16x64_bf16 v[52:55], v[44:47], v[232:239], v2
v_smfmac_f32_16x16x64_bf16 v[56:59], v[44:47], v[240:247], v2
v_smfmac_f32_16x16x64_bf16 v[60:63], v[44:47], v[248:255], v2
ds_read_b128 v[12:15], v0
ds_read_b128 v[16:19], v0 offset:4096
ds_read_b128 v[20:23], v0 offset:1024
s_nop 7
v_add_f32 v48, v48, v50
v_add_f32 v49, v49, v51
v_add_f32 v52, v52, v54
v_add_f32 v53, v53, v55
s_branch Lc_post3csc1
Lc_redo33csc1:
s_add_u32 s21, s21, 1
s_cmp_ge_u32 s21, 4194304
s_cbranch_scc1 L_abort
s_branch Lc_redo23csc1
Lc_kvslow3csc1:
s_cmp_ge_u32 s18, 62
s_cbranch_scc1 Lc_kvback3csc1
v_bfe_u32 v40, v0, 4, 3
v_lshlrev_b32 v40, 2, v40
Lc_wkvx3csc1:
buffer_load_dword v41, v40, s[8:11], s35 offen sc1
s_waitcnt vmcnt(0)
v_cmp_eq_u32 vcc, 0, v41
s_cbranch_vccz Lc_wkv_okx3csc1
s_sleep 4
s_add_u32 s21, s21, 1
s_cmp_ge_u32 s21, 4194304
s_cbranch_scc1 L_abort
s_branch Lc_wkvx3csc1
Lc_wkv_okx3csc1:
s_branch Lc_kvback3csc1
L_last:
s_endpgm
.section .rodata,"a"
.p2align 6
.amdhsa_kernel adaLN_cond__memory_aug_recurrent_mem_tr__glu_gated_glu__prompt_kernel
  .amdhsa_next_free_vgpr 512
  .amdhsa_next_free_sgpr 102
  .amdhsa_accum_offset 256
  .amdhsa_group_segment_fixed_size 0
  .amdhsa_kernarg_size 128
  .amdhsa_user_sgpr_count 2
  .amdhsa_user_sgpr_kernarg_segment_ptr 1
  .amdhsa_system_sgpr_workgroup_id_x 1
.end_amdhsa_kernel
```
